```python
import torch

def _softmax(x, axis=-1):
    return torch.softmax(x, dim=axis)

def _gelu(x):
    return torch.nn.functional.gelu(x, approximate='tanh')

def _silu(x):
    return torch.nn.functional.silu(x)

def _sigmoid(x):
    return torch.sigmoid(x)

def _layernorm(x, axis=-1, eps=1e-05):
    m = x.mean(dim=axis, keepdim=True)
    v = x.var(dim=axis, keepdim=True, unbiased=False)
    return (x - m) / torch.sqrt(v + eps)

def _scatter_add(tgt, idx, src, axis=0):
    return tgt.clone().index_add_(axis, idx, src)

def _segment_sum(src, seg, n):
    out = torch.zeros((n,) + src.shape[1:], dtype=src.dtype)
    return out.index_add_(0, seg, src)

def _pad(x, pw):
    flat = tuple((v for pair in reversed(pw) for v in pair))
    return torch.nn.functional.pad(x, flat)
kernel_name = 'adaLN_cond__grouped_kv_mqa__swiglu_ffn__prompt'

def setup_inputs():

    _w = lambda a: (lambda t: t.to(torch.bfloat16) if t.is_floating_point() else t)(torch.as_tensor(a))

    def _A_setup():
        B, S, D, H = (1, 2048, 576, 32)
        Dh = D // H
        return {'x': _w((lambda *s: torch.randn(*s, dtype=torch.bfloat16) * 0.05)(B, S, D)), 'wq': _w((lambda *s: torch.randn(*s, dtype=torch.bfloat16) * 0.05)(D, H * Dh)), 'wk': _w((lambda *s: torch.randn(*s, dtype=torch.bfloat16) * 0.05)(D, Dh)), 'wv': _w((lambda *s: torch.randn(*s, dtype=torch.bfloat16) * 0.05)(D, Dh)), 'wo': _w((lambda *s: torch.randn(*s, dtype=torch.bfloat16) * 0.05)(H * Dh, D))}
    _A_in = _A_setup()

    def _B_setup():
        B, S, D, F = (1, 2048, 576, 4608)
        return {'x': _w((lambda *s: torch.randn(*s, dtype=torch.bfloat16) * 0.05)(B, S, D)), 'w_gate': _w((lambda *s: torch.randn(*s, dtype=torch.bfloat16) * 0.05)(D, F)), 'w_up': _w((lambda *s: torch.randn(*s, dtype=torch.bfloat16) * 0.05)(D, F)), 'w_down': _w((lambda *s: torch.randn(*s, dtype=torch.bfloat16) * 0.05)(F, D))}
    _B_in = _B_setup()
    return {'A_x': _A_in['x'], 'A_wq': _A_in['wq'], 'A_wk': _A_in['wk'], 'A_wv': _A_in['wv'], 'A_wo': _A_in['wo'], 'B_x': _B_in['x'], 'B_w_gate': _B_in['w_gate'], 'B_w_up': _B_in['w_up'], 'B_w_down': _B_in['w_down'], 'c': _w((lambda *s: torch.randn(*s, dtype=torch.bfloat16) * 0.1)(1, 576) * 8.0), 'w_mod': _w((lambda *s: torch.randn(*s, dtype=torch.bfloat16) * 0.1)(576, 6 * 576) * 576 ** (-0.5) * 8.0)}

def reference(A_x, A_wq, A_wk, A_wv, A_wo, B_x, B_w_gate, B_w_up, B_w_down, c, w_mod):

    def _A_ref(x, wq, wk, wv, wo):
        B, S, D = x.shape
        H = 32
        Dh = D // H
        q = (lambda x, *d: x.permute(*d))((x @ wq).reshape(B, S, H, Dh), 0, 2, 1, 3)
        k = x @ wk
        v = x @ wv
        scores = torch.einsum('bhqd,bkd->bhqk', q, k) * Dh ** (-0.5)
        p = _softmax(scores, axis=-1)
        o = torch.einsum('bhqk,bkd->bhqd', p, v)
        return (lambda x, *d: x.permute(*d))(o, 0, 2, 1, 3).reshape(B, S, H * Dh) @ wo

    def _B_ref(x, w_gate, w_up, w_down):
        g = _silu(x @ w_gate)
        u = x @ w_up
        return g * u @ w_down
    x = A_x
    mod = (_silu(c) @ w_mod).reshape(c.shape[0], 6, 1, -1)
    sa, ca, ga, sb, cb, gb = (mod[:, 0].clone(), mod[:, 1].clone(), mod[:, 2].clone(), mod[:, 3].clone(), mod[:, 4].clone(), mod[:, 5].clone())
    h = _layernorm(x, axis=-1) * (1 + ca) + sa
    x = x + ga * _A_ref(h, A_wq, A_wk, A_wv, A_wo)
    h = _layernorm(x, axis=-1) * (1 + cb) + sb
    x = x + gb * _B_ref(h, B_w_gate, B_w_up, B_w_down)
    return x
```

```asm
; @launch kernel=k1_kernel grid=(298,1,1) block=(256,1,1) lds=1024
; @launch kernel=k2_kernel grid=(224,1,1) block=(256,1,1) lds=115200
; @launch kernel=k3_kernel grid=(256,1,1) block=(512,1,1) lds=163840
; @launch kernel=k4_kernel grid=(256,1,1) block=(256,1,1) lds=110592
; @launch kernel=k5_kernel grid=(256,1,1) block=(256,1,1) lds=151552
; @launch kernel=k6_kernel grid=(256,1,1) block=(512,1,1) lds=143360
.amdgcn_target "amdgcn-amd-amdhsa--gfx950"
.text
.globl k1_kernel
.p2align 8
.type k1_kernel,@function
k1_kernel:
    s_cmp_ge_u32 s2, 290
    s_cbranch_scc1 K1_PF
    s_load_dwordx2 s[12:13], s[0:1], 104
    s_mov_b32 s30, 0xffff0000
    s_cmp_ge_u32 s2, 162
    s_cbranch_scc1 K1_LN
    s_load_dwordx2 s[4:5], s[0:1], 80
    s_load_dwordx2 s[8:9], s[0:1], 72
    s_mul_i32 s20, s2, 1214
    s_lshr_b32 s20, s20, 16
    s_mul_i32 s21, s20, 54
    s_sub_u32 s21, s2, s21
    v_and_b32 v1, 7, v0
    v_lshrrev_b32 v2, 3, v0
    s_mul_i32 s22, s20, 192
    v_add_u32 v2, s22, v2
    v_lshlrev_b32 v3, 1, v2
    v_mul_u32_u24 v4, 6912, v2
    v_lshlrev_b32 v1, 4, v1
    v_add_u32 v4, v4, v1
    s_lshl_b32 s24, s21, 7
    s_waitcnt lgkmcnt(0)
    s_mov_b32 s6, 3981312
    s_mov_b32 s7, 0x20000
    s_mov_b32 s10, 1152
    s_mov_b32 s11, 0x20000
    buffer_load_ushort v10, v3, s[8:11], 0 offen offset:0
    buffer_load_ushort v12, v3, s[8:11], 0 offen offset:64
    buffer_load_ushort v14, v3, s[8:11], 0 offen offset:128
    buffer_load_ushort v16, v3, s[8:11], 0 offen offset:192
    buffer_load_ushort v18, v3, s[8:11], 0 offen offset:256
    buffer_load_ushort v20, v3, s[8:11], 0 offen offset:320
    buffer_load_dwordx4 v[24:27], v4, s[4:7], s24 offen
    s_add_u32 s24, s24, 221184
    buffer_load_dwordx4 v[28:31], v4, s[4:7], s24 offen
    s_add_u32 s24, s24, 221184
    buffer_load_dwordx4 v[32:35], v4, s[4:7], s24 offen
    s_add_u32 s24, s24, 221184
    buffer_load_dwordx4 v[36:39], v4, s[4:7], s24 offen
    s_add_u32 s24, s24, 221184
    buffer_load_dwordx4 v[40:43], v4, s[4:7], s24 offen
    s_add_u32 s24, s24, 221184
    buffer_load_dwordx4 v[44:47], v4, s[4:7], s24 offen
    s_mov_b32 s16, s12
    s_mov_b32 s17, s13
    s_mov_b32 s18, 41472
    s_mov_b32 s19, 0x20000
    s_waitcnt vmcnt(11)
    v_lshlrev_b32 v10, 16, v10
    v_mul_f32 v11, 0xbfb8aa3b, v10
    v_exp_f32 v11, v11
    s_nop 0
    v_add_f32 v11, 1.0, v11
    v_rcp_f32 v11, v11
    s_nop 0
    v_mul_f32 v10, v10, v11
    v_cvt_pk_bf16_f32 v10, v10, v10
    v_lshlrev_b32 v10, 16, v10
    s_waitcnt vmcnt(10)
    v_lshlrev_b32 v12, 16, v12
    v_mul_f32 v13, 0xbfb8aa3b, v12
    v_exp_f32 v13, v13
    s_nop 0
    v_add_f32 v13, 1.0, v13
    v_rcp_f32 v13, v13
    s_nop 0
    v_mul_f32 v12, v12, v13
    v_cvt_pk_bf16_f32 v12, v12, v12
    v_lshlrev_b32 v12, 16, v12
    s_waitcnt vmcnt(9)
    v_lshlrev_b32 v14, 16, v14
    v_mul_f32 v15, 0xbfb8aa3b, v14
    v_exp_f32 v15, v15
    s_nop 0
    v_add_f32 v15, 1.0, v15
    v_rcp_f32 v15, v15
    s_nop 0
    v_mul_f32 v14, v14, v15
    v_cvt_pk_bf16_f32 v14, v14, v14
    v_lshlrev_b32 v14, 16, v14
    s_waitcnt vmcnt(8)
    v_lshlrev_b32 v16, 16, v16
    v_mul_f32 v17, 0xbfb8aa3b, v16
    v_exp_f32 v17, v17
    s_nop 0
    v_add_f32 v17, 1.0, v17
    v_rcp_f32 v17, v17
    s_nop 0
    v_mul_f32 v16, v16, v17
    v_cvt_pk_bf16_f32 v16, v16, v16
    v_lshlrev_b32 v16, 16, v16
    s_waitcnt vmcnt(7)
    v_lshlrev_b32 v18, 16, v18
    v_mul_f32 v19, 0xbfb8aa3b, v18
    v_exp_f32 v19, v19
    s_nop 0
    v_add_f32 v19, 1.0, v19
    v_rcp_f32 v19, v19
    s_nop 0
    v_mul_f32 v18, v18, v19
    v_cvt_pk_bf16_f32 v18, v18, v18
    v_lshlrev_b32 v18, 16, v18
    s_waitcnt vmcnt(6)
    v_lshlrev_b32 v20, 16, v20
    v_mul_f32 v21, 0xbfb8aa3b, v20
    v_exp_f32 v21, v21
    s_nop 0
    v_add_f32 v21, 1.0, v21
    v_rcp_f32 v21, v21
    s_nop 0
    v_mul_f32 v20, v20, v21
    v_cvt_pk_bf16_f32 v20, v20, v20
    v_lshlrev_b32 v20, 16, v20
    v_mov_b32 v48, 0
    v_mov_b32 v49, 0
    v_mov_b32 v50, 0
    v_mov_b32 v51, 0
    v_mov_b32 v52, 0
    v_mov_b32 v53, 0
    v_mov_b32 v54, 0
    v_mov_b32 v55, 0
    s_waitcnt vmcnt(5)
    v_lshlrev_b32 v56, 16, v24
    v_and_b32 v57, s30, v24
    v_pk_fma_f32 v[48:49], v[56:57], v[10:11], v[48:49] op_sel_hi:[1,0,1]
    v_lshlrev_b32 v56, 16, v25
    v_and_b32 v57, s30, v25
    v_pk_fma_f32 v[50:51], v[56:57], v[10:11], v[50:51] op_sel_hi:[1,0,1]
    v_lshlrev_b32 v56, 16, v26
    v_and_b32 v57, s30, v26
    v_pk_fma_f32 v[52:53], v[56:57], v[10:11], v[52:53] op_sel_hi:[1,0,1]
    v_lshlrev_b32 v56, 16, v27
    v_and_b32 v57, s30, v27
    v_pk_fma_f32 v[54:55], v[56:57], v[10:11], v[54:55] op_sel_hi:[1,0,1]
    s_waitcnt vmcnt(4)
    v_lshlrev_b32 v56, 16, v28
    v_and_b32 v57, s30, v28
    v_pk_fma_f32 v[48:49], v[56:57], v[12:13], v[48:49] op_sel_hi:[1,0,1]
    v_lshlrev_b32 v56, 16, v29
    v_and_b32 v57, s30, v29
    v_pk_fma_f32 v[50:51], v[56:57], v[12:13], v[50:51] op_sel_hi:[1,0,1]
    v_lshlrev_b32 v56, 16, v30
    v_and_b32 v57, s30, v30
    v_pk_fma_f32 v[52:53], v[56:57], v[12:13], v[52:53] op_sel_hi:[1,0,1]
    v_lshlrev_b32 v56, 16, v31
    v_and_b32 v57, s30, v31
    v_pk_fma_f32 v[54:55], v[56:57], v[12:13], v[54:55] op_sel_hi:[1,0,1]
    s_waitcnt vmcnt(3)
    v_lshlrev_b32 v56, 16, v32
    v_and_b32 v57, s30, v32
    v_pk_fma_f32 v[48:49], v[56:57], v[14:15], v[48:49] op_sel_hi:[1,0,1]
    v_lshlrev_b32 v56, 16, v33
    v_and_b32 v57, s30, v33
    v_pk_fma_f32 v[50:51], v[56:57], v[14:15], v[50:51] op_sel_hi:[1,0,1]
    v_lshlrev_b32 v56, 16, v34
    v_and_b32 v57, s30, v34
    v_pk_fma_f32 v[52:53], v[56:57], v[14:15], v[52:53] op_sel_hi:[1,0,1]
    v_lshlrev_b32 v56, 16, v35
    v_and_b32 v57, s30, v35
    v_pk_fma_f32 v[54:55], v[56:57], v[14:15], v[54:55] op_sel_hi:[1,0,1]
    s_waitcnt vmcnt(2)
    v_lshlrev_b32 v56, 16, v36
    v_and_b32 v57, s30, v36
    v_pk_fma_f32 v[48:49], v[56:57], v[16:17], v[48:49] op_sel_hi:[1,0,1]
    v_lshlrev_b32 v56, 16, v37
    v_and_b32 v57, s30, v37
    v_pk_fma_f32 v[50:51], v[56:57], v[16:17], v[50:51] op_sel_hi:[1,0,1]
    v_lshlrev_b32 v56, 16, v38
    v_and_b32 v57, s30, v38
    v_pk_fma_f32 v[52:53], v[56:57], v[16:17], v[52:53] op_sel_hi:[1,0,1]
    v_lshlrev_b32 v56, 16, v39
    v_and_b32 v57, s30, v39
    v_pk_fma_f32 v[54:55], v[56:57], v[16:17], v[54:55] op_sel_hi:[1,0,1]
    s_waitcnt vmcnt(1)
    v_lshlrev_b32 v56, 16, v40
    v_and_b32 v57, s30, v40
    v_pk_fma_f32 v[48:49], v[56:57], v[18:19], v[48:49] op_sel_hi:[1,0,1]
    v_lshlrev_b32 v56, 16, v41
    v_and_b32 v57, s30, v41
    v_pk_fma_f32 v[50:51], v[56:57], v[18:19], v[50:51] op_sel_hi:[1,0,1]
    v_lshlrev_b32 v56, 16, v42
    v_and_b32 v57, s30, v42
    v_pk_fma_f32 v[52:53], v[56:57], v[18:19], v[52:53] op_sel_hi:[1,0,1]
    v_lshlrev_b32 v56, 16, v43
    v_and_b32 v57, s30, v43
    v_pk_fma_f32 v[54:55], v[56:57], v[18:19], v[54:55] op_sel_hi:[1,0,1]
    s_waitcnt vmcnt(0)
    v_lshlrev_b32 v56, 16, v44
    v_and_b32 v57, s30, v44
    v_pk_fma_f32 v[48:49], v[56:57], v[20:21], v[48:49] op_sel_hi:[1,0,1]
    v_lshlrev_b32 v56, 16, v45
    v_and_b32 v57, s30, v45
    v_pk_fma_f32 v[50:51], v[56:57], v[20:21], v[50:51] op_sel_hi:[1,0,1]
    v_lshlrev_b32 v56, 16, v46
    v_and_b32 v57, s30, v46
    v_pk_fma_f32 v[52:53], v[56:57], v[20:21], v[52:53] op_sel_hi:[1,0,1]
    v_lshlrev_b32 v56, 16, v47
    v_and_b32 v57, s30, v47
    v_pk_fma_f32 v[54:55], v[56:57], v[20:21], v[54:55] op_sel_hi:[1,0,1]
    v_permlane32_swap_b32 v48, v52
    v_permlane32_swap_b32 v49, v53
    v_permlane32_swap_b32 v50, v54
    v_permlane32_swap_b32 v51, v55
    v_add_f32 v48, v48, v52
    v_add_f32 v49, v49, v53
    v_add_f32 v50, v50, v54
    v_add_f32 v51, v51, v55
    s_nop 0
    v_permlane16_swap_b32 v48, v50
    v_permlane16_swap_b32 v49, v51
    v_add_f32 v48, v48, v50
    v_add_f32 v49, v49, v51
    s_nop 0
    v_add_f32_dpp v48, v48, v48 row_ror:8 row_mask:0xf bank_mask:0xf
    v_add_f32_dpp v49, v49, v49 row_ror:8 row_mask:0xf bank_mask:0xf
    v_and_b32 v5, 7, v0
    v_lshlrev_b32 v5, 5, v5
    v_bfe_u32 v6, v0, 4, 2
    v_lshl_add_u32 v5, v6, 3, v5
    v_lshrrev_b32 v6, 6, v0
    v_lshl_add_u32 v5, v6, 8, v5
    ds_write_b64 v5, v[48:49]
    s_waitcnt lgkmcnt(0)
    s_barrier
    v_readfirstlane_b32 s25, v0
    s_nop 0
    s_cmp_ge_u32 s25, 64
    s_cbranch_scc1 K1_END
    v_lshlrev_b32 v5, 2, v0
    ds_read_b32 v48, v5
    ds_read_b32 v49, v5 offset:256
    ds_read_b32 v50, v5 offset:512
    ds_read_b32 v51, v5 offset:768
    s_mul_i32 s26, s20, 13824
    s_lshl_b32 s27, s21, 8
    s_add_u32 s26, s26, s27
    s_waitcnt lgkmcnt(0)
    v_add_f32 v48, v48, v49
    v_add_f32 v50, v50, v51
    v_add_f32 v48, v48, v50
    buffer_store_dword v48, v5, s[16:19], s26 offen
    s_endpgm
K1_LN:
    s_load_dwordx2 s[4:5], s[0:1], 0
    s_sub_u32 s20, s2, 162
    v_lshrrev_b32 v1, 4, v0
    v_and_b32 v2, 15, v0
    v_mul_u32_u24 v3, 1152, v1
    v_lshl_add_u32 v3, v2, 3, v3
    s_mul_i32 s21, s20, 18432
    s_waitcnt lgkmcnt(0)
    s_mov_b32 s6, 2359296
    s_mov_b32 s7, 0x20000
    buffer_load_dwordx2 v[8:9], v3, s[4:7], s21 offen offset:0
    buffer_load_dwordx2 v[10:11], v3, s[4:7], s21 offen offset:128
    buffer_load_dwordx2 v[12:13], v3, s[4:7], s21 offen offset:256
    buffer_load_dwordx2 v[14:15], v3, s[4:7], s21 offen offset:384
    buffer_load_dwordx2 v[16:17], v3, s[4:7], s21 offen offset:512
    buffer_load_dwordx2 v[18:19], v3, s[4:7], s21 offen offset:640
    buffer_load_dwordx2 v[20:21], v3, s[4:7], s21 offen offset:768
    buffer_load_dwordx2 v[22:23], v3, s[4:7], s21 offen offset:896
    buffer_load_dwordx2 v[24:25], v3, s[4:7], s21 offen offset:1024
    s_add_u32 s16, s12, 1048576
    s_addc_u32 s17, s13, 0
    s_mov_b32 s18, 2359296
    s_mov_b32 s19, 0x20000
    v_lshrrev_b32 v4, 1, v2
    v_lshlrev_b32 v4, 8, v4
    v_lshl_add_u32 v4, v1, 4, v4
    v_and_b32 v5, 1, v2
    v_lshl_add_u32 v4, v5, 3, v4
    s_waitcnt vmcnt(0)
    v_and_b32 v66, 63, v0
    v_lshrrev_b32 v67, 6, v0
    s_nop 0
    v_readfirstlane_b32 s22, v67
    s_lshr_b32 s23, s20, 3
    s_lshl_b32 s23, s23, 2
    s_add_u32 s23, s23, s22
    s_load_dwordx2 s[24:25], s[0:1], 8
    s_mul_i32 s23, s23, 10368
    v_lshlrev_b32 v66, 7, v66
    s_add_u32 s22, s23, 2176
    s_mov_b32 s26, 663552
    s_mov_b32 s27, 0x20000
    s_waitcnt lgkmcnt(0)
    buffer_load_dword v70, v66, s[24:27], s23 offen
    buffer_load_dword v71, v66, s[24:27], s22 offen
    s_load_dwordx2 s[24:25], s[0:1], 64
    s_load_dwordx4 s[32:35], s[0:1], 16
    v_readfirstlane_b32 s22, v67
    s_lshl_b32 s23, s20, 2
    s_add_u32 s23, s23, s22
    s_mul_i32 s22, s23, 6912
    s_mov_b32 s26, 3538944
    s_mov_b32 s38, 20736
    s_mov_b32 s39, 0x20000
    s_and_b32 s28, s23, 31
    s_and_b32 s29, s28, 3
    s_lshl_b32 s29, s29, 13
    s_waitcnt lgkmcnt(0)
    s_cmp_lt_u32 s28, 4
    s_cselect_b32 s36, s32, s34
    s_cselect_b32 s37, s33, s35
    s_cmp_ge_u32 s28, 8
    s_cselect_b32 s38, 0, s38
    buffer_load_dword v65, v66, s[36:39], s29 offen
    v_lshlrev_b32 v28, 16, v8
    v_and_b32 v29, s30, v8
    v_lshlrev_b32 v30, 16, v9
    v_and_b32 v31, s30, v9
    v_lshlrev_b32 v32, 16, v10
    v_and_b32 v33, s30, v10
    v_lshlrev_b32 v34, 16, v11
    v_and_b32 v35, s30, v11
    v_lshlrev_b32 v36, 16, v12
    v_and_b32 v37, s30, v12
    v_lshlrev_b32 v38, 16, v13
    v_and_b32 v39, s30, v13
    v_lshlrev_b32 v40, 16, v14
    v_and_b32 v41, s30, v14
    v_lshlrev_b32 v42, 16, v15
    v_and_b32 v43, s30, v15
    v_lshlrev_b32 v44, 16, v16
    v_and_b32 v45, s30, v16
    v_lshlrev_b32 v46, 16, v17
    v_and_b32 v47, s30, v17
    v_lshlrev_b32 v48, 16, v18
    v_and_b32 v49, s30, v18
    v_lshlrev_b32 v50, 16, v19
    v_and_b32 v51, s30, v19
    v_lshlrev_b32 v52, 16, v20
    v_and_b32 v53, s30, v20
    v_lshlrev_b32 v54, 16, v21
    v_and_b32 v55, s30, v21
    v_lshlrev_b32 v56, 16, v22
    v_and_b32 v57, s30, v22
    v_lshlrev_b32 v58, 16, v23
    v_and_b32 v59, s30, v23
    v_lshlrev_b32 v60, 16, v24
    v_and_b32 v61, s30, v24
    v_lshlrev_b32 v62, 16, v25
    v_and_b32 v63, s30, v25
    v_pk_add_f32 v[72:73], v[28:29], v[30:31]
    v_pk_add_f32 v[72:73], v[72:73], v[32:33]
    v_pk_add_f32 v[72:73], v[72:73], v[34:35]
    v_pk_add_f32 v[72:73], v[72:73], v[36:37]
    v_pk_add_f32 v[72:73], v[72:73], v[38:39]
    v_pk_add_f32 v[72:73], v[72:73], v[40:41]
    v_pk_add_f32 v[72:73], v[72:73], v[42:43]
    v_pk_add_f32 v[72:73], v[72:73], v[44:45]
    v_pk_add_f32 v[72:73], v[72:73], v[46:47]
    v_pk_add_f32 v[72:73], v[72:73], v[48:49]
    v_pk_add_f32 v[72:73], v[72:73], v[50:51]
    v_pk_add_f32 v[72:73], v[72:73], v[52:53]
    v_pk_add_f32 v[72:73], v[72:73], v[54:55]
    v_pk_add_f32 v[72:73], v[72:73], v[56:57]
    v_pk_add_f32 v[72:73], v[72:73], v[58:59]
    v_pk_add_f32 v[72:73], v[72:73], v[60:61]
    v_pk_add_f32 v[72:73], v[72:73], v[62:63]
    v_add_f32 v72, v72, v73
    s_nop 1
    v_add_f32_dpp v72, v72, v72 quad_perm:[1,0,3,2] row_mask:0xf bank_mask:0xf
    s_nop 1
    v_add_f32_dpp v72, v72, v72 quad_perm:[2,3,0,1] row_mask:0xf bank_mask:0xf
    s_nop 1
    v_add_f32_dpp v72, v72, v72 row_half_mirror row_mask:0xf bank_mask:0xf
    s_nop 1
    v_add_f32_dpp v72, v72, v72 row_mirror row_mask:0xf bank_mask:0xf
    v_mul_f32 v72, 0xbae38e39, v72
    v_mov_b32 v74, 0
    v_mov_b32 v75, 0
    v_pk_add_f32 v[76:77], v[28:29], v[72:73] op_sel_hi:[1,0]
    s_nop 0
    v_pk_fma_f32 v[74:75], v[76:77], v[76:77], v[74:75]
    v_pk_add_f32 v[76:77], v[30:31], v[72:73] op_sel_hi:[1,0]
    s_nop 0
    v_pk_fma_f32 v[74:75], v[76:77], v[76:77], v[74:75]
    v_pk_add_f32 v[76:77], v[32:33], v[72:73] op_sel_hi:[1,0]
    s_nop 0
    v_pk_fma_f32 v[74:75], v[76:77], v[76:77], v[74:75]
    v_pk_add_f32 v[76:77], v[34:35], v[72:73] op_sel_hi:[1,0]
    s_nop 0
    v_pk_fma_f32 v[74:75], v[76:77], v[76:77], v[74:75]
    v_pk_add_f32 v[76:77], v[36:37], v[72:73] op_sel_hi:[1,0]
    s_nop 0
    v_pk_fma_f32 v[74:75], v[76:77], v[76:77], v[74:75]
    v_pk_add_f32 v[76:77], v[38:39], v[72:73] op_sel_hi:[1,0]
    s_nop 0
    v_pk_fma_f32 v[74:75], v[76:77], v[76:77], v[74:75]
    v_pk_add_f32 v[76:77], v[40:41], v[72:73] op_sel_hi:[1,0]
    s_nop 0
    v_pk_fma_f32 v[74:75], v[76:77], v[76:77], v[74:75]
    v_pk_add_f32 v[76:77], v[42:43], v[72:73] op_sel_hi:[1,0]
    s_nop 0
    v_pk_fma_f32 v[74:75], v[76:77], v[76:77], v[74:75]
    v_pk_add_f32 v[76:77], v[44:45], v[72:73] op_sel_hi:[1,0]
    s_nop 0
    v_pk_fma_f32 v[74:75], v[76:77], v[76:77], v[74:75]
    v_pk_add_f32 v[76:77], v[46:47], v[72:73] op_sel_hi:[1,0]
    s_nop 0
    v_pk_fma_f32 v[74:75], v[76:77], v[76:77], v[74:75]
    v_pk_add_f32 v[76:77], v[48:49], v[72:73] op_sel_hi:[1,0]
    s_nop 0
    v_pk_fma_f32 v[74:75], v[76:77], v[76:77], v[74:75]
    v_pk_add_f32 v[76:77], v[50:51], v[72:73] op_sel_hi:[1,0]
    s_nop 0
    v_pk_fma_f32 v[74:75], v[76:77], v[76:77], v[74:75]
    v_pk_add_f32 v[76:77], v[52:53], v[72:73] op_sel_hi:[1,0]
    s_nop 0
    v_pk_fma_f32 v[74:75], v[76:77], v[76:77], v[74:75]
    v_pk_add_f32 v[76:77], v[54:55], v[72:73] op_sel_hi:[1,0]
    s_nop 0
    v_pk_fma_f32 v[74:75], v[76:77], v[76:77], v[74:75]
    v_pk_add_f32 v[76:77], v[56:57], v[72:73] op_sel_hi:[1,0]
    s_nop 0
    v_pk_fma_f32 v[74:75], v[76:77], v[76:77], v[74:75]
    v_pk_add_f32 v[76:77], v[58:59], v[72:73] op_sel_hi:[1,0]
    s_nop 0
    v_pk_fma_f32 v[74:75], v[76:77], v[76:77], v[74:75]
    v_pk_add_f32 v[76:77], v[60:61], v[72:73] op_sel_hi:[1,0]
    s_nop 0
    v_pk_fma_f32 v[74:75], v[76:77], v[76:77], v[74:75]
    v_pk_add_f32 v[76:77], v[62:63], v[72:73] op_sel_hi:[1,0]
    s_nop 0
    v_pk_fma_f32 v[74:75], v[76:77], v[76:77], v[74:75]
    v_add_f32 v74, v74, v75
    s_nop 1
    v_add_f32_dpp v74, v74, v74 quad_perm:[1,0,3,2] row_mask:0xf bank_mask:0xf
    s_nop 1
    v_add_f32_dpp v74, v74, v74 quad_perm:[2,3,0,1] row_mask:0xf bank_mask:0xf
    s_nop 1
    v_add_f32_dpp v74, v74, v74 row_half_mirror row_mask:0xf bank_mask:0xf
    s_nop 1
    v_add_f32_dpp v74, v74, v74 row_mirror row_mask:0xf bank_mask:0xf
    v_mul_f32 v74, 0x3ae38e39, v74
    v_cvt_pk_bf16_f32 v74, v74, v74
    v_lshlrev_b32 v74, 16, v74
    v_add_f32 v74, 0x3727c5ac, v74
    v_cvt_pk_bf16_f32 v74, v74, v74
    v_lshlrev_b32 v74, 16, v74
    v_sqrt_f32 v74, v74
    s_nop 0
    v_cvt_pk_bf16_f32 v74, v74, v74
    v_lshlrev_b32 v74, 16, v74
    v_rcp_f32 v76, v74
    v_cvt_pk_bf16_f32 v72, v72, v72
    v_lshlrev_b32 v72, 16, v72
    v_mul_f32 v78, v72, v76
    v_pk_fma_f32 v[28:29], v[28:29], v[76:77], v[78:79] op_sel_hi:[1,0,0]
    s_nop 0
    v_cvt_pk_bf16_f32 v8, v28, v29
    v_pk_fma_f32 v[30:31], v[30:31], v[76:77], v[78:79] op_sel_hi:[1,0,0]
    s_nop 0
    v_cvt_pk_bf16_f32 v9, v30, v31
    buffer_store_dwordx2 v[8:9], v4, s[16:19], s21 offen offset:0
    v_pk_fma_f32 v[32:33], v[32:33], v[76:77], v[78:79] op_sel_hi:[1,0,0]
    s_nop 0
    v_cvt_pk_bf16_f32 v10, v32, v33
    v_pk_fma_f32 v[34:35], v[34:35], v[76:77], v[78:79] op_sel_hi:[1,0,0]
    s_nop 0
    v_cvt_pk_bf16_f32 v11, v34, v35
    buffer_store_dwordx2 v[10:11], v4, s[16:19], s21 offen offset:2048
    s_add_u32 s21, s21, 4096
    v_pk_fma_f32 v[36:37], v[36:37], v[76:77], v[78:79] op_sel_hi:[1,0,0]
    s_nop 0
    v_cvt_pk_bf16_f32 v12, v36, v37
    v_pk_fma_f32 v[38:39], v[38:39], v[76:77], v[78:79] op_sel_hi:[1,0,0]
    s_nop 0
    v_cvt_pk_bf16_f32 v13, v38, v39
    buffer_store_dwordx2 v[12:13], v4, s[16:19], s21 offen offset:0
    v_pk_fma_f32 v[40:41], v[40:41], v[76:77], v[78:79] op_sel_hi:[1,0,0]
    s_nop 0
    v_cvt_pk_bf16_f32 v14, v40, v41
    v_pk_fma_f32 v[42:43], v[42:43], v[76:77], v[78:79] op_sel_hi:[1,0,0]
    s_nop 0
    v_cvt_pk_bf16_f32 v15, v42, v43
    buffer_store_dwordx2 v[14:15], v4, s[16:19], s21 offen offset:2048
    s_add_u32 s21, s21, 4096
    v_pk_fma_f32 v[44:45], v[44:45], v[76:77], v[78:79] op_sel_hi:[1,0,0]
    s_nop 0
    v_cvt_pk_bf16_f32 v16, v44, v45
    v_pk_fma_f32 v[46:47], v[46:47], v[76:77], v[78:79] op_sel_hi:[1,0,0]
    s_nop 0
    v_cvt_pk_bf16_f32 v17, v46, v47
    buffer_store_dwordx2 v[16:17], v4, s[16:19], s21 offen offset:0
    v_pk_fma_f32 v[48:49], v[48:49], v[76:77], v[78:79] op_sel_hi:[1,0,0]
    s_nop 0
    v_cvt_pk_bf16_f32 v18, v48, v49
    v_pk_fma_f32 v[50:51], v[50:51], v[76:77], v[78:79] op_sel_hi:[1,0,0]
    s_nop 0
    v_cvt_pk_bf16_f32 v19, v50, v51
    buffer_store_dwordx2 v[18:19], v4, s[16:19], s21 offen offset:2048
    s_add_u32 s21, s21, 4096
    v_pk_fma_f32 v[52:53], v[52:53], v[76:77], v[78:79] op_sel_hi:[1,0,0]
    s_nop 0
    v_cvt_pk_bf16_f32 v20, v52, v53
    v_pk_fma_f32 v[54:55], v[54:55], v[76:77], v[78:79] op_sel_hi:[1,0,0]
    s_nop 0
    v_cvt_pk_bf16_f32 v21, v54, v55
    buffer_store_dwordx2 v[20:21], v4, s[16:19], s21 offen offset:0
    v_pk_fma_f32 v[56:57], v[56:57], v[76:77], v[78:79] op_sel_hi:[1,0,0]
    s_nop 0
    v_cvt_pk_bf16_f32 v22, v56, v57
    v_pk_fma_f32 v[58:59], v[58:59], v[76:77], v[78:79] op_sel_hi:[1,0,0]
    s_nop 0
    v_cvt_pk_bf16_f32 v23, v58, v59
    buffer_store_dwordx2 v[22:23], v4, s[16:19], s21 offen offset:2048
    s_add_u32 s21, s21, 4096
    v_pk_fma_f32 v[60:61], v[60:61], v[76:77], v[78:79] op_sel_hi:[1,0,0]
    s_nop 0
    v_cvt_pk_bf16_f32 v24, v60, v61
    v_pk_fma_f32 v[62:63], v[62:63], v[76:77], v[78:79] op_sel_hi:[1,0,0]
    s_nop 0
    v_cvt_pk_bf16_f32 v25, v62, v63
    buffer_store_dwordx2 v[24:25], v4, s[16:19], s21 offen offset:0
    s_endpgm
    s_endpgm
K1_PF:
    s_cmp_ge_u32 s2, 298
    s_cbranch_scc1 K1_END
    v_and_b32 v1, 63, v0
    v_lshrrev_b32 v2, 6, v0
    s_nop 0
    v_readfirstlane_b32 s20, v2
    s_getpc_b64 s[24:25]
CPF1:
    s_add_u32 s24, s24, k2_kernel-CPF1
    s_addc_u32 s25, s25, 0
    s_lshl_b32 s26, s20, 13
    v_lshlrev_b32 v4, 7, v1
    v_add_u32 v4, s26, v4
    s_mov_b32 s26, k4_kernel-k2_kernel
    v_cmp_gt_u32 vcc, s26, v4
    s_nop 0
    s_and_saveexec_b64 s[26:27], vcc
    s_cbranch_execz CPF1_SKIP
    global_load_dword v5, v4, s[24:25]
CPF1_SKIP:
    s_mov_b64 exec, s[26:27]
K1_END:
    s_endpgm
.globl k2_kernel
.p2align 8
.type k2_kernel,@function
k2_kernel:
    s_cmp_ge_u32 s2, 224
    s_cbranch_scc1 K2_END
    s_load_dwordx2 s[12:13], s[0:1], 104
    s_load_dwordx2 s[48:49], s[0:1], 64
    s_load_dwordx2 s[4:5], s[0:1], 8
    s_load_dwordx4 s[40:43], s[0:1], 16
    s_mov_b32 s30, 0xffff0000
    v_and_b32 v1, 63, v0
    v_lshrrev_b32 v2, 6, v0
    s_nop 0
    v_readfirstlane_b32 s20, v2
    s_and_b32 s21, s2, 7
    s_lshr_b32 s22, s2, 3
    s_mul_i32 s23, s22, 43
    s_lshr_b32 s23, s23, 8
    s_mul_i32 s24, s23, 6
    s_sub_u32 s24, s22, s24
    s_cmp_ge_u32 s22, 24
    s_cselect_b32 s23, s24, s23
    s_lshl_b32 s21, s21, 2
    s_add_u32 s21, s21, s23
    s_lshl_b32 s25, s21, 2
    s_add_u32 s25, s25, s20
    s_mul_i32 s26, s25, 18432
    v_lshlrev_b32 v3, 4, v1
    s_waitcnt lgkmcnt(0)
    s_add_u32 s8, s12, 1048576
    s_addc_u32 s9, s13, 0
    s_mov_b32 s10, 2359296
    s_mov_b32 s11, 0x20000
    s_mov_b32 s16, s12
    s_mov_b32 s17, s13
    s_mov_b32 s18, 41472
    s_mov_b32 s19, 0x20000
    v_lshlrev_b32 v4, 4, v0
    v_cmp_gt_u32 vcc, 144, v0
    v_mov_b32 v5, 0x7fffffff
    s_nop 0
    v_cndmask_b32 v4, v5, v4, vcc
    s_movk_i32 s27, 13824
    s_movk_i32 s28, 27648
    buffer_load_dwordx4 v[100:103], v4, s[16:19], 0 offen
    buffer_load_dwordx4 v[104:107], v4, s[16:19], s27 offen
    buffer_load_dwordx4 v[108:111], v4, s[16:19], s28 offen
    buffer_load_dwordx4 v[112:115], v4, s[16:19], 0 offen offset:2304
    buffer_load_dwordx4 v[116:119], v4, s[16:19], s27 offen offset:2304
    buffer_load_dwordx4 v[120:123], v4, s[16:19], s28 offen offset:2304
    v_mov_b32 v82, 0
    s_cmp_ge_u32 s22, 24
    s_cbranch_scc1 K2_KVLOAD
    s_mov_b32 s6, 663552
    s_mov_b32 s7, 0x20000
    v_add_u32 v84, 0, v1
    v_mul_u32_u24 v85, 43691, v84
    v_lshrrev_b32 v85, 19, v85
    v_mul_u32_u24 v86, 12, v85
    v_sub_u32 v84, v84, v86
    v_bfe_u32 v86, v85, 3, 1
    v_lshlrev_b32 v86, 1, v86
    v_xor_b32 v84, v84, v86
    v_lshlrev_b32 v84, 4, v84
    v_mul_u32_u24 v85, 1152, v85
    v_add_u32 v80, v85, v84
    v_add_u32 v84, 64, v1
    v_mul_u32_u24 v85, 43691, v84
    v_lshrrev_b32 v85, 19, v85
    v_mul_u32_u24 v86, 12, v85
    v_sub_u32 v84, v84, v86
    v_bfe_u32 v86, v85, 3, 1
    v_lshlrev_b32 v86, 1, v86
    v_xor_b32 v84, v84, v86
    v_lshlrev_b32 v84, 4, v84
    v_mul_u32_u24 v85, 1152, v85
    v_add_u32 v81, v85, v84
    v_add_u32 v84, 128, v1
    v_mul_u32_u24 v85, 43691, v84
    v_lshrrev_b32 v85, 19, v85
    v_mul_u32_u24 v86, 12, v85
    v_sub_u32 v84, v84, v86
    v_bfe_u32 v86, v85, 3, 1
    v_lshlrev_b32 v86, 1, v86
    v_xor_b32 v84, v84, v86
    v_lshlrev_b32 v84, 4, v84
    v_mul_u32_u24 v85, 1152, v85
    v_add_u32 v82, v85, v84
    s_mul_i32 s27, s24, 192
    s_mul_i32 s28, s20, 18432
    s_add_u32 s27, s27, s28
    s_mul_i32 s28, s20, 3072
    s_add_u32 m0, s28, 0
    s_add_u32 s29, s27, 0
    buffer_load_dwordx4 v80, s[4:7], s29 offen lds
    s_add_u32 m0, s28, 1024
    s_nop 0
    buffer_load_dwordx4 v81, s[4:7], s29 offen lds
    s_add_u32 m0, s28, 2048
    s_nop 0
    buffer_load_dwordx4 v82, s[4:7], s29 offen lds
    s_add_u32 s36, s26, 0
    buffer_load_dwordx4 v[8:11], v3, s[8:11], s36 offen offset:0
    s_add_u32 s36, s26, 0
    buffer_load_dwordx4 v[12:15], v3, s[8:11], s36 offen offset:1024
    s_add_u32 m0, s28, 12288
    s_add_u32 s29, s27, 73728
    buffer_load_dwordx4 v80, s[4:7], s29 offen lds
    s_add_u32 m0, s28, 13312
    s_nop 0
    buffer_load_dwordx4 v81, s[4:7], s29 offen lds
    s_add_u32 m0, s28, 14336
    s_nop 0
    buffer_load_dwordx4 v82, s[4:7], s29 offen lds
    s_add_u32 s36, s26, 0
    buffer_load_dwordx4 v[16:19], v3, s[8:11], s36 offen offset:2048
    s_add_u32 s36, s26, 0
    buffer_load_dwordx4 v[20:23], v3, s[8:11], s36 offen offset:3072
    s_add_u32 m0, s28, 24576
    s_add_u32 s29, s27, 147456
    buffer_load_dwordx4 v80, s[4:7], s29 offen lds
    s_add_u32 m0, s28, 25600
    s_nop 0
    buffer_load_dwordx4 v81, s[4:7], s29 offen lds
    s_add_u32 m0, s28, 26624
    s_nop 0
    buffer_load_dwordx4 v82, s[4:7], s29 offen lds
    s_add_u32 s36, s26, 4096
    buffer_load_dwordx4 v[24:27], v3, s[8:11], s36 offen offset:0
    s_add_u32 s36, s26, 4096
    buffer_load_dwordx4 v[28:31], v3, s[8:11], s36 offen offset:1024
    s_waitcnt vmcnt(15)
    s_branch K2_MOD
K2_KVLOAD:
    s_and_b32 s27, s2, 7
    s_mul_i32 s38, s27, 2304
    s_cmp_lg_u32 s24, 0
    s_cselect_b32 s38, 0x40000000, s38
    s_cmp_ge_u32 s27, 6
    s_cselect_b32 s38, 0x40000000, s38
    s_add_u32 s29, s38, 13824
    s_add_u32 s31, s38, 27648
    buffer_load_dwordx4 v[184:187], v4, s[16:19], s38 offen
    buffer_load_dwordx4 v[188:191], v4, s[16:19], s29 offen
    buffer_load_dwordx4 v[192:195], v4, s[16:19], s31 offen
    s_cmp_eq_u32 s27, 1
    s_cselect_b32 s39, 1.0, 0
    s_cmp_eq_u32 s27, 4
    s_cselect_b32 s39, 1.0, s39
    buffer_load_dwordx4 v[8:11], v3, s[8:11], s26 offen offset:0
    buffer_load_dwordx4 v[12:15], v3, s[8:11], s26 offen offset:1024
    buffer_load_dwordx4 v[16:19], v3, s[8:11], s26 offen offset:2048
    buffer_load_dwordx4 v[20:23], v3, s[8:11], s26 offen offset:3072
    s_add_u32 s26, s26, 4096
    buffer_load_dwordx4 v[24:27], v3, s[8:11], s26 offen offset:0
    buffer_load_dwordx4 v[28:31], v3, s[8:11], s26 offen offset:1024
    buffer_load_dwordx4 v[32:35], v3, s[8:11], s26 offen offset:2048
    buffer_load_dwordx4 v[36:39], v3, s[8:11], s26 offen offset:3072
    s_add_u32 s26, s26, 4096
    buffer_load_dwordx4 v[40:43], v3, s[8:11], s26 offen offset:0
    buffer_load_dwordx4 v[44:47], v3, s[8:11], s26 offen offset:1024
    buffer_load_dwordx4 v[48:51], v3, s[8:11], s26 offen offset:2048
    buffer_load_dwordx4 v[52:55], v3, s[8:11], s26 offen offset:3072
    s_add_u32 s26, s26, 4096
    buffer_load_dwordx4 v[56:59], v3, s[8:11], s26 offen offset:0
    buffer_load_dwordx4 v[60:63], v3, s[8:11], s26 offen offset:1024
    buffer_load_dwordx4 v[64:67], v3, s[8:11], s26 offen offset:2048
    buffer_load_dwordx4 v[68:71], v3, s[8:11], s26 offen offset:3072
    s_add_u32 s26, s26, 4096
    buffer_load_dwordx4 v[72:75], v3, s[8:11], s26 offen offset:0
    buffer_load_dwordx4 v[76:79], v3, s[8:11], s26 offen offset:1024
    s_mov_b32 s4, s40
    s_mov_b32 s5, s41
    s_mov_b32 s6, 20736
    s_mov_b32 s7, 0x20000
    s_mov_b32 s44, s42
    s_mov_b32 s45, s43
    s_mov_b32 s46, 20736
    s_mov_b32 s47, 0x20000
    v_mul_u32_u24 v80, 36, v0
    v_mul_u32_u24 v81, 48, v0
    s_movk_i32 s27, 0
    buffer_load_dwordx4 v[124:127], v80, s[4:7], s27 offen
    buffer_load_dwordx4 v[128:131], v80, s[4:7], s27 offen offset:16
    buffer_load_dword v132, v80, s[4:7], s27 offen offset:32
    s_movk_i32 s27, 9216
    buffer_load_dwordx4 v[134:137], v80, s[4:7], s27 offen
    buffer_load_dwordx4 v[138:141], v80, s[4:7], s27 offen offset:16
    buffer_load_dword v142, v80, s[4:7], s27 offen offset:32
    s_movk_i32 s27, 18432
    buffer_load_dwordx4 v[144:147], v80, s[4:7], s27 offen
    buffer_load_dwordx4 v[148:151], v80, s[4:7], s27 offen offset:16
    buffer_load_dword v152, v80, s[4:7], s27 offen offset:32
    s_movk_i32 s27, 0
    buffer_load_dwordx4 v[154:157], v80, s[44:47], s27 offen
    buffer_load_dwordx4 v[158:161], v80, s[44:47], s27 offen offset:16
    buffer_load_dword v162, v80, s[44:47], s27 offen offset:32
    s_movk_i32 s27, 9216
    buffer_load_dwordx4 v[164:167], v80, s[44:47], s27 offen
    buffer_load_dwordx4 v[168:171], v80, s[44:47], s27 offen offset:16
    buffer_load_dword v172, v80, s[44:47], s27 offen offset:32
    s_movk_i32 s27, 18432
    buffer_load_dwordx4 v[174:177], v80, s[44:47], s27 offen
    buffer_load_dwordx4 v[178:181], v80, s[44:47], s27 offen offset:16
    buffer_load_dword v182, v80, s[44:47], s27 offen offset:32
    s_waitcnt vmcnt(0)
    ds_write_b128 v81, v[124:127] offset:0
    ds_write_b128 v81, v[128:131] offset:16
    ds_write_b32 v81, v132 offset:32
    ds_write_b128 v81, v[134:137] offset:12288
    ds_write_b128 v81, v[138:141] offset:12304
    ds_write_b32 v81, v142 offset:12320
    v_cmp_gt_u32 vcc, 64, v0
    s_nop 0
    s_and_saveexec_b64 s[46:47], vcc
    ds_write_b128 v81, v[144:147] offset:24576
    ds_write_b128 v81, v[148:151] offset:24592
    ds_write_b32 v81, v152 offset:24608
    s_mov_b64 exec, s[46:47]
    ds_write_b128 v81, v[154:157] offset:27776
    ds_write_b128 v81, v[158:161] offset:27792
    ds_write_b32 v81, v162 offset:27808
    ds_write_b128 v81, v[164:167] offset:40064
    ds_write_b128 v81, v[168:171] offset:40080
    ds_write_b32 v81, v172 offset:40096
    v_cmp_gt_u32 vcc, 64, v0
    s_nop 0
    s_and_saveexec_b64 s[46:47], vcc
    ds_write_b128 v81, v[174:177] offset:52352
    ds_write_b128 v81, v[178:181] offset:52368
    ds_write_b32 v81, v182 offset:52384
    s_mov_b64 exec, s[46:47]
    s_add_u32 s44, s12, 65536
    s_addc_u32 s45, s13, 0
    s_mov_b32 s46, 13824
    s_mov_b32 s47, 0x20000
    v_add_f32 v184, v184, v188
    v_add_f32 v184, v184, v192
    v_cvt_pk_bf16_f32 v184, v184, v184
    v_lshlrev_b32 v184, 16, v184
    v_add_f32 v184, s39, v184
    v_cvt_pk_bf16_f32 v184, v184, v184
    v_lshlrev_b32 v184, 16, v184
    v_add_f32 v185, v185, v189
    v_add_f32 v185, v185, v193
    v_cvt_pk_bf16_f32 v185, v185, v185
    v_lshlrev_b32 v185, 16, v185
    v_add_f32 v185, s39, v185
    v_cvt_pk_bf16_f32 v185, v185, v185
    v_lshlrev_b32 v185, 16, v185
    v_add_f32 v186, v186, v190
    v_add_f32 v186, v186, v194
    v_cvt_pk_bf16_f32 v186, v186, v186
    v_lshlrev_b32 v186, 16, v186
    v_add_f32 v186, s39, v186
    v_cvt_pk_bf16_f32 v186, v186, v186
    v_lshlrev_b32 v186, 16, v186
    v_add_f32 v187, v187, v191
    v_add_f32 v187, v187, v195
    v_cvt_pk_bf16_f32 v187, v187, v187
    v_lshlrev_b32 v187, 16, v187
    v_add_f32 v187, s39, v187
    v_cvt_pk_bf16_f32 v187, v187, v187
    v_lshlrev_b32 v187, 16, v187
    buffer_store_dwordx4 v[184:187], v4, s[44:47], s38 offen
K2_MOD:
    v_add_f32 v100, v100, v104
    v_add_f32 v100, v100, v108
    v_cvt_pk_bf16_f32 v100, v100, v100
    v_lshlrev_b32 v100, 16, v100
    v_add_f32 v112, v112, v116
    v_add_f32 v112, v112, v120
    v_cvt_pk_bf16_f32 v112, v112, v112
    v_lshlrev_b32 v112, 16, v112
    v_add_f32 v112, 1.0, v112
    v_cvt_pk_bf16_f32 v112, v112, v112
    v_lshlrev_b32 v112, 16, v112
    v_add_f32 v101, v101, v105
    v_add_f32 v101, v101, v109
    v_cvt_pk_bf16_f32 v101, v101, v101
    v_lshlrev_b32 v101, 16, v101
    v_add_f32 v113, v113, v117
    v_add_f32 v113, v113, v121
    v_cvt_pk_bf16_f32 v113, v113, v113
    v_lshlrev_b32 v113, 16, v113
    v_add_f32 v113, 1.0, v113
    v_cvt_pk_bf16_f32 v113, v113, v113
    v_lshlrev_b32 v113, 16, v113
    v_add_f32 v102, v102, v106
    v_add_f32 v102, v102, v110
    v_cvt_pk_bf16_f32 v102, v102, v102
    v_lshlrev_b32 v102, 16, v102
    v_add_f32 v114, v114, v118
    v_add_f32 v114, v114, v122
    v_cvt_pk_bf16_f32 v114, v114, v114
    v_lshlrev_b32 v114, 16, v114
    v_add_f32 v114, 1.0, v114
    v_cvt_pk_bf16_f32 v114, v114, v114
    v_lshlrev_b32 v114, 16, v114
    v_add_f32 v103, v103, v107
    v_add_f32 v103, v103, v111
    v_cvt_pk_bf16_f32 v103, v103, v103
    v_lshlrev_b32 v103, 16, v103
    v_add_f32 v115, v115, v119
    v_add_f32 v115, v115, v123
    v_cvt_pk_bf16_f32 v115, v115, v115
    v_lshlrev_b32 v115, 16, v115
    v_add_f32 v115, 1.0, v115
    v_cvt_pk_bf16_f32 v115, v115, v115
    v_lshlrev_b32 v115, 16, v115
    v_lshlrev_b32 v4, 4, v0
    v_cmp_gt_u32 vcc, 144, v0
    s_nop 0
    s_and_saveexec_b64 s[46:47], vcc
    s_mov_b32 s37, 110592
    v_add_u32 v4, s37, v4
    ds_write_b128 v4, v[112:115]
    ds_write_b128 v4, v[100:103] offset:2304
    s_mov_b64 exec, s[46:47]
    s_waitcnt lgkmcnt(0)
    v_lshrrev_b32 v5, 4, v1
    v_lshlrev_b32 v6, 5, v5
    v_add_u32 v6, s37, v6
    v_bfe_u32 v7, v1, 2, 2
    v_lshl_add_u32 v7, v5, 3, v7
    v_and_b32 v87, 3, v1
    v_lshlrev_b32 v87, 3, v87
    s_cmp_ge_u32 s22, 24
    s_cbranch_scc1 K2_KV
    v_mul_u32_u24 v88, 192, v7
    v_add_u32 v88, v88, v87
    v_and_b32 v89, 1, v5
    v_lshlrev_b32 v89, 5, v89
    v_add_u32 v90, v88, v89
    v_sub_u32 v91, v88, v89
    v_add_u32 v92, 0xd800, v90
    v_add_u32 v93, 0xd800, v91
    s_waitcnt vmcnt(5)
    s_barrier
    ds_read_b128 v[124:127], v6 offset:0
    ds_read_b128 v[128:131], v6 offset:16
    ds_read_b128 v[132:135], v6 offset:2304
    ds_read_b128 v[136:139], v6 offset:2320
    ds_read_b128 v[140:143], v6 offset:128
    ds_read_b128 v[144:147], v6 offset:144
    ds_read_b128 v[148:151], v6 offset:2432
    ds_read_b128 v[152:155], v6 offset:2448
    ds_read_b64_tr_b16 v[100:101], v90 offset:0
    ds_read_b64_tr_b16 v[102:103], v90 offset:768
    ds_read_b64_tr_b16 v[104:105], v91 offset:32
    ds_read_b64_tr_b16 v[106:107], v91 offset:800
    ds_read_b64_tr_b16 v[108:109], v90 offset:64
    ds_read_b64_tr_b16 v[110:111], v90 offset:832
    ds_read_b64_tr_b16 v[112:113], v91 offset:96
    ds_read_b64_tr_b16 v[114:115], v91 offset:864
    s_waitcnt lgkmcnt(12)
    v_lshlrev_b32 v156, 16, v8
    v_and_b32 v157, s30, v8
    v_pk_fma_f32 v[156:157], v[156:157], v[124:125], v[132:133]
    v_cvt_pk_bf16_f32 v8, v156, v157
    v_lshlrev_b32 v158, 16, v9
    v_and_b32 v159, s30, v9
    v_pk_fma_f32 v[158:159], v[158:159], v[126:127], v[134:135]
    v_cvt_pk_bf16_f32 v9, v158, v159
    v_lshlrev_b32 v160, 16, v10
    v_and_b32 v161, s30, v10
    v_pk_fma_f32 v[160:161], v[160:161], v[128:129], v[136:137]
    v_cvt_pk_bf16_f32 v10, v160, v161
    v_lshlrev_b32 v162, 16, v11
    v_and_b32 v163, s30, v11
    v_pk_fma_f32 v[162:163], v[162:163], v[130:131], v[138:139]
    v_cvt_pk_bf16_f32 v11, v162, v163
    ds_read_b64_tr_b16 v[116:117], v90 offset:128
    ds_read_b64_tr_b16 v[118:119], v90 offset:896
    s_waitcnt lgkmcnt(8)
    v_mfma_f32_16x16x32_bf16 v[164:167], v[100:103], v[8:11], 0
    s_add_u32 m0, s28, 36864
    s_add_u32 s29, s27, 221184
    buffer_load_dwordx4 v80, s[4:7], s29 offen lds
    v_lshlrev_b32 v156, 16, v12
    v_and_b32 v157, s30, v12
    v_pk_fma_f32 v[156:157], v[156:157], v[140:141], v[148:149]
    v_cvt_pk_bf16_f32 v12, v156, v157
    v_lshlrev_b32 v158, 16, v13
    v_and_b32 v159, s30, v13
    v_pk_fma_f32 v[158:159], v[158:159], v[142:143], v[150:151]
    v_cvt_pk_bf16_f32 v13, v158, v159
    v_lshlrev_b32 v160, 16, v14
    v_and_b32 v161, s30, v14
    v_pk_fma_f32 v[160:161], v[160:161], v[144:145], v[152:153]
    v_cvt_pk_bf16_f32 v14, v160, v161
    v_lshlrev_b32 v162, 16, v15
    v_and_b32 v163, s30, v15
    v_pk_fma_f32 v[162:163], v[162:163], v[146:147], v[154:155]
    v_cvt_pk_bf16_f32 v15, v162, v163
    ds_read_b128 v[124:127], v6 offset:256
    ds_read_b128 v[128:131], v6 offset:272
    ds_read_b128 v[132:135], v6 offset:2560
    ds_read_b128 v[136:139], v6 offset:2576
    ds_read_b64_tr_b16 v[120:121], v91 offset:160
    ds_read_b64_tr_b16 v[122:123], v91 offset:928
    s_waitcnt lgkmcnt(12)
    v_mfma_f32_16x16x32_bf16 v[168:171], v[104:107], v[8:11], 0
    ds_read_b64_tr_b16 v[100:101], v90 offset:6144
    ds_read_b64_tr_b16 v[102:103], v90 offset:6912
    s_waitcnt lgkmcnt(12)
    v_mfma_f32_16x16x32_bf16 v[172:175], v[108:111], v[8:11], 0
    s_add_u32 m0, s28, 37888
    s_nop 0
    buffer_load_dwordx4 v81, s[4:7], s29 offen lds
    ds_read_b64_tr_b16 v[104:105], v91 offset:6176
    ds_read_b64_tr_b16 v[106:107], v91 offset:6944
    s_waitcnt lgkmcnt(12)
    v_mfma_f32_16x16x32_bf16 v[176:179], v[112:115], v[8:11], 0
    ds_read_b64_tr_b16 v[108:109], v90 offset:6208
    ds_read_b64_tr_b16 v[110:111], v90 offset:6976
    s_waitcnt lgkmcnt(12)
    v_mfma_f32_16x16x32_bf16 v[180:183], v[116:119], v[8:11], 0
    s_add_u32 m0, s28, 38912
    s_nop 0
    buffer_load_dwordx4 v82, s[4:7], s29 offen lds
    ds_read_b64_tr_b16 v[112:113], v91 offset:6240
    ds_read_b64_tr_b16 v[114:115], v91 offset:7008
    s_waitcnt lgkmcnt(8)
    v_mfma_f32_16x16x32_bf16 v[184:187], v[120:123], v[8:11], 0
    ds_read_b64_tr_b16 v[116:117], v90 offset:6272
    ds_read_b64_tr_b16 v[118:119], v90 offset:7040
    s_waitcnt lgkmcnt(8)
    v_mfma_f32_16x16x32_bf16 v[164:167], v[100:103], v[12:15], v[164:167]
    s_add_u32 s36, s26, 4096
    buffer_load_dwordx4 v[32:35], v3, s[8:11], s36 offen offset:2048
    v_lshlrev_b32 v156, 16, v16
    v_and_b32 v157, s30, v16
    v_pk_fma_f32 v[156:157], v[156:157], v[124:125], v[132:133]
    v_cvt_pk_bf16_f32 v16, v156, v157
    v_lshlrev_b32 v158, 16, v17
    v_and_b32 v159, s30, v17
    v_pk_fma_f32 v[158:159], v[158:159], v[126:127], v[134:135]
    v_cvt_pk_bf16_f32 v17, v158, v159
    v_lshlrev_b32 v160, 16, v18
    v_and_b32 v161, s30, v18
    v_pk_fma_f32 v[160:161], v[160:161], v[128:129], v[136:137]
    v_cvt_pk_bf16_f32 v18, v160, v161
    v_lshlrev_b32 v162, 16, v19
    v_and_b32 v163, s30, v19
    v_pk_fma_f32 v[162:163], v[162:163], v[130:131], v[138:139]
    v_cvt_pk_bf16_f32 v19, v162, v163
    ds_read_b128 v[140:143], v6 offset:384
    ds_read_b128 v[144:147], v6 offset:400
    ds_read_b128 v[148:151], v6 offset:2688
    ds_read_b128 v[152:155], v6 offset:2704
    ds_read_b64_tr_b16 v[120:121], v91 offset:6304
    ds_read_b64_tr_b16 v[122:123], v91 offset:7072
    s_waitcnt lgkmcnt(12)
    v_mfma_f32_16x16x32_bf16 v[168:171], v[104:107], v[12:15], v[168:171]
    ds_read_b64_tr_b16 v[100:101], v90 offset:12288
    ds_read_b64_tr_b16 v[102:103], v90 offset:13056
    s_waitcnt lgkmcnt(12)
    v_mfma_f32_16x16x32_bf16 v[172:175], v[108:111], v[12:15], v[172:175]
    s_add_u32 s36, s26, 4096
    buffer_load_dwordx4 v[36:39], v3, s[8:11], s36 offen offset:3072
    ds_read_b64_tr_b16 v[104:105], v91 offset:12320
    ds_read_b64_tr_b16 v[106:107], v91 offset:13088
    s_waitcnt lgkmcnt(12)
    v_mfma_f32_16x16x32_bf16 v[176:179], v[112:115], v[12:15], v[176:179]
    ds_read_b64_tr_b16 v[108:109], v90 offset:12352
    ds_read_b64_tr_b16 v[110:111], v90 offset:13120
    s_waitcnt lgkmcnt(12)
    v_mfma_f32_16x16x32_bf16 v[180:183], v[116:119], v[12:15], v[180:183]
    s_add_u32 m0, s28, 49152
    s_add_u32 s29, s27, 294912
    buffer_load_dwordx4 v80, s[4:7], s29 offen lds
    ds_read_b64_tr_b16 v[112:113], v91 offset:12384
    ds_read_b64_tr_b16 v[114:115], v91 offset:13152
    s_waitcnt lgkmcnt(8)
    v_mfma_f32_16x16x32_bf16 v[184:187], v[120:123], v[12:15], v[184:187]
    ds_read_b64_tr_b16 v[116:117], v90 offset:12416
    ds_read_b64_tr_b16 v[118:119], v90 offset:13184
    s_waitcnt lgkmcnt(8)
    v_mfma_f32_16x16x32_bf16 v[164:167], v[100:103], v[16:19], v[164:167]
    s_add_u32 m0, s28, 50176
    s_nop 0
    buffer_load_dwordx4 v81, s[4:7], s29 offen lds
    v_lshlrev_b32 v156, 16, v20
    v_and_b32 v157, s30, v20
    v_pk_fma_f32 v[156:157], v[156:157], v[140:141], v[148:149]
    v_cvt_pk_bf16_f32 v20, v156, v157
    v_lshlrev_b32 v158, 16, v21
    v_and_b32 v159, s30, v21
    v_pk_fma_f32 v[158:159], v[158:159], v[142:143], v[150:151]
    v_cvt_pk_bf16_f32 v21, v158, v159
    v_lshlrev_b32 v160, 16, v22
    v_and_b32 v161, s30, v22
    v_pk_fma_f32 v[160:161], v[160:161], v[144:145], v[152:153]
    v_cvt_pk_bf16_f32 v22, v160, v161
    v_lshlrev_b32 v162, 16, v23
    v_and_b32 v163, s30, v23
    v_pk_fma_f32 v[162:163], v[162:163], v[146:147], v[154:155]
    v_cvt_pk_bf16_f32 v23, v162, v163
    ds_read_b128 v[124:127], v6 offset:512
    ds_read_b128 v[128:131], v6 offset:528
    ds_read_b128 v[132:135], v6 offset:2816
    ds_read_b128 v[136:139], v6 offset:2832
    ds_read_b64_tr_b16 v[120:121], v91 offset:12448
    ds_read_b64_tr_b16 v[122:123], v91 offset:13216
    s_waitcnt lgkmcnt(12)
    v_mfma_f32_16x16x32_bf16 v[168:171], v[104:107], v[16:19], v[168:171]
    ds_read_b64_tr_b16 v[100:101], v90 offset:18432
    ds_read_b64_tr_b16 v[102:103], v90 offset:19200
    s_waitcnt lgkmcnt(12)
    v_mfma_f32_16x16x32_bf16 v[172:175], v[108:111], v[16:19], v[172:175]
    s_add_u32 m0, s28, 51200
    s_nop 0
    buffer_load_dwordx4 v82, s[4:7], s29 offen lds
    ds_read_b64_tr_b16 v[104:105], v91 offset:18464
    ds_read_b64_tr_b16 v[106:107], v91 offset:19232
    s_waitcnt lgkmcnt(12)
    v_mfma_f32_16x16x32_bf16 v[176:179], v[112:115], v[16:19], v[176:179]
    ds_read_b64_tr_b16 v[108:109], v90 offset:18496
    ds_read_b64_tr_b16 v[110:111], v90 offset:19264
    s_waitcnt lgkmcnt(12)
    v_mfma_f32_16x16x32_bf16 v[180:183], v[116:119], v[16:19], v[180:183]
    s_add_u32 s36, s26, 8192
    buffer_load_dwordx4 v[40:43], v3, s[8:11], s36 offen offset:0
    ds_read_b64_tr_b16 v[112:113], v91 offset:18528
    ds_read_b64_tr_b16 v[114:115], v91 offset:19296
    s_waitcnt lgkmcnt(8)
    v_mfma_f32_16x16x32_bf16 v[184:187], v[120:123], v[16:19], v[184:187]
    ds_read_b64_tr_b16 v[116:117], v90 offset:18560
    ds_read_b64_tr_b16 v[118:119], v90 offset:19328
    s_waitcnt lgkmcnt(8)
    v_mfma_f32_16x16x32_bf16 v[164:167], v[100:103], v[20:23], v[164:167]
    s_add_u32 s36, s26, 8192
    buffer_load_dwordx4 v[44:47], v3, s[8:11], s36 offen offset:1024
    ds_read_b64_tr_b16 v[120:121], v91 offset:18592
    ds_read_b64_tr_b16 v[122:123], v91 offset:19360
    s_waitcnt lgkmcnt(8)
    v_mfma_f32_16x16x32_bf16 v[168:171], v[104:107], v[20:23], v[168:171]
    s_waitcnt lgkmcnt(6)
    v_mfma_f32_16x16x32_bf16 v[172:175], v[108:111], v[20:23], v[172:175]
    s_add_u32 m0, s28, 61440
    s_add_u32 s29, s27, 368640
    buffer_load_dwordx4 v80, s[4:7], s29 offen lds
    s_waitcnt lgkmcnt(4)
    v_mfma_f32_16x16x32_bf16 v[176:179], v[112:115], v[20:23], v[176:179]
    s_waitcnt lgkmcnt(2)
    v_mfma_f32_16x16x32_bf16 v[180:183], v[116:119], v[20:23], v[180:183]
    s_add_u32 m0, s28, 62464
    s_nop 0
    buffer_load_dwordx4 v81, s[4:7], s29 offen lds
    s_waitcnt lgkmcnt(0)
    v_mfma_f32_16x16x32_bf16 v[184:187], v[120:123], v[20:23], v[184:187]
    s_waitcnt vmcnt(7)
    s_barrier
    ds_read_b64_tr_b16 v[100:101], v90 offset:24576
    ds_read_b64_tr_b16 v[102:103], v90 offset:25344
    ds_read_b64_tr_b16 v[104:105], v91 offset:24608
    ds_read_b64_tr_b16 v[106:107], v91 offset:25376
    ds_read_b64_tr_b16 v[108:109], v90 offset:24640
    ds_read_b64_tr_b16 v[110:111], v90 offset:25408
    ds_read_b64_tr_b16 v[112:113], v91 offset:24672
    ds_read_b64_tr_b16 v[114:115], v91 offset:25440
    v_lshlrev_b32 v156, 16, v24
    v_and_b32 v157, s30, v24
    v_pk_fma_f32 v[156:157], v[156:157], v[124:125], v[132:133]
    v_cvt_pk_bf16_f32 v24, v156, v157
    v_lshlrev_b32 v158, 16, v25
    v_and_b32 v159, s30, v25
    v_pk_fma_f32 v[158:159], v[158:159], v[126:127], v[134:135]
    v_cvt_pk_bf16_f32 v25, v158, v159
    v_lshlrev_b32 v160, 16, v26
    v_and_b32 v161, s30, v26
    v_pk_fma_f32 v[160:161], v[160:161], v[128:129], v[136:137]
    v_cvt_pk_bf16_f32 v26, v160, v161
    v_lshlrev_b32 v162, 16, v27
    v_and_b32 v163, s30, v27
    v_pk_fma_f32 v[162:163], v[162:163], v[130:131], v[138:139]
    v_cvt_pk_bf16_f32 v27, v162, v163
    ds_read_b128 v[140:143], v6 offset:640
    ds_read_b128 v[144:147], v6 offset:656
    ds_read_b128 v[148:151], v6 offset:2944
    ds_read_b128 v[152:155], v6 offset:2960
    ds_read_b64_tr_b16 v[116:117], v90 offset:24704
    ds_read_b64_tr_b16 v[118:119], v90 offset:25472
    s_waitcnt lgkmcnt(12)
    v_mfma_f32_16x16x32_bf16 v[164:167], v[100:103], v[24:27], v[164:167]
    s_add_u32 m0, s28, 63488
    s_nop 0
    buffer_load_dwordx4 v82, s[4:7], s29 offen lds
    s_waitcnt lgkmcnt(2)
    v_lshlrev_b32 v156, 16, v28
    v_and_b32 v157, s30, v28
    v_pk_fma_f32 v[156:157], v[156:157], v[140:141], v[148:149]
    v_cvt_pk_bf16_f32 v28, v156, v157
    v_lshlrev_b32 v158, 16, v29
    v_and_b32 v159, s30, v29
    v_pk_fma_f32 v[158:159], v[158:159], v[142:143], v[150:151]
    v_cvt_pk_bf16_f32 v29, v158, v159
    v_lshlrev_b32 v160, 16, v30
    v_and_b32 v161, s30, v30
    v_pk_fma_f32 v[160:161], v[160:161], v[144:145], v[152:153]
    v_cvt_pk_bf16_f32 v30, v160, v161
    v_lshlrev_b32 v162, 16, v31
    v_and_b32 v163, s30, v31
    v_pk_fma_f32 v[162:163], v[162:163], v[146:147], v[154:155]
    v_cvt_pk_bf16_f32 v31, v162, v163
    ds_read_b128 v[124:127], v6 offset:768
    ds_read_b128 v[128:131], v6 offset:784
    ds_read_b128 v[132:135], v6 offset:3072
    ds_read_b128 v[136:139], v6 offset:3088
    ds_read_b64_tr_b16 v[120:121], v91 offset:24736
    ds_read_b64_tr_b16 v[122:123], v91 offset:25504
    v_mfma_f32_16x16x32_bf16 v[168:171], v[104:107], v[24:27], v[168:171]
    ds_read_b64_tr_b16 v[100:101], v90 offset:30720
    ds_read_b64_tr_b16 v[102:103], v90 offset:31488
    v_mfma_f32_16x16x32_bf16 v[172:175], v[108:111], v[24:27], v[172:175]
    s_add_u32 s36, s26, 8192
    buffer_load_dwordx4 v[48:51], v3, s[8:11], s36 offen offset:2048
    ds_read_b64_tr_b16 v[104:105], v91 offset:30752
    ds_read_b64_tr_b16 v[106:107], v91 offset:31520
    v_mfma_f32_16x16x32_bf16 v[176:179], v[112:115], v[24:27], v[176:179]
    ds_read_b64_tr_b16 v[108:109], v90 offset:30784
    ds_read_b64_tr_b16 v[110:111], v90 offset:31552
    s_waitcnt lgkmcnt(12)
    v_mfma_f32_16x16x32_bf16 v[180:183], v[116:119], v[24:27], v[180:183]
    s_add_u32 s36, s26, 8192
    buffer_load_dwordx4 v[52:55], v3, s[8:11], s36 offen offset:3072
    ds_read_b64_tr_b16 v[112:113], v91 offset:30816
    ds_read_b64_tr_b16 v[114:115], v91 offset:31584
    s_waitcnt lgkmcnt(8)
    v_mfma_f32_16x16x32_bf16 v[184:187], v[120:123], v[24:27], v[184:187]
    ds_read_b64_tr_b16 v[116:117], v90 offset:30848
    ds_read_b64_tr_b16 v[118:119], v90 offset:31616
    s_waitcnt lgkmcnt(8)
    v_mfma_f32_16x16x32_bf16 v[164:167], v[100:103], v[28:31], v[164:167]
    s_add_u32 m0, s28, 73728
    s_add_u32 s29, s27, 442368
    buffer_load_dwordx4 v80, s[4:7], s29 offen lds
    v_lshlrev_b32 v156, 16, v32
    v_and_b32 v157, s30, v32
    v_pk_fma_f32 v[156:157], v[156:157], v[124:125], v[132:133]
    v_cvt_pk_bf16_f32 v32, v156, v157
    v_lshlrev_b32 v158, 16, v33
    v_and_b32 v159, s30, v33
    v_pk_fma_f32 v[158:159], v[158:159], v[126:127], v[134:135]
    v_cvt_pk_bf16_f32 v33, v158, v159
    v_lshlrev_b32 v160, 16, v34
    v_and_b32 v161, s30, v34
    v_pk_fma_f32 v[160:161], v[160:161], v[128:129], v[136:137]
    v_cvt_pk_bf16_f32 v34, v160, v161
    v_lshlrev_b32 v162, 16, v35
    v_and_b32 v163, s30, v35
    v_pk_fma_f32 v[162:163], v[162:163], v[130:131], v[138:139]
    v_cvt_pk_bf16_f32 v35, v162, v163
    ds_read_b128 v[140:143], v6 offset:896
    ds_read_b128 v[144:147], v6 offset:912
    ds_read_b128 v[148:151], v6 offset:3200
    ds_read_b128 v[152:155], v6 offset:3216
    ds_read_b64_tr_b16 v[120:121], v91 offset:30880
    ds_read_b64_tr_b16 v[122:123], v91 offset:31648
    s_waitcnt lgkmcnt(12)
    v_mfma_f32_16x16x32_bf16 v[168:171], v[104:107], v[28:31], v[168:171]
    ds_read_b64_tr_b16 v[100:101], v90 offset:36864
    ds_read_b64_tr_b16 v[102:103], v90 offset:37632
    s_waitcnt lgkmcnt(12)
    v_mfma_f32_16x16x32_bf16 v[172:175], v[108:111], v[28:31], v[172:175]
    s_add_u32 m0, s28, 74752
    s_nop 0
    buffer_load_dwordx4 v81, s[4:7], s29 offen lds
    ds_read_b64_tr_b16 v[104:105], v91 offset:36896
    ds_read_b64_tr_b16 v[106:107], v91 offset:37664
    s_waitcnt lgkmcnt(12)
    v_mfma_f32_16x16x32_bf16 v[176:179], v[112:115], v[28:31], v[176:179]
    ds_read_b64_tr_b16 v[108:109], v90 offset:36928
    ds_read_b64_tr_b16 v[110:111], v90 offset:37696
    s_waitcnt lgkmcnt(12)
    v_mfma_f32_16x16x32_bf16 v[180:183], v[116:119], v[28:31], v[180:183]
    s_add_u32 m0, s28, 75776
    s_nop 0
    buffer_load_dwordx4 v82, s[4:7], s29 offen lds
    ds_read_b64_tr_b16 v[112:113], v91 offset:36960
    ds_read_b64_tr_b16 v[114:115], v91 offset:37728
    s_waitcnt lgkmcnt(8)
    v_mfma_f32_16x16x32_bf16 v[184:187], v[120:123], v[28:31], v[184:187]
    ds_read_b64_tr_b16 v[116:117], v90 offset:36992
    ds_read_b64_tr_b16 v[118:119], v90 offset:37760
    s_waitcnt lgkmcnt(8)
    v_mfma_f32_16x16x32_bf16 v[164:167], v[100:103], v[32:35], v[164:167]
    s_add_u32 s36, s26, 12288
    buffer_load_dwordx4 v[56:59], v3, s[8:11], s36 offen offset:0
    v_lshlrev_b32 v156, 16, v36
    v_and_b32 v157, s30, v36
    v_pk_fma_f32 v[156:157], v[156:157], v[140:141], v[148:149]
    v_cvt_pk_bf16_f32 v36, v156, v157
    v_lshlrev_b32 v158, 16, v37
    v_and_b32 v159, s30, v37
    v_pk_fma_f32 v[158:159], v[158:159], v[142:143], v[150:151]
    v_cvt_pk_bf16_f32 v37, v158, v159
    v_lshlrev_b32 v160, 16, v38
    v_and_b32 v161, s30, v38
    v_pk_fma_f32 v[160:161], v[160:161], v[144:145], v[152:153]
    v_cvt_pk_bf16_f32 v38, v160, v161
    v_lshlrev_b32 v162, 16, v39
    v_and_b32 v163, s30, v39
    v_pk_fma_f32 v[162:163], v[162:163], v[146:147], v[154:155]
    v_cvt_pk_bf16_f32 v39, v162, v163
    ds_read_b128 v[124:127], v6 offset:1024
    ds_read_b128 v[128:131], v6 offset:1040
    ds_read_b128 v[132:135], v6 offset:3328
    ds_read_b128 v[136:139], v6 offset:3344
    ds_read_b64_tr_b16 v[120:121], v91 offset:37024
    ds_read_b64_tr_b16 v[122:123], v91 offset:37792
    s_waitcnt lgkmcnt(12)
    v_mfma_f32_16x16x32_bf16 v[168:171], v[104:107], v[32:35], v[168:171]
    ds_read_b64_tr_b16 v[100:101], v90 offset:43008
    ds_read_b64_tr_b16 v[102:103], v90 offset:43776
    s_waitcnt lgkmcnt(12)
    v_mfma_f32_16x16x32_bf16 v[172:175], v[108:111], v[32:35], v[172:175]
    s_add_u32 s36, s26, 12288
    buffer_load_dwordx4 v[60:63], v3, s[8:11], s36 offen offset:1024
    ds_read_b64_tr_b16 v[104:105], v91 offset:43040
    ds_read_b64_tr_b16 v[106:107], v91 offset:43808
    s_waitcnt lgkmcnt(12)
    v_mfma_f32_16x16x32_bf16 v[176:179], v[112:115], v[32:35], v[176:179]
    ds_read_b64_tr_b16 v[108:109], v90 offset:43072
    ds_read_b64_tr_b16 v[110:111], v90 offset:43840
    s_waitcnt lgkmcnt(12)
    v_mfma_f32_16x16x32_bf16 v[180:183], v[116:119], v[32:35], v[180:183]
    s_add_u32 m0, s28, 86016
    s_add_u32 s29, s27, 516096
    buffer_load_dwordx4 v80, s[4:7], s29 offen lds
    ds_read_b64_tr_b16 v[112:113], v91 offset:43104
    ds_read_b64_tr_b16 v[114:115], v91 offset:43872
    s_waitcnt lgkmcnt(8)
    v_mfma_f32_16x16x32_bf16 v[184:187], v[120:123], v[32:35], v[184:187]
    ds_read_b64_tr_b16 v[116:117], v90 offset:43136
    ds_read_b64_tr_b16 v[118:119], v90 offset:43904
    s_waitcnt lgkmcnt(8)
    v_mfma_f32_16x16x32_bf16 v[164:167], v[100:103], v[36:39], v[164:167]
    s_add_u32 m0, s28, 87040
    s_nop 0
    buffer_load_dwordx4 v81, s[4:7], s29 offen lds
    ds_read_b64_tr_b16 v[120:121], v91 offset:43168
    ds_read_b64_tr_b16 v[122:123], v91 offset:43936
    s_waitcnt lgkmcnt(8)
    v_mfma_f32_16x16x32_bf16 v[168:171], v[104:107], v[36:39], v[168:171]
    s_waitcnt lgkmcnt(6)
    v_mfma_f32_16x16x32_bf16 v[172:175], v[108:111], v[36:39], v[172:175]
    s_add_u32 m0, s28, 88064
    s_nop 0
    buffer_load_dwordx4 v82, s[4:7], s29 offen lds
    s_waitcnt lgkmcnt(4)
    v_mfma_f32_16x16x32_bf16 v[176:179], v[112:115], v[36:39], v[176:179]
    s_waitcnt lgkmcnt(2)
    v_mfma_f32_16x16x32_bf16 v[180:183], v[116:119], v[36:39], v[180:183]
    s_add_u32 s36, s26, 12288
    buffer_load_dwordx4 v[64:67], v3, s[8:11], s36 offen offset:2048
    s_waitcnt lgkmcnt(0)
    v_mfma_f32_16x16x32_bf16 v[184:187], v[120:123], v[36:39], v[184:187]
    s_waitcnt vmcnt(9)
    s_barrier
    ds_read_b64_tr_b16 v[100:101], v90 offset:49152
    ds_read_b64_tr_b16 v[102:103], v90 offset:49920
    ds_read_b64_tr_b16 v[104:105], v91 offset:49184
    ds_read_b64_tr_b16 v[106:107], v91 offset:49952
    ds_read_b64_tr_b16 v[108:109], v90 offset:49216
    ds_read_b64_tr_b16 v[110:111], v90 offset:49984
    ds_read_b64_tr_b16 v[112:113], v91 offset:49248
    ds_read_b64_tr_b16 v[114:115], v91 offset:50016
    v_lshlrev_b32 v156, 16, v40
    v_and_b32 v157, s30, v40
    v_pk_fma_f32 v[156:157], v[156:157], v[124:125], v[132:133]
    v_cvt_pk_bf16_f32 v40, v156, v157
    v_lshlrev_b32 v158, 16, v41
    v_and_b32 v159, s30, v41
    v_pk_fma_f32 v[158:159], v[158:159], v[126:127], v[134:135]
    v_cvt_pk_bf16_f32 v41, v158, v159
    v_lshlrev_b32 v160, 16, v42
    v_and_b32 v161, s30, v42
    v_pk_fma_f32 v[160:161], v[160:161], v[128:129], v[136:137]
    v_cvt_pk_bf16_f32 v42, v160, v161
    v_lshlrev_b32 v162, 16, v43
    v_and_b32 v163, s30, v43
    v_pk_fma_f32 v[162:163], v[162:163], v[130:131], v[138:139]
    v_cvt_pk_bf16_f32 v43, v162, v163
    ds_read_b128 v[140:143], v6 offset:1152
    ds_read_b128 v[144:147], v6 offset:1168
    ds_read_b128 v[148:151], v6 offset:3456
    ds_read_b128 v[152:155], v6 offset:3472
    ds_read_b64_tr_b16 v[116:117], v90 offset:49280
    ds_read_b64_tr_b16 v[118:119], v90 offset:50048
    s_waitcnt lgkmcnt(12)
    v_mfma_f32_16x16x32_bf16 v[164:167], v[100:103], v[40:43], v[164:167]
    s_add_u32 s36, s26, 12288
    buffer_load_dwordx4 v[68:71], v3, s[8:11], s36 offen offset:3072
    s_waitcnt lgkmcnt(2)
    v_lshlrev_b32 v156, 16, v44
    v_and_b32 v157, s30, v44
    v_pk_fma_f32 v[156:157], v[156:157], v[140:141], v[148:149]
    v_cvt_pk_bf16_f32 v44, v156, v157
    v_lshlrev_b32 v158, 16, v45
    v_and_b32 v159, s30, v45
    v_pk_fma_f32 v[158:159], v[158:159], v[142:143], v[150:151]
    v_cvt_pk_bf16_f32 v45, v158, v159
    v_lshlrev_b32 v160, 16, v46
    v_and_b32 v161, s30, v46
    v_pk_fma_f32 v[160:161], v[160:161], v[144:145], v[152:153]
    v_cvt_pk_bf16_f32 v46, v160, v161
    v_lshlrev_b32 v162, 16, v47
    v_and_b32 v163, s30, v47
    v_pk_fma_f32 v[162:163], v[162:163], v[146:147], v[154:155]
    v_cvt_pk_bf16_f32 v47, v162, v163
    ds_read_b128 v[124:127], v6 offset:1280
    ds_read_b128 v[128:131], v6 offset:1296
    ds_read_b128 v[132:135], v6 offset:3584
    ds_read_b128 v[136:139], v6 offset:3600
    ds_read_b64_tr_b16 v[120:121], v91 offset:49312
    ds_read_b64_tr_b16 v[122:123], v91 offset:50080
    v_mfma_f32_16x16x32_bf16 v[168:171], v[104:107], v[40:43], v[168:171]
    ds_read_b64_tr_b16 v[100:101], v92 offset:0
    ds_read_b64_tr_b16 v[102:103], v92 offset:768
    v_mfma_f32_16x16x32_bf16 v[172:175], v[108:111], v[40:43], v[172:175]
    s_add_u32 m0, s28, 98304
    s_add_u32 s29, s27, 589824
    buffer_load_dwordx4 v80, s[4:7], s29 offen lds
    ds_read_b64_tr_b16 v[104:105], v93 offset:32
    ds_read_b64_tr_b16 v[106:107], v93 offset:800
    v_mfma_f32_16x16x32_bf16 v[176:179], v[112:115], v[40:43], v[176:179]
    ds_read_b64_tr_b16 v[108:109], v92 offset:64
    ds_read_b64_tr_b16 v[110:111], v92 offset:832
    s_waitcnt lgkmcnt(12)
    v_mfma_f32_16x16x32_bf16 v[180:183], v[116:119], v[40:43], v[180:183]
    s_add_u32 m0, s28, 99328
    s_nop 0
    buffer_load_dwordx4 v81, s[4:7], s29 offen lds
    ds_read_b64_tr_b16 v[112:113], v93 offset:96
    ds_read_b64_tr_b16 v[114:115], v93 offset:864
    s_waitcnt lgkmcnt(8)
    v_mfma_f32_16x16x32_bf16 v[184:187], v[120:123], v[40:43], v[184:187]
    ds_read_b64_tr_b16 v[116:117], v92 offset:128
    ds_read_b64_tr_b16 v[118:119], v92 offset:896
    s_waitcnt lgkmcnt(8)
    v_mfma_f32_16x16x32_bf16 v[164:167], v[100:103], v[44:47], v[164:167]
    s_add_u32 m0, s28, 100352
    s_nop 0
    buffer_load_dwordx4 v82, s[4:7], s29 offen lds
    v_lshlrev_b32 v156, 16, v48
    v_and_b32 v157, s30, v48
    v_pk_fma_f32 v[156:157], v[156:157], v[124:125], v[132:133]
    v_cvt_pk_bf16_f32 v48, v156, v157
    v_lshlrev_b32 v158, 16, v49
    v_and_b32 v159, s30, v49
    v_pk_fma_f32 v[158:159], v[158:159], v[126:127], v[134:135]
    v_cvt_pk_bf16_f32 v49, v158, v159
    v_lshlrev_b32 v160, 16, v50
    v_and_b32 v161, s30, v50
    v_pk_fma_f32 v[160:161], v[160:161], v[128:129], v[136:137]
    v_cvt_pk_bf16_f32 v50, v160, v161
    v_lshlrev_b32 v162, 16, v51
    v_and_b32 v163, s30, v51
    v_pk_fma_f32 v[162:163], v[162:163], v[130:131], v[138:139]
    v_cvt_pk_bf16_f32 v51, v162, v163
    ds_read_b128 v[140:143], v6 offset:1408
    ds_read_b128 v[144:147], v6 offset:1424
    ds_read_b128 v[148:151], v6 offset:3712
    ds_read_b128 v[152:155], v6 offset:3728
    ds_read_b64_tr_b16 v[120:121], v93 offset:160
    ds_read_b64_tr_b16 v[122:123], v93 offset:928
    s_waitcnt lgkmcnt(12)
    v_mfma_f32_16x16x32_bf16 v[168:171], v[104:107], v[44:47], v[168:171]
    ds_read_b64_tr_b16 v[100:101], v92 offset:6144
    ds_read_b64_tr_b16 v[102:103], v92 offset:6912
    s_waitcnt lgkmcnt(12)
    v_mfma_f32_16x16x32_bf16 v[172:175], v[108:111], v[44:47], v[172:175]
    s_add_u32 s36, s26, 16384
    buffer_load_dwordx4 v[72:75], v3, s[8:11], s36 offen offset:0
    ds_read_b64_tr_b16 v[104:105], v93 offset:6176
    ds_read_b64_tr_b16 v[106:107], v93 offset:6944
    s_waitcnt lgkmcnt(12)
    v_mfma_f32_16x16x32_bf16 v[176:179], v[112:115], v[44:47], v[176:179]
    ds_read_b64_tr_b16 v[108:109], v92 offset:6208
    ds_read_b64_tr_b16 v[110:111], v92 offset:6976
    s_waitcnt lgkmcnt(12)
    v_mfma_f32_16x16x32_bf16 v[180:183], v[116:119], v[44:47], v[180:183]
    s_add_u32 s36, s26, 16384
    buffer_load_dwordx4 v[76:79], v3, s[8:11], s36 offen offset:1024
    ds_read_b64_tr_b16 v[112:113], v93 offset:6240
    ds_read_b64_tr_b16 v[114:115], v93 offset:7008
    s_waitcnt lgkmcnt(8)
    v_mfma_f32_16x16x32_bf16 v[184:187], v[120:123], v[44:47], v[184:187]
    ds_read_b64_tr_b16 v[116:117], v92 offset:6272
    ds_read_b64_tr_b16 v[118:119], v92 offset:7040
    s_waitcnt lgkmcnt(8)
    v_mfma_f32_16x16x32_bf16 v[164:167], v[100:103], v[48:51], v[164:167]
    v_lshlrev_b32 v156, 16, v52
    v_and_b32 v157, s30, v52
    v_pk_fma_f32 v[156:157], v[156:157], v[140:141], v[148:149]
    v_cvt_pk_bf16_f32 v52, v156, v157
    v_lshlrev_b32 v158, 16, v53
    v_and_b32 v159, s30, v53
    v_pk_fma_f32 v[158:159], v[158:159], v[142:143], v[150:151]
    v_cvt_pk_bf16_f32 v53, v158, v159
    v_lshlrev_b32 v160, 16, v54
    v_and_b32 v161, s30, v54
    v_pk_fma_f32 v[160:161], v[160:161], v[144:145], v[152:153]
    v_cvt_pk_bf16_f32 v54, v160, v161
    v_lshlrev_b32 v162, 16, v55
    v_and_b32 v163, s30, v55
    v_pk_fma_f32 v[162:163], v[162:163], v[146:147], v[154:155]
    v_cvt_pk_bf16_f32 v55, v162, v163
    ds_read_b128 v[124:127], v6 offset:1536
    ds_read_b128 v[128:131], v6 offset:1552
    ds_read_b128 v[132:135], v6 offset:3840
    ds_read_b128 v[136:139], v6 offset:3856
    ds_read_b64_tr_b16 v[120:121], v93 offset:6304
    ds_read_b64_tr_b16 v[122:123], v93 offset:7072
    s_waitcnt lgkmcnt(12)
    v_mfma_f32_16x16x32_bf16 v[168:171], v[104:107], v[48:51], v[168:171]
    ds_read_b64_tr_b16 v[100:101], v92 offset:12288
    ds_read_b64_tr_b16 v[102:103], v92 offset:13056
    s_waitcnt lgkmcnt(12)
    v_mfma_f32_16x16x32_bf16 v[172:175], v[108:111], v[48:51], v[172:175]
    ds_read_b64_tr_b16 v[104:105], v93 offset:12320
    ds_read_b64_tr_b16 v[106:107], v93 offset:13088
    s_waitcnt lgkmcnt(12)
    v_mfma_f32_16x16x32_bf16 v[176:179], v[112:115], v[48:51], v[176:179]
    ds_read_b64_tr_b16 v[108:109], v92 offset:12352
    ds_read_b64_tr_b16 v[110:111], v92 offset:13120
    s_waitcnt lgkmcnt(12)
    v_mfma_f32_16x16x32_bf16 v[180:183], v[116:119], v[48:51], v[180:183]
    ds_read_b64_tr_b16 v[112:113], v93 offset:12384
    ds_read_b64_tr_b16 v[114:115], v93 offset:13152
    s_waitcnt lgkmcnt(8)
    v_mfma_f32_16x16x32_bf16 v[184:187], v[120:123], v[48:51], v[184:187]
    ds_read_b64_tr_b16 v[116:117], v92 offset:12416
    ds_read_b64_tr_b16 v[118:119], v92 offset:13184
    s_waitcnt lgkmcnt(8)
    v_mfma_f32_16x16x32_bf16 v[164:167], v[100:103], v[52:55], v[164:167]
    ds_read_b64_tr_b16 v[120:121], v93 offset:12448
    ds_read_b64_tr_b16 v[122:123], v93 offset:13216
    s_waitcnt lgkmcnt(8)
    v_mfma_f32_16x16x32_bf16 v[168:171], v[104:107], v[52:55], v[168:171]
    s_waitcnt lgkmcnt(6)
    v_mfma_f32_16x16x32_bf16 v[172:175], v[108:111], v[52:55], v[172:175]
    s_waitcnt lgkmcnt(4)
    v_mfma_f32_16x16x32_bf16 v[176:179], v[112:115], v[52:55], v[176:179]
    s_waitcnt lgkmcnt(2)
    v_mfma_f32_16x16x32_bf16 v[180:183], v[116:119], v[52:55], v[180:183]
    s_waitcnt lgkmcnt(0)
    v_mfma_f32_16x16x32_bf16 v[184:187], v[120:123], v[52:55], v[184:187]
    s_waitcnt vmcnt(0)
    s_barrier
    ds_read_b64_tr_b16 v[100:101], v92 offset:18432
    ds_read_b64_tr_b16 v[102:103], v92 offset:19200
    ds_read_b64_tr_b16 v[104:105], v93 offset:18464
    ds_read_b64_tr_b16 v[106:107], v93 offset:19232
    ds_read_b64_tr_b16 v[108:109], v92 offset:18496
    ds_read_b64_tr_b16 v[110:111], v92 offset:19264
    ds_read_b64_tr_b16 v[112:113], v93 offset:18528
    ds_read_b64_tr_b16 v[114:115], v93 offset:19296
    v_lshlrev_b32 v156, 16, v56
    v_and_b32 v157, s30, v56
    v_pk_fma_f32 v[156:157], v[156:157], v[124:125], v[132:133]
    v_cvt_pk_bf16_f32 v56, v156, v157
    v_lshlrev_b32 v158, 16, v57
    v_and_b32 v159, s30, v57
    v_pk_fma_f32 v[158:159], v[158:159], v[126:127], v[134:135]
    v_cvt_pk_bf16_f32 v57, v158, v159
    v_lshlrev_b32 v160, 16, v58
    v_and_b32 v161, s30, v58
    v_pk_fma_f32 v[160:161], v[160:161], v[128:129], v[136:137]
    v_cvt_pk_bf16_f32 v58, v160, v161
    v_lshlrev_b32 v162, 16, v59
    v_and_b32 v163, s30, v59
    v_pk_fma_f32 v[162:163], v[162:163], v[130:131], v[138:139]
    v_cvt_pk_bf16_f32 v59, v162, v163
    ds_read_b128 v[140:143], v6 offset:1664
    ds_read_b128 v[144:147], v6 offset:1680
    ds_read_b128 v[148:151], v6 offset:3968
    ds_read_b128 v[152:155], v6 offset:3984
    ds_read_b64_tr_b16 v[116:117], v92 offset:18560
    ds_read_b64_tr_b16 v[118:119], v92 offset:19328
    s_waitcnt lgkmcnt(12)
    v_mfma_f32_16x16x32_bf16 v[164:167], v[100:103], v[56:59], v[164:167]
    s_waitcnt lgkmcnt(2)
    v_lshlrev_b32 v156, 16, v60
    v_and_b32 v157, s30, v60
    v_pk_fma_f32 v[156:157], v[156:157], v[140:141], v[148:149]
    v_cvt_pk_bf16_f32 v60, v156, v157
    v_lshlrev_b32 v158, 16, v61
    v_and_b32 v159, s30, v61
    v_pk_fma_f32 v[158:159], v[158:159], v[142:143], v[150:151]
    v_cvt_pk_bf16_f32 v61, v158, v159
    v_lshlrev_b32 v160, 16, v62
    v_and_b32 v161, s30, v62
    v_pk_fma_f32 v[160:161], v[160:161], v[144:145], v[152:153]
    v_cvt_pk_bf16_f32 v62, v160, v161
    v_lshlrev_b32 v162, 16, v63
    v_and_b32 v163, s30, v63
    v_pk_fma_f32 v[162:163], v[162:163], v[146:147], v[154:155]
    v_cvt_pk_bf16_f32 v63, v162, v163
    ds_read_b128 v[124:127], v6 offset:1792
    ds_read_b128 v[128:131], v6 offset:1808
    ds_read_b128 v[132:135], v6 offset:4096
    ds_read_b128 v[136:139], v6 offset:4112
    ds_read_b64_tr_b16 v[120:121], v93 offset:18592
    ds_read_b64_tr_b16 v[122:123], v93 offset:19360
    v_mfma_f32_16x16x32_bf16 v[168:171], v[104:107], v[56:59], v[168:171]
    ds_read_b64_tr_b16 v[100:101], v92 offset:24576
    ds_read_b64_tr_b16 v[102:103], v92 offset:25344
    v_mfma_f32_16x16x32_bf16 v[172:175], v[108:111], v[56:59], v[172:175]
    ds_read_b64_tr_b16 v[104:105], v93 offset:24608
    ds_read_b64_tr_b16 v[106:107], v93 offset:25376
    v_mfma_f32_16x16x32_bf16 v[176:179], v[112:115], v[56:59], v[176:179]
    ds_read_b64_tr_b16 v[108:109], v92 offset:24640
    ds_read_b64_tr_b16 v[110:111], v92 offset:25408
    s_waitcnt lgkmcnt(12)
    v_mfma_f32_16x16x32_bf16 v[180:183], v[116:119], v[56:59], v[180:183]
    ds_read_b64_tr_b16 v[112:113], v93 offset:24672
    ds_read_b64_tr_b16 v[114:115], v93 offset:25440
    s_waitcnt lgkmcnt(8)
    v_mfma_f32_16x16x32_bf16 v[184:187], v[120:123], v[56:59], v[184:187]
    ds_read_b64_tr_b16 v[116:117], v92 offset:24704
    ds_read_b64_tr_b16 v[118:119], v92 offset:25472
    s_waitcnt lgkmcnt(8)
    v_mfma_f32_16x16x32_bf16 v[164:167], v[100:103], v[60:63], v[164:167]
    v_lshlrev_b32 v156, 16, v64
    v_and_b32 v157, s30, v64
    v_pk_fma_f32 v[156:157], v[156:157], v[124:125], v[132:133]
    v_cvt_pk_bf16_f32 v64, v156, v157
    v_lshlrev_b32 v158, 16, v65
    v_and_b32 v159, s30, v65
    v_pk_fma_f32 v[158:159], v[158:159], v[126:127], v[134:135]
    v_cvt_pk_bf16_f32 v65, v158, v159
    v_lshlrev_b32 v160, 16, v66
    v_and_b32 v161, s30, v66
    v_pk_fma_f32 v[160:161], v[160:161], v[128:129], v[136:137]
    v_cvt_pk_bf16_f32 v66, v160, v161
    v_lshlrev_b32 v162, 16, v67
    v_and_b32 v163, s30, v67
    v_pk_fma_f32 v[162:163], v[162:163], v[130:131], v[138:139]
    v_cvt_pk_bf16_f32 v67, v162, v163
    ds_read_b128 v[140:143], v6 offset:1920
    ds_read_b128 v[144:147], v6 offset:1936
    ds_read_b128 v[148:151], v6 offset:4224
    ds_read_b128 v[152:155], v6 offset:4240
    ds_read_b64_tr_b16 v[120:121], v93 offset:24736
    ds_read_b64_tr_b16 v[122:123], v93 offset:25504
    s_waitcnt lgkmcnt(12)
    v_mfma_f32_16x16x32_bf16 v[168:171], v[104:107], v[60:63], v[168:171]
    ds_read_b64_tr_b16 v[100:101], v92 offset:30720
    ds_read_b64_tr_b16 v[102:103], v92 offset:31488
    s_waitcnt lgkmcnt(12)
    v_mfma_f32_16x16x32_bf16 v[172:175], v[108:111], v[60:63], v[172:175]
    ds_read_b64_tr_b16 v[104:105], v93 offset:30752
    ds_read_b64_tr_b16 v[106:107], v93 offset:31520
    s_waitcnt lgkmcnt(12)
    v_mfma_f32_16x16x32_bf16 v[176:179], v[112:115], v[60:63], v[176:179]
    ds_read_b64_tr_b16 v[108:109], v92 offset:30784
    ds_read_b64_tr_b16 v[110:111], v92 offset:31552
    s_waitcnt lgkmcnt(12)
    v_mfma_f32_16x16x32_bf16 v[180:183], v[116:119], v[60:63], v[180:183]
    ds_read_b64_tr_b16 v[112:113], v93 offset:30816
    ds_read_b64_tr_b16 v[114:115], v93 offset:31584
    s_waitcnt lgkmcnt(8)
    v_mfma_f32_16x16x32_bf16 v[184:187], v[120:123], v[60:63], v[184:187]
    ds_read_b64_tr_b16 v[116:117], v92 offset:30848
    ds_read_b64_tr_b16 v[118:119], v92 offset:31616
    s_waitcnt lgkmcnt(8)
    v_mfma_f32_16x16x32_bf16 v[164:167], v[100:103], v[64:67], v[164:167]
    v_lshlrev_b32 v156, 16, v68
    v_and_b32 v157, s30, v68
    v_pk_fma_f32 v[156:157], v[156:157], v[140:141], v[148:149]
    v_cvt_pk_bf16_f32 v68, v156, v157
    v_lshlrev_b32 v158, 16, v69
    v_and_b32 v159, s30, v69
    v_pk_fma_f32 v[158:159], v[158:159], v[142:143], v[150:151]
    v_cvt_pk_bf16_f32 v69, v158, v159
    v_lshlrev_b32 v160, 16, v70
    v_and_b32 v161, s30, v70
    v_pk_fma_f32 v[160:161], v[160:161], v[144:145], v[152:153]
    v_cvt_pk_bf16_f32 v70, v160, v161
    v_lshlrev_b32 v162, 16, v71
    v_and_b32 v163, s30, v71
    v_pk_fma_f32 v[162:163], v[162:163], v[146:147], v[154:155]
    v_cvt_pk_bf16_f32 v71, v162, v163
    ds_read_b128 v[124:127], v6 offset:2048
    ds_read_b128 v[128:131], v6 offset:2064
    ds_read_b128 v[132:135], v6 offset:4352
    ds_read_b128 v[136:139], v6 offset:4368
    ds_read_b64_tr_b16 v[120:121], v93 offset:30880
    ds_read_b64_tr_b16 v[122:123], v93 offset:31648
    s_waitcnt lgkmcnt(12)
    v_mfma_f32_16x16x32_bf16 v[168:171], v[104:107], v[64:67], v[168:171]
    ds_read_b64_tr_b16 v[100:101], v92 offset:36864
    ds_read_b64_tr_b16 v[102:103], v92 offset:37632
    s_waitcnt lgkmcnt(12)
    v_mfma_f32_16x16x32_bf16 v[172:175], v[108:111], v[64:67], v[172:175]
    ds_read_b64_tr_b16 v[104:105], v93 offset:36896
    ds_read_b64_tr_b16 v[106:107], v93 offset:37664
    s_waitcnt lgkmcnt(12)
    v_mfma_f32_16x16x32_bf16 v[176:179], v[112:115], v[64:67], v[176:179]
    ds_read_b64_tr_b16 v[108:109], v92 offset:36928
    ds_read_b64_tr_b16 v[110:111], v92 offset:37696
    s_waitcnt lgkmcnt(12)
    v_mfma_f32_16x16x32_bf16 v[180:183], v[116:119], v[64:67], v[180:183]
    ds_read_b64_tr_b16 v[112:113], v93 offset:36960
    ds_read_b64_tr_b16 v[114:115], v93 offset:37728
    s_waitcnt lgkmcnt(8)
    v_mfma_f32_16x16x32_bf16 v[184:187], v[120:123], v[64:67], v[184:187]
    ds_read_b64_tr_b16 v[116:117], v92 offset:36992
    ds_read_b64_tr_b16 v[118:119], v92 offset:37760
    s_waitcnt lgkmcnt(8)
    v_mfma_f32_16x16x32_bf16 v[164:167], v[100:103], v[68:71], v[164:167]
    v_lshlrev_b32 v156, 16, v72
    v_and_b32 v157, s30, v72
    v_pk_fma_f32 v[156:157], v[156:157], v[124:125], v[132:133]
    v_cvt_pk_bf16_f32 v72, v156, v157
    v_lshlrev_b32 v158, 16, v73
    v_and_b32 v159, s30, v73
    v_pk_fma_f32 v[158:159], v[158:159], v[126:127], v[134:135]
    v_cvt_pk_bf16_f32 v73, v158, v159
    v_lshlrev_b32 v160, 16, v74
    v_and_b32 v161, s30, v74
    v_pk_fma_f32 v[160:161], v[160:161], v[128:129], v[136:137]
    v_cvt_pk_bf16_f32 v74, v160, v161
    v_lshlrev_b32 v162, 16, v75
    v_and_b32 v163, s30, v75
    v_pk_fma_f32 v[162:163], v[162:163], v[130:131], v[138:139]
    v_cvt_pk_bf16_f32 v75, v162, v163
    ds_read_b128 v[140:143], v6 offset:2176
    ds_read_b128 v[144:147], v6 offset:2192
    ds_read_b128 v[148:151], v6 offset:4480
    ds_read_b128 v[152:155], v6 offset:4496
    ds_read_b64_tr_b16 v[120:121], v93 offset:37024
    ds_read_b64_tr_b16 v[122:123], v93 offset:37792
    s_waitcnt lgkmcnt(12)
    v_mfma_f32_16x16x32_bf16 v[168:171], v[104:107], v[68:71], v[168:171]
    ds_read_b64_tr_b16 v[100:101], v92 offset:43008
    ds_read_b64_tr_b16 v[102:103], v92 offset:43776
    s_waitcnt lgkmcnt(12)
    v_mfma_f32_16x16x32_bf16 v[172:175], v[108:111], v[68:71], v[172:175]
    ds_read_b64_tr_b16 v[104:105], v93 offset:43040
    ds_read_b64_tr_b16 v[106:107], v93 offset:43808
    s_waitcnt lgkmcnt(12)
    v_mfma_f32_16x16x32_bf16 v[176:179], v[112:115], v[68:71], v[176:179]
    ds_read_b64_tr_b16 v[108:109], v92 offset:43072
    ds_read_b64_tr_b16 v[110:111], v92 offset:43840
    s_waitcnt lgkmcnt(12)
    v_mfma_f32_16x16x32_bf16 v[180:183], v[116:119], v[68:71], v[180:183]
    ds_read_b64_tr_b16 v[112:113], v93 offset:43104
    ds_read_b64_tr_b16 v[114:115], v93 offset:43872
    s_waitcnt lgkmcnt(8)
    v_mfma_f32_16x16x32_bf16 v[184:187], v[120:123], v[68:71], v[184:187]
    ds_read_b64_tr_b16 v[116:117], v92 offset:43136
    ds_read_b64_tr_b16 v[118:119], v92 offset:43904
    s_waitcnt lgkmcnt(8)
    v_mfma_f32_16x16x32_bf16 v[164:167], v[100:103], v[72:75], v[164:167]
    v_lshlrev_b32 v156, 16, v76
    v_and_b32 v157, s30, v76
    v_pk_fma_f32 v[156:157], v[156:157], v[140:141], v[148:149]
    v_cvt_pk_bf16_f32 v76, v156, v157
    v_lshlrev_b32 v158, 16, v77
    v_and_b32 v159, s30, v77
    v_pk_fma_f32 v[158:159], v[158:159], v[142:143], v[150:151]
    v_cvt_pk_bf16_f32 v77, v158, v159
    v_lshlrev_b32 v160, 16, v78
    v_and_b32 v161, s30, v78
    v_pk_fma_f32 v[160:161], v[160:161], v[144:145], v[152:153]
    v_cvt_pk_bf16_f32 v78, v160, v161
    v_lshlrev_b32 v162, 16, v79
    v_and_b32 v163, s30, v79
    v_pk_fma_f32 v[162:163], v[162:163], v[146:147], v[154:155]
    v_cvt_pk_bf16_f32 v79, v162, v163
    ds_read_b64_tr_b16 v[120:121], v93 offset:43168
    ds_read_b64_tr_b16 v[122:123], v93 offset:43936
    s_waitcnt lgkmcnt(8)
    v_mfma_f32_16x16x32_bf16 v[168:171], v[104:107], v[72:75], v[168:171]
    ds_read_b64_tr_b16 v[100:101], v92 offset:49152
    ds_read_b64_tr_b16 v[102:103], v92 offset:49920
    s_waitcnt lgkmcnt(8)
    v_mfma_f32_16x16x32_bf16 v[172:175], v[108:111], v[72:75], v[172:175]
    ds_read_b64_tr_b16 v[104:105], v93 offset:49184
    ds_read_b64_tr_b16 v[106:107], v93 offset:49952
    s_waitcnt lgkmcnt(8)
    v_mfma_f32_16x16x32_bf16 v[176:179], v[112:115], v[72:75], v[176:179]
    ds_read_b64_tr_b16 v[108:109], v92 offset:49216
    ds_read_b64_tr_b16 v[110:111], v92 offset:49984
    s_waitcnt lgkmcnt(8)
    v_mfma_f32_16x16x32_bf16 v[180:183], v[116:119], v[72:75], v[180:183]
    ds_read_b64_tr_b16 v[112:113], v93 offset:49248
    ds_read_b64_tr_b16 v[114:115], v93 offset:50016
    s_waitcnt lgkmcnt(8)
    v_mfma_f32_16x16x32_bf16 v[184:187], v[120:123], v[72:75], v[184:187]
    ds_read_b64_tr_b16 v[116:117], v92 offset:49280
    ds_read_b64_tr_b16 v[118:119], v92 offset:50048
    s_waitcnt lgkmcnt(8)
    v_mfma_f32_16x16x32_bf16 v[164:167], v[100:103], v[76:79], v[164:167]
    ds_read_b64_tr_b16 v[120:121], v93 offset:49312
    ds_read_b64_tr_b16 v[122:123], v93 offset:50080
    s_waitcnt lgkmcnt(8)
    v_mfma_f32_16x16x32_bf16 v[168:171], v[104:107], v[76:79], v[168:171]
    s_waitcnt lgkmcnt(6)
    v_mfma_f32_16x16x32_bf16 v[172:175], v[108:111], v[76:79], v[172:175]
    s_waitcnt lgkmcnt(4)
    v_mfma_f32_16x16x32_bf16 v[176:179], v[112:115], v[76:79], v[176:179]
    s_waitcnt lgkmcnt(2)
    v_mfma_f32_16x16x32_bf16 v[180:183], v[116:119], v[76:79], v[180:183]
    s_waitcnt lgkmcnt(0)
    v_mfma_f32_16x16x32_bf16 v[184:187], v[120:123], v[76:79], v[184:187]
    s_add_u32 s16, s12, 4194304
    s_addc_u32 s17, s13, 0
    s_mov_b32 s18, 2359296
    s_mov_b32 s19, 0x20000
    v_and_b32 v2, 15, v1
    v_mul_u32_u24 v2, 1152, v2
    v_lshl_add_u32 v2, v5, 3, v2
    s_mul_i32 s26, s25, 18432
    s_mul_i32 s27, s24, 192
    s_add_u32 s26, s26, s27
    s_mov_b32 s27, 0x3eae1a93
    v_mul_f32 v164, s27, v164
    v_mul_f32 v165, s27, v165
    v_mul_f32 v166, s27, v166
    v_mul_f32 v167, s27, v167
    v_cvt_pk_bf16_f32 v164, v164, v165
    v_cvt_pk_bf16_f32 v165, v166, v167
    buffer_store_dwordx2 v[164:165], v2, s[16:19], s26 offen offset:0
    v_mul_f32 v168, s27, v168
    v_mul_f32 v169, s27, v169
    v_mul_f32 v170, s27, v170
    v_mul_f32 v171, s27, v171
    v_cvt_pk_bf16_f32 v168, v168, v169
    v_cvt_pk_bf16_f32 v169, v170, v171
    buffer_store_dwordx2 v[168:169], v2, s[16:19], s26 offen offset:32
    v_mul_f32 v172, s27, v172
    v_mul_f32 v173, s27, v173
    v_mul_f32 v174, s27, v174
    v_mul_f32 v175, s27, v175
    v_cvt_pk_bf16_f32 v172, v172, v173
    v_cvt_pk_bf16_f32 v173, v174, v175
    buffer_store_dwordx2 v[172:173], v2, s[16:19], s26 offen offset:64
    v_mul_f32 v176, s27, v176
    v_mul_f32 v177, s27, v177
    v_mul_f32 v178, s27, v178
    v_mul_f32 v179, s27, v179
    v_cvt_pk_bf16_f32 v176, v176, v177
    v_cvt_pk_bf16_f32 v177, v178, v179
    buffer_store_dwordx2 v[176:177], v2, s[16:19], s26 offen offset:96
    v_mul_f32 v180, s27, v180
    v_mul_f32 v181, s27, v181
    v_mul_f32 v182, s27, v182
    v_mul_f32 v183, s27, v183
    v_cvt_pk_bf16_f32 v180, v180, v181
    v_cvt_pk_bf16_f32 v181, v182, v183
    buffer_store_dwordx2 v[180:181], v2, s[16:19], s26 offen offset:128
    v_mul_f32 v184, s27, v184
    v_mul_f32 v185, s27, v185
    v_mul_f32 v186, s27, v186
    v_mul_f32 v187, s27, v187
    v_cvt_pk_bf16_f32 v184, v184, v185
    v_cvt_pk_bf16_f32 v185, v186, v187
    buffer_store_dwordx2 v[184:185], v2, s[16:19], s26 offen offset:160
    s_endpgm
K2_KV:
    v_mul_u32_u24 v81, 48, v7
    v_add_u32 v81, v81, v87
    s_waitcnt vmcnt(0)
    s_barrier
    ds_read_b128 v[124:127], v6 offset:0
    ds_read_b128 v[128:131], v6 offset:16
    ds_read_b128 v[132:135], v6 offset:2304
    ds_read_b128 v[136:139], v6 offset:2320
    ds_read_b128 v[140:143], v6 offset:128
    ds_read_b128 v[144:147], v6 offset:144
    ds_read_b128 v[148:151], v6 offset:2432
    ds_read_b128 v[152:155], v6 offset:2448
    ds_read_b64_tr_b16 v[100:101], v81 offset:0
    ds_read_b64_tr_b16 v[102:103], v81 offset:192
    ds_read_b64_tr_b16 v[104:105], v81 offset:32
    ds_read_b64_tr_b16 v[106:107], v81 offset:224
    ds_read_b64_tr_b16 v[108:109], v81 offset:27776
    ds_read_b64_tr_b16 v[110:111], v81 offset:27968
    ds_read_b64_tr_b16 v[112:113], v81 offset:27808
    ds_read_b64_tr_b16 v[114:115], v81 offset:28000
    s_waitcnt lgkmcnt(12)
    v_lshlrev_b32 v156, 16, v8
    v_and_b32 v157, s30, v8
    v_pk_fma_f32 v[156:157], v[156:157], v[124:125], v[132:133]
    v_cvt_pk_bf16_f32 v8, v156, v157
    v_lshlrev_b32 v158, 16, v9
    v_and_b32 v159, s30, v9
    v_pk_fma_f32 v[158:159], v[158:159], v[126:127], v[134:135]
    v_cvt_pk_bf16_f32 v9, v158, v159
    v_lshlrev_b32 v160, 16, v10
    v_and_b32 v161, s30, v10
    v_pk_fma_f32 v[160:161], v[160:161], v[128:129], v[136:137]
    v_cvt_pk_bf16_f32 v10, v160, v161
    v_lshlrev_b32 v162, 16, v11
    v_and_b32 v163, s30, v11
    v_pk_fma_f32 v[162:163], v[162:163], v[130:131], v[138:139]
    v_cvt_pk_bf16_f32 v11, v162, v163
    ds_read_b64_tr_b16 v[116:117], v81 offset:1536
    ds_read_b64_tr_b16 v[118:119], v81 offset:1728
    s_waitcnt lgkmcnt(8)
    v_mfma_f32_16x16x32_bf16 v[164:167], v[100:103], v[8:11], 0
    v_lshlrev_b32 v156, 16, v12
    v_and_b32 v157, s30, v12
    v_pk_fma_f32 v[156:157], v[156:157], v[140:141], v[148:149]
    v_cvt_pk_bf16_f32 v12, v156, v157
    v_lshlrev_b32 v158, 16, v13
    v_and_b32 v159, s30, v13
    v_pk_fma_f32 v[158:159], v[158:159], v[142:143], v[150:151]
    v_cvt_pk_bf16_f32 v13, v158, v159
    v_lshlrev_b32 v160, 16, v14
    v_and_b32 v161, s30, v14
    v_pk_fma_f32 v[160:161], v[160:161], v[144:145], v[152:153]
    v_cvt_pk_bf16_f32 v14, v160, v161
    v_lshlrev_b32 v162, 16, v15
    v_and_b32 v163, s30, v15
    v_pk_fma_f32 v[162:163], v[162:163], v[146:147], v[154:155]
    v_cvt_pk_bf16_f32 v15, v162, v163
    ds_read_b128 v[124:127], v6 offset:256
    ds_read_b128 v[128:131], v6 offset:272
    ds_read_b128 v[132:135], v6 offset:2560
    ds_read_b128 v[136:139], v6 offset:2576
    ds_read_b64_tr_b16 v[120:121], v81 offset:1568
    ds_read_b64_tr_b16 v[122:123], v81 offset:1760
    s_waitcnt lgkmcnt(12)
    v_mfma_f32_16x16x32_bf16 v[168:171], v[104:107], v[8:11], 0
    ds_read_b64_tr_b16 v[100:101], v81 offset:29312
    ds_read_b64_tr_b16 v[102:103], v81 offset:29504
    s_waitcnt lgkmcnt(12)
    v_mfma_f32_16x16x32_bf16 v[172:175], v[8:11], v[108:111], 0
    ds_read_b64_tr_b16 v[104:105], v81 offset:29344
    ds_read_b64_tr_b16 v[106:107], v81 offset:29536
    s_waitcnt lgkmcnt(12)
    v_mfma_f32_16x16x32_bf16 v[176:179], v[8:11], v[112:115], 0
    ds_read_b64_tr_b16 v[108:109], v81 offset:3072
    ds_read_b64_tr_b16 v[110:111], v81 offset:3264
    s_waitcnt lgkmcnt(12)
    v_mfma_f32_16x16x32_bf16 v[164:167], v[116:119], v[12:15], v[164:167]
    s_waitcnt lgkmcnt(8)
    v_lshlrev_b32 v156, 16, v16
    v_and_b32 v157, s30, v16
    v_pk_fma_f32 v[156:157], v[156:157], v[124:125], v[132:133]
    v_cvt_pk_bf16_f32 v16, v156, v157
    v_lshlrev_b32 v158, 16, v17
    v_and_b32 v159, s30, v17
    v_pk_fma_f32 v[158:159], v[158:159], v[126:127], v[134:135]
    v_cvt_pk_bf16_f32 v17, v158, v159
    v_lshlrev_b32 v160, 16, v18
    v_and_b32 v161, s30, v18
    v_pk_fma_f32 v[160:161], v[160:161], v[128:129], v[136:137]
    v_cvt_pk_bf16_f32 v18, v160, v161
    v_lshlrev_b32 v162, 16, v19
    v_and_b32 v163, s30, v19
    v_pk_fma_f32 v[162:163], v[162:163], v[130:131], v[138:139]
    v_cvt_pk_bf16_f32 v19, v162, v163
    ds_read_b128 v[140:143], v6 offset:384
    ds_read_b128 v[144:147], v6 offset:400
    ds_read_b128 v[148:151], v6 offset:2688
    ds_read_b128 v[152:155], v6 offset:2704
    ds_read_b64_tr_b16 v[112:113], v81 offset:3104
    ds_read_b64_tr_b16 v[114:115], v81 offset:3296
    s_waitcnt lgkmcnt(12)
    v_mfma_f32_16x16x32_bf16 v[168:171], v[120:123], v[12:15], v[168:171]
    ds_read_b64_tr_b16 v[116:117], v81 offset:30848
    ds_read_b64_tr_b16 v[118:119], v81 offset:31040
    s_waitcnt lgkmcnt(12)
    v_mfma_f32_16x16x32_bf16 v[172:175], v[12:15], v[100:103], v[172:175]
    ds_read_b64_tr_b16 v[120:121], v81 offset:30880
    ds_read_b64_tr_b16 v[122:123], v81 offset:31072
    s_waitcnt lgkmcnt(12)
    v_mfma_f32_16x16x32_bf16 v[176:179], v[12:15], v[104:107], v[176:179]
    ds_read_b64_tr_b16 v[100:101], v81 offset:4608
    ds_read_b64_tr_b16 v[102:103], v81 offset:4800
    s_waitcnt lgkmcnt(12)
    v_mfma_f32_16x16x32_bf16 v[164:167], v[108:111], v[16:19], v[164:167]
    s_waitcnt lgkmcnt(8)
    v_lshlrev_b32 v156, 16, v20
    v_and_b32 v157, s30, v20
    v_pk_fma_f32 v[156:157], v[156:157], v[140:141], v[148:149]
    v_cvt_pk_bf16_f32 v20, v156, v157
    v_lshlrev_b32 v158, 16, v21
    v_and_b32 v159, s30, v21
    v_pk_fma_f32 v[158:159], v[158:159], v[142:143], v[150:151]
    v_cvt_pk_bf16_f32 v21, v158, v159
    v_lshlrev_b32 v160, 16, v22
    v_and_b32 v161, s30, v22
    v_pk_fma_f32 v[160:161], v[160:161], v[144:145], v[152:153]
    v_cvt_pk_bf16_f32 v22, v160, v161
    v_lshlrev_b32 v162, 16, v23
    v_and_b32 v163, s30, v23
    v_pk_fma_f32 v[162:163], v[162:163], v[146:147], v[154:155]
    v_cvt_pk_bf16_f32 v23, v162, v163
    ds_read_b128 v[124:127], v6 offset:512
    ds_read_b128 v[128:131], v6 offset:528
    ds_read_b128 v[132:135], v6 offset:2816
    ds_read_b128 v[136:139], v6 offset:2832
    ds_read_b64_tr_b16 v[104:105], v81 offset:4640
    ds_read_b64_tr_b16 v[106:107], v81 offset:4832
    s_waitcnt lgkmcnt(12)
    v_mfma_f32_16x16x32_bf16 v[168:171], v[112:115], v[16:19], v[168:171]
    ds_read_b64_tr_b16 v[108:109], v81 offset:32384
    ds_read_b64_tr_b16 v[110:111], v81 offset:32576
    s_waitcnt lgkmcnt(12)
    v_mfma_f32_16x16x32_bf16 v[172:175], v[16:19], v[116:119], v[172:175]
    ds_read_b64_tr_b16 v[112:113], v81 offset:32416
    ds_read_b64_tr_b16 v[114:115], v81 offset:32608
    s_waitcnt lgkmcnt(12)
    v_mfma_f32_16x16x32_bf16 v[176:179], v[16:19], v[120:123], v[176:179]
    ds_read_b64_tr_b16 v[116:117], v81 offset:6144
    ds_read_b64_tr_b16 v[118:119], v81 offset:6336
    s_waitcnt lgkmcnt(12)
    v_mfma_f32_16x16x32_bf16 v[164:167], v[100:103], v[20:23], v[164:167]
    s_waitcnt lgkmcnt(8)
    v_lshlrev_b32 v156, 16, v24
    v_and_b32 v157, s30, v24
    v_pk_fma_f32 v[156:157], v[156:157], v[124:125], v[132:133]
    v_cvt_pk_bf16_f32 v24, v156, v157
    v_lshlrev_b32 v158, 16, v25
    v_and_b32 v159, s30, v25
    v_pk_fma_f32 v[158:159], v[158:159], v[126:127], v[134:135]
    v_cvt_pk_bf16_f32 v25, v158, v159
    v_lshlrev_b32 v160, 16, v26
    v_and_b32 v161, s30, v26
    v_pk_fma_f32 v[160:161], v[160:161], v[128:129], v[136:137]
    v_cvt_pk_bf16_f32 v26, v160, v161
    v_lshlrev_b32 v162, 16, v27
    v_and_b32 v163, s30, v27
    v_pk_fma_f32 v[162:163], v[162:163], v[130:131], v[138:139]
    v_cvt_pk_bf16_f32 v27, v162, v163
    ds_read_b128 v[140:143], v6 offset:640
    ds_read_b128 v[144:147], v6 offset:656
    ds_read_b128 v[148:151], v6 offset:2944
    ds_read_b128 v[152:155], v6 offset:2960
    ds_read_b64_tr_b16 v[120:121], v81 offset:6176
    ds_read_b64_tr_b16 v[122:123], v81 offset:6368
    s_waitcnt lgkmcnt(12)
    v_mfma_f32_16x16x32_bf16 v[168:171], v[104:107], v[20:23], v[168:171]
    ds_read_b64_tr_b16 v[100:101], v81 offset:33920
    ds_read_b64_tr_b16 v[102:103], v81 offset:34112
    s_waitcnt lgkmcnt(12)
    v_mfma_f32_16x16x32_bf16 v[172:175], v[20:23], v[108:111], v[172:175]
    ds_read_b64_tr_b16 v[104:105], v81 offset:33952
    ds_read_b64_tr_b16 v[106:107], v81 offset:34144
    s_waitcnt lgkmcnt(12)
    v_mfma_f32_16x16x32_bf16 v[176:179], v[20:23], v[112:115], v[176:179]
    ds_read_b64_tr_b16 v[108:109], v81 offset:7680
    ds_read_b64_tr_b16 v[110:111], v81 offset:7872
    s_waitcnt lgkmcnt(12)
    v_mfma_f32_16x16x32_bf16 v[164:167], v[116:119], v[24:27], v[164:167]
    s_waitcnt lgkmcnt(8)
    v_lshlrev_b32 v156, 16, v28
    v_and_b32 v157, s30, v28
    v_pk_fma_f32 v[156:157], v[156:157], v[140:141], v[148:149]
    v_cvt_pk_bf16_f32 v28, v156, v157
    v_lshlrev_b32 v158, 16, v29
    v_and_b32 v159, s30, v29
    v_pk_fma_f32 v[158:159], v[158:159], v[142:143], v[150:151]
    v_cvt_pk_bf16_f32 v29, v158, v159
    v_lshlrev_b32 v160, 16, v30
    v_and_b32 v161, s30, v30
    v_pk_fma_f32 v[160:161], v[160:161], v[144:145], v[152:153]
    v_cvt_pk_bf16_f32 v30, v160, v161
    v_lshlrev_b32 v162, 16, v31
    v_and_b32 v163, s30, v31
    v_pk_fma_f32 v[162:163], v[162:163], v[146:147], v[154:155]
    v_cvt_pk_bf16_f32 v31, v162, v163
    ds_read_b128 v[124:127], v6 offset:768
    ds_read_b128 v[128:131], v6 offset:784
    ds_read_b128 v[132:135], v6 offset:3072
    ds_read_b128 v[136:139], v6 offset:3088
    ds_read_b64_tr_b16 v[112:113], v81 offset:7712
    ds_read_b64_tr_b16 v[114:115], v81 offset:7904
    s_waitcnt lgkmcnt(12)
    v_mfma_f32_16x16x32_bf16 v[168:171], v[120:123], v[24:27], v[168:171]
    ds_read_b64_tr_b16 v[116:117], v81 offset:35456
    ds_read_b64_tr_b16 v[118:119], v81 offset:35648
    s_waitcnt lgkmcnt(12)
    v_mfma_f32_16x16x32_bf16 v[172:175], v[24:27], v[100:103], v[172:175]
    ds_read_b64_tr_b16 v[120:121], v81 offset:35488
    ds_read_b64_tr_b16 v[122:123], v81 offset:35680
    s_waitcnt lgkmcnt(12)
    v_mfma_f32_16x16x32_bf16 v[176:179], v[24:27], v[104:107], v[176:179]
    ds_read_b64_tr_b16 v[100:101], v81 offset:9216
    ds_read_b64_tr_b16 v[102:103], v81 offset:9408
    s_waitcnt lgkmcnt(12)
    v_mfma_f32_16x16x32_bf16 v[164:167], v[108:111], v[28:31], v[164:167]
    s_waitcnt lgkmcnt(8)
    v_lshlrev_b32 v156, 16, v32
    v_and_b32 v157, s30, v32
    v_pk_fma_f32 v[156:157], v[156:157], v[124:125], v[132:133]
    v_cvt_pk_bf16_f32 v32, v156, v157
    v_lshlrev_b32 v158, 16, v33
    v_and_b32 v159, s30, v33
    v_pk_fma_f32 v[158:159], v[158:159], v[126:127], v[134:135]
    v_cvt_pk_bf16_f32 v33, v158, v159
    v_lshlrev_b32 v160, 16, v34
    v_and_b32 v161, s30, v34
    v_pk_fma_f32 v[160:161], v[160:161], v[128:129], v[136:137]
    v_cvt_pk_bf16_f32 v34, v160, v161
    v_lshlrev_b32 v162, 16, v35
    v_and_b32 v163, s30, v35
    v_pk_fma_f32 v[162:163], v[162:163], v[130:131], v[138:139]
    v_cvt_pk_bf16_f32 v35, v162, v163
    ds_read_b128 v[140:143], v6 offset:896
    ds_read_b128 v[144:147], v6 offset:912
    ds_read_b128 v[148:151], v6 offset:3200
    ds_read_b128 v[152:155], v6 offset:3216
    ds_read_b64_tr_b16 v[104:105], v81 offset:9248
    ds_read_b64_tr_b16 v[106:107], v81 offset:9440
    s_waitcnt lgkmcnt(12)
    v_mfma_f32_16x16x32_bf16 v[168:171], v[112:115], v[28:31], v[168:171]
    ds_read_b64_tr_b16 v[108:109], v81 offset:36992
    ds_read_b64_tr_b16 v[110:111], v81 offset:37184
    s_waitcnt lgkmcnt(12)
    v_mfma_f32_16x16x32_bf16 v[172:175], v[28:31], v[116:119], v[172:175]
    ds_read_b64_tr_b16 v[112:113], v81 offset:37024
    ds_read_b64_tr_b16 v[114:115], v81 offset:37216
    s_waitcnt lgkmcnt(12)
    v_mfma_f32_16x16x32_bf16 v[176:179], v[28:31], v[120:123], v[176:179]
    ds_read_b64_tr_b16 v[116:117], v81 offset:10752
    ds_read_b64_tr_b16 v[118:119], v81 offset:10944
    s_waitcnt lgkmcnt(12)
    v_mfma_f32_16x16x32_bf16 v[164:167], v[100:103], v[32:35], v[164:167]
    s_waitcnt lgkmcnt(8)
    v_lshlrev_b32 v156, 16, v36
    v_and_b32 v157, s30, v36
    v_pk_fma_f32 v[156:157], v[156:157], v[140:141], v[148:149]
    v_cvt_pk_bf16_f32 v36, v156, v157
    v_lshlrev_b32 v158, 16, v37
    v_and_b32 v159, s30, v37
    v_pk_fma_f32 v[158:159], v[158:159], v[142:143], v[150:151]
    v_cvt_pk_bf16_f32 v37, v158, v159
    v_lshlrev_b32 v160, 16, v38
    v_and_b32 v161, s30, v38
    v_pk_fma_f32 v[160:161], v[160:161], v[144:145], v[152:153]
    v_cvt_pk_bf16_f32 v38, v160, v161
    v_lshlrev_b32 v162, 16, v39
    v_and_b32 v163, s30, v39
    v_pk_fma_f32 v[162:163], v[162:163], v[146:147], v[154:155]
    v_cvt_pk_bf16_f32 v39, v162, v163
    ds_read_b128 v[124:127], v6 offset:1024
    ds_read_b128 v[128:131], v6 offset:1040
    ds_read_b128 v[132:135], v6 offset:3328
    ds_read_b128 v[136:139], v6 offset:3344
    ds_read_b64_tr_b16 v[120:121], v81 offset:10784
    ds_read_b64_tr_b16 v[122:123], v81 offset:10976
    s_waitcnt lgkmcnt(12)
    v_mfma_f32_16x16x32_bf16 v[168:171], v[104:107], v[32:35], v[168:171]
    ds_read_b64_tr_b16 v[100:101], v81 offset:38528
    ds_read_b64_tr_b16 v[102:103], v81 offset:38720
    s_waitcnt lgkmcnt(12)
    v_mfma_f32_16x16x32_bf16 v[172:175], v[32:35], v[108:111], v[172:175]
    ds_read_b64_tr_b16 v[104:105], v81 offset:38560
    ds_read_b64_tr_b16 v[106:107], v81 offset:38752
    s_waitcnt lgkmcnt(12)
    v_mfma_f32_16x16x32_bf16 v[176:179], v[32:35], v[112:115], v[176:179]
    ds_read_b64_tr_b16 v[108:109], v81 offset:12288
    ds_read_b64_tr_b16 v[110:111], v81 offset:12480
    s_waitcnt lgkmcnt(12)
    v_mfma_f32_16x16x32_bf16 v[164:167], v[116:119], v[36:39], v[164:167]
    s_waitcnt lgkmcnt(8)
    v_lshlrev_b32 v156, 16, v40
    v_and_b32 v157, s30, v40
    v_pk_fma_f32 v[156:157], v[156:157], v[124:125], v[132:133]
    v_cvt_pk_bf16_f32 v40, v156, v157
    v_lshlrev_b32 v158, 16, v41
    v_and_b32 v159, s30, v41
    v_pk_fma_f32 v[158:159], v[158:159], v[126:127], v[134:135]
    v_cvt_pk_bf16_f32 v41, v158, v159
    v_lshlrev_b32 v160, 16, v42
    v_and_b32 v161, s30, v42
    v_pk_fma_f32 v[160:161], v[160:161], v[128:129], v[136:137]
    v_cvt_pk_bf16_f32 v42, v160, v161
    v_lshlrev_b32 v162, 16, v43
    v_and_b32 v163, s30, v43
    v_pk_fma_f32 v[162:163], v[162:163], v[130:131], v[138:139]
    v_cvt_pk_bf16_f32 v43, v162, v163
    ds_read_b128 v[140:143], v6 offset:1152
    ds_read_b128 v[144:147], v6 offset:1168
    ds_read_b128 v[148:151], v6 offset:3456
    ds_read_b128 v[152:155], v6 offset:3472
    ds_read_b64_tr_b16 v[112:113], v81 offset:12320
    ds_read_b64_tr_b16 v[114:115], v81 offset:12512
    s_waitcnt lgkmcnt(12)
    v_mfma_f32_16x16x32_bf16 v[168:171], v[120:123], v[36:39], v[168:171]
    ds_read_b64_tr_b16 v[116:117], v81 offset:40064
    ds_read_b64_tr_b16 v[118:119], v81 offset:40256
    s_waitcnt lgkmcnt(12)
    v_mfma_f32_16x16x32_bf16 v[172:175], v[36:39], v[100:103], v[172:175]
    ds_read_b64_tr_b16 v[120:121], v81 offset:40096
    ds_read_b64_tr_b16 v[122:123], v81 offset:40288
    s_waitcnt lgkmcnt(12)
    v_mfma_f32_16x16x32_bf16 v[176:179], v[36:39], v[104:107], v[176:179]
    ds_read_b64_tr_b16 v[100:101], v81 offset:13824
    ds_read_b64_tr_b16 v[102:103], v81 offset:14016
    s_waitcnt lgkmcnt(12)
    v_mfma_f32_16x16x32_bf16 v[164:167], v[108:111], v[40:43], v[164:167]
    s_waitcnt lgkmcnt(8)
    v_lshlrev_b32 v156, 16, v44
    v_and_b32 v157, s30, v44
    v_pk_fma_f32 v[156:157], v[156:157], v[140:141], v[148:149]
    v_cvt_pk_bf16_f32 v44, v156, v157
    v_lshlrev_b32 v158, 16, v45
    v_and_b32 v159, s30, v45
    v_pk_fma_f32 v[158:159], v[158:159], v[142:143], v[150:151]
    v_cvt_pk_bf16_f32 v45, v158, v159
    v_lshlrev_b32 v160, 16, v46
    v_and_b32 v161, s30, v46
    v_pk_fma_f32 v[160:161], v[160:161], v[144:145], v[152:153]
    v_cvt_pk_bf16_f32 v46, v160, v161
    v_lshlrev_b32 v162, 16, v47
    v_and_b32 v163, s30, v47
    v_pk_fma_f32 v[162:163], v[162:163], v[146:147], v[154:155]
    v_cvt_pk_bf16_f32 v47, v162, v163
    ds_read_b128 v[124:127], v6 offset:1280
    ds_read_b128 v[128:131], v6 offset:1296
    ds_read_b128 v[132:135], v6 offset:3584
    ds_read_b128 v[136:139], v6 offset:3600
    ds_read_b64_tr_b16 v[104:105], v81 offset:13856
    ds_read_b64_tr_b16 v[106:107], v81 offset:14048
    s_waitcnt lgkmcnt(12)
    v_mfma_f32_16x16x32_bf16 v[168:171], v[112:115], v[40:43], v[168:171]
    ds_read_b64_tr_b16 v[108:109], v81 offset:41600
    ds_read_b64_tr_b16 v[110:111], v81 offset:41792
    s_waitcnt lgkmcnt(12)
    v_mfma_f32_16x16x32_bf16 v[172:175], v[40:43], v[116:119], v[172:175]
    ds_read_b64_tr_b16 v[112:113], v81 offset:41632
    ds_read_b64_tr_b16 v[114:115], v81 offset:41824
    s_waitcnt lgkmcnt(12)
    v_mfma_f32_16x16x32_bf16 v[176:179], v[40:43], v[120:123], v[176:179]
    ds_read_b64_tr_b16 v[116:117], v81 offset:15360
    ds_read_b64_tr_b16 v[118:119], v81 offset:15552
    s_waitcnt lgkmcnt(12)
    v_mfma_f32_16x16x32_bf16 v[164:167], v[100:103], v[44:47], v[164:167]
    s_waitcnt lgkmcnt(8)
    v_lshlrev_b32 v156, 16, v48
    v_and_b32 v157, s30, v48
    v_pk_fma_f32 v[156:157], v[156:157], v[124:125], v[132:133]
    v_cvt_pk_bf16_f32 v48, v156, v157
    v_lshlrev_b32 v158, 16, v49
    v_and_b32 v159, s30, v49
    v_pk_fma_f32 v[158:159], v[158:159], v[126:127], v[134:135]
    v_cvt_pk_bf16_f32 v49, v158, v159
    v_lshlrev_b32 v160, 16, v50
    v_and_b32 v161, s30, v50
    v_pk_fma_f32 v[160:161], v[160:161], v[128:129], v[136:137]
    v_cvt_pk_bf16_f32 v50, v160, v161
    v_lshlrev_b32 v162, 16, v51
    v_and_b32 v163, s30, v51
    v_pk_fma_f32 v[162:163], v[162:163], v[130:131], v[138:139]
    v_cvt_pk_bf16_f32 v51, v162, v163
    ds_read_b128 v[140:143], v6 offset:1408
    ds_read_b128 v[144:147], v6 offset:1424
    ds_read_b128 v[148:151], v6 offset:3712
    ds_read_b128 v[152:155], v6 offset:3728
    ds_read_b64_tr_b16 v[120:121], v81 offset:15392
    ds_read_b64_tr_b16 v[122:123], v81 offset:15584
    s_waitcnt lgkmcnt(12)
    v_mfma_f32_16x16x32_bf16 v[168:171], v[104:107], v[44:47], v[168:171]
    ds_read_b64_tr_b16 v[100:101], v81 offset:43136
    ds_read_b64_tr_b16 v[102:103], v81 offset:43328
    s_waitcnt lgkmcnt(12)
    v_mfma_f32_16x16x32_bf16 v[172:175], v[44:47], v[108:111], v[172:175]
    ds_read_b64_tr_b16 v[104:105], v81 offset:43168
    ds_read_b64_tr_b16 v[106:107], v81 offset:43360
    s_waitcnt lgkmcnt(12)
    v_mfma_f32_16x16x32_bf16 v[176:179], v[44:47], v[112:115], v[176:179]
    ds_read_b64_tr_b16 v[108:109], v81 offset:16896
    ds_read_b64_tr_b16 v[110:111], v81 offset:17088
    s_waitcnt lgkmcnt(12)
    v_mfma_f32_16x16x32_bf16 v[164:167], v[116:119], v[48:51], v[164:167]
    s_waitcnt lgkmcnt(8)
    v_lshlrev_b32 v156, 16, v52
    v_and_b32 v157, s30, v52
    v_pk_fma_f32 v[156:157], v[156:157], v[140:141], v[148:149]
    v_cvt_pk_bf16_f32 v52, v156, v157
    v_lshlrev_b32 v158, 16, v53
    v_and_b32 v159, s30, v53
    v_pk_fma_f32 v[158:159], v[158:159], v[142:143], v[150:151]
    v_cvt_pk_bf16_f32 v53, v158, v159
    v_lshlrev_b32 v160, 16, v54
    v_and_b32 v161, s30, v54
    v_pk_fma_f32 v[160:161], v[160:161], v[144:145], v[152:153]
    v_cvt_pk_bf16_f32 v54, v160, v161
    v_lshlrev_b32 v162, 16, v55
    v_and_b32 v163, s30, v55
    v_pk_fma_f32 v[162:163], v[162:163], v[146:147], v[154:155]
    v_cvt_pk_bf16_f32 v55, v162, v163
    ds_read_b128 v[124:127], v6 offset:1536
    ds_read_b128 v[128:131], v6 offset:1552
    ds_read_b128 v[132:135], v6 offset:3840
    ds_read_b128 v[136:139], v6 offset:3856
    ds_read_b64_tr_b16 v[112:113], v81 offset:16928
    ds_read_b64_tr_b16 v[114:115], v81 offset:17120
    s_waitcnt lgkmcnt(12)
    v_mfma_f32_16x16x32_bf16 v[168:171], v[120:123], v[48:51], v[168:171]
    ds_read_b64_tr_b16 v[116:117], v81 offset:44672
    ds_read_b64_tr_b16 v[118:119], v81 offset:44864
    s_waitcnt lgkmcnt(12)
    v_mfma_f32_16x16x32_bf16 v[172:175], v[48:51], v[100:103], v[172:175]
    ds_read_b64_tr_b16 v[120:121], v81 offset:44704
    ds_read_b64_tr_b16 v[122:123], v81 offset:44896
    s_waitcnt lgkmcnt(12)
    v_mfma_f32_16x16x32_bf16 v[176:179], v[48:51], v[104:107], v[176:179]
    ds_read_b64_tr_b16 v[100:101], v81 offset:18432
    ds_read_b64_tr_b16 v[102:103], v81 offset:18624
    s_waitcnt lgkmcnt(12)
    v_mfma_f32_16x16x32_bf16 v[164:167], v[108:111], v[52:55], v[164:167]
    s_waitcnt lgkmcnt(8)
    v_lshlrev_b32 v156, 16, v56
    v_and_b32 v157, s30, v56
    v_pk_fma_f32 v[156:157], v[156:157], v[124:125], v[132:133]
    v_cvt_pk_bf16_f32 v56, v156, v157
    v_lshlrev_b32 v158, 16, v57
    v_and_b32 v159, s30, v57
    v_pk_fma_f32 v[158:159], v[158:159], v[126:127], v[134:135]
    v_cvt_pk_bf16_f32 v57, v158, v159
    v_lshlrev_b32 v160, 16, v58
    v_and_b32 v161, s30, v58
    v_pk_fma_f32 v[160:161], v[160:161], v[128:129], v[136:137]
    v_cvt_pk_bf16_f32 v58, v160, v161
    v_lshlrev_b32 v162, 16, v59
    v_and_b32 v163, s30, v59
    v_pk_fma_f32 v[162:163], v[162:163], v[130:131], v[138:139]
    v_cvt_pk_bf16_f32 v59, v162, v163
    ds_read_b128 v[140:143], v6 offset:1664
    ds_read_b128 v[144:147], v6 offset:1680
    ds_read_b128 v[148:151], v6 offset:3968
    ds_read_b128 v[152:155], v6 offset:3984
    ds_read_b64_tr_b16 v[104:105], v81 offset:18464
    ds_read_b64_tr_b16 v[106:107], v81 offset:18656
    s_waitcnt lgkmcnt(12)
    v_mfma_f32_16x16x32_bf16 v[168:171], v[112:115], v[52:55], v[168:171]
    ds_read_b64_tr_b16 v[108:109], v81 offset:46208
    ds_read_b64_tr_b16 v[110:111], v81 offset:46400
    s_waitcnt lgkmcnt(12)
    v_mfma_f32_16x16x32_bf16 v[172:175], v[52:55], v[116:119], v[172:175]
    ds_read_b64_tr_b16 v[112:113], v81 offset:46240
    ds_read_b64_tr_b16 v[114:115], v81 offset:46432
    s_waitcnt lgkmcnt(12)
    v_mfma_f32_16x16x32_bf16 v[176:179], v[52:55], v[120:123], v[176:179]
    ds_read_b64_tr_b16 v[116:117], v81 offset:19968
    ds_read_b64_tr_b16 v[118:119], v81 offset:20160
    s_waitcnt lgkmcnt(12)
    v_mfma_f32_16x16x32_bf16 v[164:167], v[100:103], v[56:59], v[164:167]
    s_waitcnt lgkmcnt(8)
    v_lshlrev_b32 v156, 16, v60
    v_and_b32 v157, s30, v60
    v_pk_fma_f32 v[156:157], v[156:157], v[140:141], v[148:149]
    v_cvt_pk_bf16_f32 v60, v156, v157
    v_lshlrev_b32 v158, 16, v61
    v_and_b32 v159, s30, v61
    v_pk_fma_f32 v[158:159], v[158:159], v[142:143], v[150:151]
    v_cvt_pk_bf16_f32 v61, v158, v159
    v_lshlrev_b32 v160, 16, v62
    v_and_b32 v161, s30, v62
    v_pk_fma_f32 v[160:161], v[160:161], v[144:145], v[152:153]
    v_cvt_pk_bf16_f32 v62, v160, v161
    v_lshlrev_b32 v162, 16, v63
    v_and_b32 v163, s30, v63
    v_pk_fma_f32 v[162:163], v[162:163], v[146:147], v[154:155]
    v_cvt_pk_bf16_f32 v63, v162, v163
    ds_read_b128 v[124:127], v6 offset:1792
    ds_read_b128 v[128:131], v6 offset:1808
    ds_read_b128 v[132:135], v6 offset:4096
    ds_read_b128 v[136:139], v6 offset:4112
    ds_read_b64_tr_b16 v[120:121], v81 offset:20000
    ds_read_b64_tr_b16 v[122:123], v81 offset:20192
    s_waitcnt lgkmcnt(12)
    v_mfma_f32_16x16x32_bf16 v[168:171], v[104:107], v[56:59], v[168:171]
    ds_read_b64_tr_b16 v[100:101], v81 offset:47744
    ds_read_b64_tr_b16 v[102:103], v81 offset:47936
    s_waitcnt lgkmcnt(12)
    v_mfma_f32_16x16x32_bf16 v[172:175], v[56:59], v[108:111], v[172:175]
    ds_read_b64_tr_b16 v[104:105], v81 offset:47776
    ds_read_b64_tr_b16 v[106:107], v81 offset:47968
    s_waitcnt lgkmcnt(12)
    v_mfma_f32_16x16x32_bf16 v[176:179], v[56:59], v[112:115], v[176:179]
    ds_read_b64_tr_b16 v[108:109], v81 offset:21504
    ds_read_b64_tr_b16 v[110:111], v81 offset:21696
    s_waitcnt lgkmcnt(12)
    v_mfma_f32_16x16x32_bf16 v[164:167], v[116:119], v[60:63], v[164:167]
    s_waitcnt lgkmcnt(8)
    v_lshlrev_b32 v156, 16, v64
    v_and_b32 v157, s30, v64
    v_pk_fma_f32 v[156:157], v[156:157], v[124:125], v[132:133]
    v_cvt_pk_bf16_f32 v64, v156, v157
    v_lshlrev_b32 v158, 16, v65
    v_and_b32 v159, s30, v65
    v_pk_fma_f32 v[158:159], v[158:159], v[126:127], v[134:135]
    v_cvt_pk_bf16_f32 v65, v158, v159
    v_lshlrev_b32 v160, 16, v66
    v_and_b32 v161, s30, v66
    v_pk_fma_f32 v[160:161], v[160:161], v[128:129], v[136:137]
    v_cvt_pk_bf16_f32 v66, v160, v161
    v_lshlrev_b32 v162, 16, v67
    v_and_b32 v163, s30, v67
    v_pk_fma_f32 v[162:163], v[162:163], v[130:131], v[138:139]
    v_cvt_pk_bf16_f32 v67, v162, v163
    ds_read_b128 v[140:143], v6 offset:1920
    ds_read_b128 v[144:147], v6 offset:1936
    ds_read_b128 v[148:151], v6 offset:4224
    ds_read_b128 v[152:155], v6 offset:4240
    ds_read_b64_tr_b16 v[112:113], v81 offset:21536
    ds_read_b64_tr_b16 v[114:115], v81 offset:21728
    s_waitcnt lgkmcnt(12)
    v_mfma_f32_16x16x32_bf16 v[168:171], v[120:123], v[60:63], v[168:171]
    ds_read_b64_tr_b16 v[116:117], v81 offset:49280
    ds_read_b64_tr_b16 v[118:119], v81 offset:49472
    s_waitcnt lgkmcnt(12)
    v_mfma_f32_16x16x32_bf16 v[172:175], v[60:63], v[100:103], v[172:175]
    ds_read_b64_tr_b16 v[120:121], v81 offset:49312
    ds_read_b64_tr_b16 v[122:123], v81 offset:49504
    s_waitcnt lgkmcnt(12)
    v_mfma_f32_16x16x32_bf16 v[176:179], v[60:63], v[104:107], v[176:179]
    ds_read_b64_tr_b16 v[100:101], v81 offset:23040
    ds_read_b64_tr_b16 v[102:103], v81 offset:23232
    s_waitcnt lgkmcnt(12)
    v_mfma_f32_16x16x32_bf16 v[164:167], v[108:111], v[64:67], v[164:167]
    s_waitcnt lgkmcnt(8)
    v_lshlrev_b32 v156, 16, v68
    v_and_b32 v157, s30, v68
    v_pk_fma_f32 v[156:157], v[156:157], v[140:141], v[148:149]
    v_cvt_pk_bf16_f32 v68, v156, v157
    v_lshlrev_b32 v158, 16, v69
    v_and_b32 v159, s30, v69
    v_pk_fma_f32 v[158:159], v[158:159], v[142:143], v[150:151]
    v_cvt_pk_bf16_f32 v69, v158, v159
    v_lshlrev_b32 v160, 16, v70
    v_and_b32 v161, s30, v70
    v_pk_fma_f32 v[160:161], v[160:161], v[144:145], v[152:153]
    v_cvt_pk_bf16_f32 v70, v160, v161
    v_lshlrev_b32 v162, 16, v71
    v_and_b32 v163, s30, v71
    v_pk_fma_f32 v[162:163], v[162:163], v[146:147], v[154:155]
    v_cvt_pk_bf16_f32 v71, v162, v163
    ds_read_b128 v[124:127], v6 offset:2048
    ds_read_b128 v[128:131], v6 offset:2064
    ds_read_b128 v[132:135], v6 offset:4352
    ds_read_b128 v[136:139], v6 offset:4368
    ds_read_b64_tr_b16 v[104:105], v81 offset:23072
    ds_read_b64_tr_b16 v[106:107], v81 offset:23264
    s_waitcnt lgkmcnt(12)
    v_mfma_f32_16x16x32_bf16 v[168:171], v[112:115], v[64:67], v[168:171]
    ds_read_b64_tr_b16 v[108:109], v81 offset:50816
    ds_read_b64_tr_b16 v[110:111], v81 offset:51008
    s_waitcnt lgkmcnt(12)
    v_mfma_f32_16x16x32_bf16 v[172:175], v[64:67], v[116:119], v[172:175]
    ds_read_b64_tr_b16 v[112:113], v81 offset:50848
    ds_read_b64_tr_b16 v[114:115], v81 offset:51040
    s_waitcnt lgkmcnt(12)
    v_mfma_f32_16x16x32_bf16 v[176:179], v[64:67], v[120:123], v[176:179]
    ds_read_b64_tr_b16 v[116:117], v81 offset:24576
    ds_read_b64_tr_b16 v[118:119], v81 offset:24768
    s_waitcnt lgkmcnt(12)
    v_mfma_f32_16x16x32_bf16 v[164:167], v[100:103], v[68:71], v[164:167]
    s_waitcnt lgkmcnt(8)
    v_lshlrev_b32 v156, 16, v72
    v_and_b32 v157, s30, v72
    v_pk_fma_f32 v[156:157], v[156:157], v[124:125], v[132:133]
    v_cvt_pk_bf16_f32 v72, v156, v157
    v_lshlrev_b32 v158, 16, v73
    v_and_b32 v159, s30, v73
    v_pk_fma_f32 v[158:159], v[158:159], v[126:127], v[134:135]
    v_cvt_pk_bf16_f32 v73, v158, v159
    v_lshlrev_b32 v160, 16, v74
    v_and_b32 v161, s30, v74
    v_pk_fma_f32 v[160:161], v[160:161], v[128:129], v[136:137]
    v_cvt_pk_bf16_f32 v74, v160, v161
    v_lshlrev_b32 v162, 16, v75
    v_and_b32 v163, s30, v75
    v_pk_fma_f32 v[162:163], v[162:163], v[130:131], v[138:139]
    v_cvt_pk_bf16_f32 v75, v162, v163
    ds_read_b128 v[140:143], v6 offset:2176
    ds_read_b128 v[144:147], v6 offset:2192
    ds_read_b128 v[148:151], v6 offset:4480
    ds_read_b128 v[152:155], v6 offset:4496
    ds_read_b64_tr_b16 v[120:121], v81 offset:24608
    ds_read_b64_tr_b16 v[122:123], v81 offset:24800
    s_waitcnt lgkmcnt(12)
    v_mfma_f32_16x16x32_bf16 v[168:171], v[104:107], v[68:71], v[168:171]
    ds_read_b64_tr_b16 v[100:101], v81 offset:52352
    ds_read_b64_tr_b16 v[102:103], v81 offset:52544
    s_waitcnt lgkmcnt(12)
    v_mfma_f32_16x16x32_bf16 v[172:175], v[68:71], v[108:111], v[172:175]
    ds_read_b64_tr_b16 v[104:105], v81 offset:52384
    ds_read_b64_tr_b16 v[106:107], v81 offset:52576
    s_waitcnt lgkmcnt(12)
    v_mfma_f32_16x16x32_bf16 v[176:179], v[68:71], v[112:115], v[176:179]
    ds_read_b64_tr_b16 v[108:109], v81 offset:26112
    ds_read_b64_tr_b16 v[110:111], v81 offset:26304
    s_waitcnt lgkmcnt(12)
    v_mfma_f32_16x16x32_bf16 v[164:167], v[116:119], v[72:75], v[164:167]
    s_waitcnt lgkmcnt(8)
    v_lshlrev_b32 v156, 16, v76
    v_and_b32 v157, s30, v76
    v_pk_fma_f32 v[156:157], v[156:157], v[140:141], v[148:149]
    v_cvt_pk_bf16_f32 v76, v156, v157
    v_lshlrev_b32 v158, 16, v77
    v_and_b32 v159, s30, v77
    v_pk_fma_f32 v[158:159], v[158:159], v[142:143], v[150:151]
    v_cvt_pk_bf16_f32 v77, v158, v159
    v_lshlrev_b32 v160, 16, v78
    v_and_b32 v161, s30, v78
    v_pk_fma_f32 v[160:161], v[160:161], v[144:145], v[152:153]
    v_cvt_pk_bf16_f32 v78, v160, v161
    v_lshlrev_b32 v162, 16, v79
    v_and_b32 v163, s30, v79
    v_pk_fma_f32 v[162:163], v[162:163], v[146:147], v[154:155]
    v_cvt_pk_bf16_f32 v79, v162, v163
    ds_read_b64_tr_b16 v[112:113], v81 offset:26144
    ds_read_b64_tr_b16 v[114:115], v81 offset:26336
    s_waitcnt lgkmcnt(8)
    v_mfma_f32_16x16x32_bf16 v[168:171], v[120:123], v[72:75], v[168:171]
    ds_read_b64_tr_b16 v[116:117], v81 offset:53888
    ds_read_b64_tr_b16 v[118:119], v81 offset:54080
    s_waitcnt lgkmcnt(8)
    v_mfma_f32_16x16x32_bf16 v[172:175], v[72:75], v[100:103], v[172:175]
    ds_read_b64_tr_b16 v[120:121], v81 offset:53920
    ds_read_b64_tr_b16 v[122:123], v81 offset:54112
    s_waitcnt lgkmcnt(8)
    v_mfma_f32_16x16x32_bf16 v[176:179], v[72:75], v[104:107], v[176:179]
    s_waitcnt lgkmcnt(6)
    v_mfma_f32_16x16x32_bf16 v[164:167], v[108:111], v[76:79], v[164:167]
    s_waitcnt lgkmcnt(4)
    v_mfma_f32_16x16x32_bf16 v[168:171], v[112:115], v[76:79], v[168:171]
    s_waitcnt lgkmcnt(2)
    v_mfma_f32_16x16x32_bf16 v[172:175], v[76:79], v[116:119], v[172:175]
    s_waitcnt lgkmcnt(0)
    v_mfma_f32_16x16x32_bf16 v[176:179], v[76:79], v[120:123], v[176:179]
    s_add_u32 s16, s12, 7340032
    s_addc_u32 s17, s13, 0
    s_mov_b32 s18, 155648
    s_mov_b32 s19, 0x20000
    s_lshr_b32 s26, s25, 4
    s_mul_i32 s26, s26, 19456
    s_and_b32 s27, s25, 15
    v_and_b32 v2, 15, v1
    v_mul_f32 v90, v164, v164
    v_fmac_f32 v90, v165, v165
    v_fmac_f32 v90, v166, v166
    v_fmac_f32 v90, v167, v167
    v_mul_f32 v91, v168, v168
    v_fmac_f32 v91, v169, v169
    v_cmp_gt_u32 vcc, 16, v1
    v_mov_b32 v92, 0
    s_nop 0
    v_cndmask_b32 v91, v92, v91, vcc
    v_add_f32 v90, v90, v91
    v_mov_b32 v91, v90
    s_nop 1
    v_permlane32_swap_b32 v90, v91
    v_add_f32 v90, v90, v91
    v_mov_b32 v91, v90
    s_nop 1
    v_permlane16_swap_b32 v90, v91
    v_add_f32 v90, v90, v91
    s_nop 1
    v_max_f32_dpp v90, v90, v90 quad_perm:[1,0,3,2] row_mask:0xf bank_mask:0xf
    s_nop 1
    v_max_f32_dpp v90, v90, v90 quad_perm:[2,3,0,1] row_mask:0xf bank_mask:0xf
    s_nop 1
    v_max_f32_dpp v90, v90, v90 row_half_mirror row_mask:0xf bank_mask:0xf
    s_nop 1
    v_max_f32_dpp v90, v90, v90 row_mirror row_mask:0xf bank_mask:0xf
    v_cvt_pk_bf16_f32 v164, v164, v165
    v_cvt_pk_bf16_f32 v165, v166, v167
    v_cvt_pk_bf16_f32 v168, v168, v169
    s_lshr_b32 s28, s27, 1
    s_lshl_b32 s28, s28, 10
    s_and_b32 s29, s27, 1
    s_lshl_b32 s29, s29, 8
    s_add_u32 s28, s28, s29
    s_add_u32 s28, s28, s26
    v_lshrrev_b32 v93, 1, v5
    v_lshlrev_b32 v93, 9, v93
    v_lshl_add_u32 v93, v2, 4, v93
    v_and_b32 v94, 1, v5
    v_lshl_add_u32 v93, v94, 3, v93
    buffer_store_dwordx2 v[164:165], v93, s[16:19], s28 offen
    s_lshl_b32 s28, s27, 6
    s_add_u32 s28, s28, s26
    v_lshlrev_b32 v93, 2, v1
    v_mov_b32 v92, 0x7fffffff
    v_cndmask_b32 v93, v92, v93, vcc
    s_add_u32 s28, s28, 8192
    buffer_store_dword v168, v93, s[16:19], s28 offen
    v_cvt_pk_bf16_f32 v172, v172, v173
    v_cvt_pk_bf16_f32 v173, v174, v175
    v_cvt_pk_bf16_f32 v176, v176, v177
    v_cvt_pk_bf16_f32 v177, v178, v179
    s_mul_i32 s28, s27, 640
    s_add_u32 s28, s28, s26
    s_add_u32 s28, s28, 9216
    v_mul_u32_u24 v93, 320, v94
    v_lshl_add_u32 v93, v2, 4, v93
    v_lshrrev_b32 v94, 1, v5
    v_lshl_add_u32 v93, v94, 3, v93
    buffer_store_dwordx2 v[172:173], v93, s[16:19], s28 offen
    v_mov_b32 v95, 0x3f803f80
    v_cmp_eq_u32 vcc, 2, v2
    s_nop 1
    v_cndmask_b32 v176, v176, v95, vcc
    v_cndmask_b32 v177, v177, v95, vcc
    v_mov_b32 v95, 0
    v_cmp_eq_u32 vcc, 3, v2
    s_nop 1
    v_cndmask_b32 v176, v176, v95, vcc
    v_cndmask_b32 v177, v177, v95, vcc
    v_cmp_gt_u32 vcc, 4, v2
    s_nop 1
    v_cndmask_b32 v93, v92, v93, vcc
    buffer_store_dwordx2 v[176:177], v93, s[16:19], s28 offen offset:256
    s_add_u32 s16, s12, 81920
    s_addc_u32 s17, s13, 0
    s_mov_b32 s18, 512
    s_mov_b32 s19, 0x20000
    v_cmp_eq_u32 vcc, 0, v1
    v_mov_b32 v93, 0
    s_nop 0
    v_cndmask_b32 v93, v92, v93, vcc
    s_lshl_b32 s28, s25, 2
    buffer_store_dword v90, v93, s[16:19], s28 offen
    s_endpgm
K2_END:
    s_endpgm
.globl k3_kernel
.p2align 8
.type k3_kernel,@function
k3_kernel:
    s_cmp_ge_u32 s2, 256
    s_cbranch_scc1 K3_END
    s_load_dwordx2 s[12:13], s[0:1], 104
    s_load_dwordx2 s[48:49], s[0:1], 32
    s_load_dwordx4 s[52:55], s[0:1], 48
    s_load_dwordx2 s[56:57], s[0:1], 64
    v_and_b32 v1, 63, v0
    v_lshrrev_b32 v2, 6, v0
    s_nop 0
    v_readfirstlane_b32 s20, v2
    s_nop 0
    s_lshr_b32 s21, s20, 2
    s_and_b32 s22, s20, 3
    s_mov_b32 s36, 0
    v_and_b32 v5, 31, v1
    v_lshrrev_b32 v6, 5, v1
    s_waitcnt lgkmcnt(0)
    s_add_u32 s4, s12, 4194304
    s_addc_u32 s5, s13, 0
    s_mov_b32 s6, 2359296
    s_mov_b32 s7, 0x20000
    s_add_u32 s8, s12, 7340032
    s_addc_u32 s9, s13, 0
    s_mov_b32 s10, 155648
    s_mov_b32 s11, 0x20000
    s_add_u32 s16, s12, 81920
    s_addc_u32 s17, s13, 0
    s_mov_b32 s18, 512
    s_mov_b32 s19, 0x20000
    s_add_u32 s40, s12, 8388608
    s_addc_u32 s41, s13, 0
    s_mov_b32 s42, 2359296
    s_mov_b32 s43, 0x20000
    s_mov_b32 s63, 0
K3_RESTART:
    s_and_b32 s23, s2, 7
    s_lshl_b32 s23, s23, 8
    s_andn2_b32 s24, s2, 7
    s_add_u32 s37, s23, s24
    s_lshl_b32 s24, s22, 1
    s_add_u32 s23, s37, s24
    s_mul_i32 s23, s23, 1152
    v_mul_u32_u24 v7, 36, v5
    v_lshl_add_u32 v44, v6, 4, v7
    v_cmp_gt_u32 vcc, 32, v1
    v_mov_b32 v45, 0x7fffffff
    s_nop 0
    v_cndmask_b32 v45, v45, v7, vcc
    buffer_load_dwordx4 v[8:11], v44, s[4:7], s23 offen
    buffer_load_dwordx4 v[12:15], v44, s[4:7], s23 offen offset:1152
    buffer_load_dword v16, v45, s[4:7], s23 offen offset:32
    buffer_load_dword v18, v45, s[4:7], s23 offen offset:1184
    v_lshlrev_b32 v46, 3, v1
    buffer_load_dwordx2 v[38:39], v46, s[16:19], 0 offen
    v_lshlrev_b32 v47, 4, v1
    s_mul_i32 s25, s21, 77824
    s_lshl_b32 s26, s22, 10
    s_add_u32 s26, s26, s25
    s_add_u32 s27, s26, 0
    s_mov_b32 m0, s27
    s_nop 0
    buffer_load_dwordx4 v47, s[8:11], s27 offen lds
    s_add_u32 s27, s26, 4096
    s_mov_b32 m0, s27
    s_nop 0
    buffer_load_dwordx4 v47, s[8:11], s27 offen lds
    s_add_u32 s27, s26, 8192
    s_mov_b32 m0, s27
    s_nop 0
    buffer_load_dwordx4 v47, s[8:11], s27 offen lds
    s_add_u32 s27, s26, 12288
    s_mov_b32 m0, s27
    s_nop 0
    buffer_load_dwordx4 v47, s[8:11], s27 offen lds
    s_add_u32 s27, s26, 16384
    s_mov_b32 m0, s27
    s_nop 0
    buffer_load_dwordx4 v47, s[8:11], s27 offen lds
    v_lshlrev_b32 v2, 4, v1
    v_add_u32 v2, s25, v2
    v_lshlrev_b32 v3, 2, v5
    v_add_u32 v3, s25, v3
    v_min_u32 v4, 19, v5
    v_lshlrev_b32 v4, 4, v4
    v_mul_u32_u24 v46, 320, v6
    v_add3_u32 v4, v4, v46, s25
    v_mov_b32 v25, 0x3f803f80
    v_mov_b32 v133, 0x3f803f80
    v_mov_b32 v96, 0
    v_mov_b32 v97, 0
    v_mov_b32 v98, 0
    v_mov_b32 v99, 0
    v_mov_b32 v100, 0
    v_mov_b32 v101, 0
    v_mov_b32 v102, 0
    v_mov_b32 v103, 0
    v_mov_b32 v104, 0
    v_mov_b32 v105, 0
    v_mov_b32 v106, 0
    v_mov_b32 v107, 0
    v_mov_b32 v108, 0
    v_mov_b32 v109, 0
    v_mov_b32 v110, 0
    v_mov_b32 v111, 0
    v_mov_b32 v112, 0
    v_mov_b32 v113, 0
    v_mov_b32 v114, 0
    v_mov_b32 v115, 0
    v_mov_b32 v116, 0
    v_mov_b32 v117, 0
    v_mov_b32 v118, 0
    v_mov_b32 v119, 0
    v_mov_b32 v120, 0
    v_mov_b32 v121, 0
    v_mov_b32 v122, 0
    v_mov_b32 v123, 0
    v_mov_b32 v124, 0
    v_mov_b32 v125, 0
    v_mov_b32 v126, 0
    v_mov_b32 v127, 0
    s_cmp_lg_u32 s36, 0
    s_cbranch_scc1 K3_NOSETUP
    s_lshr_b32 s44, s2, 3
    s_lshl_b32 s44, s44, 2
    s_add_u32 s44, s44, s22
    s_and_b32 s45, s2, 7
    s_lshl_b32 s47, s44, 6
    v_add_u32 v143, s47, v1
    v_mul_u32_u24 v141, 7282, v143
    v_lshrrev_b32 v141, 16, v141
    v_mul_u32_u24 v138, 9, v141
    v_sub_u32 v138, v143, v138
    v_mul_u32_u24 v141, 9216, v141
    v_lshl_add_u32 v141, v138, 7, v141
    s_mul_i32 s46, s45, 1152
    v_add_u32 v141, s46, v141
    v_subrev_u32 v143, 3008, v143
    v_lshlrev_b32 v143, 7, v143
    s_lshl_b32 s47, s2, 2
    s_add_u32 s47, s47, s22
    s_mul_i32 s45, s47, 10240
    s_lshl_b32 s47, s47, 13
    v_lshl_add_u32 v138, v1, 7, s47
    s_mov_b32 s50, 663552
    s_mov_b32 s51, 0x20000
    s_mov_b64 s[64:65], s[54:55]
    s_mov_b32 s54, 5308416
    s_mov_b32 s55, 0x20000
    s_mov_b32 s66, 5308416
    s_mov_b32 s67, 0x20000
    s_mov_b32 s58, 5308416
    s_mov_b32 s59, 0x20000
    s_add_u32 s68, s12, 37748736
    s_addc_u32 s69, s13, 0
    s_mov_b32 s70, 10485760
    s_mov_b32 s71, 0x20000
    v_mov_b32 v144, -1
    v_mov_b32 v145, -1
    v_mov_b32 v146, -1
    v_mov_b32 v147, -1
K3_NOSETUP:
    s_waitcnt vmcnt(5)
    v_max_f32 v38, v38, v39
    s_nop 1
    v_max_f32_dpp v38, v38, v38 quad_perm:[1,0,3,2] row_mask:0xf bank_mask:0xf
    s_nop 1
    v_max_f32_dpp v38, v38, v38 quad_perm:[2,3,0,1] row_mask:0xf bank_mask:0xf
    s_nop 1
    v_max_f32_dpp v38, v38, v38 row_half_mirror row_mask:0xf bank_mask:0xf
    s_nop 1
    v_max_f32_dpp v38, v38, v38 row_mirror row_mask:0xf bank_mask:0xf
    v_mov_b32 v39, v38
    s_nop 1
    v_permlane16_swap_b32 v38, v39
    v_max_f32 v38, v38, v39
    v_mov_b32 v39, v38
    s_nop 1
    v_permlane32_swap_b32 v38, v39
    v_max_f32 v38, v38, v39
    v_cmp_gt_u32 vcc, 32, v1
    v_dot2_f32_bf16 v40, v16, v16, 0
    v_dot2_f32_bf16 v40, v8, v8, v40
    v_dot2_f32_bf16 v40, v9, v9, v40
    v_dot2_f32_bf16 v40, v10, v10, v40
    v_dot2_f32_bf16 v40, v11, v11, v40
    s_nop 2
    v_mov_b32 v41, v40
    s_nop 1
    v_permlane32_swap_b32 v40, v41
    v_add_f32 v40, v40, v41
    v_mul_f32 v40, v40, v38
    v_sqrt_f32 v40, v40
    v_mov_b32 v41, 0xbd800000
    v_fmac_f32 v41, 0xbf8147ae, v40
    v_mov_b32 v42, 0
    v_cvt_pk_bf16_f32 v41, v41, v42
    v_cndmask_b32 v17, v42, v41, vcc
    v_dot2_f32_bf16 v40, v18, v18, 0
    v_dot2_f32_bf16 v40, v12, v12, v40
    v_dot2_f32_bf16 v40, v13, v13, v40
    v_dot2_f32_bf16 v40, v14, v14, v40
    v_dot2_f32_bf16 v40, v15, v15, v40
    s_nop 2
    v_mov_b32 v41, v40
    s_nop 1
    v_permlane32_swap_b32 v40, v41
    v_add_f32 v40, v40, v41
    v_mul_f32 v40, v40, v38
    v_sqrt_f32 v40, v40
    v_mov_b32 v41, 0xbd800000
    v_fmac_f32 v41, 0xbf8147ae, v40
    v_mov_b32 v42, 0
    v_cvt_pk_bf16_f32 v41, v41, v42
    v_cndmask_b32 v19, v42, v41, vcc
    s_cmp_eq_u32 s36, 0
    s_cbranch_scc1 K3_FAST
    s_add_u32 s27, s26, 19456
    s_mov_b32 m0, s27
    s_nop 0
    buffer_load_dwordx4 v47, s[8:11], s27 offen lds
    s_add_u32 s27, s26, 23552
    s_mov_b32 m0, s27
    s_nop 0
    buffer_load_dwordx4 v47, s[8:11], s27 offen lds
    s_add_u32 s27, s26, 27648
    s_mov_b32 m0, s27
    s_nop 0
    buffer_load_dwordx4 v47, s[8:11], s27 offen lds
    s_add_u32 s27, s26, 31744
    s_mov_b32 m0, s27
    s_nop 0
    buffer_load_dwordx4 v47, s[8:11], s27 offen lds
    s_add_u32 s27, s26, 35840
    s_mov_b32 m0, s27
    s_nop 0
    buffer_load_dwordx4 v47, s[8:11], s27 offen lds
    s_add_u32 s27, s26, 38912
    s_mov_b32 m0, s27
    s_nop 0
    buffer_load_dwordx4 v47, s[8:11], s27 offen lds
    s_add_u32 s27, s26, 43008
    s_mov_b32 m0, s27
    s_nop 0
    buffer_load_dwordx4 v47, s[8:11], s27 offen lds
    s_add_u32 s27, s26, 47104
    s_mov_b32 m0, s27
    s_nop 0
    buffer_load_dwordx4 v47, s[8:11], s27 offen lds
    s_add_u32 s27, s26, 51200
    s_mov_b32 m0, s27
    s_nop 0
    buffer_load_dwordx4 v47, s[8:11], s27 offen lds
    s_add_u32 s27, s26, 55296
    s_mov_b32 m0, s27
    s_nop 0
    buffer_load_dwordx4 v47, s[8:11], s27 offen lds
    s_add_u32 s27, s26, 58368
    s_mov_b32 m0, s27
    s_nop 0
    buffer_load_dwordx4 v47, s[8:11], s27 offen lds
    s_add_u32 s27, s26, 62464
    s_mov_b32 m0, s27
    s_nop 0
    buffer_load_dwordx4 v47, s[8:11], s27 offen lds
    s_add_u32 s27, s26, 66560
    s_mov_b32 m0, s27
    s_nop 0
    buffer_load_dwordx4 v47, s[8:11], s27 offen lds
    s_add_u32 s27, s26, 70656
    s_mov_b32 m0, s27
    s_nop 0
    buffer_load_dwordx4 v47, s[8:11], s27 offen lds
    s_add_u32 s27, s26, 74752
    s_mov_b32 m0, s27
    s_nop 0
    buffer_load_dwordx4 v47, s[8:11], s27 offen lds
    s_waitcnt vmcnt(0)
    s_barrier
    v_mov_b32 v17, 0
    v_mov_b32 v19, 0
    v_mov_b32 v36, 0xff800000
    v_mov_b32 v37, 0xff800000
    s_mov_b32 s28, 0
K3_MAXLOOP:
    s_lshr_b32 s29, s28, 3
    s_mul_i32 s29, s29, 19456
    s_and_b32 s31, s28, 7
    s_lshl_b32 s32, s31, 10
    s_add_u32 s32, s32, s29
    s_lshl_b32 s31, s31, 7
    s_add_u32 s31, s31, s29
    v_add_u32 v40, s32, v2
    v_add_u32 v41, s31, v3
    ds_read_b128 v[20:23], v40
    ds_read_b32 v24, v41 offset:8192
    s_waitcnt lgkmcnt(0)
    v_mfma_f32_32x32x16_bf16 v[48:63], v[20:23], v[8:11], 0
    v_mfma_f32_32x32x8_bf16 v[48:63], v[24:25], v[16:17], v[48:63]
    v_mfma_f32_32x32x16_bf16 v[64:79], v[20:23], v[12:15], 0
    v_mfma_f32_32x32x8_bf16 v[64:79], v[24:25], v[18:19], v[64:79]
    s_nop 9
    v_max3_f32 v36, v36, v48, v49
    v_max3_f32 v36, v36, v50, v51
    v_max3_f32 v36, v36, v52, v53
    v_max3_f32 v36, v36, v54, v55
    v_max3_f32 v36, v36, v56, v57
    v_max3_f32 v36, v36, v58, v59
    v_max3_f32 v36, v36, v60, v61
    v_max3_f32 v36, v36, v62, v63
    v_max3_f32 v37, v37, v64, v65
    v_max3_f32 v37, v37, v66, v67
    v_max3_f32 v37, v37, v68, v69
    v_max3_f32 v37, v37, v70, v71
    v_max3_f32 v37, v37, v72, v73
    v_max3_f32 v37, v37, v74, v75
    v_max3_f32 v37, v37, v76, v77
    v_max3_f32 v37, v37, v78, v79
    s_add_u32 s28, s28, 1
    s_cmp_lt_u32 s28, 32
    s_cbranch_scc1 K3_MAXLOOP
    v_mov_b32 v40, v36
    s_nop 1
    v_permlane32_swap_b32 v36, v40
    v_max_f32 v36, v36, v40
    v_mov_b32 v40, v37
    s_nop 1
    v_permlane32_swap_b32 v37, v40
    v_max_f32 v37, v37, v40
    s_lshl_b32 s28, s20, 9
    s_add_u32 s28, s28, 157760
    v_lshlrev_b32 v40, 3, v1
    v_add_u32 v41, s28, v40
    ds_write_b64 v41, v[36:37]
    s_xor_b32 s28, s20, 4
    s_lshl_b32 s28, s28, 9
    s_add_u32 s28, s28, 157760
    v_add_u32 v41, s28, v40
    s_waitcnt lgkmcnt(0)
    s_barrier
    ds_read_b64 v[40:41], v41
    s_waitcnt lgkmcnt(0)
    v_cmp_gt_u32 vcc, 32, v1
    v_max_f32 v36, v36, v40
    v_sub_f32 v36, 0, v36
    v_cvt_pk_bf16_f32 v42, v36, v36
    v_lshlrev_b32 v42, 16, v42
    v_sub_f32 v43, v36, v42
    v_cvt_pk_bf16_f32 v42, v42, v43
    v_mov_b32 v43, 0
    v_cndmask_b32 v17, v43, v42, vcc
    v_max_f32 v37, v37, v41
    v_sub_f32 v37, 0, v37
    v_cvt_pk_bf16_f32 v42, v37, v37
    v_lshlrev_b32 v42, 16, v42
    v_sub_f32 v43, v37, v42
    v_cvt_pk_bf16_f32 v42, v42, v43
    v_mov_b32 v43, 0
    v_cndmask_b32 v19, v43, v42, vcc
K3_FAST:
    s_waitcnt vmcnt(0)
    s_barrier
    ds_read_b128 v[20:23], v2
    ds_read_b32 v24, v3 offset:8192
    ds_read_b128 v[28:31], v4 offset:9216
    ds_read_b128 v[32:35], v4 offset:9856
    v_mov_b32 v92, 0
    v_mov_b32 v93, 0
    v_mov_b32 v94, 0
    v_mov_b32 v95, 0
    s_waitcnt lgkmcnt(2)
    v_mfma_f32_32x32x16_bf16 v[48:63], v[20:23], v[8:11], 0
    v_mfma_f32_32x32x8_bf16 v[48:63], v[24:25], v[16:17], v[48:63]
    s_waitcnt lgkmcnt(0)
    s_mov_b32 s28, 0
    s_cmp_lt_u32 s20, 4
    s_cselect_b32 s62, 1, 9
    s_cmp_ge_u32 s63, 5
    s_cselect_b32 s62, 9, s62
    s_nop 5
.p2align 6
K3_LOOP:
    v_exp_f32 v36, v48
    v_exp_f32 v37, v49
    v_mfma_f32_32x32x16_bf16 v[112:127], v[32:35], v[92:95], v[112:127]
    ds_read_b128 v[32:35], v4 offset:9856
    ds_read_b128 v[128:131], v2 offset:1024
    ds_read_b32 v132, v3 offset:8320
    v_exp_f32 v38, v50
    v_exp_f32 v39, v51
    v_cvt_pk_bf16_f32 v80, v36, v37
    v_exp_f32 v40, v52
    v_exp_f32 v41, v53
    v_cvt_pk_bf16_f32 v81, v38, v39
    v_mfma_f32_32x32x16_bf16 v[64:79], v[20:23], v[12:15], 0
    v_exp_f32 v42, v54
    v_exp_f32 v43, v55
    v_cvt_pk_bf16_f32 v82, v40, v41
    v_exp_f32 v36, v56
    v_cvt_pk_bf16_f32 v83, v42, v43
    v_exp_f32 v37, v57
    v_mfma_f32_32x32x8_bf16 v[64:79], v[24:25], v[18:19], v[64:79]
    v_exp_f32 v38, v58
    v_exp_f32 v39, v59
    v_cvt_pk_bf16_f32 v84, v36, v37
    v_exp_f32 v40, v60
    v_exp_f32 v41, v61
    v_cvt_pk_bf16_f32 v85, v38, v39
    s_waitcnt lgkmcnt(3)
    v_mfma_f32_32x32x16_bf16 v[96:111], v[28:31], v[80:83], v[96:111]
    v_exp_f32 v42, v62
    v_exp_f32 v43, v63
    v_cvt_pk_bf16_f32 v86, v40, v41
    v_cvt_pk_bf16_f32 v87, v42, v43
    v_exp_f32 v36, v64
    v_exp_f32 v37, v65
    s_waitcnt lgkmcnt(2)
    v_mfma_f32_32x32x16_bf16 v[96:111], v[32:35], v[84:87], v[96:111]
    v_exp_f32 v38, v66
    v_exp_f32 v39, v67
    v_cvt_pk_bf16_f32 v88, v36, v37
    v_exp_f32 v40, v68
    v_exp_f32 v41, v69
    v_cvt_pk_bf16_f32 v89, v38, v39
    s_waitcnt lgkmcnt(0)
    v_mfma_f32_32x32x16_bf16 v[48:63], v[128:131], v[8:11], 0
    v_exp_f32 v42, v70
    v_exp_f32 v43, v71
    v_cvt_pk_bf16_f32 v90, v40, v41
    v_exp_f32 v36, v72
    v_cvt_pk_bf16_f32 v91, v42, v43
    v_exp_f32 v37, v73
    v_mfma_f32_32x32x8_bf16 v[48:63], v[132:133], v[16:17], v[48:63]
    v_exp_f32 v38, v74
    v_exp_f32 v39, v75
    v_cvt_pk_bf16_f32 v92, v36, v37
    v_exp_f32 v40, v76
    v_exp_f32 v41, v77
    v_cvt_pk_bf16_f32 v93, v38, v39
    v_mfma_f32_32x32x16_bf16 v[112:127], v[28:31], v[88:91], v[112:127]
    ds_read_b128 v[28:31], v4 offset:10496
    v_exp_f32 v42, v78
    v_exp_f32 v43, v79
    v_cvt_pk_bf16_f32 v94, v40, v41
    v_cvt_pk_bf16_f32 v95, v42, v43
    s_cmp_lg_u32 s28, 0
    s_cbranch_scc1 K3_NODMA0
    s_add_u32 s27, s26, 19456
    s_mov_b32 m0, s27
    s_nop 0
    buffer_load_dwordx4 v47, s[8:11], s27 offen lds
    s_add_u32 s27, s26, 23552
    s_mov_b32 m0, s27
    s_nop 0
    buffer_load_dwordx4 v47, s[8:11], s27 offen lds
    s_add_u32 s27, s26, 27648
    s_mov_b32 m0, s27
    s_nop 0
    buffer_load_dwordx4 v47, s[8:11], s27 offen lds
    s_add_u32 s27, s26, 31744
    s_mov_b32 m0, s27
    s_nop 0
    buffer_load_dwordx4 v47, s[8:11], s27 offen lds
    s_add_u32 s27, s26, 35840
    s_mov_b32 m0, s27
    s_nop 0
    buffer_load_dwordx4 v47, s[8:11], s27 offen lds
K3_NODMA0:
    v_exp_f32 v36, v48
    v_exp_f32 v37, v49
    v_mfma_f32_32x32x16_bf16 v[112:127], v[32:35], v[92:95], v[112:127]
    ds_read_b128 v[32:35], v4 offset:11136
    ds_read_b128 v[20:23], v2 offset:2048
    ds_read_b32 v24, v3 offset:8448
    v_exp_f32 v38, v50
    v_exp_f32 v39, v51
    v_cvt_pk_bf16_f32 v80, v36, v37
    v_exp_f32 v40, v52
    v_exp_f32 v41, v53
    v_cvt_pk_bf16_f32 v81, v38, v39
    v_mfma_f32_32x32x16_bf16 v[64:79], v[128:131], v[12:15], 0
    v_exp_f32 v42, v54
    v_exp_f32 v43, v55
    v_cvt_pk_bf16_f32 v82, v40, v41
    v_exp_f32 v36, v56
    v_cvt_pk_bf16_f32 v83, v42, v43
    v_exp_f32 v37, v57
    v_mfma_f32_32x32x8_bf16 v[64:79], v[132:133], v[18:19], v[64:79]
    v_exp_f32 v38, v58
    v_exp_f32 v39, v59
    v_cvt_pk_bf16_f32 v84, v36, v37
    v_exp_f32 v40, v60
    v_exp_f32 v41, v61
    v_cvt_pk_bf16_f32 v85, v38, v39
    s_waitcnt lgkmcnt(3)
    v_mfma_f32_32x32x16_bf16 v[96:111], v[28:31], v[80:83], v[96:111]
    v_exp_f32 v42, v62
    v_exp_f32 v43, v63
    v_cvt_pk_bf16_f32 v86, v40, v41
    v_cvt_pk_bf16_f32 v87, v42, v43
    v_exp_f32 v36, v64
    v_exp_f32 v37, v65
    s_waitcnt lgkmcnt(2)
    v_mfma_f32_32x32x16_bf16 v[96:111], v[32:35], v[84:87], v[96:111]
    v_exp_f32 v38, v66
    v_exp_f32 v39, v67
    v_cvt_pk_bf16_f32 v88, v36, v37
    v_exp_f32 v40, v68
    v_exp_f32 v41, v69
    v_cvt_pk_bf16_f32 v89, v38, v39
    s_waitcnt lgkmcnt(0)
    v_mfma_f32_32x32x16_bf16 v[48:63], v[20:23], v[8:11], 0
    v_exp_f32 v42, v70
    v_exp_f32 v43, v71
    v_cvt_pk_bf16_f32 v90, v40, v41
    v_exp_f32 v36, v72
    v_cvt_pk_bf16_f32 v91, v42, v43
    v_exp_f32 v37, v73
    v_mfma_f32_32x32x8_bf16 v[48:63], v[24:25], v[16:17], v[48:63]
    v_exp_f32 v38, v74
    v_exp_f32 v39, v75
    v_cvt_pk_bf16_f32 v92, v36, v37
    v_exp_f32 v40, v76
    v_exp_f32 v41, v77
    v_cvt_pk_bf16_f32 v93, v38, v39
    v_mfma_f32_32x32x16_bf16 v[112:127], v[28:31], v[88:91], v[112:127]
    ds_read_b128 v[28:31], v4 offset:11776
    v_exp_f32 v42, v78
    v_exp_f32 v43, v79
    v_cvt_pk_bf16_f32 v94, v40, v41
    v_cvt_pk_bf16_f32 v95, v42, v43
    s_cmp_lt_u32 s62, s28
    s_cbranch_scc0 K3_NOSENT1
    buffer_store_dwordx4 v[144:147], v47, s[68:71], s45 offen sc1
    buffer_store_dwordx4 v[144:147], v47, s[68:71], s45 offen offset:1024 sc1
    s_add_u32 s45, s45, 2048
    s_add_u32 s63, s63, 1
    s_cmp_ge_u32 s63, 5
    s_cselect_b32 s62, 9, s62
K3_NOSENT1:
    s_cmp_lg_u32 s28, 0
    s_cbranch_scc1 K3_NODMA1
    s_add_u32 s27, s26, 38912
    s_mov_b32 m0, s27
    s_nop 0
    buffer_load_dwordx4 v47, s[8:11], s27 offen lds
    s_add_u32 s27, s26, 43008
    s_mov_b32 m0, s27
    s_nop 0
    buffer_load_dwordx4 v47, s[8:11], s27 offen lds
    s_add_u32 s27, s26, 47104
    s_mov_b32 m0, s27
    s_nop 0
    buffer_load_dwordx4 v47, s[8:11], s27 offen lds
    s_add_u32 s27, s26, 51200
    s_mov_b32 m0, s27
    s_nop 0
    buffer_load_dwordx4 v47, s[8:11], s27 offen lds
    s_add_u32 s27, s26, 55296
    s_mov_b32 m0, s27
    s_nop 0
    buffer_load_dwordx4 v47, s[8:11], s27 offen lds
K3_NODMA1:
    v_exp_f32 v36, v48
    v_exp_f32 v37, v49
    v_mfma_f32_32x32x16_bf16 v[112:127], v[32:35], v[92:95], v[112:127]
    ds_read_b128 v[32:35], v4 offset:12416
    ds_read_b128 v[128:131], v2 offset:3072
    ds_read_b32 v132, v3 offset:8576
    v_exp_f32 v38, v50
    v_exp_f32 v39, v51
    v_cvt_pk_bf16_f32 v80, v36, v37
    v_exp_f32 v40, v52
    v_exp_f32 v41, v53
    v_cvt_pk_bf16_f32 v81, v38, v39
    v_mfma_f32_32x32x16_bf16 v[64:79], v[20:23], v[12:15], 0
    v_exp_f32 v42, v54
    v_exp_f32 v43, v55
    v_cvt_pk_bf16_f32 v82, v40, v41
    v_exp_f32 v36, v56
    v_cvt_pk_bf16_f32 v83, v42, v43
    v_exp_f32 v37, v57
    v_mfma_f32_32x32x8_bf16 v[64:79], v[24:25], v[18:19], v[64:79]
    v_exp_f32 v38, v58
    v_exp_f32 v39, v59
    v_cvt_pk_bf16_f32 v84, v36, v37
    v_exp_f32 v40, v60
    v_exp_f32 v41, v61
    v_cvt_pk_bf16_f32 v85, v38, v39
    s_waitcnt lgkmcnt(3)
    v_mfma_f32_32x32x16_bf16 v[96:111], v[28:31], v[80:83], v[96:111]
    v_exp_f32 v42, v62
    v_exp_f32 v43, v63
    v_cvt_pk_bf16_f32 v86, v40, v41
    v_cvt_pk_bf16_f32 v87, v42, v43
    v_exp_f32 v36, v64
    v_exp_f32 v37, v65
    s_waitcnt lgkmcnt(2)
    v_mfma_f32_32x32x16_bf16 v[96:111], v[32:35], v[84:87], v[96:111]
    v_exp_f32 v38, v66
    v_exp_f32 v39, v67
    v_cvt_pk_bf16_f32 v88, v36, v37
    v_exp_f32 v40, v68
    v_exp_f32 v41, v69
    v_cvt_pk_bf16_f32 v89, v38, v39
    s_waitcnt lgkmcnt(0)
    v_mfma_f32_32x32x16_bf16 v[48:63], v[128:131], v[8:11], 0
    v_exp_f32 v42, v70
    v_exp_f32 v43, v71
    v_cvt_pk_bf16_f32 v90, v40, v41
    v_exp_f32 v36, v72
    v_cvt_pk_bf16_f32 v91, v42, v43
    v_exp_f32 v37, v73
    v_mfma_f32_32x32x8_bf16 v[48:63], v[132:133], v[16:17], v[48:63]
    v_exp_f32 v38, v74
    v_exp_f32 v39, v75
    v_cvt_pk_bf16_f32 v92, v36, v37
    v_exp_f32 v40, v76
    v_exp_f32 v41, v77
    v_cvt_pk_bf16_f32 v93, v38, v39
    v_mfma_f32_32x32x16_bf16 v[112:127], v[28:31], v[88:91], v[112:127]
    ds_read_b128 v[28:31], v4 offset:13056
    v_exp_f32 v42, v78
    v_exp_f32 v43, v79
    v_cvt_pk_bf16_f32 v94, v40, v41
    v_cvt_pk_bf16_f32 v95, v42, v43
    s_cmp_lg_u32 s28, 0
    s_cbranch_scc1 K3_NODMA2
    s_add_u32 s27, s26, 58368
    s_mov_b32 m0, s27
    s_nop 0
    buffer_load_dwordx4 v47, s[8:11], s27 offen lds
    s_add_u32 s27, s26, 62464
    s_mov_b32 m0, s27
    s_nop 0
    buffer_load_dwordx4 v47, s[8:11], s27 offen lds
    s_add_u32 s27, s26, 66560
    s_mov_b32 m0, s27
    s_nop 0
    buffer_load_dwordx4 v47, s[8:11], s27 offen lds
    s_add_u32 s27, s26, 70656
    s_mov_b32 m0, s27
    s_nop 0
    buffer_load_dwordx4 v47, s[8:11], s27 offen lds
    s_add_u32 s27, s26, 74752
    s_mov_b32 m0, s27
    s_nop 0
    buffer_load_dwordx4 v47, s[8:11], s27 offen lds
K3_NODMA2:
    v_exp_f32 v36, v48
    v_exp_f32 v37, v49
    v_mfma_f32_32x32x16_bf16 v[112:127], v[32:35], v[92:95], v[112:127]
    ds_read_b128 v[32:35], v4 offset:13696
    ds_read_b128 v[20:23], v2 offset:4096
    ds_read_b32 v24, v3 offset:8704
    v_exp_f32 v38, v50
    v_exp_f32 v39, v51
    v_cvt_pk_bf16_f32 v80, v36, v37
    v_exp_f32 v40, v52
    v_exp_f32 v41, v53
    v_cvt_pk_bf16_f32 v81, v38, v39
    v_mfma_f32_32x32x16_bf16 v[64:79], v[128:131], v[12:15], 0
    v_exp_f32 v42, v54
    v_exp_f32 v43, v55
    v_cvt_pk_bf16_f32 v82, v40, v41
    v_exp_f32 v36, v56
    v_cvt_pk_bf16_f32 v83, v42, v43
    v_exp_f32 v37, v57
    v_mfma_f32_32x32x8_bf16 v[64:79], v[132:133], v[18:19], v[64:79]
    v_exp_f32 v38, v58
    v_exp_f32 v39, v59
    v_cvt_pk_bf16_f32 v84, v36, v37
    v_exp_f32 v40, v60
    v_exp_f32 v41, v61
    v_cvt_pk_bf16_f32 v85, v38, v39
    s_waitcnt lgkmcnt(3)
    v_mfma_f32_32x32x16_bf16 v[96:111], v[28:31], v[80:83], v[96:111]
    v_exp_f32 v42, v62
    v_exp_f32 v43, v63
    v_cvt_pk_bf16_f32 v86, v40, v41
    v_cvt_pk_bf16_f32 v87, v42, v43
    v_exp_f32 v36, v64
    v_exp_f32 v37, v65
    s_waitcnt lgkmcnt(2)
    v_mfma_f32_32x32x16_bf16 v[96:111], v[32:35], v[84:87], v[96:111]
    v_exp_f32 v38, v66
    v_exp_f32 v39, v67
    v_cvt_pk_bf16_f32 v88, v36, v37
    v_exp_f32 v40, v68
    v_exp_f32 v41, v69
    v_cvt_pk_bf16_f32 v89, v38, v39
    s_waitcnt lgkmcnt(0)
    v_mfma_f32_32x32x16_bf16 v[48:63], v[20:23], v[8:11], 0
    v_exp_f32 v42, v70
    v_exp_f32 v43, v71
    v_cvt_pk_bf16_f32 v90, v40, v41
    v_exp_f32 v36, v72
    v_cvt_pk_bf16_f32 v91, v42, v43
    v_exp_f32 v37, v73
    v_mfma_f32_32x32x8_bf16 v[48:63], v[24:25], v[16:17], v[48:63]
    v_exp_f32 v38, v74
    v_exp_f32 v39, v75
    v_cvt_pk_bf16_f32 v92, v36, v37
    v_exp_f32 v40, v76
    v_exp_f32 v41, v77
    v_cvt_pk_bf16_f32 v93, v38, v39
    v_mfma_f32_32x32x16_bf16 v[112:127], v[28:31], v[88:91], v[112:127]
    ds_read_b128 v[28:31], v4 offset:14336
    v_exp_f32 v42, v78
    v_exp_f32 v43, v79
    v_cvt_pk_bf16_f32 v94, v40, v41
    v_cvt_pk_bf16_f32 v95, v42, v43
    v_exp_f32 v36, v48
    v_exp_f32 v37, v49
    v_mfma_f32_32x32x16_bf16 v[112:127], v[32:35], v[92:95], v[112:127]
    ds_read_b128 v[32:35], v4 offset:14976
    ds_read_b128 v[128:131], v2 offset:5120
    ds_read_b32 v132, v3 offset:8832
    v_exp_f32 v38, v50
    v_exp_f32 v39, v51
    v_cvt_pk_bf16_f32 v80, v36, v37
    v_exp_f32 v40, v52
    v_exp_f32 v41, v53
    v_cvt_pk_bf16_f32 v81, v38, v39
    v_mfma_f32_32x32x16_bf16 v[64:79], v[20:23], v[12:15], 0
    v_exp_f32 v42, v54
    v_exp_f32 v43, v55
    v_cvt_pk_bf16_f32 v82, v40, v41
    v_exp_f32 v36, v56
    v_cvt_pk_bf16_f32 v83, v42, v43
    v_exp_f32 v37, v57
    v_mfma_f32_32x32x8_bf16 v[64:79], v[24:25], v[18:19], v[64:79]
    v_exp_f32 v38, v58
    v_exp_f32 v39, v59
    v_cvt_pk_bf16_f32 v84, v36, v37
    v_exp_f32 v40, v60
    v_exp_f32 v41, v61
    v_cvt_pk_bf16_f32 v85, v38, v39
    s_waitcnt lgkmcnt(3)
    v_mfma_f32_32x32x16_bf16 v[96:111], v[28:31], v[80:83], v[96:111]
    v_exp_f32 v42, v62
    v_exp_f32 v43, v63
    v_cvt_pk_bf16_f32 v86, v40, v41
    v_cvt_pk_bf16_f32 v87, v42, v43
    v_exp_f32 v36, v64
    v_exp_f32 v37, v65
    s_waitcnt lgkmcnt(2)
    v_mfma_f32_32x32x16_bf16 v[96:111], v[32:35], v[84:87], v[96:111]
    v_exp_f32 v38, v66
    v_exp_f32 v39, v67
    v_cvt_pk_bf16_f32 v88, v36, v37
    v_exp_f32 v40, v68
    v_exp_f32 v41, v69
    v_cvt_pk_bf16_f32 v89, v38, v39
    s_waitcnt lgkmcnt(0)
    v_mfma_f32_32x32x16_bf16 v[48:63], v[128:131], v[8:11], 0
    v_exp_f32 v42, v70
    v_exp_f32 v43, v71
    v_cvt_pk_bf16_f32 v90, v40, v41
    v_exp_f32 v36, v72
    v_cvt_pk_bf16_f32 v91, v42, v43
    v_exp_f32 v37, v73
    v_mfma_f32_32x32x8_bf16 v[48:63], v[132:133], v[16:17], v[48:63]
    v_exp_f32 v38, v74
    v_exp_f32 v39, v75
    v_cvt_pk_bf16_f32 v92, v36, v37
    v_exp_f32 v40, v76
    v_exp_f32 v41, v77
    v_cvt_pk_bf16_f32 v93, v38, v39
    v_mfma_f32_32x32x16_bf16 v[112:127], v[28:31], v[88:91], v[112:127]
    ds_read_b128 v[28:31], v4 offset:15616
    v_exp_f32 v42, v78
    v_exp_f32 v43, v79
    v_cvt_pk_bf16_f32 v94, v40, v41
    v_cvt_pk_bf16_f32 v95, v42, v43
    s_cmp_lt_u32 s62, s28
    s_cbranch_scc0 K3_NOSENT4
    buffer_store_dwordx4 v[144:147], v47, s[68:71], s45 offen sc1
    buffer_store_dwordx4 v[144:147], v47, s[68:71], s45 offen offset:1024 sc1
    s_add_u32 s45, s45, 2048
    s_add_u32 s63, s63, 1
    s_cmp_ge_u32 s63, 5
    s_cselect_b32 s62, 9, s62
K3_NOSENT4:
    v_exp_f32 v36, v48
    v_exp_f32 v37, v49
    v_mfma_f32_32x32x16_bf16 v[112:127], v[32:35], v[92:95], v[112:127]
    ds_read_b128 v[32:35], v4 offset:16256
    ds_read_b128 v[20:23], v2 offset:6144
    ds_read_b32 v24, v3 offset:8960
    v_exp_f32 v38, v50
    v_exp_f32 v39, v51
    v_cvt_pk_bf16_f32 v80, v36, v37
    v_exp_f32 v40, v52
    v_exp_f32 v41, v53
    v_cvt_pk_bf16_f32 v81, v38, v39
    v_mfma_f32_32x32x16_bf16 v[64:79], v[128:131], v[12:15], 0
    v_exp_f32 v42, v54
    v_exp_f32 v43, v55
    v_cvt_pk_bf16_f32 v82, v40, v41
    v_exp_f32 v36, v56
    v_cvt_pk_bf16_f32 v83, v42, v43
    v_exp_f32 v37, v57
    v_mfma_f32_32x32x8_bf16 v[64:79], v[132:133], v[18:19], v[64:79]
    v_exp_f32 v38, v58
    v_exp_f32 v39, v59
    v_cvt_pk_bf16_f32 v84, v36, v37
    v_exp_f32 v40, v60
    v_exp_f32 v41, v61
    v_cvt_pk_bf16_f32 v85, v38, v39
    s_waitcnt lgkmcnt(3)
    v_mfma_f32_32x32x16_bf16 v[96:111], v[28:31], v[80:83], v[96:111]
    v_exp_f32 v42, v62
    v_exp_f32 v43, v63
    v_cvt_pk_bf16_f32 v86, v40, v41
    v_cvt_pk_bf16_f32 v87, v42, v43
    v_exp_f32 v36, v64
    v_exp_f32 v37, v65
    s_waitcnt lgkmcnt(2)
    v_mfma_f32_32x32x16_bf16 v[96:111], v[32:35], v[84:87], v[96:111]
    v_exp_f32 v38, v66
    v_exp_f32 v39, v67
    v_cvt_pk_bf16_f32 v88, v36, v37
    v_exp_f32 v40, v68
    v_exp_f32 v41, v69
    v_cvt_pk_bf16_f32 v89, v38, v39
    s_waitcnt lgkmcnt(0)
    v_mfma_f32_32x32x16_bf16 v[48:63], v[20:23], v[8:11], 0
    v_exp_f32 v42, v70
    v_exp_f32 v43, v71
    v_cvt_pk_bf16_f32 v90, v40, v41
    v_exp_f32 v36, v72
    v_cvt_pk_bf16_f32 v91, v42, v43
    v_exp_f32 v37, v73
    v_mfma_f32_32x32x8_bf16 v[48:63], v[24:25], v[16:17], v[48:63]
    v_exp_f32 v38, v74
    v_exp_f32 v39, v75
    v_cvt_pk_bf16_f32 v92, v36, v37
    v_exp_f32 v40, v76
    v_exp_f32 v41, v77
    v_cvt_pk_bf16_f32 v93, v38, v39
    v_mfma_f32_32x32x16_bf16 v[112:127], v[28:31], v[88:91], v[112:127]
    ds_read_b128 v[28:31], v4 offset:16896
    v_exp_f32 v42, v78
    v_exp_f32 v43, v79
    v_cvt_pk_bf16_f32 v94, v40, v41
    v_cvt_pk_bf16_f32 v95, v42, v43
    s_cmp_lg_u32 s28, 0
    s_cbranch_scc1 K3_NOBAR
    s_waitcnt vmcnt(0)
    s_barrier
    s_cmp_ge_u32 s20, 4
    s_cbranch_scc1 K3_PFD
    s_getpc_b64 s[32:33]
CPF2:
    s_add_u32 s32, s32, k4_kernel-CPF2
    s_addc_u32 s33, s33, 0
    s_lshl_b32 s34, s44, 13
    v_lshlrev_b32 v136, 7, v1
    v_add_u32 v136, s34, v136
    s_mov_b32 s34, CODE_END-k4_kernel
    v_cmp_gt_u32 vcc, s34, v136
    s_nop 0
    s_and_saveexec_b64 s[34:35], vcc
    s_cbranch_execz CPF2_SKIP
    global_load_dword v137, v136, s[32:33]
CPF2_SKIP:
    s_mov_b64 exec, s[34:35]
    buffer_load_dword v142, v141, s[52:55], 0 offen
    buffer_load_dword v139, v141, s[64:67], 0 offen
    buffer_load_dword v140, v143, s[48:51], 0 offen
    buffer_load_dword v148, v138, s[56:59], 0 offen
K3_PFD:
K3_NOBAR:
    v_exp_f32 v36, v48
    v_exp_f32 v37, v49
    v_mfma_f32_32x32x16_bf16 v[112:127], v[32:35], v[92:95], v[112:127]
    ds_read_b128 v[32:35], v4 offset:17536
    ds_read_b128 v[128:131], v2 offset:7168
    ds_read_b32 v132, v3 offset:9088
    v_exp_f32 v38, v50
    v_exp_f32 v39, v51
    v_cvt_pk_bf16_f32 v80, v36, v37
    v_exp_f32 v40, v52
    v_exp_f32 v41, v53
    v_cvt_pk_bf16_f32 v81, v38, v39
    v_mfma_f32_32x32x16_bf16 v[64:79], v[20:23], v[12:15], 0
    v_exp_f32 v42, v54
    v_exp_f32 v43, v55
    v_cvt_pk_bf16_f32 v82, v40, v41
    v_exp_f32 v36, v56
    v_cvt_pk_bf16_f32 v83, v42, v43
    v_exp_f32 v37, v57
    v_mfma_f32_32x32x8_bf16 v[64:79], v[24:25], v[18:19], v[64:79]
    v_exp_f32 v38, v58
    v_exp_f32 v39, v59
    v_cvt_pk_bf16_f32 v84, v36, v37
    v_exp_f32 v40, v60
    v_exp_f32 v41, v61
    v_cvt_pk_bf16_f32 v85, v38, v39
    s_waitcnt lgkmcnt(3)
    v_mfma_f32_32x32x16_bf16 v[96:111], v[28:31], v[80:83], v[96:111]
    v_exp_f32 v42, v62
    v_exp_f32 v43, v63
    v_cvt_pk_bf16_f32 v86, v40, v41
    v_cvt_pk_bf16_f32 v87, v42, v43
    v_exp_f32 v36, v64
    v_exp_f32 v37, v65
    s_waitcnt lgkmcnt(2)
    v_mfma_f32_32x32x16_bf16 v[96:111], v[32:35], v[84:87], v[96:111]
    v_exp_f32 v38, v66
    v_exp_f32 v39, v67
    v_cvt_pk_bf16_f32 v88, v36, v37
    v_exp_f32 v40, v68
    v_exp_f32 v41, v69
    v_cvt_pk_bf16_f32 v89, v38, v39
    s_waitcnt lgkmcnt(0)
    v_mfma_f32_32x32x16_bf16 v[48:63], v[128:131], v[8:11], 0
    v_exp_f32 v42, v70
    v_exp_f32 v43, v71
    v_cvt_pk_bf16_f32 v90, v40, v41
    v_exp_f32 v36, v72
    v_cvt_pk_bf16_f32 v91, v42, v43
    v_exp_f32 v37, v73
    v_mfma_f32_32x32x8_bf16 v[48:63], v[132:133], v[16:17], v[48:63]
    v_exp_f32 v38, v74
    v_exp_f32 v39, v75
    v_cvt_pk_bf16_f32 v92, v36, v37
    v_exp_f32 v40, v76
    v_exp_f32 v41, v77
    v_cvt_pk_bf16_f32 v93, v38, v39
    v_mfma_f32_32x32x16_bf16 v[112:127], v[28:31], v[88:91], v[112:127]
    ds_read_b128 v[28:31], v4 offset:18176
    v_exp_f32 v42, v78
    v_exp_f32 v43, v79
    v_cvt_pk_bf16_f32 v94, v40, v41
    v_cvt_pk_bf16_f32 v95, v42, v43
    v_exp_f32 v36, v48
    v_exp_f32 v37, v49
    v_mfma_f32_32x32x16_bf16 v[112:127], v[32:35], v[92:95], v[112:127]
    ds_read_b128 v[32:35], v4 offset:18816
    ds_read_b128 v[20:23], v2 offset:19456
    ds_read_b32 v24, v3 offset:27648
    v_exp_f32 v38, v50
    v_exp_f32 v39, v51
    v_cvt_pk_bf16_f32 v80, v36, v37
    v_exp_f32 v40, v52
    v_exp_f32 v41, v53
    v_cvt_pk_bf16_f32 v81, v38, v39
    v_mfma_f32_32x32x16_bf16 v[64:79], v[128:131], v[12:15], 0
    v_exp_f32 v42, v54
    v_exp_f32 v43, v55
    v_cvt_pk_bf16_f32 v82, v40, v41
    v_exp_f32 v36, v56
    v_cvt_pk_bf16_f32 v83, v42, v43
    v_exp_f32 v37, v57
    v_mfma_f32_32x32x8_bf16 v[64:79], v[132:133], v[18:19], v[64:79]
    v_exp_f32 v38, v58
    v_exp_f32 v39, v59
    v_cvt_pk_bf16_f32 v84, v36, v37
    v_exp_f32 v40, v60
    v_exp_f32 v41, v61
    v_cvt_pk_bf16_f32 v85, v38, v39
    s_waitcnt lgkmcnt(3)
    v_mfma_f32_32x32x16_bf16 v[96:111], v[28:31], v[80:83], v[96:111]
    v_exp_f32 v42, v62
    v_exp_f32 v43, v63
    v_cvt_pk_bf16_f32 v86, v40, v41
    v_cvt_pk_bf16_f32 v87, v42, v43
    v_exp_f32 v36, v64
    v_exp_f32 v37, v65
    s_waitcnt lgkmcnt(2)
    v_mfma_f32_32x32x16_bf16 v[96:111], v[32:35], v[84:87], v[96:111]
    v_exp_f32 v38, v66
    v_exp_f32 v39, v67
    v_cvt_pk_bf16_f32 v88, v36, v37
    v_exp_f32 v40, v68
    v_exp_f32 v41, v69
    v_cvt_pk_bf16_f32 v89, v38, v39
    s_waitcnt lgkmcnt(0)
    v_mfma_f32_32x32x16_bf16 v[48:63], v[20:23], v[8:11], 0
    v_exp_f32 v42, v70
    v_exp_f32 v43, v71
    v_cvt_pk_bf16_f32 v90, v40, v41
    v_exp_f32 v36, v72
    v_cvt_pk_bf16_f32 v91, v42, v43
    v_exp_f32 v37, v73
    v_mfma_f32_32x32x8_bf16 v[48:63], v[24:25], v[16:17], v[48:63]
    v_exp_f32 v38, v74
    v_exp_f32 v39, v75
    v_cvt_pk_bf16_f32 v92, v36, v37
    v_exp_f32 v40, v76
    v_exp_f32 v41, v77
    v_cvt_pk_bf16_f32 v93, v38, v39
    v_mfma_f32_32x32x16_bf16 v[112:127], v[28:31], v[88:91], v[112:127]
    ds_read_b128 v[28:31], v4 offset:28672
    v_exp_f32 v42, v78
    v_exp_f32 v43, v79
    v_cvt_pk_bf16_f32 v94, v40, v41
    v_cvt_pk_bf16_f32 v95, v42, v43
    s_cmp_lt_u32 s62, s28
    s_cbranch_scc0 K3_NOSENT7
    buffer_store_dwordx4 v[144:147], v47, s[68:71], s45 offen sc1
    buffer_store_dwordx4 v[144:147], v47, s[68:71], s45 offen offset:1024 sc1
    s_add_u32 s45, s45, 2048
    s_add_u32 s63, s63, 1
    s_cmp_ge_u32 s63, 5
    s_cselect_b32 s62, 9, s62
K3_NOSENT7:
    v_add_u32 v2, 19456, v2
    v_add_u32 v3, 19456, v3
    v_add_u32 v4, 19456, v4
    s_add_u32 s28, s28, 1
    s_cmp_lt_u32 s28, 4
    s_cbranch_scc1 K3_LOOP
    v_mfma_f32_32x32x16_bf16 v[112:127], v[32:35], v[92:95], v[112:127]
    s_cmp_ge_u32 s20, 4
    s_cbranch_scc1 K3_NOUV
    s_cmp_lg_u32 s36, 0
    s_cbranch_scc1 K3_NOUV
    s_mul_i32 s28, s44, 3641
    s_lshr_b32 s28, s28, 16
    s_mul_i32 s29, s28, 18
    s_sub_u32 s29, s44, s29
    s_sub_u32 s31, s29, 9
    s_cmp_ge_u32 s29, 9
    s_cselect_b32 s32, s64, s52
    s_cselect_b32 s33, s65, s53
    s_cselect_b32 s31, s31, s29
    s_cselect_b32 s29, 18432, 0
    s_mov_b32 s34, 5308416
    s_mov_b32 s35, 0x20000
    s_and_b32 s24, s2, 7
    s_mul_i32 s24, s24, 9
    s_add_u32 s24, s24, s31
    s_lshl_b32 s25, s24, 7
    s_lshl_b32 s24, s24, 8
    s_add_u32 s29, s29, s24
    s_mul_i32 s24, s28, 73728
    s_add_u32 s29, s29, s24
    s_mul_i32 s28, s28, 88
    v_lshrrev_b32 v8, 3, v1
    v_add_u32 v8, s28, v8
    v_lshlrev_b32 v9, 2, v8
    v_mul_u32_u24 v8, 9216, v8
    v_and_b32 v10, 7, v1
    v_lshl_add_u32 v8, v10, 4, v8
    s_add_u32 s16, s12, 65536
    s_addc_u32 s17, s13, 0
    s_mov_b32 s18, 13824
    s_mov_b32 s19, 0x20000
    s_movk_i32 s24, 6912
    s_movk_i32 s26, 9216
    buffer_load_dwordx4 v[12:15], v8, s[32:35], s25 offen
    buffer_load_dword v56, v9, s[16:19], s24 offen offset:0
    buffer_load_dword v57, v9, s[16:19], s26 offen offset:0
    s_add_u32 s25, s25, 73728
    buffer_load_dwordx4 v[16:19], v8, s[32:35], s25 offen
    buffer_load_dword v58, v9, s[16:19], s24 offen offset:32
    buffer_load_dword v59, v9, s[16:19], s26 offen offset:32
    s_add_u32 s25, s25, 73728
    buffer_load_dwordx4 v[20:23], v8, s[32:35], s25 offen
    buffer_load_dword v60, v9, s[16:19], s24 offen offset:64
    buffer_load_dword v61, v9, s[16:19], s26 offen offset:64
    s_add_u32 s25, s25, 73728
    buffer_load_dwordx4 v[24:27], v8, s[32:35], s25 offen
    buffer_load_dword v62, v9, s[16:19], s24 offen offset:96
    buffer_load_dword v63, v9, s[16:19], s26 offen offset:96
    s_add_u32 s25, s25, 73728
    buffer_load_dwordx4 v[28:31], v8, s[32:35], s25 offen
    buffer_load_dword v64, v9, s[16:19], s24 offen offset:128
    buffer_load_dword v65, v9, s[16:19], s26 offen offset:128
    s_add_u32 s25, s25, 73728
    buffer_load_dwordx4 v[32:35], v8, s[32:35], s25 offen
    buffer_load_dword v66, v9, s[16:19], s24 offen offset:160
    buffer_load_dword v67, v9, s[16:19], s26 offen offset:160
    s_add_u32 s25, s25, 73728
    buffer_load_dwordx4 v[36:39], v8, s[32:35], s25 offen
    buffer_load_dword v68, v9, s[16:19], s24 offen offset:192
    buffer_load_dword v69, v9, s[16:19], s26 offen offset:192
    s_add_u32 s25, s25, 73728
    buffer_load_dwordx4 v[40:43], v8, s[32:35], s25 offen
    buffer_load_dword v70, v9, s[16:19], s24 offen offset:224
    buffer_load_dword v71, v9, s[16:19], s26 offen offset:224
    s_add_u32 s25, s25, 73728
    buffer_load_dwordx4 v[44:47], v8, s[32:35], s25 offen
    buffer_load_dword v72, v9, s[16:19], s24 offen offset:256
    buffer_load_dword v73, v9, s[16:19], s26 offen offset:256
    s_add_u32 s25, s25, 73728
    buffer_load_dwordx4 v[48:51], v8, s[32:35], s25 offen
    buffer_load_dword v74, v9, s[16:19], s24 offen offset:288
    buffer_load_dword v75, v9, s[16:19], s26 offen offset:288
    s_add_u32 s25, s25, 73728
    buffer_load_dwordx4 v[52:55], v8, s[32:35], s25 offen
    buffer_load_dword v76, v9, s[16:19], s24 offen offset:320
    buffer_load_dword v77, v9, s[16:19], s26 offen offset:320
    s_add_u32 s25, s25, 73728
    s_mov_b32 s30, 0xffff0000
    v_mov_b32 v80, 0
    v_mov_b32 v81, 0
    v_mov_b32 v82, 0
    v_mov_b32 v83, 0
    v_mov_b32 v84, 0
    v_mov_b32 v85, 0
    v_mov_b32 v86, 0
    v_mov_b32 v87, 0
    v_mov_b32 v88, 0
    v_mov_b32 v89, 0
    v_mov_b32 v90, 0
    v_mov_b32 v91, 0
    v_mov_b32 v92, 0
    v_mov_b32 v93, 0
    v_mov_b32 v94, 0
    v_mov_b32 v95, 0
    s_waitcnt vmcnt(30)
    v_lshlrev_b32 v78, 16, v12
    v_and_b32 v79, s30, v12
    v_pk_fma_f32 v[80:81], v[78:79], v[56:57], v[80:81] op_sel:[0,1,0] op_sel_hi:[1,1,1]
    v_pk_fma_f32 v[88:89], v[78:79], v[56:57], v[88:89] op_sel_hi:[1,0,1]
    v_lshlrev_b32 v78, 16, v13
    v_and_b32 v79, s30, v13
    v_pk_fma_f32 v[82:83], v[78:79], v[56:57], v[82:83] op_sel:[0,1,0] op_sel_hi:[1,1,1]
    v_pk_fma_f32 v[90:91], v[78:79], v[56:57], v[90:91] op_sel_hi:[1,0,1]
    v_lshlrev_b32 v78, 16, v14
    v_and_b32 v79, s30, v14
    v_pk_fma_f32 v[84:85], v[78:79], v[56:57], v[84:85] op_sel:[0,1,0] op_sel_hi:[1,1,1]
    v_pk_fma_f32 v[92:93], v[78:79], v[56:57], v[92:93] op_sel_hi:[1,0,1]
    v_lshlrev_b32 v78, 16, v15
    v_and_b32 v79, s30, v15
    v_pk_fma_f32 v[86:87], v[78:79], v[56:57], v[86:87] op_sel:[0,1,0] op_sel_hi:[1,1,1]
    v_pk_fma_f32 v[94:95], v[78:79], v[56:57], v[94:95] op_sel_hi:[1,0,1]
    s_waitcnt vmcnt(27)
    v_lshlrev_b32 v78, 16, v16
    v_and_b32 v79, s30, v16
    v_pk_fma_f32 v[80:81], v[78:79], v[58:59], v[80:81] op_sel:[0,1,0] op_sel_hi:[1,1,1]
    v_pk_fma_f32 v[88:89], v[78:79], v[58:59], v[88:89] op_sel_hi:[1,0,1]
    v_lshlrev_b32 v78, 16, v17
    v_and_b32 v79, s30, v17
    v_pk_fma_f32 v[82:83], v[78:79], v[58:59], v[82:83] op_sel:[0,1,0] op_sel_hi:[1,1,1]
    v_pk_fma_f32 v[90:91], v[78:79], v[58:59], v[90:91] op_sel_hi:[1,0,1]
    v_lshlrev_b32 v78, 16, v18
    v_and_b32 v79, s30, v18
    v_pk_fma_f32 v[84:85], v[78:79], v[58:59], v[84:85] op_sel:[0,1,0] op_sel_hi:[1,1,1]
    v_pk_fma_f32 v[92:93], v[78:79], v[58:59], v[92:93] op_sel_hi:[1,0,1]
    v_lshlrev_b32 v78, 16, v19
    v_and_b32 v79, s30, v19
    v_pk_fma_f32 v[86:87], v[78:79], v[58:59], v[86:87] op_sel:[0,1,0] op_sel_hi:[1,1,1]
    v_pk_fma_f32 v[94:95], v[78:79], v[58:59], v[94:95] op_sel_hi:[1,0,1]
    s_waitcnt vmcnt(24)
    v_lshlrev_b32 v78, 16, v20
    v_and_b32 v79, s30, v20
    v_pk_fma_f32 v[80:81], v[78:79], v[60:61], v[80:81] op_sel:[0,1,0] op_sel_hi:[1,1,1]
    v_pk_fma_f32 v[88:89], v[78:79], v[60:61], v[88:89] op_sel_hi:[1,0,1]
    v_lshlrev_b32 v78, 16, v21
    v_and_b32 v79, s30, v21
    v_pk_fma_f32 v[82:83], v[78:79], v[60:61], v[82:83] op_sel:[0,1,0] op_sel_hi:[1,1,1]
    v_pk_fma_f32 v[90:91], v[78:79], v[60:61], v[90:91] op_sel_hi:[1,0,1]
    v_lshlrev_b32 v78, 16, v22
    v_and_b32 v79, s30, v22
    v_pk_fma_f32 v[84:85], v[78:79], v[60:61], v[84:85] op_sel:[0,1,0] op_sel_hi:[1,1,1]
    v_pk_fma_f32 v[92:93], v[78:79], v[60:61], v[92:93] op_sel_hi:[1,0,1]
    v_lshlrev_b32 v78, 16, v23
    v_and_b32 v79, s30, v23
    v_pk_fma_f32 v[86:87], v[78:79], v[60:61], v[86:87] op_sel:[0,1,0] op_sel_hi:[1,1,1]
    v_pk_fma_f32 v[94:95], v[78:79], v[60:61], v[94:95] op_sel_hi:[1,0,1]
    s_waitcnt vmcnt(21)
    v_lshlrev_b32 v78, 16, v24
    v_and_b32 v79, s30, v24
    v_pk_fma_f32 v[80:81], v[78:79], v[62:63], v[80:81] op_sel:[0,1,0] op_sel_hi:[1,1,1]
    v_pk_fma_f32 v[88:89], v[78:79], v[62:63], v[88:89] op_sel_hi:[1,0,1]
    v_lshlrev_b32 v78, 16, v25
    v_and_b32 v79, s30, v25
    v_pk_fma_f32 v[82:83], v[78:79], v[62:63], v[82:83] op_sel:[0,1,0] op_sel_hi:[1,1,1]
    v_pk_fma_f32 v[90:91], v[78:79], v[62:63], v[90:91] op_sel_hi:[1,0,1]
    v_lshlrev_b32 v78, 16, v26
    v_and_b32 v79, s30, v26
    v_pk_fma_f32 v[84:85], v[78:79], v[62:63], v[84:85] op_sel:[0,1,0] op_sel_hi:[1,1,1]
    v_pk_fma_f32 v[92:93], v[78:79], v[62:63], v[92:93] op_sel_hi:[1,0,1]
    v_lshlrev_b32 v78, 16, v27
    v_and_b32 v79, s30, v27
    v_pk_fma_f32 v[86:87], v[78:79], v[62:63], v[86:87] op_sel:[0,1,0] op_sel_hi:[1,1,1]
    v_pk_fma_f32 v[94:95], v[78:79], v[62:63], v[94:95] op_sel_hi:[1,0,1]
    s_waitcnt vmcnt(18)
    v_lshlrev_b32 v78, 16, v28
    v_and_b32 v79, s30, v28
    v_pk_fma_f32 v[80:81], v[78:79], v[64:65], v[80:81] op_sel:[0,1,0] op_sel_hi:[1,1,1]
    v_pk_fma_f32 v[88:89], v[78:79], v[64:65], v[88:89] op_sel_hi:[1,0,1]
    v_lshlrev_b32 v78, 16, v29
    v_and_b32 v79, s30, v29
    v_pk_fma_f32 v[82:83], v[78:79], v[64:65], v[82:83] op_sel:[0,1,0] op_sel_hi:[1,1,1]
    v_pk_fma_f32 v[90:91], v[78:79], v[64:65], v[90:91] op_sel_hi:[1,0,1]
    v_lshlrev_b32 v78, 16, v30
    v_and_b32 v79, s30, v30
    v_pk_fma_f32 v[84:85], v[78:79], v[64:65], v[84:85] op_sel:[0,1,0] op_sel_hi:[1,1,1]
    v_pk_fma_f32 v[92:93], v[78:79], v[64:65], v[92:93] op_sel_hi:[1,0,1]
    v_lshlrev_b32 v78, 16, v31
    v_and_b32 v79, s30, v31
    v_pk_fma_f32 v[86:87], v[78:79], v[64:65], v[86:87] op_sel:[0,1,0] op_sel_hi:[1,1,1]
    v_pk_fma_f32 v[94:95], v[78:79], v[64:65], v[94:95] op_sel_hi:[1,0,1]
    s_waitcnt vmcnt(15)
    v_lshlrev_b32 v78, 16, v32
    v_and_b32 v79, s30, v32
    v_pk_fma_f32 v[80:81], v[78:79], v[66:67], v[80:81] op_sel:[0,1,0] op_sel_hi:[1,1,1]
    v_pk_fma_f32 v[88:89], v[78:79], v[66:67], v[88:89] op_sel_hi:[1,0,1]
    v_lshlrev_b32 v78, 16, v33
    v_and_b32 v79, s30, v33
    v_pk_fma_f32 v[82:83], v[78:79], v[66:67], v[82:83] op_sel:[0,1,0] op_sel_hi:[1,1,1]
    v_pk_fma_f32 v[90:91], v[78:79], v[66:67], v[90:91] op_sel_hi:[1,0,1]
    v_lshlrev_b32 v78, 16, v34
    v_and_b32 v79, s30, v34
    v_pk_fma_f32 v[84:85], v[78:79], v[66:67], v[84:85] op_sel:[0,1,0] op_sel_hi:[1,1,1]
    v_pk_fma_f32 v[92:93], v[78:79], v[66:67], v[92:93] op_sel_hi:[1,0,1]
    v_lshlrev_b32 v78, 16, v35
    v_and_b32 v79, s30, v35
    v_pk_fma_f32 v[86:87], v[78:79], v[66:67], v[86:87] op_sel:[0,1,0] op_sel_hi:[1,1,1]
    v_pk_fma_f32 v[94:95], v[78:79], v[66:67], v[94:95] op_sel_hi:[1,0,1]
    s_waitcnt vmcnt(12)
    v_lshlrev_b32 v78, 16, v36
    v_and_b32 v79, s30, v36
    v_pk_fma_f32 v[80:81], v[78:79], v[68:69], v[80:81] op_sel:[0,1,0] op_sel_hi:[1,1,1]
    v_pk_fma_f32 v[88:89], v[78:79], v[68:69], v[88:89] op_sel_hi:[1,0,1]
    v_lshlrev_b32 v78, 16, v37
    v_and_b32 v79, s30, v37
    v_pk_fma_f32 v[82:83], v[78:79], v[68:69], v[82:83] op_sel:[0,1,0] op_sel_hi:[1,1,1]
    v_pk_fma_f32 v[90:91], v[78:79], v[68:69], v[90:91] op_sel_hi:[1,0,1]
    v_lshlrev_b32 v78, 16, v38
    v_and_b32 v79, s30, v38
    v_pk_fma_f32 v[84:85], v[78:79], v[68:69], v[84:85] op_sel:[0,1,0] op_sel_hi:[1,1,1]
    v_pk_fma_f32 v[92:93], v[78:79], v[68:69], v[92:93] op_sel_hi:[1,0,1]
    v_lshlrev_b32 v78, 16, v39
    v_and_b32 v79, s30, v39
    v_pk_fma_f32 v[86:87], v[78:79], v[68:69], v[86:87] op_sel:[0,1,0] op_sel_hi:[1,1,1]
    v_pk_fma_f32 v[94:95], v[78:79], v[68:69], v[94:95] op_sel_hi:[1,0,1]
    s_waitcnt vmcnt(9)
    v_lshlrev_b32 v78, 16, v40
    v_and_b32 v79, s30, v40
    v_pk_fma_f32 v[80:81], v[78:79], v[70:71], v[80:81] op_sel:[0,1,0] op_sel_hi:[1,1,1]
    v_pk_fma_f32 v[88:89], v[78:79], v[70:71], v[88:89] op_sel_hi:[1,0,1]
    v_lshlrev_b32 v78, 16, v41
    v_and_b32 v79, s30, v41
    v_pk_fma_f32 v[82:83], v[78:79], v[70:71], v[82:83] op_sel:[0,1,0] op_sel_hi:[1,1,1]
    v_pk_fma_f32 v[90:91], v[78:79], v[70:71], v[90:91] op_sel_hi:[1,0,1]
    v_lshlrev_b32 v78, 16, v42
    v_and_b32 v79, s30, v42
    v_pk_fma_f32 v[84:85], v[78:79], v[70:71], v[84:85] op_sel:[0,1,0] op_sel_hi:[1,1,1]
    v_pk_fma_f32 v[92:93], v[78:79], v[70:71], v[92:93] op_sel_hi:[1,0,1]
    v_lshlrev_b32 v78, 16, v43
    v_and_b32 v79, s30, v43
    v_pk_fma_f32 v[86:87], v[78:79], v[70:71], v[86:87] op_sel:[0,1,0] op_sel_hi:[1,1,1]
    v_pk_fma_f32 v[94:95], v[78:79], v[70:71], v[94:95] op_sel_hi:[1,0,1]
    s_waitcnt vmcnt(6)
    v_lshlrev_b32 v78, 16, v44
    v_and_b32 v79, s30, v44
    v_pk_fma_f32 v[80:81], v[78:79], v[72:73], v[80:81] op_sel:[0,1,0] op_sel_hi:[1,1,1]
    v_pk_fma_f32 v[88:89], v[78:79], v[72:73], v[88:89] op_sel_hi:[1,0,1]
    v_lshlrev_b32 v78, 16, v45
    v_and_b32 v79, s30, v45
    v_pk_fma_f32 v[82:83], v[78:79], v[72:73], v[82:83] op_sel:[0,1,0] op_sel_hi:[1,1,1]
    v_pk_fma_f32 v[90:91], v[78:79], v[72:73], v[90:91] op_sel_hi:[1,0,1]
    v_lshlrev_b32 v78, 16, v46
    v_and_b32 v79, s30, v46
    v_pk_fma_f32 v[84:85], v[78:79], v[72:73], v[84:85] op_sel:[0,1,0] op_sel_hi:[1,1,1]
    v_pk_fma_f32 v[92:93], v[78:79], v[72:73], v[92:93] op_sel_hi:[1,0,1]
    v_lshlrev_b32 v78, 16, v47
    v_and_b32 v79, s30, v47
    v_pk_fma_f32 v[86:87], v[78:79], v[72:73], v[86:87] op_sel:[0,1,0] op_sel_hi:[1,1,1]
    v_pk_fma_f32 v[94:95], v[78:79], v[72:73], v[94:95] op_sel_hi:[1,0,1]
    s_waitcnt vmcnt(3)
    v_lshlrev_b32 v78, 16, v48
    v_and_b32 v79, s30, v48
    v_pk_fma_f32 v[80:81], v[78:79], v[74:75], v[80:81] op_sel:[0,1,0] op_sel_hi:[1,1,1]
    v_pk_fma_f32 v[88:89], v[78:79], v[74:75], v[88:89] op_sel_hi:[1,0,1]
    v_lshlrev_b32 v78, 16, v49
    v_and_b32 v79, s30, v49
    v_pk_fma_f32 v[82:83], v[78:79], v[74:75], v[82:83] op_sel:[0,1,0] op_sel_hi:[1,1,1]
    v_pk_fma_f32 v[90:91], v[78:79], v[74:75], v[90:91] op_sel_hi:[1,0,1]
    v_lshlrev_b32 v78, 16, v50
    v_and_b32 v79, s30, v50
    v_pk_fma_f32 v[84:85], v[78:79], v[74:75], v[84:85] op_sel:[0,1,0] op_sel_hi:[1,1,1]
    v_pk_fma_f32 v[92:93], v[78:79], v[74:75], v[92:93] op_sel_hi:[1,0,1]
    v_lshlrev_b32 v78, 16, v51
    v_and_b32 v79, s30, v51
    v_pk_fma_f32 v[86:87], v[78:79], v[74:75], v[86:87] op_sel:[0,1,0] op_sel_hi:[1,1,1]
    v_pk_fma_f32 v[94:95], v[78:79], v[74:75], v[94:95] op_sel_hi:[1,0,1]
    s_waitcnt vmcnt(0)
    v_lshlrev_b32 v78, 16, v52
    v_and_b32 v79, s30, v52
    v_pk_fma_f32 v[80:81], v[78:79], v[76:77], v[80:81] op_sel:[0,1,0] op_sel_hi:[1,1,1]
    v_pk_fma_f32 v[88:89], v[78:79], v[76:77], v[88:89] op_sel_hi:[1,0,1]
    v_lshlrev_b32 v78, 16, v53
    v_and_b32 v79, s30, v53
    v_pk_fma_f32 v[82:83], v[78:79], v[76:77], v[82:83] op_sel:[0,1,0] op_sel_hi:[1,1,1]
    v_pk_fma_f32 v[90:91], v[78:79], v[76:77], v[90:91] op_sel_hi:[1,0,1]
    v_lshlrev_b32 v78, 16, v54
    v_and_b32 v79, s30, v54
    v_pk_fma_f32 v[84:85], v[78:79], v[76:77], v[84:85] op_sel:[0,1,0] op_sel_hi:[1,1,1]
    v_pk_fma_f32 v[92:93], v[78:79], v[76:77], v[92:93] op_sel_hi:[1,0,1]
    v_lshlrev_b32 v78, 16, v55
    v_and_b32 v79, s30, v55
    v_pk_fma_f32 v[86:87], v[78:79], v[76:77], v[86:87] op_sel:[0,1,0] op_sel_hi:[1,1,1]
    v_pk_fma_f32 v[94:95], v[78:79], v[76:77], v[94:95] op_sel_hi:[1,0,1]
    v_permlane32_swap_b32 v80, v84
    v_permlane32_swap_b32 v81, v85
    v_permlane32_swap_b32 v82, v86
    v_permlane32_swap_b32 v83, v87
    v_add_f32 v80, v80, v84
    v_add_f32 v81, v81, v85
    v_add_f32 v82, v82, v86
    v_add_f32 v83, v83, v87
    s_nop 0
    v_permlane16_swap_b32 v80, v82
    v_permlane16_swap_b32 v81, v83
    v_add_f32 v80, v80, v82
    v_add_f32 v81, v81, v83
    s_nop 0
    v_add_f32_dpp v80, v80, v80 row_ror:8 row_mask:0xf bank_mask:0xf
    v_add_f32_dpp v81, v81, v81 row_ror:8 row_mask:0xf bank_mask:0xf
    v_permlane32_swap_b32 v88, v92
    v_permlane32_swap_b32 v89, v93
    v_permlane32_swap_b32 v90, v94
    v_permlane32_swap_b32 v91, v95
    v_add_f32 v88, v88, v92
    v_add_f32 v89, v89, v93
    v_add_f32 v90, v90, v94
    v_add_f32 v91, v91, v95
    s_nop 0
    v_permlane16_swap_b32 v88, v90
    v_permlane16_swap_b32 v89, v91
    v_add_f32 v88, v88, v90
    v_add_f32 v89, v89, v91
    s_nop 0
    v_add_f32_dpp v88, v88, v88 row_ror:8 row_mask:0xf bank_mask:0xf
    v_add_f32_dpp v89, v89, v89 row_ror:8 row_mask:0xf bank_mask:0xf
    s_add_u32 s16, s12, 655360
    s_addc_u32 s17, s13, 0
    s_mov_b32 s18, 516096
    s_mov_b32 s19, 0x20000
    v_lshlrev_b32 v10, 5, v10
    v_lshrrev_b32 v9, 4, v1
    v_lshl_add_u32 v10, v9, 3, v10
    s_add_u32 s24, s29, 36864
    buffer_store_dwordx2 v[80:81], v10, s[16:19], s29 offen
    buffer_store_dwordx2 v[88:89], v10, s[16:19], s24 offen
    s_add_u32 s16, s12, 81920
    s_addc_u32 s17, s13, 0
    s_mov_b32 s18, 512
    s_mov_b32 s19, 0x20000
K3_NOUV:
    s_waitcnt lgkmcnt(0)
    s_barrier
    v_min_f32 v36, v106, v122
    v_mov_b32 v37, 0x2b800000
    v_cmp_nlt_f32 vcc, v37, v36
    s_nop 0
    s_and_b32 s29, vcc_lo, -1
    s_cselect_b32 s29, 1, 0
    v_mov_b32 v37, s29
    s_lshl_b32 s31, s20, 2
    s_add_u32 s31, s31, 157696
    v_mov_b32 v36, s31
    ds_write_b32 v36, v37
    s_mul_i32 s31, s22, 3072
    s_add_u32 s31, s31, 58368
    v_lshlrev_b32 v36, 4, v1
    v_add_u32 v36, s31, v36
    s_mul_i32 s31, s21, 77824
    v_add_u32 v37, s31, v36
    s_sub_u32 s31, 77824, s31
    v_add_u32 v38, s31, v36
    s_cmp_eq_u32 s21, 0
    s_cbranch_scc1 K3_KH0
    ds_write_b128 v37, v[96:99] offset:0
    ds_write_b128 v37, v[100:103] offset:1024
    ds_write_b128 v37, v[104:107] offset:2048
    v_mov_b32 v96, v112
    v_mov_b32 v97, v113
    v_mov_b32 v98, v114
    v_mov_b32 v99, v115
    v_mov_b32 v100, v116
    v_mov_b32 v101, v117
    v_mov_b32 v102, v118
    v_mov_b32 v103, v119
    v_mov_b32 v104, v120
    v_mov_b32 v105, v121
    v_mov_b32 v106, v122
    v_mov_b32 v107, v123
    s_add_u32 s23, s23, 1152
    s_branch K3_SENT
K3_KH0:
    ds_write_b128 v37, v[112:115] offset:0
    ds_write_b128 v37, v[116:119] offset:1024
    ds_write_b128 v37, v[120:123] offset:2048
K3_SENT:
    s_waitcnt lgkmcnt(0)
    s_barrier
    v_mov_b32 v39, 157696
    ds_read_b128 v[48:51], v39
    ds_read_b128 v[52:55], v39 offset:16
    ds_read_b128 v[64:67], v38 offset:0
    ds_read_b128 v[68:71], v38 offset:1024
    ds_read_b128 v[72:75], v38 offset:2048
    s_waitcnt lgkmcnt(3)
    v_or3_b32 v48, v48, v49, v50
    v_or3_b32 v52, v52, v53, v54
    v_or3_b32 v48, v48, v51, v55
    v_or_b32 v48, v48, v52
    s_nop 0
    v_readfirstlane_b32 s29, v48
    s_nop 0
    s_andn2_b32 s29, s29, s36
    s_cmp_lg_u32 s29, 0
    s_cbranch_scc0 K3_FIN
    s_mov_b32 s36, 1
    s_waitcnt lgkmcnt(0)
    s_barrier
    s_branch K3_RESTART
K3_FIN:
    s_waitcnt lgkmcnt(0)
    v_add_f32 v96, v96, v64
    v_add_f32 v97, v97, v65
    v_add_f32 v98, v98, v66
    v_add_f32 v99, v99, v67
    v_add_f32 v100, v100, v68
    v_add_f32 v101, v101, v69
    v_add_f32 v102, v102, v70
    v_add_f32 v103, v103, v71
    v_add_f32 v104, v104, v72
    v_add_f32 v105, v105, v73
    v_add_f32 v106, v106, v74
    v_add_f32 v107, v107, v75
    v_mov_b32 v36, v106
    v_mov_b32 v37, v106
    s_nop 1
    v_permlane32_swap_b32 v36, v37
    v_rcp_f32 v36, v36
    s_nop 0
    v_mul_f32 v96, v96, v36
    v_mul_f32 v97, v97, v36
    v_mul_f32 v98, v98, v36
    v_mul_f32 v99, v99, v36
    v_mul_f32 v100, v100, v36
    v_mul_f32 v101, v101, v36
    v_mul_f32 v102, v102, v36
    v_mul_f32 v103, v103, v36
    v_mul_f32 v104, v104, v36
    v_mul_f32 v105, v105, v36
    v_cvt_pk_bf16_f32 v48, v96, v97
    v_cvt_pk_bf16_f32 v49, v98, v99
    v_cvt_pk_bf16_f32 v50, v100, v101
    v_cvt_pk_bf16_f32 v51, v102, v103
    v_cvt_pk_bf16_f32 v52, v104, v105
    s_lshl_b32 s24, s22, 1
    s_add_u32 s24, s24, s21
    s_and_b32 s25, s24, 3
    s_mul_i32 s25, s25, 1152
    s_lshr_b32 s24, s24, 2
    s_mul_i32 s24, s24, 77824
    s_add_u32 s24, s24, s25
    s_add_u32 s24, s24, 70656
    v_lshl_add_u32 v44, v6, 3, v7
    v_add_u32 v44, s24, v44
    ds_write2_b32 v44, v48, v49 offset0:0 offset1:1
    ds_write2_b32 v44, v50, v51 offset0:4 offset1:5
    v_cmp_gt_u32 vcc, 32, v1
    s_nop 0
    s_and_saveexec_b64 s[28:29], vcc
    ds_write_b32 v44, v52 offset:32
    s_mov_b64 exec, s[28:29]
    v_and_b32 v44, 7, v0
    v_lshrrev_b32 v45, 3, v0
    v_and_b32 v46, 3, v0
    v_mul_u32_u24 v46, 1152, v46
    v_lshl_add_u32 v46, v45, 4, v46
    v_bfe_u32 v47, v0, 2, 1
    v_mul_u32_u24 v47, 77824, v47
    v_add3_u32 v46, v46, v47, 0
    v_add_u32 v46, 70656, v46
    v_lshlrev_b32 v45, 8, v45
    v_lshl_add_u32 v45, v44, 4, v45
    s_lshr_b32 s24, s37, 4
    s_mul_i32 s24, s24, 18432
    s_and_b32 s25, s37, 8
    s_lshl_b32 s25, s25, 4
    s_add_u32 s24, s24, s25
    s_add_u32 s25, s24, 16384
    s_waitcnt vmcnt(0) lgkmcnt(0)
    s_barrier
    ds_read_b128 v[48:51], v46
    s_cmp_lg_u32 s20, 0
    s_cbranch_scc1 K3_ST1
    ds_read_b128 v[52:55], v46 offset:1024
    s_waitcnt lgkmcnt(0)
    buffer_store_dwordx4 v[52:55], v45, s[40:43], s25 offen
K3_ST1:
    s_waitcnt lgkmcnt(0)
    buffer_store_dwordx4 v[48:51], v45, s[40:43], s24 offen
K3_END:
    s_endpgm
.globl k4_kernel
.p2align 8
.type k4_kernel,@function
k4_kernel:
    s_cmp_ge_u32 s2, 256
    s_cbranch_scc1 K4_END
    s_load_dwordx2 s[12:13], s[0:1], 104
    s_mov_b32 s30, 0xffff0000
    v_and_b32 v1, 63, v0
    v_lshrrev_b32 v2, 6, v0
    s_nop 0
    v_readfirstlane_b32 s20, v2
    s_cmp_ge_u32 s2, 192
    s_cbranch_scc1 K4_RL
    s_load_dwordx2 s[4:5], s[0:1], 32
    s_load_dwordx2 s[40:41], s[0:1], 0
    s_and_b32 s21, s2, 7
    s_lshr_b32 s22, s2, 3
    s_mul_i32 s23, s22, 43
    s_lshr_b32 s23, s23, 8
    s_mul_i32 s24, s23, 6
    s_sub_u32 s24, s22, s24
    s_lshl_b32 s21, s21, 2
    s_add_u32 s21, s21, s23
    s_lshl_b32 s25, s21, 2
    s_add_u32 s25, s25, s20
    s_mul_i32 s26, s25, 18432
    v_lshrrev_b32 v5, 4, v1
    v_and_b32 v6, 15, v1
    v_mul_u32_u24 v2, 1152, v6
    v_lshlrev_b32 v3, 4, v1
    v_lshl_add_u32 v2, v5, 3, v2
    v_add_u32 v84, 0, v1
    v_mul_u32_u24 v85, 43691, v84
    v_lshrrev_b32 v85, 19, v85
    v_mul_u32_u24 v86, 12, v85
    v_sub_u32 v84, v84, v86
    v_bfe_u32 v86, v85, 3, 1
    v_lshlrev_b32 v86, 1, v86
    v_xor_b32 v84, v84, v86
    v_lshlrev_b32 v84, 4, v84
    v_mul_u32_u24 v85, 1152, v85
    v_add_u32 v80, v85, v84
    v_add_u32 v84, 64, v1
    v_mul_u32_u24 v85, 43691, v84
    v_lshrrev_b32 v85, 19, v85
    v_mul_u32_u24 v86, 12, v85
    v_sub_u32 v84, v84, v86
    v_bfe_u32 v86, v85, 3, 1
    v_lshlrev_b32 v86, 1, v86
    v_xor_b32 v84, v84, v86
    v_lshlrev_b32 v84, 4, v84
    v_mul_u32_u24 v85, 1152, v85
    v_add_u32 v81, v85, v84
    v_add_u32 v84, 128, v1
    v_mul_u32_u24 v85, 43691, v84
    v_lshrrev_b32 v85, 19, v85
    v_mul_u32_u24 v86, 12, v85
    v_sub_u32 v84, v84, v86
    v_bfe_u32 v86, v85, 3, 1
    v_lshlrev_b32 v86, 1, v86
    v_xor_b32 v84, v84, v86
    v_lshlrev_b32 v84, 4, v84
    v_mul_u32_u24 v85, 1152, v85
    v_add_u32 v82, v85, v84
    s_mul_i32 s27, s24, 192
    s_mul_i32 s28, s20, 18432
    s_add_u32 s27, s27, s28
    s_mul_i32 s28, s20, 3072
    s_waitcnt lgkmcnt(0)
    s_add_u32 s8, s12, 8388608
    s_addc_u32 s9, s13, 0
    s_mov_b32 s10, 2359296
    s_mov_b32 s11, 0x20000
    s_mov_b32 s6, 663552
    s_mov_b32 s7, 0x20000
    s_add_u32 m0, s28, 0
    s_add_u32 s29, s27, 0
    buffer_load_dwordx4 v80, s[4:7], s29 offen lds
    s_add_u32 m0, s28, 1024
    s_nop 0
    buffer_load_dwordx4 v81, s[4:7], s29 offen lds
    s_add_u32 m0, s28, 2048
    s_nop 0
    buffer_load_dwordx4 v82, s[4:7], s29 offen lds
    s_add_u32 s36, s26, 0
    buffer_load_dwordx4 v[8:11], v3, s[8:11], s36 offen offset:0
    s_add_u32 s36, s26, 0
    buffer_load_dwordx4 v[12:15], v3, s[8:11], s36 offen offset:1024
    s_add_u32 m0, s28, 12288
    s_add_u32 s29, s27, 73728
    buffer_load_dwordx4 v80, s[4:7], s29 offen lds
    s_add_u32 m0, s28, 13312
    s_nop 0
    buffer_load_dwordx4 v81, s[4:7], s29 offen lds
    s_add_u32 m0, s28, 14336
    s_nop 0
    buffer_load_dwordx4 v82, s[4:7], s29 offen lds
    s_add_u32 s36, s26, 0
    buffer_load_dwordx4 v[16:19], v3, s[8:11], s36 offen offset:2048
    s_add_u32 s36, s26, 0
    buffer_load_dwordx4 v[20:23], v3, s[8:11], s36 offen offset:3072
    s_add_u32 m0, s28, 24576
    s_add_u32 s29, s27, 147456
    buffer_load_dwordx4 v80, s[4:7], s29 offen lds
    s_add_u32 m0, s28, 25600
    s_nop 0
    buffer_load_dwordx4 v81, s[4:7], s29 offen lds
    s_add_u32 m0, s28, 26624
    s_nop 0
    buffer_load_dwordx4 v82, s[4:7], s29 offen lds
    s_add_u32 s36, s26, 4096
    buffer_load_dwordx4 v[24:27], v3, s[8:11], s36 offen offset:0
    s_add_u32 s36, s26, 4096
    buffer_load_dwordx4 v[28:31], v3, s[8:11], s36 offen offset:1024
    s_add_u32 m0, s28, 36864
    s_add_u32 s29, s27, 221184
    buffer_load_dwordx4 v80, s[4:7], s29 offen lds
    s_add_u32 m0, s28, 37888
    s_nop 0
    buffer_load_dwordx4 v81, s[4:7], s29 offen lds
    s_add_u32 m0, s28, 38912
    s_nop 0
    buffer_load_dwordx4 v82, s[4:7], s29 offen lds
    s_add_u32 s36, s26, 4096
    buffer_load_dwordx4 v[32:35], v3, s[8:11], s36 offen offset:2048
    s_add_u32 s36, s26, 4096
    buffer_load_dwordx4 v[36:39], v3, s[8:11], s36 offen offset:3072
    s_add_u32 m0, s28, 49152
    s_add_u32 s29, s27, 294912
    buffer_load_dwordx4 v80, s[4:7], s29 offen lds
    s_add_u32 m0, s28, 50176
    s_nop 0
    buffer_load_dwordx4 v81, s[4:7], s29 offen lds
    s_add_u32 m0, s28, 51200
    s_nop 0
    buffer_load_dwordx4 v82, s[4:7], s29 offen lds
    s_add_u32 s36, s26, 8192
    buffer_load_dwordx4 v[40:43], v3, s[8:11], s36 offen offset:0
    s_add_u32 s36, s26, 8192
    buffer_load_dwordx4 v[44:47], v3, s[8:11], s36 offen offset:1024
    s_mov_b32 s42, 2359296
    s_mov_b32 s43, 0x20000
    s_add_u32 s44, s12, 65536
    s_addc_u32 s45, s13, 0
    s_mov_b32 s46, 13824
    s_mov_b32 s47, 0x20000
    s_mul_i32 s31, s24, 192
    s_add_u32 s31, s26, s31
    s_mul_i32 s32, s24, 384
    s_add_u32 s33, s32, 9216
    s_add_u32 s32, s32, 4608
    v_lshlrev_b32 v4, 4, v5
    v_bfe_u32 v7, v1, 2, 2
    v_lshl_add_u32 v7, v5, 3, v7
    v_and_b32 v87, 3, v1
    v_lshlrev_b32 v87, 3, v87
    v_mul_u32_u24 v88, 192, v7
    v_add_u32 v88, v88, v87
    v_and_b32 v89, 1, v5
    v_lshlrev_b32 v89, 5, v89
    v_add_u32 v90, v88, v89
    v_sub_u32 v91, v88, v89
    v_add_u32 v92, 0xd800, v90
    v_add_u32 v93, 0xd800, v91
    s_waitcnt vmcnt(15)
    s_barrier
    ds_read_b64_tr_b16 v[100:101], v90 offset:0
    ds_read_b64_tr_b16 v[102:103], v90 offset:768
    ds_read_b64_tr_b16 v[104:105], v91 offset:32
    ds_read_b64_tr_b16 v[106:107], v91 offset:800
    ds_read_b64_tr_b16 v[108:109], v90 offset:64
    ds_read_b64_tr_b16 v[110:111], v90 offset:832
    ds_read_b64_tr_b16 v[112:113], v91 offset:96
    ds_read_b64_tr_b16 v[114:115], v91 offset:864
    ds_read_b64_tr_b16 v[116:117], v90 offset:128
    ds_read_b64_tr_b16 v[118:119], v90 offset:896
    s_waitcnt lgkmcnt(8)
    v_mfma_f32_16x16x32_bf16 v[140:143], v[100:103], v[8:11], 0
    s_add_u32 m0, s28, 61440
    s_add_u32 s29, s27, 368640
    buffer_load_dwordx4 v80, s[4:7], s29 offen lds
    ds_read_b64_tr_b16 v[120:121], v91 offset:160
    ds_read_b64_tr_b16 v[122:123], v91 offset:928
    s_waitcnt lgkmcnt(8)
    v_mfma_f32_16x16x32_bf16 v[144:147], v[104:107], v[8:11], 0
    s_add_u32 m0, s28, 62464
    s_nop 0
    buffer_load_dwordx4 v81, s[4:7], s29 offen lds
    ds_read_b64_tr_b16 v[100:101], v90 offset:6144
    ds_read_b64_tr_b16 v[102:103], v90 offset:6912
    s_waitcnt lgkmcnt(8)
    v_mfma_f32_16x16x32_bf16 v[148:151], v[108:111], v[8:11], 0
    s_add_u32 m0, s28, 63488
    s_nop 0
    buffer_load_dwordx4 v82, s[4:7], s29 offen lds
    ds_read_b64_tr_b16 v[104:105], v91 offset:6176
    ds_read_b64_tr_b16 v[106:107], v91 offset:6944
    s_waitcnt lgkmcnt(8)
    v_mfma_f32_16x16x32_bf16 v[152:155], v[112:115], v[8:11], 0
    s_add_u32 s36, s26, 8192
    buffer_load_dwordx4 v[48:51], v3, s[8:11], s36 offen offset:2048
    ds_read_b64_tr_b16 v[108:109], v90 offset:6208
    ds_read_b64_tr_b16 v[110:111], v90 offset:6976
    s_waitcnt lgkmcnt(8)
    v_mfma_f32_16x16x32_bf16 v[156:159], v[116:119], v[8:11], 0
    s_add_u32 s36, s26, 8192
    buffer_load_dwordx4 v[52:55], v3, s[8:11], s36 offen offset:3072
    ds_read_b64_tr_b16 v[112:113], v91 offset:6240
    ds_read_b64_tr_b16 v[114:115], v91 offset:7008
    s_waitcnt lgkmcnt(8)
    v_mfma_f32_16x16x32_bf16 v[160:163], v[120:123], v[8:11], 0
    s_add_u32 m0, s28, 73728
    s_add_u32 s29, s27, 442368
    buffer_load_dwordx4 v80, s[4:7], s29 offen lds
    ds_read_b64_tr_b16 v[116:117], v90 offset:6272
    ds_read_b64_tr_b16 v[118:119], v90 offset:7040
    s_waitcnt lgkmcnt(8)
    v_mfma_f32_16x16x32_bf16 v[140:143], v[100:103], v[12:15], v[140:143]
    s_add_u32 m0, s28, 74752
    s_nop 0
    buffer_load_dwordx4 v81, s[4:7], s29 offen lds
    ds_read_b64_tr_b16 v[120:121], v91 offset:6304
    ds_read_b64_tr_b16 v[122:123], v91 offset:7072
    s_waitcnt lgkmcnt(8)
    v_mfma_f32_16x16x32_bf16 v[144:147], v[104:107], v[12:15], v[144:147]
    s_add_u32 m0, s28, 75776
    s_nop 0
    buffer_load_dwordx4 v82, s[4:7], s29 offen lds
    ds_read_b64_tr_b16 v[100:101], v90 offset:12288
    ds_read_b64_tr_b16 v[102:103], v90 offset:13056
    s_waitcnt lgkmcnt(8)
    v_mfma_f32_16x16x32_bf16 v[148:151], v[108:111], v[12:15], v[148:151]
    s_add_u32 s36, s26, 12288
    buffer_load_dwordx4 v[56:59], v3, s[8:11], s36 offen offset:0
    ds_read_b64_tr_b16 v[104:105], v91 offset:12320
    ds_read_b64_tr_b16 v[106:107], v91 offset:13088
    s_waitcnt lgkmcnt(8)
    v_mfma_f32_16x16x32_bf16 v[152:155], v[112:115], v[12:15], v[152:155]
    s_add_u32 s36, s26, 12288
    buffer_load_dwordx4 v[60:63], v3, s[8:11], s36 offen offset:1024
    ds_read_b64_tr_b16 v[108:109], v90 offset:12352
    ds_read_b64_tr_b16 v[110:111], v90 offset:13120
    s_waitcnt lgkmcnt(8)
    v_mfma_f32_16x16x32_bf16 v[156:159], v[116:119], v[12:15], v[156:159]
    s_add_u32 m0, s28, 86016
    s_add_u32 s29, s27, 516096
    buffer_load_dwordx4 v80, s[4:7], s29 offen lds
    ds_read_b64_tr_b16 v[112:113], v91 offset:12384
    ds_read_b64_tr_b16 v[114:115], v91 offset:13152
    s_waitcnt lgkmcnt(8)
    v_mfma_f32_16x16x32_bf16 v[160:163], v[120:123], v[12:15], v[160:163]
    s_add_u32 m0, s28, 87040
    s_nop 0
    buffer_load_dwordx4 v81, s[4:7], s29 offen lds
    ds_read_b64_tr_b16 v[116:117], v90 offset:12416
    ds_read_b64_tr_b16 v[118:119], v90 offset:13184
    s_waitcnt lgkmcnt(8)
    v_mfma_f32_16x16x32_bf16 v[140:143], v[100:103], v[16:19], v[140:143]
    s_add_u32 m0, s28, 88064
    s_nop 0
    buffer_load_dwordx4 v82, s[4:7], s29 offen lds
    ds_read_b64_tr_b16 v[120:121], v91 offset:12448
    ds_read_b64_tr_b16 v[122:123], v91 offset:13216
    s_waitcnt lgkmcnt(8)
    v_mfma_f32_16x16x32_bf16 v[144:147], v[104:107], v[16:19], v[144:147]
    s_add_u32 s36, s26, 12288
    buffer_load_dwordx4 v[64:67], v3, s[8:11], s36 offen offset:2048
    ds_read_b64_tr_b16 v[100:101], v90 offset:18432
    ds_read_b64_tr_b16 v[102:103], v90 offset:19200
    s_waitcnt lgkmcnt(8)
    v_mfma_f32_16x16x32_bf16 v[148:151], v[108:111], v[16:19], v[148:151]
    s_add_u32 s36, s26, 12288
    buffer_load_dwordx4 v[68:71], v3, s[8:11], s36 offen offset:3072
    ds_read_b64_tr_b16 v[104:105], v91 offset:18464
    ds_read_b64_tr_b16 v[106:107], v91 offset:19232
    s_waitcnt lgkmcnt(8)
    v_mfma_f32_16x16x32_bf16 v[152:155], v[112:115], v[16:19], v[152:155]
    s_add_u32 m0, s28, 98304
    s_add_u32 s29, s27, 589824
    buffer_load_dwordx4 v80, s[4:7], s29 offen lds
    ds_read_b64_tr_b16 v[108:109], v90 offset:18496
    ds_read_b64_tr_b16 v[110:111], v90 offset:19264
    s_waitcnt lgkmcnt(8)
    v_mfma_f32_16x16x32_bf16 v[156:159], v[116:119], v[16:19], v[156:159]
    s_add_u32 m0, s28, 99328
    s_nop 0
    buffer_load_dwordx4 v81, s[4:7], s29 offen lds
    ds_read_b64_tr_b16 v[112:113], v91 offset:18528
    ds_read_b64_tr_b16 v[114:115], v91 offset:19296
    s_waitcnt lgkmcnt(8)
    v_mfma_f32_16x16x32_bf16 v[160:163], v[120:123], v[16:19], v[160:163]
    s_add_u32 m0, s28, 100352
    s_nop 0
    buffer_load_dwordx4 v82, s[4:7], s29 offen lds
    ds_read_b64_tr_b16 v[116:117], v90 offset:18560
    ds_read_b64_tr_b16 v[118:119], v90 offset:19328
    s_waitcnt lgkmcnt(8)
    v_mfma_f32_16x16x32_bf16 v[140:143], v[100:103], v[20:23], v[140:143]
    s_add_u32 s36, s26, 16384
    buffer_load_dwordx4 v[72:75], v3, s[8:11], s36 offen offset:0
    ds_read_b64_tr_b16 v[120:121], v91 offset:18592
    ds_read_b64_tr_b16 v[122:123], v91 offset:19360
    s_waitcnt lgkmcnt(8)
    v_mfma_f32_16x16x32_bf16 v[144:147], v[104:107], v[20:23], v[144:147]
    s_add_u32 s36, s26, 16384
    buffer_load_dwordx4 v[76:79], v3, s[8:11], s36 offen offset:1024
    s_waitcnt lgkmcnt(6)
    v_mfma_f32_16x16x32_bf16 v[148:151], v[108:111], v[20:23], v[148:151]
    buffer_load_dwordx2 v[164:165], v2, s[40:43], s31 offen offset:0
    s_waitcnt lgkmcnt(4)
    v_mfma_f32_16x16x32_bf16 v[152:155], v[112:115], v[20:23], v[152:155]
    buffer_load_dwordx4 v[176:179], v4, s[44:47], s32 offen offset:0
    s_waitcnt lgkmcnt(2)
    v_mfma_f32_16x16x32_bf16 v[156:159], v[116:119], v[20:23], v[156:159]
    buffer_load_dwordx4 v[200:203], v4, s[44:47], s33 offen offset:0
    s_waitcnt lgkmcnt(0)
    v_mfma_f32_16x16x32_bf16 v[160:163], v[120:123], v[20:23], v[160:163]
    buffer_load_dwordx2 v[166:167], v2, s[40:43], s31 offen offset:32
    s_waitcnt vmcnt(24)
    s_barrier
    ds_read_b64_tr_b16 v[100:101], v90 offset:24576
    ds_read_b64_tr_b16 v[102:103], v90 offset:25344
    ds_read_b64_tr_b16 v[104:105], v91 offset:24608
    ds_read_b64_tr_b16 v[106:107], v91 offset:25376
    ds_read_b64_tr_b16 v[108:109], v90 offset:24640
    ds_read_b64_tr_b16 v[110:111], v90 offset:25408
    ds_read_b64_tr_b16 v[112:113], v91 offset:24672
    ds_read_b64_tr_b16 v[114:115], v91 offset:25440
    ds_read_b64_tr_b16 v[116:117], v90 offset:24704
    ds_read_b64_tr_b16 v[118:119], v90 offset:25472
    s_waitcnt lgkmcnt(8)
    v_mfma_f32_16x16x32_bf16 v[140:143], v[100:103], v[24:27], v[140:143]
    buffer_load_dwordx4 v[180:183], v4, s[44:47], s32 offen offset:64
    ds_read_b64_tr_b16 v[120:121], v91 offset:24736
    ds_read_b64_tr_b16 v[122:123], v91 offset:25504
    s_waitcnt lgkmcnt(8)
    v_mfma_f32_16x16x32_bf16 v[144:147], v[104:107], v[24:27], v[144:147]
    buffer_load_dwordx4 v[204:207], v4, s[44:47], s33 offen offset:64
    ds_read_b64_tr_b16 v[100:101], v90 offset:30720
    ds_read_b64_tr_b16 v[102:103], v90 offset:31488
    s_waitcnt lgkmcnt(8)
    v_mfma_f32_16x16x32_bf16 v[148:151], v[108:111], v[24:27], v[148:151]
    buffer_load_dwordx2 v[168:169], v2, s[40:43], s31 offen offset:64
    ds_read_b64_tr_b16 v[104:105], v91 offset:30752
    ds_read_b64_tr_b16 v[106:107], v91 offset:31520
    s_waitcnt lgkmcnt(8)
    v_mfma_f32_16x16x32_bf16 v[152:155], v[112:115], v[24:27], v[152:155]
    buffer_load_dwordx4 v[184:187], v4, s[44:47], s32 offen offset:128
    ds_read_b64_tr_b16 v[108:109], v90 offset:30784
    ds_read_b64_tr_b16 v[110:111], v90 offset:31552
    s_waitcnt lgkmcnt(8)
    v_mfma_f32_16x16x32_bf16 v[156:159], v[116:119], v[24:27], v[156:159]
    buffer_load_dwordx4 v[208:211], v4, s[44:47], s33 offen offset:128
    ds_read_b64_tr_b16 v[112:113], v91 offset:30816
    ds_read_b64_tr_b16 v[114:115], v91 offset:31584
    s_waitcnt lgkmcnt(8)
    v_mfma_f32_16x16x32_bf16 v[160:163], v[120:123], v[24:27], v[160:163]
    buffer_load_dwordx2 v[170:171], v2, s[40:43], s31 offen offset:96
    ds_read_b64_tr_b16 v[116:117], v90 offset:30848
    ds_read_b64_tr_b16 v[118:119], v90 offset:31616
    s_waitcnt lgkmcnt(8)
    v_mfma_f32_16x16x32_bf16 v[140:143], v[100:103], v[28:31], v[140:143]
    buffer_load_dwordx4 v[188:191], v4, s[44:47], s32 offen offset:192
    ds_read_b64_tr_b16 v[120:121], v91 offset:30880
    ds_read_b64_tr_b16 v[122:123], v91 offset:31648
    s_waitcnt lgkmcnt(8)
    v_mfma_f32_16x16x32_bf16 v[144:147], v[104:107], v[28:31], v[144:147]
    buffer_load_dwordx4 v[212:215], v4, s[44:47], s33 offen offset:192
    ds_read_b64_tr_b16 v[100:101], v90 offset:36864
    ds_read_b64_tr_b16 v[102:103], v90 offset:37632
    s_waitcnt lgkmcnt(8)
    v_mfma_f32_16x16x32_bf16 v[148:151], v[108:111], v[28:31], v[148:151]
    buffer_load_dwordx2 v[172:173], v2, s[40:43], s31 offen offset:128
    ds_read_b64_tr_b16 v[104:105], v91 offset:36896
    ds_read_b64_tr_b16 v[106:107], v91 offset:37664
    s_waitcnt lgkmcnt(8)
    v_mfma_f32_16x16x32_bf16 v[152:155], v[112:115], v[28:31], v[152:155]
    buffer_load_dwordx4 v[192:195], v4, s[44:47], s32 offen offset:256
    ds_read_b64_tr_b16 v[108:109], v90 offset:36928
    ds_read_b64_tr_b16 v[110:111], v90 offset:37696
    s_waitcnt lgkmcnt(8)
    v_mfma_f32_16x16x32_bf16 v[156:159], v[116:119], v[28:31], v[156:159]
    buffer_load_dwordx4 v[216:219], v4, s[44:47], s33 offen offset:256
    ds_read_b64_tr_b16 v[112:113], v91 offset:36960
    ds_read_b64_tr_b16 v[114:115], v91 offset:37728
    s_waitcnt lgkmcnt(8)
    v_mfma_f32_16x16x32_bf16 v[160:163], v[120:123], v[28:31], v[160:163]
    buffer_load_dwordx2 v[174:175], v2, s[40:43], s31 offen offset:160
    ds_read_b64_tr_b16 v[116:117], v90 offset:36992
    ds_read_b64_tr_b16 v[118:119], v90 offset:37760
    s_waitcnt lgkmcnt(8)
    v_mfma_f32_16x16x32_bf16 v[140:143], v[100:103], v[32:35], v[140:143]
    buffer_load_dwordx4 v[196:199], v4, s[44:47], s32 offen offset:320
    ds_read_b64_tr_b16 v[120:121], v91 offset:37024
    ds_read_b64_tr_b16 v[122:123], v91 offset:37792
    s_waitcnt lgkmcnt(8)
    v_mfma_f32_16x16x32_bf16 v[144:147], v[104:107], v[32:35], v[144:147]
    buffer_load_dwordx4 v[220:223], v4, s[44:47], s33 offen offset:320
    ds_read_b64_tr_b16 v[100:101], v90 offset:43008
    ds_read_b64_tr_b16 v[102:103], v90 offset:43776
    s_waitcnt lgkmcnt(8)
    v_mfma_f32_16x16x32_bf16 v[148:151], v[108:111], v[32:35], v[148:151]
    ds_read_b64_tr_b16 v[104:105], v91 offset:43040
    ds_read_b64_tr_b16 v[106:107], v91 offset:43808
    s_waitcnt lgkmcnt(8)
    v_mfma_f32_16x16x32_bf16 v[152:155], v[112:115], v[32:35], v[152:155]
    ds_read_b64_tr_b16 v[108:109], v90 offset:43072
    ds_read_b64_tr_b16 v[110:111], v90 offset:43840
    s_waitcnt lgkmcnt(8)
    v_mfma_f32_16x16x32_bf16 v[156:159], v[116:119], v[32:35], v[156:159]
    ds_read_b64_tr_b16 v[112:113], v91 offset:43104
    ds_read_b64_tr_b16 v[114:115], v91 offset:43872
    s_waitcnt lgkmcnt(8)
    v_mfma_f32_16x16x32_bf16 v[160:163], v[120:123], v[32:35], v[160:163]
    ds_read_b64_tr_b16 v[116:117], v90 offset:43136
    ds_read_b64_tr_b16 v[118:119], v90 offset:43904
    s_waitcnt lgkmcnt(8)
    v_mfma_f32_16x16x32_bf16 v[140:143], v[100:103], v[36:39], v[140:143]
    ds_read_b64_tr_b16 v[120:121], v91 offset:43168
    ds_read_b64_tr_b16 v[122:123], v91 offset:43936
    s_waitcnt lgkmcnt(8)
    v_mfma_f32_16x16x32_bf16 v[144:147], v[104:107], v[36:39], v[144:147]
    ds_read_b64_tr_b16 v[100:101], v90 offset:49152
    ds_read_b64_tr_b16 v[102:103], v90 offset:49920
    s_waitcnt lgkmcnt(8)
    v_mfma_f32_16x16x32_bf16 v[148:151], v[108:111], v[36:39], v[148:151]
    ds_read_b64_tr_b16 v[104:105], v91 offset:49184
    ds_read_b64_tr_b16 v[106:107], v91 offset:49952
    s_waitcnt lgkmcnt(8)
    v_mfma_f32_16x16x32_bf16 v[152:155], v[112:115], v[36:39], v[152:155]
    ds_read_b64_tr_b16 v[108:109], v90 offset:49216
    ds_read_b64_tr_b16 v[110:111], v90 offset:49984
    s_waitcnt lgkmcnt(8)
    v_mfma_f32_16x16x32_bf16 v[156:159], v[116:119], v[36:39], v[156:159]
    ds_read_b64_tr_b16 v[112:113], v91 offset:49248
    ds_read_b64_tr_b16 v[114:115], v91 offset:50016
    s_waitcnt lgkmcnt(8)
    v_mfma_f32_16x16x32_bf16 v[160:163], v[120:123], v[36:39], v[160:163]
    ds_read_b64_tr_b16 v[116:117], v90 offset:49280
    ds_read_b64_tr_b16 v[118:119], v90 offset:50048
    s_waitcnt lgkmcnt(8)
    v_mfma_f32_16x16x32_bf16 v[140:143], v[100:103], v[40:43], v[140:143]
    ds_read_b64_tr_b16 v[120:121], v91 offset:49312
    ds_read_b64_tr_b16 v[122:123], v91 offset:50080
    s_waitcnt lgkmcnt(8)
    v_mfma_f32_16x16x32_bf16 v[144:147], v[104:107], v[40:43], v[144:147]
    ds_read_b64_tr_b16 v[100:101], v92 offset:0
    ds_read_b64_tr_b16 v[102:103], v92 offset:768
    s_waitcnt lgkmcnt(8)
    v_mfma_f32_16x16x32_bf16 v[148:151], v[108:111], v[40:43], v[148:151]
    ds_read_b64_tr_b16 v[104:105], v93 offset:32
    ds_read_b64_tr_b16 v[106:107], v93 offset:800
    s_waitcnt lgkmcnt(8)
    v_mfma_f32_16x16x32_bf16 v[152:155], v[112:115], v[40:43], v[152:155]
    ds_read_b64_tr_b16 v[108:109], v92 offset:64
    ds_read_b64_tr_b16 v[110:111], v92 offset:832
    s_waitcnt lgkmcnt(8)
    v_mfma_f32_16x16x32_bf16 v[156:159], v[116:119], v[40:43], v[156:159]
    ds_read_b64_tr_b16 v[112:113], v93 offset:96
    ds_read_b64_tr_b16 v[114:115], v93 offset:864
    s_waitcnt lgkmcnt(8)
    v_mfma_f32_16x16x32_bf16 v[160:163], v[120:123], v[40:43], v[160:163]
    ds_read_b64_tr_b16 v[116:117], v92 offset:128
    ds_read_b64_tr_b16 v[118:119], v92 offset:896
    s_waitcnt lgkmcnt(8)
    v_mfma_f32_16x16x32_bf16 v[140:143], v[100:103], v[44:47], v[140:143]
    ds_read_b64_tr_b16 v[120:121], v93 offset:160
    ds_read_b64_tr_b16 v[122:123], v93 offset:928
    s_waitcnt lgkmcnt(8)
    v_mfma_f32_16x16x32_bf16 v[144:147], v[104:107], v[44:47], v[144:147]
    s_waitcnt lgkmcnt(6)
    v_mfma_f32_16x16x32_bf16 v[148:151], v[108:111], v[44:47], v[148:151]
    s_waitcnt lgkmcnt(4)
    v_mfma_f32_16x16x32_bf16 v[152:155], v[112:115], v[44:47], v[152:155]
    s_waitcnt lgkmcnt(2)
    v_mfma_f32_16x16x32_bf16 v[156:159], v[116:119], v[44:47], v[156:159]
    s_waitcnt lgkmcnt(0)
    v_mfma_f32_16x16x32_bf16 v[160:163], v[120:123], v[44:47], v[160:163]
    s_waitcnt vmcnt(28)
    s_barrier
    ds_read_b64_tr_b16 v[100:101], v92 offset:6144
    ds_read_b64_tr_b16 v[102:103], v92 offset:6912
    ds_read_b64_tr_b16 v[104:105], v93 offset:6176
    ds_read_b64_tr_b16 v[106:107], v93 offset:6944
    ds_read_b64_tr_b16 v[108:109], v92 offset:6208
    ds_read_b64_tr_b16 v[110:111], v92 offset:6976
    ds_read_b64_tr_b16 v[112:113], v93 offset:6240
    ds_read_b64_tr_b16 v[114:115], v93 offset:7008
    ds_read_b64_tr_b16 v[116:117], v92 offset:6272
    ds_read_b64_tr_b16 v[118:119], v92 offset:7040
    s_waitcnt lgkmcnt(8)
    v_mfma_f32_16x16x32_bf16 v[140:143], v[100:103], v[48:51], v[140:143]
    ds_read_b64_tr_b16 v[120:121], v93 offset:6304
    ds_read_b64_tr_b16 v[122:123], v93 offset:7072
    s_waitcnt lgkmcnt(8)
    v_mfma_f32_16x16x32_bf16 v[144:147], v[104:107], v[48:51], v[144:147]
    ds_read_b64_tr_b16 v[100:101], v92 offset:12288
    ds_read_b64_tr_b16 v[102:103], v92 offset:13056
    s_waitcnt lgkmcnt(8)
    v_mfma_f32_16x16x32_bf16 v[148:151], v[108:111], v[48:51], v[148:151]
    ds_read_b64_tr_b16 v[104:105], v93 offset:12320
    ds_read_b64_tr_b16 v[106:107], v93 offset:13088
    s_waitcnt lgkmcnt(8)
    v_mfma_f32_16x16x32_bf16 v[152:155], v[112:115], v[48:51], v[152:155]
    ds_read_b64_tr_b16 v[108:109], v92 offset:12352
    ds_read_b64_tr_b16 v[110:111], v92 offset:13120
    s_waitcnt lgkmcnt(8)
    v_mfma_f32_16x16x32_bf16 v[156:159], v[116:119], v[48:51], v[156:159]
    ds_read_b64_tr_b16 v[112:113], v93 offset:12384
    ds_read_b64_tr_b16 v[114:115], v93 offset:13152
    s_waitcnt lgkmcnt(8)
    v_mfma_f32_16x16x32_bf16 v[160:163], v[120:123], v[48:51], v[160:163]
    ds_read_b64_tr_b16 v[116:117], v92 offset:12416
    ds_read_b64_tr_b16 v[118:119], v92 offset:13184
    s_waitcnt lgkmcnt(8)
    v_mfma_f32_16x16x32_bf16 v[140:143], v[100:103], v[52:55], v[140:143]
    ds_read_b64_tr_b16 v[120:121], v93 offset:12448
    ds_read_b64_tr_b16 v[122:123], v93 offset:13216
    s_waitcnt lgkmcnt(8)
    v_mfma_f32_16x16x32_bf16 v[144:147], v[104:107], v[52:55], v[144:147]
    ds_read_b64_tr_b16 v[100:101], v92 offset:18432
    ds_read_b64_tr_b16 v[102:103], v92 offset:19200
    s_waitcnt lgkmcnt(8)
    v_mfma_f32_16x16x32_bf16 v[148:151], v[108:111], v[52:55], v[148:151]
    ds_read_b64_tr_b16 v[104:105], v93 offset:18464
    ds_read_b64_tr_b16 v[106:107], v93 offset:19232
    s_waitcnt lgkmcnt(8)
    v_mfma_f32_16x16x32_bf16 v[152:155], v[112:115], v[52:55], v[152:155]
    ds_read_b64_tr_b16 v[108:109], v92 offset:18496
    ds_read_b64_tr_b16 v[110:111], v92 offset:19264
    s_waitcnt lgkmcnt(8)
    v_mfma_f32_16x16x32_bf16 v[156:159], v[116:119], v[52:55], v[156:159]
    ds_read_b64_tr_b16 v[112:113], v93 offset:18528
    ds_read_b64_tr_b16 v[114:115], v93 offset:19296
    s_waitcnt lgkmcnt(8)
    v_mfma_f32_16x16x32_bf16 v[160:163], v[120:123], v[52:55], v[160:163]
    ds_read_b64_tr_b16 v[116:117], v92 offset:18560
    ds_read_b64_tr_b16 v[118:119], v92 offset:19328
    s_waitcnt lgkmcnt(8)
    v_mfma_f32_16x16x32_bf16 v[140:143], v[100:103], v[56:59], v[140:143]
    ds_read_b64_tr_b16 v[120:121], v93 offset:18592
    ds_read_b64_tr_b16 v[122:123], v93 offset:19360
    s_waitcnt lgkmcnt(8)
    v_mfma_f32_16x16x32_bf16 v[144:147], v[104:107], v[56:59], v[144:147]
    ds_read_b64_tr_b16 v[100:101], v92 offset:24576
    ds_read_b64_tr_b16 v[102:103], v92 offset:25344
    s_waitcnt lgkmcnt(8)
    v_mfma_f32_16x16x32_bf16 v[148:151], v[108:111], v[56:59], v[148:151]
    ds_read_b64_tr_b16 v[104:105], v93 offset:24608
    ds_read_b64_tr_b16 v[106:107], v93 offset:25376
    s_waitcnt lgkmcnt(8)
    v_mfma_f32_16x16x32_bf16 v[152:155], v[112:115], v[56:59], v[152:155]
    ds_read_b64_tr_b16 v[108:109], v92 offset:24640
    ds_read_b64_tr_b16 v[110:111], v92 offset:25408
    s_waitcnt lgkmcnt(8)
    v_mfma_f32_16x16x32_bf16 v[156:159], v[116:119], v[56:59], v[156:159]
    ds_read_b64_tr_b16 v[112:113], v93 offset:24672
    ds_read_b64_tr_b16 v[114:115], v93 offset:25440
    s_waitcnt lgkmcnt(8)
    v_mfma_f32_16x16x32_bf16 v[160:163], v[120:123], v[56:59], v[160:163]
    ds_read_b64_tr_b16 v[116:117], v92 offset:24704
    ds_read_b64_tr_b16 v[118:119], v92 offset:25472
    s_waitcnt lgkmcnt(8)
    v_mfma_f32_16x16x32_bf16 v[140:143], v[100:103], v[60:63], v[140:143]
    ds_read_b64_tr_b16 v[120:121], v93 offset:24736
    ds_read_b64_tr_b16 v[122:123], v93 offset:25504
    s_waitcnt lgkmcnt(8)
    v_mfma_f32_16x16x32_bf16 v[144:147], v[104:107], v[60:63], v[144:147]
    s_waitcnt lgkmcnt(6)
    v_mfma_f32_16x16x32_bf16 v[148:151], v[108:111], v[60:63], v[148:151]
    s_waitcnt lgkmcnt(4)
    v_mfma_f32_16x16x32_bf16 v[152:155], v[112:115], v[60:63], v[152:155]
    s_waitcnt lgkmcnt(2)
    v_mfma_f32_16x16x32_bf16 v[156:159], v[116:119], v[60:63], v[156:159]
    s_waitcnt lgkmcnt(0)
    v_mfma_f32_16x16x32_bf16 v[160:163], v[120:123], v[60:63], v[160:163]
    s_waitcnt vmcnt(18)
    s_barrier
    ds_read_b64_tr_b16 v[100:101], v92 offset:30720
    ds_read_b64_tr_b16 v[102:103], v92 offset:31488
    ds_read_b64_tr_b16 v[104:105], v93 offset:30752
    ds_read_b64_tr_b16 v[106:107], v93 offset:31520
    ds_read_b64_tr_b16 v[108:109], v92 offset:30784
    ds_read_b64_tr_b16 v[110:111], v92 offset:31552
    ds_read_b64_tr_b16 v[112:113], v93 offset:30816
    ds_read_b64_tr_b16 v[114:115], v93 offset:31584
    ds_read_b64_tr_b16 v[116:117], v92 offset:30848
    ds_read_b64_tr_b16 v[118:119], v92 offset:31616
    s_waitcnt lgkmcnt(8)
    v_mfma_f32_16x16x32_bf16 v[140:143], v[100:103], v[64:67], v[140:143]
    ds_read_b64_tr_b16 v[120:121], v93 offset:30880
    ds_read_b64_tr_b16 v[122:123], v93 offset:31648
    s_waitcnt lgkmcnt(8)
    v_mfma_f32_16x16x32_bf16 v[144:147], v[104:107], v[64:67], v[144:147]
    ds_read_b64_tr_b16 v[100:101], v92 offset:36864
    ds_read_b64_tr_b16 v[102:103], v92 offset:37632
    s_waitcnt lgkmcnt(8)
    v_mfma_f32_16x16x32_bf16 v[148:151], v[108:111], v[64:67], v[148:151]
    ds_read_b64_tr_b16 v[104:105], v93 offset:36896
    ds_read_b64_tr_b16 v[106:107], v93 offset:37664
    s_waitcnt lgkmcnt(8)
    v_mfma_f32_16x16x32_bf16 v[152:155], v[112:115], v[64:67], v[152:155]
    ds_read_b64_tr_b16 v[108:109], v92 offset:36928
    ds_read_b64_tr_b16 v[110:111], v92 offset:37696
    s_waitcnt lgkmcnt(8)
    v_mfma_f32_16x16x32_bf16 v[156:159], v[116:119], v[64:67], v[156:159]
    ds_read_b64_tr_b16 v[112:113], v93 offset:36960
    ds_read_b64_tr_b16 v[114:115], v93 offset:37728
    s_waitcnt lgkmcnt(8)
    v_mfma_f32_16x16x32_bf16 v[160:163], v[120:123], v[64:67], v[160:163]
    ds_read_b64_tr_b16 v[116:117], v92 offset:36992
    ds_read_b64_tr_b16 v[118:119], v92 offset:37760
    s_waitcnt lgkmcnt(8)
    v_mfma_f32_16x16x32_bf16 v[140:143], v[100:103], v[68:71], v[140:143]
    ds_read_b64_tr_b16 v[120:121], v93 offset:37024
    ds_read_b64_tr_b16 v[122:123], v93 offset:37792
    s_waitcnt lgkmcnt(8)
    v_mfma_f32_16x16x32_bf16 v[144:147], v[104:107], v[68:71], v[144:147]
    ds_read_b64_tr_b16 v[100:101], v92 offset:43008
    ds_read_b64_tr_b16 v[102:103], v92 offset:43776
    s_waitcnt lgkmcnt(8)
    v_mfma_f32_16x16x32_bf16 v[148:151], v[108:111], v[68:71], v[148:151]
    ds_read_b64_tr_b16 v[104:105], v93 offset:43040
    ds_read_b64_tr_b16 v[106:107], v93 offset:43808
    s_waitcnt lgkmcnt(8)
    v_mfma_f32_16x16x32_bf16 v[152:155], v[112:115], v[68:71], v[152:155]
    ds_read_b64_tr_b16 v[108:109], v92 offset:43072
    ds_read_b64_tr_b16 v[110:111], v92 offset:43840
    s_waitcnt lgkmcnt(8)
    v_mfma_f32_16x16x32_bf16 v[156:159], v[116:119], v[68:71], v[156:159]
    ds_read_b64_tr_b16 v[112:113], v93 offset:43104
    ds_read_b64_tr_b16 v[114:115], v93 offset:43872
    s_waitcnt lgkmcnt(8)
    v_mfma_f32_16x16x32_bf16 v[160:163], v[120:123], v[68:71], v[160:163]
    ds_read_b64_tr_b16 v[116:117], v92 offset:43136
    ds_read_b64_tr_b16 v[118:119], v92 offset:43904
    s_waitcnt lgkmcnt(8)
    v_mfma_f32_16x16x32_bf16 v[140:143], v[100:103], v[72:75], v[140:143]
    ds_read_b64_tr_b16 v[120:121], v93 offset:43168
    ds_read_b64_tr_b16 v[122:123], v93 offset:43936
    s_waitcnt lgkmcnt(8)
    v_mfma_f32_16x16x32_bf16 v[144:147], v[104:107], v[72:75], v[144:147]
    ds_read_b64_tr_b16 v[100:101], v92 offset:49152
    ds_read_b64_tr_b16 v[102:103], v92 offset:49920
    s_waitcnt lgkmcnt(8)
    v_mfma_f32_16x16x32_bf16 v[148:151], v[108:111], v[72:75], v[148:151]
    ds_read_b64_tr_b16 v[104:105], v93 offset:49184
    ds_read_b64_tr_b16 v[106:107], v93 offset:49952
    s_waitcnt lgkmcnt(8)
    v_mfma_f32_16x16x32_bf16 v[152:155], v[112:115], v[72:75], v[152:155]
    ds_read_b64_tr_b16 v[108:109], v92 offset:49216
    ds_read_b64_tr_b16 v[110:111], v92 offset:49984
    s_waitcnt lgkmcnt(8)
    v_mfma_f32_16x16x32_bf16 v[156:159], v[116:119], v[72:75], v[156:159]
    ds_read_b64_tr_b16 v[112:113], v93 offset:49248
    ds_read_b64_tr_b16 v[114:115], v93 offset:50016
    s_waitcnt lgkmcnt(8)
    v_mfma_f32_16x16x32_bf16 v[160:163], v[120:123], v[72:75], v[160:163]
    ds_read_b64_tr_b16 v[116:117], v92 offset:49280
    ds_read_b64_tr_b16 v[118:119], v92 offset:50048
    s_waitcnt lgkmcnt(8)
    v_mfma_f32_16x16x32_bf16 v[140:143], v[100:103], v[76:79], v[140:143]
    ds_read_b64_tr_b16 v[120:121], v93 offset:49312
    ds_read_b64_tr_b16 v[122:123], v93 offset:50080
    s_waitcnt lgkmcnt(8)
    v_mfma_f32_16x16x32_bf16 v[144:147], v[104:107], v[76:79], v[144:147]
    s_waitcnt lgkmcnt(6)
    v_mfma_f32_16x16x32_bf16 v[148:151], v[108:111], v[76:79], v[148:151]
    s_waitcnt lgkmcnt(4)
    v_mfma_f32_16x16x32_bf16 v[152:155], v[112:115], v[76:79], v[152:155]
    s_waitcnt lgkmcnt(2)
    v_mfma_f32_16x16x32_bf16 v[156:159], v[116:119], v[76:79], v[156:159]
    s_waitcnt lgkmcnt(0)
    v_mfma_f32_16x16x32_bf16 v[160:163], v[120:123], v[76:79], v[160:163]
    s_add_u32 s16, s12, 11534336
    s_addc_u32 s17, s13, 0
    s_mov_b32 s18, 2359296
    s_mov_b32 s19, 0x20000
    s_add_u32 s48, s12, 14680064
    s_addc_u32 s49, s13, 0
    s_mov_b32 s50, 2359296
    s_mov_b32 s51, 0x20000
    s_add_u32 s52, s12, 131072
    s_addc_u32 s53, s13, 0
    s_mov_b32 s54, 131072
    s_mov_b32 s55, 0x20000
    s_lshr_b32 s34, s25, 1
    s_mul_i32 s34, s34, 36864
    s_mul_i32 s35, s24, 6144
    s_add_u32 s34, s34, s35
    s_and_b32 s35, s25, 1
    s_lshl_b32 s35, s35, 8
    s_add_u32 s34, s34, s35
    s_add_u32 s35, s34, 4096
    v_lshrrev_b32 v7, 1, v5
    v_lshlrev_b32 v7, 9, v7
    v_lshl_add_u32 v7, v6, 4, v7
    v_and_b32 v87, 1, v5
    v_lshl_add_u32 v7, v87, 3, v7
    v_lshrrev_b32 v96, 1, v5
    v_mul_u32_u24 v94, 1152, v6
    v_lshl_add_u32 v94, v96, 4, v94
    v_lshl_add_u32 v94, v87, 5, v94
    v_lshlrev_b32 v95, 9, v96
    v_lshl_add_u32 v95, v6, 4, v95
    v_lshl_add_u32 v95, v87, 10, v95
    s_waitcnt vmcnt(0)
    v_lshlrev_b32 v100, 16, v164
    v_and_b32 v101, s30, v164
    v_pk_fma_f32 v[100:101], v[140:141], v[176:177], v[100:101]
    v_cvt_pk_bf16_f32 v102, v100, v101
    v_lshlrev_b32 v8, 16, v102
    v_and_b32 v9, s30, v102
    v_pk_mul_f32 v[100:101], v[8:9], v[200:201]
    v_cvt_pk_bf16_f32 v116, v100, v101
    v_lshlrev_b32 v100, 16, v165
    v_and_b32 v101, s30, v165
    v_pk_fma_f32 v[100:101], v[142:143], v[178:179], v[100:101]
    v_cvt_pk_bf16_f32 v103, v100, v101
    v_lshlrev_b32 v10, 16, v103
    v_and_b32 v11, s30, v103
    v_pk_mul_f32 v[100:101], v[10:11], v[202:203]
    v_cvt_pk_bf16_f32 v117, v100, v101
    v_lshlrev_b32 v100, 16, v166
    v_and_b32 v101, s30, v166
    v_pk_fma_f32 v[100:101], v[144:145], v[180:181], v[100:101]
    v_cvt_pk_bf16_f32 v104, v100, v101
    v_lshlrev_b32 v12, 16, v104
    v_and_b32 v13, s30, v104
    v_pk_mul_f32 v[100:101], v[12:13], v[204:205]
    v_cvt_pk_bf16_f32 v118, v100, v101
    v_lshlrev_b32 v100, 16, v167
    v_and_b32 v101, s30, v167
    v_pk_fma_f32 v[100:101], v[146:147], v[182:183], v[100:101]
    v_cvt_pk_bf16_f32 v105, v100, v101
    v_lshlrev_b32 v14, 16, v105
    v_and_b32 v15, s30, v105
    v_pk_mul_f32 v[100:101], v[14:15], v[206:207]
    v_cvt_pk_bf16_f32 v119, v100, v101
    v_permlane16_swap_b32 v102, v104
    v_permlane16_swap_b32 v103, v105
    buffer_store_dwordx4 v[102:105], v94, s[16:19], s31 offen offset:0 sc1
    v_permlane16_swap_b32 v116, v118
    v_permlane16_swap_b32 v117, v119
    buffer_store_dwordx4 v[116:119], v95, s[48:51], s34 offen offset:0 sc1
    v_lshlrev_b32 v100, 16, v168
    v_and_b32 v101, s30, v168
    v_pk_fma_f32 v[100:101], v[148:149], v[184:185], v[100:101]
    v_cvt_pk_bf16_f32 v106, v100, v101
    v_lshlrev_b32 v16, 16, v106
    v_and_b32 v17, s30, v106
    v_pk_mul_f32 v[100:101], v[16:17], v[208:209]
    v_cvt_pk_bf16_f32 v120, v100, v101
    v_lshlrev_b32 v100, 16, v169
    v_and_b32 v101, s30, v169
    v_pk_fma_f32 v[100:101], v[150:151], v[186:187], v[100:101]
    v_cvt_pk_bf16_f32 v107, v100, v101
    v_lshlrev_b32 v18, 16, v107
    v_and_b32 v19, s30, v107
    v_pk_mul_f32 v[100:101], v[18:19], v[210:211]
    v_cvt_pk_bf16_f32 v121, v100, v101
    v_lshlrev_b32 v100, 16, v170
    v_and_b32 v101, s30, v170
    v_pk_fma_f32 v[100:101], v[152:153], v[188:189], v[100:101]
    v_cvt_pk_bf16_f32 v108, v100, v101
    v_lshlrev_b32 v20, 16, v108
    v_and_b32 v21, s30, v108
    v_pk_mul_f32 v[100:101], v[20:21], v[212:213]
    v_cvt_pk_bf16_f32 v122, v100, v101
    v_lshlrev_b32 v100, 16, v171
    v_and_b32 v101, s30, v171
    v_pk_fma_f32 v[100:101], v[154:155], v[190:191], v[100:101]
    v_cvt_pk_bf16_f32 v109, v100, v101
    v_lshlrev_b32 v22, 16, v109
    v_and_b32 v23, s30, v109
    v_pk_mul_f32 v[100:101], v[22:23], v[214:215]
    v_cvt_pk_bf16_f32 v123, v100, v101
    v_permlane16_swap_b32 v106, v108
    v_permlane16_swap_b32 v107, v109
    buffer_store_dwordx4 v[106:109], v94, s[16:19], s31 offen offset:64 sc1
    v_permlane16_swap_b32 v120, v122
    v_permlane16_swap_b32 v121, v123
    buffer_store_dwordx4 v[120:123], v95, s[48:51], s34 offen offset:2048 sc1
    v_lshlrev_b32 v100, 16, v172
    v_and_b32 v101, s30, v172
    v_pk_fma_f32 v[100:101], v[156:157], v[192:193], v[100:101]
    v_cvt_pk_bf16_f32 v110, v100, v101
    v_lshlrev_b32 v24, 16, v110
    v_and_b32 v25, s30, v110
    v_pk_mul_f32 v[100:101], v[24:25], v[216:217]
    v_cvt_pk_bf16_f32 v124, v100, v101
    v_lshlrev_b32 v100, 16, v173
    v_and_b32 v101, s30, v173
    v_pk_fma_f32 v[100:101], v[158:159], v[194:195], v[100:101]
    v_cvt_pk_bf16_f32 v111, v100, v101
    v_lshlrev_b32 v26, 16, v111
    v_and_b32 v27, s30, v111
    v_pk_mul_f32 v[100:101], v[26:27], v[218:219]
    v_cvt_pk_bf16_f32 v125, v100, v101
    v_lshlrev_b32 v100, 16, v174
    v_and_b32 v101, s30, v174
    v_pk_fma_f32 v[100:101], v[160:161], v[196:197], v[100:101]
    v_cvt_pk_bf16_f32 v112, v100, v101
    v_lshlrev_b32 v28, 16, v112
    v_and_b32 v29, s30, v112
    v_pk_mul_f32 v[100:101], v[28:29], v[220:221]
    v_cvt_pk_bf16_f32 v126, v100, v101
    v_lshlrev_b32 v100, 16, v175
    v_and_b32 v101, s30, v175
    v_pk_fma_f32 v[100:101], v[162:163], v[198:199], v[100:101]
    v_cvt_pk_bf16_f32 v113, v100, v101
    v_lshlrev_b32 v30, 16, v113
    v_and_b32 v31, s30, v113
    v_pk_mul_f32 v[100:101], v[30:31], v[222:223]
    v_cvt_pk_bf16_f32 v127, v100, v101
    v_permlane16_swap_b32 v110, v112
    v_permlane16_swap_b32 v111, v113
    buffer_store_dwordx4 v[110:113], v94, s[16:19], s31 offen offset:128 sc1
    v_permlane16_swap_b32 v124, v126
    v_permlane16_swap_b32 v125, v127
    buffer_store_dwordx4 v[124:127], v95, s[48:51], s35 offen offset:0 sc1
    v_pk_add_f32 v[40:41], v[8:9], v[10:11]
    v_pk_add_f32 v[40:41], v[40:41], v[12:13]
    v_pk_add_f32 v[40:41], v[40:41], v[14:15]
    v_pk_add_f32 v[40:41], v[40:41], v[16:17]
    v_pk_add_f32 v[40:41], v[40:41], v[18:19]
    v_pk_add_f32 v[40:41], v[40:41], v[20:21]
    v_pk_add_f32 v[40:41], v[40:41], v[22:23]
    v_pk_add_f32 v[40:41], v[40:41], v[24:25]
    v_pk_add_f32 v[40:41], v[40:41], v[26:27]
    v_pk_add_f32 v[40:41], v[40:41], v[28:29]
    v_pk_add_f32 v[40:41], v[40:41], v[30:31]
    v_add_f32 v40, v40, v41
    v_mov_b32 v41, v40
    s_nop 1
    v_permlane32_swap_b32 v40, v41
    v_add_f32 v40, v40, v41
    v_mov_b32 v41, v40
    s_nop 1
    v_permlane16_swap_b32 v40, v41
    v_add_f32 v40, v40, v41
    v_mul_f32 v40, 0x3c2aaaab, v40
    v_sub_f32 v42, 0, v40
    v_mov_b32 v44, 0
    v_mov_b32 v45, 0
    v_pk_add_f32 v[46:47], v[8:9], v[42:43] op_sel_hi:[1,0]
    s_nop 0
    v_pk_fma_f32 v[44:45], v[46:47], v[46:47], v[44:45]
    v_pk_add_f32 v[46:47], v[10:11], v[42:43] op_sel_hi:[1,0]
    s_nop 0
    v_pk_fma_f32 v[44:45], v[46:47], v[46:47], v[44:45]
    v_pk_add_f32 v[46:47], v[12:13], v[42:43] op_sel_hi:[1,0]
    s_nop 0
    v_pk_fma_f32 v[44:45], v[46:47], v[46:47], v[44:45]
    v_pk_add_f32 v[46:47], v[14:15], v[42:43] op_sel_hi:[1,0]
    s_nop 0
    v_pk_fma_f32 v[44:45], v[46:47], v[46:47], v[44:45]
    v_pk_add_f32 v[46:47], v[16:17], v[42:43] op_sel_hi:[1,0]
    s_nop 0
    v_pk_fma_f32 v[44:45], v[46:47], v[46:47], v[44:45]
    v_pk_add_f32 v[46:47], v[18:19], v[42:43] op_sel_hi:[1,0]
    s_nop 0
    v_pk_fma_f32 v[44:45], v[46:47], v[46:47], v[44:45]
    v_pk_add_f32 v[46:47], v[20:21], v[42:43] op_sel_hi:[1,0]
    s_nop 0
    v_pk_fma_f32 v[44:45], v[46:47], v[46:47], v[44:45]
    v_pk_add_f32 v[46:47], v[22:23], v[42:43] op_sel_hi:[1,0]
    s_nop 0
    v_pk_fma_f32 v[44:45], v[46:47], v[46:47], v[44:45]
    v_pk_add_f32 v[46:47], v[24:25], v[42:43] op_sel_hi:[1,0]
    s_nop 0
    v_pk_fma_f32 v[44:45], v[46:47], v[46:47], v[44:45]
    v_pk_add_f32 v[46:47], v[26:27], v[42:43] op_sel_hi:[1,0]
    s_nop 0
    v_pk_fma_f32 v[44:45], v[46:47], v[46:47], v[44:45]
    v_pk_add_f32 v[46:47], v[28:29], v[42:43] op_sel_hi:[1,0]
    s_nop 0
    v_pk_fma_f32 v[44:45], v[46:47], v[46:47], v[44:45]
    v_pk_add_f32 v[46:47], v[30:31], v[42:43] op_sel_hi:[1,0]
    s_nop 0
    v_pk_fma_f32 v[44:45], v[46:47], v[46:47], v[44:45]
    v_add_f32 v41, v44, v45
    v_mov_b32 v42, v41
    s_nop 1
    v_permlane32_swap_b32 v41, v42
    v_add_f32 v41, v41, v42
    v_mov_b32 v42, v41
    s_nop 1
    v_permlane16_swap_b32 v41, v42
    v_add_f32 v41, v41, v42
    v_lshlrev_b32 v42, 6, v6
    v_mov_b32 v43, 0x7fffffff
    v_cmp_gt_u32 vcc, 16, v1
    s_nop 1
    v_cndmask_b32 v42, v43, v42, vcc
    s_lshl_b32 s34, s25, 10
    s_lshl_b32 s35, s24, 3
    s_add_u32 s34, s34, s35
    buffer_store_dwordx2 v[40:41], v42, s[52:55], s34 offen
    s_endpgm
K4_RL:
    s_load_dwordx4 s[36:39], s[0:1], 48
    s_load_dwordx2 s[48:49], s[0:1], 64
    s_and_b32 s21, s2, 7
    s_sub_u32 s40, s2, 192
    s_lshr_b32 s40, s40, 3
    v_lshlrev_b32 v3, 4, v1
    s_cmp_ge_u32 s2, 240
    s_cbranch_scc1 K4_UV
    v_lshrrev_b32 v2, 5, v1
    v_bfe_u32 v9, v1, 2, 2
    v_lshl_add_u32 v9, v2, 2, v9
    v_mul_u32_u24 v9, 1152, v9
    v_bfe_u32 v8, v1, 4, 1
    v_lshlrev_b32 v8, 1, v8
    v_bfe_u32 v6, v1, 1, 1
    v_add_u32 v8, v8, v6
    v_and_b32 v6, 1, v1
    v_lshl_add_u32 v9, v6, 3, v9
    s_lshl_b32 s26, s20, 6
    v_add_u32 v9, s26, v9
    s_sub_u32 s24, s2, 192
    s_waitcnt lgkmcnt(0)
    s_mov_b32 s4, s48
    s_mov_b32 s5, s49
    s_mov_b32 s6, 5308416
    s_mov_b32 s7, 0x20000
    s_add_u32 s8, s12, 50331648
    s_addc_u32 s9, s13, 0
    s_mov_b32 s10, 5308416
    s_mov_b32 s11, 0x20000
    s_mul_i32 s22, s24, 5462
    s_lshr_b32 s22, s22, 16
    s_mul_i32 s23, s22, 12
    s_sub_u32 s23, s24, s23
    s_mul_i32 s29, s24, 110592
    s_lshl_b32 s25, s20, 10
    s_add_u32 s29, s29, s25
    s_mov_b32 s26, 0
K4_RL_D:
    s_add_u32 m0, s25, s26
    s_add_u32 s27, s29, s26
    buffer_load_dwordx4 v3, s[4:7], s27 offen lds
    s_add_u32 s26, s26, 4096
    s_cmp_lt_u32 s26, 110592
    s_cbranch_scc1 K4_RL_D
    v_add_u32 v5, s22, v8
    v_and_b32 v5, 3, v5
    v_lshl_add_u32 v4, v5, 4, v9
    v_add_u32 v7, 55296, v4
    s_mul_i32 s27, s22, 1327104
    s_mov_b32 s28, s20
    s_waitcnt vmcnt(0)
    s_barrier
K4_RL_T:
    s_cmp_ge_u32 s28, 9
    s_cselect_b32 s29, 9, 0
    s_cselect_b32 s31, 663552, 0
    s_sub_u32 s29, s28, s29
    s_cmp_ge_u32 s29, 5
    s_cselect_b32 s32, 5, 0
    s_cselect_b32 s33, 368640, 0
    s_cselect_b32 s34, 4, 5
    s_lshl_b32 s34, s34, 10
    s_sub_u32 s29, s29, s32
    s_add_u32 s31, s31, s33
    s_add_u32 s31, s31, s27
    s_lshl_b32 s29, s29, 10
    s_add_u32 s31, s31, s29
    s_mul_i32 s33, s23, 6
    s_mul_i32 s33, s33, s34
    s_add_u32 s31, s31, s33
    ds_read_b64_tr_b16 v[12:13], v4 offset:0
    ds_read_b64_tr_b16 v[14:15], v4 offset:9216
    ds_read_b64_tr_b16 v[16:17], v4 offset:18432
    ds_read_b64_tr_b16 v[18:19], v4 offset:27648
    ds_read_b64_tr_b16 v[20:21], v4 offset:36864
    ds_read_b64_tr_b16 v[22:23], v4 offset:46080
    ds_read_b64_tr_b16 v[24:25], v7 offset:0
    ds_read_b64_tr_b16 v[26:27], v7 offset:9216
    ds_read_b64_tr_b16 v[28:29], v7 offset:18432
    ds_read_b64_tr_b16 v[30:31], v7 offset:27648
    ds_read_b64_tr_b16 v[32:33], v7 offset:36864
    ds_read_b64_tr_b16 v[34:35], v7 offset:46080
    v_add_u32 v4, 256, v4
    v_add_u32 v7, 256, v7
    s_waitcnt lgkmcnt(10)
    buffer_store_dwordx4 v[12:15], v3, s[8:11], s31 offen sc1
    s_add_u32 s31, s31, s34
    s_waitcnt lgkmcnt(8)
    buffer_store_dwordx4 v[16:19], v3, s[8:11], s31 offen sc1
    s_add_u32 s31, s31, s34
    s_waitcnt lgkmcnt(6)
    buffer_store_dwordx4 v[20:23], v3, s[8:11], s31 offen sc1
    s_add_u32 s31, s31, s34
    s_waitcnt lgkmcnt(4)
    buffer_store_dwordx4 v[24:27], v3, s[8:11], s31 offen sc1
    s_add_u32 s31, s31, s34
    s_waitcnt lgkmcnt(2)
    buffer_store_dwordx4 v[28:31], v3, s[8:11], s31 offen sc1
    s_add_u32 s31, s31, s34
    s_waitcnt lgkmcnt(0)
    buffer_store_dwordx4 v[32:35], v3, s[8:11], s31 offen sc1
    s_add_u32 s31, s31, s34
    s_add_u32 s28, s28, 4
    s_cmp_lt_u32 s28, 18
    s_cbranch_scc1 K4_RL_T
    s_endpgm
K4_UV:
    s_waitcnt lgkmcnt(0)
    s_add_u32 s4, s12, 655360
    s_addc_u32 s5, s13, 0
    s_mov_b32 s6, 516096
    s_mov_b32 s7, 0x20000
    s_add_u32 s8, s12, 524288
    s_addc_u32 s9, s13, 0
    s_mov_b32 s10, 73728
    s_mov_b32 s11, 0x20000
    s_sub_u32 s21, s2, 240
    s_mul_i32 s21, s21, 576
    v_add_u32 v4, 0, v0
    v_cmp_gt_u32 vcc, 0x240, v4
    v_add_u32 v4, s21, v4
    v_mov_b32 v5, 0xfffffff
    v_cndmask_b32 v4, v5, v4, vcc
    v_lshlrev_b32 v5, 3, v4
    s_mov_b32 s22, 0
    buffer_load_dwordx2 v[8:9], v5, s[4:7], s22 offen
    s_add_u32 s22, s22, 73728
    buffer_load_dwordx2 v[10:11], v5, s[4:7], s22 offen
    s_add_u32 s22, s22, 73728
    buffer_load_dwordx2 v[12:13], v5, s[4:7], s22 offen
    s_add_u32 s22, s22, 73728
    buffer_load_dwordx2 v[14:15], v5, s[4:7], s22 offen
    s_add_u32 s22, s22, 73728
    buffer_load_dwordx2 v[16:17], v5, s[4:7], s22 offen
    s_add_u32 s22, s22, 73728
    buffer_load_dwordx2 v[18:19], v5, s[4:7], s22 offen
    s_add_u32 s22, s22, 73728
    buffer_load_dwordx2 v[20:21], v5, s[4:7], s22 offen
    v_mul_u32_u24 v6, 29128, v4
    v_lshrrev_b32 v6, 26, v6
    v_mul_u32_u24 v7, 2304, v6
    v_sub_u32 v7, v4, v7
    v_lshlrev_b32 v7, 2, v7
    v_and_b32 v22, 1, v6
    v_lshlrev_b32 v22, 2, v22
    v_and_b32 v6, 2, v6
    v_add_u32 v6, v6, v22
    v_mul_u32_u24 v6, 9216, v6
    v_add_u32 v7, v7, v6
    v_mov_b32 v6, 0x7fffffff
    v_cndmask_b32 v7, v6, v7, vcc
    s_waitcnt vmcnt(0)
    v_pk_add_f32 v[8:9], v[8:9], v[10:11]
    v_pk_add_f32 v[8:9], v[8:9], v[12:13]
    v_pk_add_f32 v[8:9], v[8:9], v[14:15]
    v_pk_add_f32 v[8:9], v[8:9], v[16:17]
    v_pk_add_f32 v[8:9], v[8:9], v[18:19]
    v_pk_add_f32 v[8:9], v[8:9], v[20:21]
    v_cvt_pk_bf16_f32 v10, v8, v9
    v_lshlrev_b32 v12, 16, v10
    v_and_b32 v13, s30, v10
    v_sub_f32 v8, v8, v12
    v_sub_f32 v9, v9, v13
    v_cvt_pk_bf16_f32 v11, v8, v9
    s_movk_i32 s23, 9216
    buffer_store_dword v10, v7, s[8:11], 0 offen
    buffer_store_dword v11, v7, s[8:11], s23 offen
    v_add_u32 v4, 256, v0
    v_cmp_gt_u32 vcc, 0x240, v4
    v_add_u32 v4, s21, v4
    v_mov_b32 v5, 0xfffffff
    v_cndmask_b32 v4, v5, v4, vcc
    v_lshlrev_b32 v5, 3, v4
    s_mov_b32 s22, 0
    buffer_load_dwordx2 v[8:9], v5, s[4:7], s22 offen
    s_add_u32 s22, s22, 73728
    buffer_load_dwordx2 v[10:11], v5, s[4:7], s22 offen
    s_add_u32 s22, s22, 73728
    buffer_load_dwordx2 v[12:13], v5, s[4:7], s22 offen
    s_add_u32 s22, s22, 73728
    buffer_load_dwordx2 v[14:15], v5, s[4:7], s22 offen
    s_add_u32 s22, s22, 73728
    buffer_load_dwordx2 v[16:17], v5, s[4:7], s22 offen
    s_add_u32 s22, s22, 73728
    buffer_load_dwordx2 v[18:19], v5, s[4:7], s22 offen
    s_add_u32 s22, s22, 73728
    buffer_load_dwordx2 v[20:21], v5, s[4:7], s22 offen
    v_mul_u32_u24 v6, 29128, v4
    v_lshrrev_b32 v6, 26, v6
    v_mul_u32_u24 v7, 2304, v6
    v_sub_u32 v7, v4, v7
    v_lshlrev_b32 v7, 2, v7
    v_and_b32 v22, 1, v6
    v_lshlrev_b32 v22, 2, v22
    v_and_b32 v6, 2, v6
    v_add_u32 v6, v6, v22
    v_mul_u32_u24 v6, 9216, v6
    v_add_u32 v7, v7, v6
    v_mov_b32 v6, 0x7fffffff
    v_cndmask_b32 v7, v6, v7, vcc
    s_waitcnt vmcnt(0)
    v_pk_add_f32 v[8:9], v[8:9], v[10:11]
    v_pk_add_f32 v[8:9], v[8:9], v[12:13]
    v_pk_add_f32 v[8:9], v[8:9], v[14:15]
    v_pk_add_f32 v[8:9], v[8:9], v[16:17]
    v_pk_add_f32 v[8:9], v[8:9], v[18:19]
    v_pk_add_f32 v[8:9], v[8:9], v[20:21]
    v_cvt_pk_bf16_f32 v10, v8, v9
    v_lshlrev_b32 v12, 16, v10
    v_and_b32 v13, s30, v10
    v_sub_f32 v8, v8, v12
    v_sub_f32 v9, v9, v13
    v_cvt_pk_bf16_f32 v11, v8, v9
    s_movk_i32 s23, 9216
    buffer_store_dword v10, v7, s[8:11], 0 offen
    buffer_store_dword v11, v7, s[8:11], s23 offen
    v_add_u32 v4, 512, v0
    v_cmp_gt_u32 vcc, 0x240, v4
    v_add_u32 v4, s21, v4
    v_mov_b32 v5, 0xfffffff
    v_cndmask_b32 v4, v5, v4, vcc
    v_lshlrev_b32 v5, 3, v4
    s_mov_b32 s22, 0
    buffer_load_dwordx2 v[8:9], v5, s[4:7], s22 offen
    s_add_u32 s22, s22, 73728
    buffer_load_dwordx2 v[10:11], v5, s[4:7], s22 offen
    s_add_u32 s22, s22, 73728
    buffer_load_dwordx2 v[12:13], v5, s[4:7], s22 offen
    s_add_u32 s22, s22, 73728
    buffer_load_dwordx2 v[14:15], v5, s[4:7], s22 offen
    s_add_u32 s22, s22, 73728
    buffer_load_dwordx2 v[16:17], v5, s[4:7], s22 offen
    s_add_u32 s22, s22, 73728
    buffer_load_dwordx2 v[18:19], v5, s[4:7], s22 offen
    s_add_u32 s22, s22, 73728
    buffer_load_dwordx2 v[20:21], v5, s[4:7], s22 offen
    v_mul_u32_u24 v6, 29128, v4
    v_lshrrev_b32 v6, 26, v6
    v_mul_u32_u24 v7, 2304, v6
    v_sub_u32 v7, v4, v7
    v_lshlrev_b32 v7, 2, v7
    v_and_b32 v22, 1, v6
    v_lshlrev_b32 v22, 2, v22
    v_and_b32 v6, 2, v6
    v_add_u32 v6, v6, v22
    v_mul_u32_u24 v6, 9216, v6
    v_add_u32 v7, v7, v6
    v_mov_b32 v6, 0x7fffffff
    v_cndmask_b32 v7, v6, v7, vcc
    s_waitcnt vmcnt(0)
    v_pk_add_f32 v[8:9], v[8:9], v[10:11]
    v_pk_add_f32 v[8:9], v[8:9], v[12:13]
    v_pk_add_f32 v[8:9], v[8:9], v[14:15]
    v_pk_add_f32 v[8:9], v[8:9], v[16:17]
    v_pk_add_f32 v[8:9], v[8:9], v[18:19]
    v_pk_add_f32 v[8:9], v[8:9], v[20:21]
    v_cvt_pk_bf16_f32 v10, v8, v9
    v_lshlrev_b32 v12, 16, v10
    v_and_b32 v13, s30, v10
    v_sub_f32 v8, v8, v12
    v_sub_f32 v9, v9, v13
    v_cvt_pk_bf16_f32 v11, v8, v9
    s_movk_i32 s23, 9216
    buffer_store_dword v10, v7, s[8:11], 0 offen
    buffer_store_dword v11, v7, s[8:11], s23 offen
K4_END:
    s_endpgm
.globl k5_kernel
.p2align 8
.type k5_kernel,@function
k5_kernel:
    s_cmp_ge_u32 s2, 256
    s_cbranch_scc1 K5_END
    s_load_dwordx2 s[12:13], s[0:1], 104
    s_load_dwordx4 s[36:39], s[0:1], 48
    v_and_b32 v1, 63, v0
    v_lshrrev_b32 v2, 6, v0
    s_nop 0
    v_readfirstlane_b32 s20, v2
    s_and_b32 s21, s2, 7
    s_bfe_u32 s23, s2, 0x20003
    s_lshr_b32 s22, s2, 5
    s_lshl_b32 s24, s22, 3
    s_lshl_b32 s25, s20, 1
    s_add_u32 s24, s24, s25
    s_mul_i32 s25, s24, 36864
    s_add_u32 s40, s25, 36864
    v_lshrrev_b32 v2, 3, v1
    v_bfe_u32 v3, v1, 4, 1
    v_lshlrev_b32 v3, 1, v3
    v_and_b32 v4, 7, v1
    v_xor_b32 v4, v4, v3
    v_mul_u32_u24 v2, 9216, v2
    v_lshl_add_u32 v216, v4, 4, v2
    v_xor_b32 v4, 4, v4
    v_lshl_add_u32 v217, v4, 4, v2
    s_mul_i32 s26, s20, 73728
    s_mul_i32 s29, s21, 1152
    s_lshl_b32 s31, s23, 8
    s_add_u32 s31, s31, s29
    s_add_u32 s31, s31, s26
    s_add_u32 s29, s29, 1024
    s_add_u32 s29, s29, s26
    s_lshl_b32 s32, s20, 10
    v_lshlrev_b32 v218, 4, v1
    s_waitcnt lgkmcnt(0)
    s_mov_b32 s4, s36
    s_mov_b32 s5, s37
    s_mov_b32 s6, 5308416
    s_mov_b32 s7, 0x20000
    s_mov_b32 s8, s38
    s_mov_b32 s9, s39
    s_mov_b32 s10, 5308416
    s_mov_b32 s11, 0x20000
    s_add_u32 s16, s12, 14680064
    s_addc_u32 s17, s13, 0
    s_mov_b32 s18, 2359296
    s_mov_b32 s19, 0x20000
    s_add_u32 s44, s12, 17825792
    s_addc_u32 s45, s13, 0
    s_mov_b32 s46, 18874368
    s_mov_b32 s47, 0x20000
    s_add_u32 s52, s12, 131072
    s_addc_u32 s53, s13, 0
    s_mov_b32 s54, 131072
    s_mov_b32 s55, 0x20000
    v_and_b32 v2, 31, v1
    v_lshlrev_b32 v2, 6, v2
    s_lshl_b32 s49, s24, 11
    s_add_u32 s50, s49, 2048
    v_mov_b32 v199, v2
    s_mov_b32 s60, s49
    s_mov_b32 s61, s50
    s_add_u32 s56, s12, 524288
    s_addc_u32 s57, s13, 0
    s_mov_b32 s58, 73728
    s_mov_b32 s59, 0x20000
    v_lshrrev_b32 v2, 3, v1
    v_mul_u32_u24 v2, 9216, v2
    v_and_b32 v3, 7, v1
    v_lshl_add_u32 v2, v3, 4, v2
    s_sub_u32 s49, s31, s26
    s_add_u32 s50, s49, 128
    s_cmp_eq_u32 s20, 1
    s_cselect_b32 s49, s50, s49
    s_sub_u32 s50, s29, s26
    s_cmp_ge_u32 s20, 2
    s_cselect_b32 s49, s50, s49
    v_mov_b32 v198, v2
    s_mov_b32 s62, s49
    s_add_u32 s33, s31, 0
    s_add_u32 m0, s32, 0
    s_nop 0
    buffer_load_dwordx4 v216, s[4:7], s33 offen lds
    s_add_u32 s33, s31, 294912
    s_add_u32 m0, s32, 4096
    s_nop 0
    buffer_load_dwordx4 v216, s[4:7], s33 offen lds
    s_add_u32 s33, s31, 589824
    s_add_u32 m0, s32, 8192
    s_nop 0
    buffer_load_dwordx4 v216, s[4:7], s33 offen lds
    s_add_u32 s33, s31, 0
    s_add_u32 m0, s32, 12288
    s_nop 0
    buffer_load_dwordx4 v217, s[8:11], s33 offen lds
    s_add_u32 s33, s31, 294912
    s_add_u32 m0, s32, 16384
    s_nop 0
    buffer_load_dwordx4 v217, s[8:11], s33 offen lds
    s_add_u32 s33, s31, 589824
    s_add_u32 m0, s32, 20480
    s_nop 0
    buffer_load_dwordx4 v217, s[8:11], s33 offen lds
    buffer_load_dwordx4 a[0:3], v218, s[16:19], s25 offen offset:0
    buffer_load_dwordx4 a[144:147], v218, s[16:19], s40 offen offset:0
    buffer_load_dwordx4 a[4:7], v218, s[16:19], s25 offen offset:1024
    buffer_load_dwordx4 a[148:151], v218, s[16:19], s40 offen offset:1024
    buffer_load_dwordx4 a[8:11], v218, s[16:19], s25 offen offset:2048
    buffer_load_dwordx4 a[152:155], v218, s[16:19], s40 offen offset:2048
    buffer_load_dwordx4 a[12:15], v218, s[16:19], s25 offen offset:3072
    buffer_load_dwordx4 a[156:159], v218, s[16:19], s40 offen offset:3072
    s_add_u32 s33, s25, 4096
    buffer_load_dwordx4 a[16:19], v218, s[16:19], s33 offen offset:0
    s_add_u32 s33, s40, 4096
    buffer_load_dwordx4 a[160:163], v218, s[16:19], s33 offen offset:0
    s_add_u32 s33, s25, 4096
    buffer_load_dwordx4 a[20:23], v218, s[16:19], s33 offen offset:1024
    s_add_u32 s33, s40, 4096
    buffer_load_dwordx4 a[164:167], v218, s[16:19], s33 offen offset:1024
    v_lshrrev_b32 v2, 5, v1
    v_bfe_u32 v3, v1, 4, 1
    v_bfe_u32 v4, v1, 2, 2
    v_lshl_add_u32 v6, v2, 3, v4
    v_lshlrev_b32 v6, 7, v6
    v_mul_u32_u24 v7, 12288, v3
    v_add_u32 v6, v6, v7
    v_and_b32 v7, 3, v1
    v_lshl_add_u32 v6, v7, 3, v6
    v_lshrrev_b32 v4, 1, v4
    v_lshl_add_u32 v4, v3, 1, v4
    v_xor_b32 v7, 0, v4
    v_lshl_add_u32 v192, v7, 5, v6
    v_xor_b32 v7, 1, v4
    v_lshl_add_u32 v193, v7, 5, v6
    v_xor_b32 v7, 2, v4
    v_lshl_add_u32 v194, v7, 5, v6
    v_xor_b32 v7, 3, v4
    v_lshl_add_u32 v195, v7, 5, v6
    v_xor_b32 v7, s23, v4
    v_lshl_add_u32 v196, v7, 5, v6
    v_bfe_u32 v4, v1, 2, 2
    v_lshlrev_b32 v4, 7, v4
    v_lshl_add_u32 v4, v3, 9, v4
    v_and_b32 v7, 3, v1
    v_lshl_add_u32 v4, v7, 3, v4
    v_add_u32 v230, 147456, v4
    s_lshl_b32 s49, s23, 5
    v_add_u32 v231, s49, v230
    s_lshl_b32 s34, s24, 10
    s_mul_i32 s35, s21, 2359296
    s_add_u32 s34, s34, s35
    s_lshl_b32 s35, s23, 19
    s_add_u32 s35, s35, s34
    s_lshl_b32 s33, s23, 16
    s_add_u32 s34, s34, s33
    s_add_u32 s34, s34, 2097152
    s_mov_b32 s48, 0xbfb8aa3b
    s_waitcnt vmcnt(12)
    s_barrier
    ds_read_b64_tr_b16 v[168:169], v192 offset:0
    ds_read_b64_tr_b16 v[170:171], v192 offset:512
    ds_read_b64_tr_b16 v[172:173], v192 offset:2048
    ds_read_b64_tr_b16 v[174:175], v192 offset:2560
    ds_read_b64_tr_b16 v[176:177], v192 offset:4096
    ds_read_b64_tr_b16 v[178:179], v192 offset:4608
    ds_read_b64_tr_b16 v[180:181], v192 offset:6144
    ds_read_b64_tr_b16 v[182:183], v192 offset:6656
    ds_read_b64_tr_b16 v[184:185], v192 offset:8192
    ds_read_b64_tr_b16 v[186:187], v192 offset:8704
    s_waitcnt vmcnt(10)
    s_waitcnt lgkmcnt(8)
    v_mfma_f32_32x32x16_bf16 v[8:23], v[168:171], a[0:3], 0
    ds_read_b64_tr_b16 v[188:189], v192 offset:10240
    v_mfma_f32_32x32x16_bf16 v[24:39], v[168:171], a[144:147], 0
    ds_read_b64_tr_b16 v[190:191], v192 offset:10752
    s_add_u32 s33, s31, 884736
    s_add_u32 m0, s32, 24576
    s_nop 0
    buffer_load_dwordx4 v216, s[4:7], s33 offen lds
    s_waitcnt vmcnt(9)
    s_waitcnt lgkmcnt(8)
    v_mfma_f32_32x32x16_bf16 v[8:23], v[172:175], a[4:7], v[8:23]
    ds_read_b64_tr_b16 v[168:169], v193 offset:0
    v_mfma_f32_32x32x16_bf16 v[24:39], v[172:175], a[148:151], v[24:39]
    ds_read_b64_tr_b16 v[170:171], v193 offset:512
    s_add_u32 s33, s31, 1179648
    s_add_u32 m0, s32, 28672
    s_nop 0
    buffer_load_dwordx4 v216, s[4:7], s33 offen lds
    s_add_u32 s33, s31, 1474560
    s_add_u32 m0, s32, 32768
    s_nop 0
    buffer_load_dwordx4 v216, s[4:7], s33 offen lds
    s_waitcnt vmcnt(9)
    s_waitcnt lgkmcnt(8)
    v_mfma_f32_32x32x16_bf16 v[8:23], v[176:179], a[8:11], v[8:23]
    ds_read_b64_tr_b16 v[172:173], v193 offset:2048
    v_mfma_f32_32x32x16_bf16 v[24:39], v[176:179], a[152:155], v[24:39]
    ds_read_b64_tr_b16 v[174:175], v193 offset:2560
    s_add_u32 s33, s31, 884736
    s_add_u32 m0, s32, 36864
    s_nop 0
    buffer_load_dwordx4 v217, s[8:11], s33 offen lds
    s_waitcnt vmcnt(8)
    s_waitcnt lgkmcnt(8)
    v_mfma_f32_32x32x16_bf16 v[8:23], v[180:183], a[12:15], v[8:23]
    ds_read_b64_tr_b16 v[176:177], v193 offset:4096
    v_mfma_f32_32x32x16_bf16 v[24:39], v[180:183], a[156:159], v[24:39]
    ds_read_b64_tr_b16 v[178:179], v193 offset:4608
    s_add_u32 s33, s31, 1179648
    s_add_u32 m0, s32, 40960
    s_nop 0
    buffer_load_dwordx4 v217, s[8:11], s33 offen lds
    s_add_u32 s33, s31, 1474560
    s_add_u32 m0, s32, 45056
    s_nop 0
    buffer_load_dwordx4 v217, s[8:11], s33 offen lds
    s_waitcnt vmcnt(8)
    s_waitcnt lgkmcnt(8)
    v_mfma_f32_32x32x16_bf16 v[8:23], v[184:187], a[16:19], v[8:23]
    ds_read_b64_tr_b16 v[180:181], v193 offset:6144
    v_mfma_f32_32x32x16_bf16 v[24:39], v[184:187], a[160:163], v[24:39]
    ds_read_b64_tr_b16 v[182:183], v193 offset:6656
    s_add_u32 s33, s25, 4096
    buffer_load_dwordx4 a[24:27], v218, s[16:19], s33 offen offset:2048
    s_waitcnt vmcnt(7)
    s_waitcnt lgkmcnt(8)
    v_mfma_f32_32x32x16_bf16 v[8:23], v[188:191], a[20:23], v[8:23]
    ds_read_b64_tr_b16 v[184:185], v193 offset:8192
    v_mfma_f32_32x32x16_bf16 v[24:39], v[188:191], a[164:167], v[24:39]
    ds_read_b64_tr_b16 v[186:187], v193 offset:8704
    s_add_u32 s33, s40, 4096
    buffer_load_dwordx4 a[168:171], v218, s[16:19], s33 offen offset:2048
    s_add_u32 s33, s25, 4096
    buffer_load_dwordx4 a[28:31], v218, s[16:19], s33 offen offset:3072
    s_waitcnt lgkmcnt(8)
    v_mfma_f32_32x32x16_bf16 v[40:55], v[168:171], a[0:3], 0
    ds_read_b64_tr_b16 v[188:189], v193 offset:10240
    v_mfma_f32_32x32x16_bf16 v[56:71], v[168:171], a[144:147], 0
    ds_read_b64_tr_b16 v[190:191], v193 offset:10752
    s_add_u32 s33, s40, 4096
    buffer_load_dwordx4 a[172:175], v218, s[16:19], s33 offen offset:3072
    s_waitcnt lgkmcnt(8)
    v_mfma_f32_32x32x16_bf16 v[40:55], v[172:175], a[4:7], v[40:55]
    ds_read_b64_tr_b16 v[168:169], v194 offset:0
    v_mfma_f32_32x32x16_bf16 v[56:71], v[172:175], a[148:151], v[56:71]
    ds_read_b64_tr_b16 v[170:171], v194 offset:512
    s_add_u32 s33, s25, 8192
    buffer_load_dwordx4 a[32:35], v218, s[16:19], s33 offen offset:0
    s_add_u32 s33, s40, 8192
    buffer_load_dwordx4 a[176:179], v218, s[16:19], s33 offen offset:0
    s_waitcnt lgkmcnt(8)
    v_mfma_f32_32x32x16_bf16 v[40:55], v[176:179], a[8:11], v[40:55]
    ds_read_b64_tr_b16 v[172:173], v194 offset:2048
    v_mfma_f32_32x32x16_bf16 v[56:71], v[176:179], a[152:155], v[56:71]
    ds_read_b64_tr_b16 v[174:175], v194 offset:2560
    s_add_u32 s33, s25, 8192
    buffer_load_dwordx4 a[36:39], v218, s[16:19], s33 offen offset:1024
    s_waitcnt lgkmcnt(8)
    v_mfma_f32_32x32x16_bf16 v[40:55], v[180:183], a[12:15], v[40:55]
    ds_read_b64_tr_b16 v[176:177], v194 offset:4096
    v_mfma_f32_32x32x16_bf16 v[56:71], v[180:183], a[156:159], v[56:71]
    ds_read_b64_tr_b16 v[178:179], v194 offset:4608
    s_add_u32 s33, s40, 8192
    buffer_load_dwordx4 a[180:183], v218, s[16:19], s33 offen offset:1024
    s_add_u32 s33, s25, 8192
    buffer_load_dwordx4 a[40:43], v218, s[16:19], s33 offen offset:2048
    s_waitcnt lgkmcnt(8)
    v_mfma_f32_32x32x16_bf16 v[40:55], v[184:187], a[16:19], v[40:55]
    ds_read_b64_tr_b16 v[180:181], v194 offset:6144
    v_mfma_f32_32x32x16_bf16 v[56:71], v[184:187], a[160:163], v[56:71]
    ds_read_b64_tr_b16 v[182:183], v194 offset:6656
    s_add_u32 s33, s40, 8192
    buffer_load_dwordx4 a[184:187], v218, s[16:19], s33 offen offset:2048
    s_waitcnt lgkmcnt(8)
    v_mfma_f32_32x32x16_bf16 v[40:55], v[188:191], a[20:23], v[40:55]
    ds_read_b64_tr_b16 v[184:185], v194 offset:8192
    v_mfma_f32_32x32x16_bf16 v[56:71], v[188:191], a[164:167], v[56:71]
    ds_read_b64_tr_b16 v[186:187], v194 offset:8704
    s_add_u32 s33, s25, 8192
    buffer_load_dwordx4 a[44:47], v218, s[16:19], s33 offen offset:3072
    s_add_u32 s33, s40, 8192
    buffer_load_dwordx4 a[188:191], v218, s[16:19], s33 offen offset:3072
    s_waitcnt lgkmcnt(8)
    v_mfma_f32_32x32x16_bf16 v[72:87], v[168:171], a[0:3], 0
    ds_read_b64_tr_b16 v[188:189], v194 offset:10240
    v_mfma_f32_32x32x16_bf16 v[88:103], v[168:171], a[144:147], 0
    ds_read_b64_tr_b16 v[190:191], v194 offset:10752
    s_add_u32 s33, s31, 1769472
    s_add_u32 m0, s32, 49152
    s_nop 0
    buffer_load_dwordx4 v216, s[4:7], s33 offen lds
    s_waitcnt vmcnt(13)
    s_barrier
    s_waitcnt lgkmcnt(8)
    v_mfma_f32_32x32x16_bf16 v[72:87], v[172:175], a[4:7], v[72:87]
    ds_read_b64_tr_b16 v[168:169], v195 offset:0
    v_mfma_f32_32x32x16_bf16 v[88:103], v[172:175], a[148:151], v[88:103]
    ds_read_b64_tr_b16 v[170:171], v195 offset:512
    s_add_u32 s33, s31, 2064384
    s_add_u32 m0, s32, 53248
    s_nop 0
    buffer_load_dwordx4 v216, s[4:7], s33 offen lds
    s_add_u32 s33, s31, 2359296
    s_add_u32 m0, s32, 57344
    s_nop 0
    buffer_load_dwordx4 v216, s[4:7], s33 offen lds
    s_waitcnt lgkmcnt(8)
    v_mfma_f32_32x32x16_bf16 v[72:87], v[176:179], a[8:11], v[72:87]
    ds_read_b64_tr_b16 v[172:173], v195 offset:2048
    v_mfma_f32_32x32x16_bf16 v[88:103], v[176:179], a[152:155], v[88:103]
    ds_read_b64_tr_b16 v[174:175], v195 offset:2560
    s_add_u32 s33, s31, 1769472
    s_add_u32 m0, s32, 61440
    s_nop 0
    buffer_load_dwordx4 v217, s[8:11], s33 offen lds
    s_waitcnt lgkmcnt(8)
    v_mfma_f32_32x32x16_bf16 v[72:87], v[180:183], a[12:15], v[72:87]
    ds_read_b64_tr_b16 v[176:177], v195 offset:4096
    v_mfma_f32_32x32x16_bf16 v[88:103], v[180:183], a[156:159], v[88:103]
    ds_read_b64_tr_b16 v[178:179], v195 offset:4608
    s_add_u32 s33, s31, 2064384
    s_add_u32 m0, s32, 65536
    s_nop 0
    buffer_load_dwordx4 v217, s[8:11], s33 offen lds
    s_add_u32 s33, s31, 2359296
    s_add_u32 m0, s32, 69632
    s_nop 0
    buffer_load_dwordx4 v217, s[8:11], s33 offen lds
    s_waitcnt lgkmcnt(8)
    v_mfma_f32_32x32x16_bf16 v[72:87], v[184:187], a[16:19], v[72:87]
    ds_read_b64_tr_b16 v[180:181], v195 offset:6144
    v_mfma_f32_32x32x16_bf16 v[88:103], v[184:187], a[160:163], v[88:103]
    ds_read_b64_tr_b16 v[182:183], v195 offset:6656
    s_add_u32 s33, s25, 12288
    buffer_load_dwordx4 a[48:51], v218, s[16:19], s33 offen offset:0
    s_waitcnt lgkmcnt(8)
    v_mfma_f32_32x32x16_bf16 v[72:87], v[188:191], a[20:23], v[72:87]
    ds_read_b64_tr_b16 v[184:185], v195 offset:8192
    v_mfma_f32_32x32x16_bf16 v[88:103], v[188:191], a[164:167], v[88:103]
    ds_read_b64_tr_b16 v[186:187], v195 offset:8704
    s_add_u32 s33, s40, 12288
    buffer_load_dwordx4 a[192:195], v218, s[16:19], s33 offen offset:0
    s_add_u32 s33, s25, 12288
    buffer_load_dwordx4 a[52:55], v218, s[16:19], s33 offen offset:1024
    s_waitcnt lgkmcnt(8)
    v_mfma_f32_32x32x16_bf16 v[104:119], v[168:171], a[0:3], 0
    ds_read_b64_tr_b16 v[188:189], v195 offset:10240
    v_mfma_f32_32x32x16_bf16 v[120:135], v[168:171], a[144:147], 0
    ds_read_b64_tr_b16 v[190:191], v195 offset:10752
    s_add_u32 s33, s40, 12288
    buffer_load_dwordx4 a[196:199], v218, s[16:19], s33 offen offset:1024
    s_waitcnt lgkmcnt(8)
    v_mfma_f32_32x32x16_bf16 v[104:119], v[172:175], a[4:7], v[104:119]
    ds_read_b64_tr_b16 v[168:169], v192 offset:24576
    v_mfma_f32_32x32x16_bf16 v[120:135], v[172:175], a[148:151], v[120:135]
    ds_read_b64_tr_b16 v[170:171], v192 offset:25088
    s_add_u32 s33, s25, 12288
    buffer_load_dwordx4 a[56:59], v218, s[16:19], s33 offen offset:2048
    s_add_u32 s33, s40, 12288
    buffer_load_dwordx4 a[200:203], v218, s[16:19], s33 offen offset:2048
    s_waitcnt lgkmcnt(8)
    v_mfma_f32_32x32x16_bf16 v[104:119], v[176:179], a[8:11], v[104:119]
    ds_read_b64_tr_b16 v[172:173], v192 offset:26624
    v_mfma_f32_32x32x16_bf16 v[120:135], v[176:179], a[152:155], v[120:135]
    ds_read_b64_tr_b16 v[174:175], v192 offset:27136
    s_add_u32 s33, s25, 12288
    buffer_load_dwordx4 a[60:63], v218, s[16:19], s33 offen offset:3072
    s_waitcnt lgkmcnt(8)
    v_mfma_f32_32x32x16_bf16 v[104:119], v[180:183], a[12:15], v[104:119]
    ds_read_b64_tr_b16 v[176:177], v192 offset:28672
    v_mfma_f32_32x32x16_bf16 v[120:135], v[180:183], a[156:159], v[120:135]
    ds_read_b64_tr_b16 v[178:179], v192 offset:29184
    s_add_u32 s33, s40, 12288
    buffer_load_dwordx4 a[204:207], v218, s[16:19], s33 offen offset:3072
    s_add_u32 s33, s25, 16384
    buffer_load_dwordx4 a[64:67], v218, s[16:19], s33 offen offset:0
    s_waitcnt lgkmcnt(8)
    v_mfma_f32_32x32x16_bf16 v[104:119], v[184:187], a[16:19], v[104:119]
    ds_read_b64_tr_b16 v[180:181], v192 offset:30720
    v_mfma_f32_32x32x16_bf16 v[120:135], v[184:187], a[160:163], v[120:135]
    ds_read_b64_tr_b16 v[182:183], v192 offset:31232
    s_add_u32 s33, s40, 16384
    buffer_load_dwordx4 a[208:211], v218, s[16:19], s33 offen offset:0
    s_waitcnt lgkmcnt(8)
    v_mfma_f32_32x32x16_bf16 v[104:119], v[188:191], a[20:23], v[104:119]
    ds_read_b64_tr_b16 v[184:185], v192 offset:32768
    v_mfma_f32_32x32x16_bf16 v[120:135], v[188:191], a[164:167], v[120:135]
    ds_read_b64_tr_b16 v[186:187], v192 offset:33280
    s_add_u32 s33, s25, 16384
    buffer_load_dwordx4 a[68:71], v218, s[16:19], s33 offen offset:1024
    s_add_u32 s33, s40, 16384
    buffer_load_dwordx4 a[212:215], v218, s[16:19], s33 offen offset:1024
    s_waitcnt vmcnt(28)
    s_waitcnt lgkmcnt(8)
    v_mfma_f32_32x32x16_bf16 v[8:23], v[168:171], a[24:27], v[8:23]
    ds_read_b64_tr_b16 v[188:189], v192 offset:34816
    v_mfma_f32_32x32x16_bf16 v[24:39], v[168:171], a[168:171], v[24:39]
    ds_read_b64_tr_b16 v[190:191], v192 offset:35328
    s_waitcnt vmcnt(26)
    s_waitcnt lgkmcnt(8)
    v_mfma_f32_32x32x16_bf16 v[8:23], v[172:175], a[28:31], v[8:23]
    ds_read_b64_tr_b16 v[168:169], v193 offset:24576
    v_mfma_f32_32x32x16_bf16 v[24:39], v[172:175], a[172:175], v[24:39]
    ds_read_b64_tr_b16 v[170:171], v193 offset:25088
    s_add_u32 m0, s32, 147456
    s_nop 0
    buffer_load_dwordx4 v198, s[56:59], s62 offen lds
    s_waitcnt vmcnt(25)
    s_waitcnt lgkmcnt(8)
    v_mfma_f32_32x32x16_bf16 v[8:23], v[176:179], a[32:35], v[8:23]
    ds_read_b64_tr_b16 v[172:173], v193 offset:26624
    v_mfma_f32_32x32x16_bf16 v[24:39], v[176:179], a[176:179], v[24:39]
    ds_read_b64_tr_b16 v[174:175], v193 offset:27136
    buffer_load_dwordx4 v[232:235], v199, s[52:55], s60 offen offset:0
    s_waitcnt vmcnt(24)
    s_waitcnt lgkmcnt(8)
    v_mfma_f32_32x32x16_bf16 v[8:23], v[180:183], a[36:39], v[8:23]
    ds_read_b64_tr_b16 v[176:177], v193 offset:28672
    v_mfma_f32_32x32x16_bf16 v[24:39], v[180:183], a[180:183], v[24:39]
    ds_read_b64_tr_b16 v[178:179], v193 offset:29184
    buffer_load_dwordx4 v[236:239], v199, s[52:55], s60 offen offset:16
    s_waitcnt vmcnt(23)
    s_waitcnt lgkmcnt(8)
    v_mfma_f32_32x32x16_bf16 v[8:23], v[184:187], a[40:43], v[8:23]
    ds_read_b64_tr_b16 v[180:181], v193 offset:30720
    v_mfma_f32_32x32x16_bf16 v[24:39], v[184:187], a[184:187], v[24:39]
    ds_read_b64_tr_b16 v[182:183], v193 offset:31232
    buffer_load_dwordx4 v[240:243], v199, s[52:55], s60 offen offset:32
    s_waitcnt vmcnt(22)
    s_waitcnt lgkmcnt(8)
    v_mfma_f32_32x32x16_bf16 v[8:23], v[188:191], a[44:47], v[8:23]
    ds_read_b64_tr_b16 v[184:185], v193 offset:32768
    v_mfma_f32_32x32x16_bf16 v[24:39], v[188:191], a[188:191], v[24:39]
    ds_read_b64_tr_b16 v[186:187], v193 offset:33280
    s_waitcnt lgkmcnt(8)
    v_mfma_f32_32x32x16_bf16 v[40:55], v[168:171], a[24:27], v[40:55]
    ds_read_b64_tr_b16 v[188:189], v193 offset:34816
    v_mfma_f32_32x32x16_bf16 v[56:71], v[168:171], a[168:171], v[56:71]
    ds_read_b64_tr_b16 v[190:191], v193 offset:35328
    buffer_load_dwordx4 v[244:247], v199, s[52:55], s61 offen offset:0
    s_waitcnt lgkmcnt(8)
    v_mfma_f32_32x32x16_bf16 v[40:55], v[172:175], a[28:31], v[40:55]
    ds_read_b64_tr_b16 v[168:169], v194 offset:24576
    v_mfma_f32_32x32x16_bf16 v[56:71], v[172:175], a[172:175], v[56:71]
    ds_read_b64_tr_b16 v[170:171], v194 offset:25088
    buffer_load_dwordx4 v[248:251], v199, s[52:55], s61 offen offset:16
    s_waitcnt lgkmcnt(8)
    v_mfma_f32_32x32x16_bf16 v[40:55], v[176:179], a[32:35], v[40:55]
    ds_read_b64_tr_b16 v[172:173], v194 offset:26624
    v_mfma_f32_32x32x16_bf16 v[56:71], v[176:179], a[176:179], v[56:71]
    ds_read_b64_tr_b16 v[174:175], v194 offset:27136
    buffer_load_dwordx4 v[252:255], v199, s[52:55], s61 offen offset:32
    s_waitcnt lgkmcnt(8)
    v_mfma_f32_32x32x16_bf16 v[40:55], v[180:183], a[36:39], v[40:55]
    ds_read_b64_tr_b16 v[176:177], v194 offset:28672
    v_mfma_f32_32x32x16_bf16 v[56:71], v[180:183], a[180:183], v[56:71]
    ds_read_b64_tr_b16 v[178:179], v194 offset:29184
    s_add_u32 s33, s31, 2654208
    s_add_u32 m0, s32, 73728
    s_nop 0
    buffer_load_dwordx4 v216, s[4:7], s33 offen lds
    s_waitcnt lgkmcnt(8)
    v_mfma_f32_32x32x16_bf16 v[40:55], v[184:187], a[40:43], v[40:55]
    ds_read_b64_tr_b16 v[180:181], v194 offset:30720
    v_mfma_f32_32x32x16_bf16 v[56:71], v[184:187], a[184:187], v[56:71]
    ds_read_b64_tr_b16 v[182:183], v194 offset:31232
    s_waitcnt lgkmcnt(8)
    v_mfma_f32_32x32x16_bf16 v[40:55], v[188:191], a[44:47], v[40:55]
    ds_read_b64_tr_b16 v[184:185], v194 offset:32768
    v_mfma_f32_32x32x16_bf16 v[56:71], v[188:191], a[188:191], v[56:71]
    ds_read_b64_tr_b16 v[186:187], v194 offset:33280
    s_add_u32 s33, s31, 2949120
    s_add_u32 m0, s32, 77824
    s_nop 0
    buffer_load_dwordx4 v216, s[4:7], s33 offen lds
    s_waitcnt lgkmcnt(8)
    v_mfma_f32_32x32x16_bf16 v[72:87], v[168:171], a[24:27], v[72:87]
    ds_read_b64_tr_b16 v[188:189], v194 offset:34816
    v_mfma_f32_32x32x16_bf16 v[88:103], v[168:171], a[168:171], v[88:103]
    ds_read_b64_tr_b16 v[190:191], v194 offset:35328
    s_add_u32 s33, s31, 3244032
    s_add_u32 m0, s32, 81920
    s_nop 0
    buffer_load_dwordx4 v216, s[4:7], s33 offen lds
    s_waitcnt vmcnt(22)
    s_barrier
    s_waitcnt lgkmcnt(8)
    v_mfma_f32_32x32x16_bf16 v[72:87], v[172:175], a[28:31], v[72:87]
    ds_read_b64_tr_b16 v[168:169], v195 offset:24576
    v_mfma_f32_32x32x16_bf16 v[88:103], v[172:175], a[172:175], v[88:103]
    ds_read_b64_tr_b16 v[170:171], v195 offset:25088
    s_add_u32 s33, s31, 2654208
    s_add_u32 m0, s32, 86016
    s_nop 0
    buffer_load_dwordx4 v217, s[8:11], s33 offen lds
    s_waitcnt lgkmcnt(8)
    v_mfma_f32_32x32x16_bf16 v[72:87], v[176:179], a[32:35], v[72:87]
    ds_read_b64_tr_b16 v[172:173], v195 offset:26624
    v_mfma_f32_32x32x16_bf16 v[88:103], v[176:179], a[176:179], v[88:103]
    ds_read_b64_tr_b16 v[174:175], v195 offset:27136
    s_add_u32 s33, s31, 2949120
    s_add_u32 m0, s32, 90112
    s_nop 0
    buffer_load_dwordx4 v217, s[8:11], s33 offen lds
    s_waitcnt lgkmcnt(8)
    v_mfma_f32_32x32x16_bf16 v[72:87], v[180:183], a[36:39], v[72:87]
    ds_read_b64_tr_b16 v[176:177], v195 offset:28672
    v_mfma_f32_32x32x16_bf16 v[88:103], v[180:183], a[180:183], v[88:103]
    ds_read_b64_tr_b16 v[178:179], v195 offset:29184
    s_waitcnt lgkmcnt(8)
    v_mfma_f32_32x32x16_bf16 v[72:87], v[184:187], a[40:43], v[72:87]
    ds_read_b64_tr_b16 v[180:181], v195 offset:30720
    v_mfma_f32_32x32x16_bf16 v[88:103], v[184:187], a[184:187], v[88:103]
    ds_read_b64_tr_b16 v[182:183], v195 offset:31232
    s_add_u32 s33, s31, 3244032
    s_add_u32 m0, s32, 94208
    s_nop 0
    buffer_load_dwordx4 v217, s[8:11], s33 offen lds
    s_waitcnt lgkmcnt(8)
    v_mfma_f32_32x32x16_bf16 v[72:87], v[188:191], a[44:47], v[72:87]
    ds_read_b64_tr_b16 v[184:185], v195 offset:32768
    v_mfma_f32_32x32x16_bf16 v[88:103], v[188:191], a[188:191], v[88:103]
    ds_read_b64_tr_b16 v[186:187], v195 offset:33280
    s_add_u32 s33, s25, 16384
    buffer_load_dwordx4 a[72:75], v218, s[16:19], s33 offen offset:2048
    s_waitcnt lgkmcnt(8)
    v_mfma_f32_32x32x16_bf16 v[104:119], v[168:171], a[24:27], v[104:119]
    ds_read_b64_tr_b16 v[188:189], v195 offset:34816
    v_mfma_f32_32x32x16_bf16 v[120:135], v[168:171], a[168:171], v[120:135]
    ds_read_b64_tr_b16 v[190:191], v195 offset:35328
    s_add_u32 s33, s40, 16384
    buffer_load_dwordx4 a[216:219], v218, s[16:19], s33 offen offset:2048
    s_waitcnt lgkmcnt(8)
    v_mfma_f32_32x32x16_bf16 v[104:119], v[172:175], a[28:31], v[104:119]
    v_add_u32 v192, 0xc000, v192
    v_add_u32 v193, 0xc000, v193
    v_add_u32 v194, 0xc000, v194
    v_add_u32 v195, 0xc000, v195
    v_add_u32 v196, 0xc000, v196
    ds_read_b64_tr_b16 v[168:169], v192 offset:0
    v_mfma_f32_32x32x16_bf16 v[120:135], v[172:175], a[172:175], v[120:135]
    ds_read_b64_tr_b16 v[170:171], v192 offset:512
    s_add_u32 s33, s25, 16384
    buffer_load_dwordx4 a[76:79], v218, s[16:19], s33 offen offset:3072
    s_waitcnt lgkmcnt(8)
    v_mfma_f32_32x32x16_bf16 v[104:119], v[176:179], a[32:35], v[104:119]
    ds_read_b64_tr_b16 v[172:173], v192 offset:2048
    v_mfma_f32_32x32x16_bf16 v[120:135], v[176:179], a[176:179], v[120:135]
    ds_read_b64_tr_b16 v[174:175], v192 offset:2560
    s_waitcnt lgkmcnt(8)
    v_mfma_f32_32x32x16_bf16 v[104:119], v[180:183], a[36:39], v[104:119]
    ds_read_b64_tr_b16 v[176:177], v192 offset:4096
    v_mfma_f32_32x32x16_bf16 v[120:135], v[180:183], a[180:183], v[120:135]
    ds_read_b64_tr_b16 v[178:179], v192 offset:4608
    s_add_u32 s33, s40, 16384
    buffer_load_dwordx4 a[220:223], v218, s[16:19], s33 offen offset:3072
    s_waitcnt lgkmcnt(8)
    v_mfma_f32_32x32x16_bf16 v[104:119], v[184:187], a[40:43], v[104:119]
    ds_read_b64_tr_b16 v[180:181], v192 offset:6144
    v_mfma_f32_32x32x16_bf16 v[120:135], v[184:187], a[184:187], v[120:135]
    ds_read_b64_tr_b16 v[182:183], v192 offset:6656
    s_add_u32 s33, s25, 20480
    buffer_load_dwordx4 a[80:83], v218, s[16:19], s33 offen offset:0
    s_waitcnt lgkmcnt(8)
    v_mfma_f32_32x32x16_bf16 v[104:119], v[188:191], a[44:47], v[104:119]
    ds_read_b64_tr_b16 v[184:185], v192 offset:8192
    v_mfma_f32_32x32x16_bf16 v[120:135], v[188:191], a[188:191], v[120:135]
    ds_read_b64_tr_b16 v[186:187], v192 offset:8704
    s_add_u32 s33, s40, 20480
    buffer_load_dwordx4 a[224:227], v218, s[16:19], s33 offen offset:0
    s_waitcnt vmcnt(29)
    s_waitcnt lgkmcnt(8)
    v_mfma_f32_32x32x16_bf16 v[8:23], v[168:171], a[48:51], v[8:23]
    ds_read_b64_tr_b16 v[188:189], v192 offset:10240
    v_mfma_f32_32x32x16_bf16 v[24:39], v[168:171], a[192:195], v[24:39]
    ds_read_b64_tr_b16 v[190:191], v192 offset:10752
    s_add_u32 s33, s25, 20480
    buffer_load_dwordx4 a[84:87], v218, s[16:19], s33 offen offset:1024
    s_waitcnt vmcnt(28)
    s_waitcnt lgkmcnt(8)
    v_mfma_f32_32x32x16_bf16 v[8:23], v[172:175], a[52:55], v[8:23]
    ds_read_b64_tr_b16 v[168:169], v193 offset:0
    v_mfma_f32_32x32x16_bf16 v[24:39], v[172:175], a[196:199], v[24:39]
    ds_read_b64_tr_b16 v[170:171], v193 offset:512
    s_waitcnt vmcnt(26)
    s_waitcnt lgkmcnt(8)
    v_mfma_f32_32x32x16_bf16 v[8:23], v[176:179], a[56:59], v[8:23]
    ds_read_b64_tr_b16 v[172:173], v193 offset:2048
    v_mfma_f32_32x32x16_bf16 v[24:39], v[176:179], a[200:203], v[24:39]
    ds_read_b64_tr_b16 v[174:175], v193 offset:2560
    s_add_u32 s33, s40, 20480
    buffer_load_dwordx4 a[228:231], v218, s[16:19], s33 offen offset:1024
    s_waitcnt vmcnt(25)
    s_waitcnt lgkmcnt(8)
    v_mfma_f32_32x32x16_bf16 v[8:23], v[180:183], a[60:63], v[8:23]
    ds_read_b64_tr_b16 v[176:177], v193 offset:4096
    v_mfma_f32_32x32x16_bf16 v[24:39], v[180:183], a[204:207], v[24:39]
    ds_read_b64_tr_b16 v[178:179], v193 offset:4608
    s_add_u32 s33, s25, 20480
    buffer_load_dwordx4 a[88:91], v218, s[16:19], s33 offen offset:2048
    s_waitcnt vmcnt(24)
    s_waitcnt lgkmcnt(8)
    v_mfma_f32_32x32x16_bf16 v[8:23], v[184:187], a[64:67], v[8:23]
    ds_read_b64_tr_b16 v[180:181], v193 offset:6144
    v_mfma_f32_32x32x16_bf16 v[24:39], v[184:187], a[208:211], v[24:39]
    ds_read_b64_tr_b16 v[182:183], v193 offset:6656
    s_add_u32 s33, s40, 20480
    buffer_load_dwordx4 a[232:235], v218, s[16:19], s33 offen offset:2048
    s_waitcnt vmcnt(23)
    s_waitcnt lgkmcnt(8)
    v_mfma_f32_32x32x16_bf16 v[8:23], v[188:191], a[68:71], v[8:23]
    ds_read_b64_tr_b16 v[184:185], v193 offset:8192
    v_mfma_f32_32x32x16_bf16 v[24:39], v[188:191], a[212:215], v[24:39]
    ds_read_b64_tr_b16 v[186:187], v193 offset:8704
    s_add_u32 s33, s25, 20480
    buffer_load_dwordx4 a[92:95], v218, s[16:19], s33 offen offset:3072
    s_waitcnt lgkmcnt(8)
    v_mfma_f32_32x32x16_bf16 v[40:55], v[168:171], a[48:51], v[40:55]
    ds_read_b64_tr_b16 v[188:189], v193 offset:10240
    v_mfma_f32_32x32x16_bf16 v[56:71], v[168:171], a[192:195], v[56:71]
    ds_read_b64_tr_b16 v[190:191], v193 offset:10752
    s_waitcnt lgkmcnt(8)
    v_mfma_f32_32x32x16_bf16 v[40:55], v[172:175], a[52:55], v[40:55]
    ds_read_b64_tr_b16 v[168:169], v194 offset:0
    v_mfma_f32_32x32x16_bf16 v[56:71], v[172:175], a[196:199], v[56:71]
    ds_read_b64_tr_b16 v[170:171], v194 offset:512
    s_add_u32 s33, s40, 20480
    buffer_load_dwordx4 a[236:239], v218, s[16:19], s33 offen offset:3072
    s_waitcnt lgkmcnt(8)
    v_mfma_f32_32x32x16_bf16 v[40:55], v[176:179], a[56:59], v[40:55]
    ds_read_b64_tr_b16 v[172:173], v194 offset:2048
    v_mfma_f32_32x32x16_bf16 v[56:71], v[176:179], a[200:203], v[56:71]
    ds_read_b64_tr_b16 v[174:175], v194 offset:2560
    s_add_u32 s33, s31, 3538944
    s_add_u32 m0, s32, 98304
    s_nop 0
    buffer_load_dwordx4 v216, s[4:7], s33 offen lds
    s_waitcnt lgkmcnt(8)
    v_mfma_f32_32x32x16_bf16 v[40:55], v[180:183], a[60:63], v[40:55]
    ds_read_b64_tr_b16 v[176:177], v194 offset:4096
    v_mfma_f32_32x32x16_bf16 v[56:71], v[180:183], a[204:207], v[56:71]
    ds_read_b64_tr_b16 v[178:179], v194 offset:4608
    s_add_u32 s33, s31, 3833856
    s_add_u32 m0, s32, 102400
    s_nop 0
    buffer_load_dwordx4 v216, s[4:7], s33 offen lds
    s_waitcnt lgkmcnt(8)
    v_mfma_f32_32x32x16_bf16 v[40:55], v[184:187], a[64:67], v[40:55]
    ds_read_b64_tr_b16 v[180:181], v194 offset:6144
    v_mfma_f32_32x32x16_bf16 v[56:71], v[184:187], a[208:211], v[56:71]
    ds_read_b64_tr_b16 v[182:183], v194 offset:6656
    s_add_u32 s33, s31, 4128768
    s_add_u32 m0, s32, 106496
    s_nop 0
    buffer_load_dwordx4 v216, s[4:7], s33 offen lds
    s_waitcnt lgkmcnt(8)
    v_mfma_f32_32x32x16_bf16 v[40:55], v[188:191], a[68:71], v[40:55]
    ds_read_b64_tr_b16 v[184:185], v194 offset:8192
    v_mfma_f32_32x32x16_bf16 v[56:71], v[188:191], a[212:215], v[56:71]
    ds_read_b64_tr_b16 v[186:187], v194 offset:8704
    s_waitcnt lgkmcnt(8)
    v_mfma_f32_32x32x16_bf16 v[72:87], v[168:171], a[48:51], v[72:87]
    ds_read_b64_tr_b16 v[188:189], v194 offset:10240
    v_mfma_f32_32x32x16_bf16 v[88:103], v[168:171], a[192:195], v[88:103]
    ds_read_b64_tr_b16 v[190:191], v194 offset:10752
    s_add_u32 s33, s31, 3538944
    s_add_u32 m0, s32, 110592
    s_nop 0
    buffer_load_dwordx4 v217, s[8:11], s33 offen lds
    s_waitcnt vmcnt(16)
    s_barrier
    s_waitcnt lgkmcnt(8)
    v_mfma_f32_32x32x16_bf16 v[72:87], v[172:175], a[52:55], v[72:87]
    ds_read_b64_tr_b16 v[168:169], v195 offset:0
    v_mfma_f32_32x32x16_bf16 v[88:103], v[172:175], a[196:199], v[88:103]
    ds_read_b64_tr_b16 v[170:171], v195 offset:512
    s_add_u32 s33, s31, 3833856
    s_add_u32 m0, s32, 114688
    s_nop 0
    buffer_load_dwordx4 v217, s[8:11], s33 offen lds
    s_waitcnt lgkmcnt(8)
    v_mfma_f32_32x32x16_bf16 v[72:87], v[176:179], a[56:59], v[72:87]
    ds_read_b64_tr_b16 v[172:173], v195 offset:2048
    v_mfma_f32_32x32x16_bf16 v[88:103], v[176:179], a[200:203], v[88:103]
    ds_read_b64_tr_b16 v[174:175], v195 offset:2560
    s_add_u32 s33, s31, 4128768
    s_add_u32 m0, s32, 118784
    s_nop 0
    buffer_load_dwordx4 v217, s[8:11], s33 offen lds
    s_waitcnt lgkmcnt(8)
    v_mfma_f32_32x32x16_bf16 v[72:87], v[180:183], a[60:63], v[72:87]
    ds_read_b64_tr_b16 v[176:177], v195 offset:4096
    v_mfma_f32_32x32x16_bf16 v[88:103], v[180:183], a[204:207], v[88:103]
    ds_read_b64_tr_b16 v[178:179], v195 offset:4608
    s_add_u32 s33, s25, 24576
    buffer_load_dwordx4 a[96:99], v218, s[16:19], s33 offen offset:0
    s_waitcnt lgkmcnt(8)
    v_mfma_f32_32x32x16_bf16 v[72:87], v[184:187], a[64:67], v[72:87]
    ds_read_b64_tr_b16 v[180:181], v195 offset:6144
    v_mfma_f32_32x32x16_bf16 v[88:103], v[184:187], a[208:211], v[88:103]
    ds_read_b64_tr_b16 v[182:183], v195 offset:6656
    s_waitcnt lgkmcnt(8)
    v_mfma_f32_32x32x16_bf16 v[72:87], v[188:191], a[68:71], v[72:87]
    ds_read_b64_tr_b16 v[184:185], v195 offset:8192
    v_mfma_f32_32x32x16_bf16 v[88:103], v[188:191], a[212:215], v[88:103]
    ds_read_b64_tr_b16 v[186:187], v195 offset:8704
    s_add_u32 s33, s40, 24576
    buffer_load_dwordx4 a[240:243], v218, s[16:19], s33 offen offset:0
    s_waitcnt lgkmcnt(8)
    v_mfma_f32_32x32x16_bf16 v[104:119], v[168:171], a[48:51], v[104:119]
    ds_read_b64_tr_b16 v[188:189], v195 offset:10240
    v_mfma_f32_32x32x16_bf16 v[120:135], v[168:171], a[192:195], v[120:135]
    ds_read_b64_tr_b16 v[190:191], v195 offset:10752
    s_add_u32 s33, s25, 24576
    buffer_load_dwordx4 a[100:103], v218, s[16:19], s33 offen offset:1024
    s_waitcnt lgkmcnt(8)
    v_mfma_f32_32x32x16_bf16 v[104:119], v[172:175], a[52:55], v[104:119]
    ds_read_b64_tr_b16 v[168:169], v192 offset:24576
    v_mfma_f32_32x32x16_bf16 v[120:135], v[172:175], a[196:199], v[120:135]
    ds_read_b64_tr_b16 v[170:171], v192 offset:25088
    s_add_u32 s33, s40, 24576
    buffer_load_dwordx4 a[244:247], v218, s[16:19], s33 offen offset:1024
    s_waitcnt lgkmcnt(8)
    v_mfma_f32_32x32x16_bf16 v[104:119], v[176:179], a[56:59], v[104:119]
    ds_read_b64_tr_b16 v[172:173], v192 offset:26624
    v_mfma_f32_32x32x16_bf16 v[120:135], v[176:179], a[200:203], v[120:135]
    ds_read_b64_tr_b16 v[174:175], v192 offset:27136
    s_add_u32 s33, s25, 24576
    buffer_load_dwordx4 a[104:107], v218, s[16:19], s33 offen offset:2048
    s_waitcnt lgkmcnt(8)
    v_mfma_f32_32x32x16_bf16 v[104:119], v[180:183], a[60:63], v[104:119]
    ds_read_b64_tr_b16 v[176:177], v192 offset:28672
    v_mfma_f32_32x32x16_bf16 v[120:135], v[180:183], a[204:207], v[120:135]
    ds_read_b64_tr_b16 v[178:179], v192 offset:29184
    s_waitcnt lgkmcnt(8)
    v_mfma_f32_32x32x16_bf16 v[104:119], v[184:187], a[64:67], v[104:119]
    ds_read_b64_tr_b16 v[180:181], v192 offset:30720
    v_mfma_f32_32x32x16_bf16 v[120:135], v[184:187], a[208:211], v[120:135]
    ds_read_b64_tr_b16 v[182:183], v192 offset:31232
    s_add_u32 s33, s40, 24576
    buffer_load_dwordx4 a[248:251], v218, s[16:19], s33 offen offset:2048
    s_waitcnt lgkmcnt(8)
    v_mfma_f32_32x32x16_bf16 v[104:119], v[188:191], a[68:71], v[104:119]
    ds_read_b64_tr_b16 v[184:185], v192 offset:32768
    v_mfma_f32_32x32x16_bf16 v[120:135], v[188:191], a[212:215], v[120:135]
    ds_read_b64_tr_b16 v[186:187], v192 offset:33280
    s_add_u32 s33, s25, 24576
    buffer_load_dwordx4 a[108:111], v218, s[16:19], s33 offen offset:3072
    s_waitcnt vmcnt(23)
    s_waitcnt lgkmcnt(8)
    v_mfma_f32_32x32x16_bf16 v[8:23], v[168:171], a[72:75], v[8:23]
    ds_read_b64_tr_b16 v[188:189], v192 offset:34816
    v_mfma_f32_32x32x16_bf16 v[24:39], v[168:171], a[216:219], v[24:39]
    ds_read_b64_tr_b16 v[190:191], v192 offset:35328
    s_add_u32 s33, s40, 24576
    buffer_load_dwordx4 a[252:255], v218, s[16:19], s33 offen offset:3072
    s_waitcnt vmcnt(22)
    s_waitcnt lgkmcnt(8)
    v_mfma_f32_32x32x16_bf16 v[8:23], v[172:175], a[76:79], v[8:23]
    ds_read_b64_tr_b16 v[168:169], v193 offset:24576
    v_mfma_f32_32x32x16_bf16 v[24:39], v[172:175], a[220:223], v[24:39]
    ds_read_b64_tr_b16 v[170:171], v193 offset:25088
    s_add_u32 s33, s25, 28672
    buffer_load_dwordx4 a[112:115], v218, s[16:19], s33 offen offset:0
    s_waitcnt vmcnt(21)
    s_waitcnt lgkmcnt(8)
    v_mfma_f32_32x32x16_bf16 v[8:23], v[176:179], a[80:83], v[8:23]
    ds_read_b64_tr_b16 v[172:173], v193 offset:26624
    v_mfma_f32_32x32x16_bf16 v[24:39], v[176:179], a[224:227], v[24:39]
    ds_read_b64_tr_b16 v[174:175], v193 offset:27136
    s_waitcnt vmcnt(19)
    s_waitcnt lgkmcnt(8)
    v_mfma_f32_32x32x16_bf16 v[8:23], v[180:183], a[84:87], v[8:23]
    ds_read_b64_tr_b16 v[176:177], v193 offset:28672
    v_mfma_f32_32x32x16_bf16 v[24:39], v[180:183], a[228:231], v[24:39]
    ds_read_b64_tr_b16 v[178:179], v193 offset:29184
    s_add_u32 s33, s40, 28672
    buffer_load_dwordx4 v[136:139], v218, s[16:19], s33 offen offset:0
    s_waitcnt vmcnt(18)
    s_waitcnt lgkmcnt(8)
    v_mfma_f32_32x32x16_bf16 v[8:23], v[184:187], a[88:91], v[8:23]
    ds_read_b64_tr_b16 v[180:181], v193 offset:30720
    v_mfma_f32_32x32x16_bf16 v[24:39], v[184:187], a[232:235], v[24:39]
    ds_read_b64_tr_b16 v[182:183], v193 offset:31232
    s_add_u32 s33, s25, 28672
    buffer_load_dwordx4 a[116:119], v218, s[16:19], s33 offen offset:1024
    s_waitcnt vmcnt(17)
    s_waitcnt lgkmcnt(8)
    v_mfma_f32_32x32x16_bf16 v[8:23], v[188:191], a[92:95], v[8:23]
    ds_read_b64_tr_b16 v[184:185], v193 offset:32768
    v_mfma_f32_32x32x16_bf16 v[24:39], v[188:191], a[236:239], v[24:39]
    ds_read_b64_tr_b16 v[186:187], v193 offset:33280
    s_add_u32 s33, s40, 28672
    buffer_load_dwordx4 v[140:143], v218, s[16:19], s33 offen offset:1024
    s_waitcnt lgkmcnt(8)
    v_mfma_f32_32x32x16_bf16 v[40:55], v[168:171], a[72:75], v[40:55]
    ds_read_b64_tr_b16 v[188:189], v193 offset:34816
    v_mfma_f32_32x32x16_bf16 v[56:71], v[168:171], a[216:219], v[56:71]
    ds_read_b64_tr_b16 v[190:191], v193 offset:35328
    s_add_u32 s33, s31, 4423680
    s_add_u32 m0, s32, 122880
    s_nop 0
    buffer_load_dwordx4 v216, s[4:7], s33 offen lds
    v_cmp_gt_u32 vcc, 32, v1
    v_add_f32 v200, v232, v234
    v_add_f32 v200, v200, v236
    v_add_f32 v200, v200, v238
    v_add_f32 v200, v200, v240
    v_add_f32 v200, v200, v242
    v_mul_f32 v200, 0xbe2aaaab, v200
    v_add_f32 v201, v233, v235
    v_add_f32 v201, v201, v237
    v_add_f32 v201, v201, v239
    v_add_f32 v201, v201, v241
    v_add_f32 v201, v201, v243
    v_mov_b32 v202, 0
    v_add_f32 v232, v232, v200
    v_fmac_f32 v202, v232, v232
    v_add_f32 v234, v234, v200
    v_fmac_f32 v202, v234, v234
    v_add_f32 v236, v236, v200
    v_fmac_f32 v202, v236, v236
    v_add_f32 v238, v238, v200
    v_fmac_f32 v202, v238, v238
    v_add_f32 v240, v240, v200
    v_fmac_f32 v202, v240, v240
    v_add_f32 v242, v242, v200
    v_fmac_f32 v202, v242, v242
    v_fmac_f32 v201, 0x42c00000, v202
    v_mul_f32 v201, 0x3ae38e39, v201
    v_cvt_pk_bf16_f32 v201, v201, v201
    v_lshlrev_b32 v201, 16, v201
    v_add_f32 v201, 0x3727c5ac, v201
    v_cvt_pk_bf16_f32 v201, v201, v201
    v_lshlrev_b32 v201, 16, v201
    v_sqrt_f32 v201, v201
    s_nop 0
    v_cvt_pk_bf16_f32 v201, v201, v201
    v_lshlrev_b32 v201, 16, v201
    v_rcp_f32 v202, v201
    v_cvt_pk_bf16_f32 v200, v200, v200
    v_lshlrev_b32 v200, 16, v200
    v_cvt_pk_bf16_f32 v204, v200, v200
    v_cvt_pk_bf16_f32 v205, v201, v201
    v_mov_b32 v222, 0
    v_mov_b32 v223, 0
    v_cndmask_b32 v220, v222, v204, vcc
    v_cndmask_b32 v221, v222, v205, vcc
    v_mul_f32 v228, 0xbfb8aa3b, v202
    v_add_f32 v200, v244, v246
    v_add_f32 v200, v200, v248
    v_add_f32 v200, v200, v250
    v_add_f32 v200, v200, v252
    v_add_f32 v200, v200, v254
    v_mul_f32 v200, 0xbe2aaaab, v200
    v_add_f32 v201, v245, v247
    v_add_f32 v201, v201, v249
    v_add_f32 v201, v201, v251
    v_add_f32 v201, v201, v253
    v_add_f32 v201, v201, v255
    v_mov_b32 v202, 0
    v_add_f32 v244, v244, v200
    v_fmac_f32 v202, v244, v244
    v_add_f32 v246, v246, v200
    v_fmac_f32 v202, v246, v246
    v_add_f32 v248, v248, v200
    v_fmac_f32 v202, v248, v248
    v_add_f32 v250, v250, v200
    v_fmac_f32 v202, v250, v250
    v_add_f32 v252, v252, v200
    v_fmac_f32 v202, v252, v252
    v_add_f32 v254, v254, v200
    v_fmac_f32 v202, v254, v254
    v_fmac_f32 v201, 0x42c00000, v202
    v_mul_f32 v201, 0x3ae38e39, v201
    v_cvt_pk_bf16_f32 v201, v201, v201
    v_lshlrev_b32 v201, 16, v201
    v_add_f32 v201, 0x3727c5ac, v201
    v_cvt_pk_bf16_f32 v201, v201, v201
    v_lshlrev_b32 v201, 16, v201
    v_sqrt_f32 v201, v201
    s_nop 0
    v_cvt_pk_bf16_f32 v201, v201, v201
    v_lshlrev_b32 v201, 16, v201
    v_rcp_f32 v202, v201
    v_cvt_pk_bf16_f32 v200, v200, v200
    v_lshlrev_b32 v200, 16, v200
    v_cvt_pk_bf16_f32 v204, v200, v200
    v_cvt_pk_bf16_f32 v205, v201, v201
    v_mov_b32 v226, 0
    v_mov_b32 v227, 0
    v_cndmask_b32 v224, v226, v204, vcc
    v_cndmask_b32 v225, v226, v205, vcc
    v_mul_f32 v229, 0xbfb8aa3b, v202
    s_waitcnt vmcnt(13)
    s_barrier
    s_waitcnt lgkmcnt(8)
    v_mfma_f32_32x32x16_bf16 v[40:55], v[172:175], a[76:79], v[40:55]
    ds_read_b64_tr_b16 v[168:169], v194 offset:24576
    v_mfma_f32_32x32x16_bf16 v[56:71], v[172:175], a[220:223], v[56:71]
    ds_read_b64_tr_b16 v[170:171], v194 offset:25088
    s_waitcnt lgkmcnt(8)
    v_mfma_f32_32x32x16_bf16 v[40:55], v[176:179], a[80:83], v[40:55]
    ds_read_b64_tr_b16 v[172:173], v194 offset:26624
    v_mfma_f32_32x32x16_bf16 v[56:71], v[176:179], a[224:227], v[56:71]
    ds_read_b64_tr_b16 v[174:175], v194 offset:27136
    s_add_u32 s33, s31, 4718592
    s_add_u32 m0, s32, 126976
    s_nop 0
    buffer_load_dwordx4 v216, s[4:7], s33 offen lds
    s_waitcnt lgkmcnt(8)
    v_mfma_f32_32x32x16_bf16 v[40:55], v[180:183], a[84:87], v[40:55]
    ds_read_b64_tr_b16 v[176:177], v194 offset:28672
    v_mfma_f32_32x32x16_bf16 v[56:71], v[180:183], a[228:231], v[56:71]
    ds_read_b64_tr_b16 v[178:179], v194 offset:29184
    s_add_u32 s33, s31, 5013504
    s_add_u32 m0, s32, 131072
    s_nop 0
    buffer_load_dwordx4 v216, s[4:7], s33 offen lds
    s_waitcnt lgkmcnt(8)
    v_mfma_f32_32x32x16_bf16 v[40:55], v[184:187], a[88:91], v[40:55]
    ds_read_b64_tr_b16 v[180:181], v194 offset:30720
    v_mfma_f32_32x32x16_bf16 v[56:71], v[184:187], a[232:235], v[56:71]
    ds_read_b64_tr_b16 v[182:183], v194 offset:31232
    s_add_u32 s33, s31, 4423680
    s_add_u32 m0, s32, 135168
    s_nop 0
    buffer_load_dwordx4 v217, s[8:11], s33 offen lds
    s_waitcnt lgkmcnt(8)
    v_mfma_f32_32x32x16_bf16 v[40:55], v[188:191], a[92:95], v[40:55]
    ds_read_b64_tr_b16 v[184:185], v194 offset:32768
    v_mfma_f32_32x32x16_bf16 v[56:71], v[188:191], a[236:239], v[56:71]
    ds_read_b64_tr_b16 v[186:187], v194 offset:33280
    s_add_u32 s33, s31, 4718592
    s_add_u32 m0, s32, 139264
    s_nop 0
    buffer_load_dwordx4 v217, s[8:11], s33 offen lds
    s_waitcnt lgkmcnt(8)
    v_mfma_f32_32x32x16_bf16 v[72:87], v[168:171], a[72:75], v[72:87]
    ds_read_b64_tr_b16 v[188:189], v194 offset:34816
    v_mfma_f32_32x32x16_bf16 v[88:103], v[168:171], a[216:219], v[88:103]
    ds_read_b64_tr_b16 v[190:191], v194 offset:35328
    s_waitcnt lgkmcnt(8)
    v_mfma_f32_32x32x16_bf16 v[72:87], v[172:175], a[76:79], v[72:87]
    ds_read_b64_tr_b16 v[168:169], v195 offset:24576
    v_mfma_f32_32x32x16_bf16 v[88:103], v[172:175], a[220:223], v[88:103]
    ds_read_b64_tr_b16 v[170:171], v195 offset:25088
    s_add_u32 s33, s31, 5013504
    s_add_u32 m0, s32, 143360
    s_nop 0
    buffer_load_dwordx4 v217, s[8:11], s33 offen lds
    s_waitcnt lgkmcnt(8)
    v_mfma_f32_32x32x16_bf16 v[72:87], v[176:179], a[80:83], v[72:87]
    ds_read_b64_tr_b16 v[172:173], v195 offset:26624
    v_mfma_f32_32x32x16_bf16 v[88:103], v[176:179], a[224:227], v[88:103]
    ds_read_b64_tr_b16 v[174:175], v195 offset:27136
    s_add_u32 s33, s25, 28672
    buffer_load_dwordx4 a[120:123], v218, s[16:19], s33 offen offset:2048
    s_waitcnt lgkmcnt(8)
    v_mfma_f32_32x32x16_bf16 v[72:87], v[180:183], a[84:87], v[72:87]
    ds_read_b64_tr_b16 v[176:177], v195 offset:28672
    v_mfma_f32_32x32x16_bf16 v[88:103], v[180:183], a[228:231], v[88:103]
    ds_read_b64_tr_b16 v[178:179], v195 offset:29184
    s_add_u32 s33, s40, 28672
    buffer_load_dwordx4 v[144:147], v218, s[16:19], s33 offen offset:2048
    s_waitcnt lgkmcnt(8)
    v_mfma_f32_32x32x16_bf16 v[72:87], v[184:187], a[88:91], v[72:87]
    ds_read_b64_tr_b16 v[180:181], v195 offset:30720
    v_mfma_f32_32x32x16_bf16 v[88:103], v[184:187], a[232:235], v[88:103]
    ds_read_b64_tr_b16 v[182:183], v195 offset:31232
    s_add_u32 s33, s25, 28672
    buffer_load_dwordx4 a[124:127], v218, s[16:19], s33 offen offset:3072
    s_waitcnt lgkmcnt(8)
    v_mfma_f32_32x32x16_bf16 v[72:87], v[188:191], a[92:95], v[72:87]
    ds_read_b64_tr_b16 v[184:185], v195 offset:32768
    v_mfma_f32_32x32x16_bf16 v[88:103], v[188:191], a[236:239], v[88:103]
    ds_read_b64_tr_b16 v[186:187], v195 offset:33280
    s_waitcnt lgkmcnt(8)
    v_mfma_f32_32x32x16_bf16 v[104:119], v[168:171], a[72:75], v[104:119]
    ds_read_b64_tr_b16 v[188:189], v195 offset:34816
    v_mfma_f32_32x32x16_bf16 v[120:135], v[168:171], a[216:219], v[120:135]
    ds_read_b64_tr_b16 v[190:191], v195 offset:35328
    s_add_u32 s33, s40, 28672
    buffer_load_dwordx4 v[148:151], v218, s[16:19], s33 offen offset:3072
    s_waitcnt lgkmcnt(8)
    v_mfma_f32_32x32x16_bf16 v[104:119], v[172:175], a[76:79], v[104:119]
    v_add_u32 v192, 0xc000, v192
    v_add_u32 v193, 0xc000, v193
    v_add_u32 v194, 0xc000, v194
    v_add_u32 v195, 0xc000, v195
    v_add_u32 v196, 0xc000, v196
    ds_read_b64_tr_b16 v[168:169], v192 offset:0
    v_mfma_f32_32x32x16_bf16 v[120:135], v[172:175], a[220:223], v[120:135]
    ds_read_b64_tr_b16 v[170:171], v192 offset:512
    s_add_u32 s33, s25, 32768
    buffer_load_dwordx4 a[128:131], v218, s[16:19], s33 offen offset:0
    s_waitcnt lgkmcnt(8)
    v_mfma_f32_32x32x16_bf16 v[104:119], v[176:179], a[80:83], v[104:119]
    ds_read_b64_tr_b16 v[172:173], v192 offset:2048
    v_mfma_f32_32x32x16_bf16 v[120:135], v[176:179], a[224:227], v[120:135]
    ds_read_b64_tr_b16 v[174:175], v192 offset:2560
    s_add_u32 s33, s40, 32768
    buffer_load_dwordx4 v[152:155], v218, s[16:19], s33 offen offset:0
    s_waitcnt lgkmcnt(8)
    v_mfma_f32_32x32x16_bf16 v[104:119], v[180:183], a[84:87], v[104:119]
    ds_read_b64_tr_b16 v[176:177], v192 offset:4096
    v_mfma_f32_32x32x16_bf16 v[120:135], v[180:183], a[228:231], v[120:135]
    ds_read_b64_tr_b16 v[178:179], v192 offset:4608
    s_add_u32 s33, s25, 32768
    buffer_load_dwordx4 a[132:135], v218, s[16:19], s33 offen offset:1024
    s_waitcnt lgkmcnt(8)
    v_mfma_f32_32x32x16_bf16 v[104:119], v[184:187], a[88:91], v[104:119]
    ds_read_b64_tr_b16 v[180:181], v192 offset:6144
    v_mfma_f32_32x32x16_bf16 v[120:135], v[184:187], a[232:235], v[120:135]
    ds_read_b64_tr_b16 v[182:183], v192 offset:6656
    s_waitcnt lgkmcnt(8)
    v_mfma_f32_32x32x16_bf16 v[104:119], v[188:191], a[92:95], v[104:119]
    ds_read_b64_tr_b16 v[184:185], v192 offset:8192
    v_mfma_f32_32x32x16_bf16 v[120:135], v[188:191], a[236:239], v[120:135]
    ds_read_b64_tr_b16 v[186:187], v192 offset:8704
    s_add_u32 s33, s40, 32768
    buffer_load_dwordx4 v[156:159], v218, s[16:19], s33 offen offset:1024
    s_waitcnt vmcnt(24)
    s_waitcnt lgkmcnt(8)
    v_mfma_f32_32x32x16_bf16 v[8:23], v[168:171], a[96:99], v[8:23]
    ds_read_b64_tr_b16 v[188:189], v192 offset:10240
    v_mfma_f32_32x32x16_bf16 v[24:39], v[168:171], a[240:243], v[24:39]
    ds_read_b64_tr_b16 v[190:191], v192 offset:10752
    s_add_u32 s33, s25, 32768
    buffer_load_dwordx4 a[136:139], v218, s[16:19], s33 offen offset:2048
    s_waitcnt vmcnt(9)
    s_barrier
    s_waitcnt lgkmcnt(8)
    v_mfma_f32_32x32x16_bf16 v[8:23], v[172:175], a[100:103], v[8:23]
    ds_read_b64_tr_b16 v[168:169], v192 offset:24576
    v_mfma_f32_32x32x16_bf16 v[24:39], v[172:175], a[244:247], v[24:39]
    ds_read_b64_tr_b16 v[170:171], v192 offset:25088
    s_add_u32 s33, s40, 32768
    buffer_load_dwordx4 v[160:163], v218, s[16:19], s33 offen offset:2048
    s_waitcnt lgkmcnt(8)
    v_mfma_f32_32x32x16_bf16 v[8:23], v[176:179], a[104:107], v[8:23]
    ds_read_b64_tr_b16 v[172:173], v192 offset:26624
    v_mfma_f32_32x32x16_bf16 v[24:39], v[176:179], a[248:251], v[24:39]
    ds_read_b64_tr_b16 v[174:175], v192 offset:27136
    s_add_u32 s33, s25, 32768
    buffer_load_dwordx4 a[140:143], v218, s[16:19], s33 offen offset:3072
    s_waitcnt lgkmcnt(8)
    v_mfma_f32_32x32x16_bf16 v[8:23], v[180:183], a[108:111], v[8:23]
    ds_read_b64_tr_b16 v[176:177], v192 offset:28672
    v_mfma_f32_32x32x16_bf16 v[24:39], v[180:183], a[252:255], v[24:39]
    ds_read_b64_tr_b16 v[178:179], v192 offset:29184
    s_waitcnt lgkmcnt(8)
    v_mfma_f32_32x32x16_bf16 v[8:23], v[184:187], a[112:115], v[8:23]
    ds_read_b64_tr_b16 v[180:181], v192 offset:30720
    v_mfma_f32_32x32x16_bf16 v[24:39], v[184:187], v[136:139], v[24:39]
    ds_read_b64_tr_b16 v[182:183], v192 offset:31232
    s_add_u32 s33, s40, 32768
    buffer_load_dwordx4 v[164:167], v218, s[16:19], s33 offen offset:3072
    s_waitcnt lgkmcnt(8)
    v_mfma_f32_32x32x16_bf16 v[8:23], v[188:191], a[116:119], v[8:23]
    ds_read_b64_tr_b16 v[184:185], v192 offset:32768
    v_mfma_f32_32x32x16_bf16 v[24:39], v[188:191], v[140:143], v[24:39]
    ds_read_b64_tr_b16 v[186:187], v192 offset:33280
    s_add_u32 s33, s31, 128
    s_add_u32 m0, s32, 0
    s_nop 0
    buffer_load_dwordx4 v216, s[4:7], s33 offen lds
    s_waitcnt vmcnt(11)
    s_waitcnt lgkmcnt(8)
    v_mfma_f32_32x32x16_bf16 v[8:23], v[168:171], a[120:123], v[8:23]
    ds_read_b64_tr_b16 v[188:189], v192 offset:34816
    v_mfma_f32_32x32x16_bf16 v[24:39], v[168:171], v[144:147], v[24:39]
    ds_read_b64_tr_b16 v[190:191], v192 offset:35328
    s_add_u32 s33, s31, 295040
    s_add_u32 m0, s32, 4096
    s_nop 0
    buffer_load_dwordx4 v216, s[4:7], s33 offen lds
    s_waitcnt vmcnt(10)
    s_waitcnt lgkmcnt(8)
    v_mfma_f32_32x32x16_bf16 v[8:23], v[172:175], a[124:127], v[8:23]
    ds_read_b64_tr_b16 v[168:169], v230 offset:0
    v_mfma_f32_32x32x16_bf16 v[24:39], v[172:175], v[148:151], v[24:39]
    ds_read_b64_tr_b16 v[170:171], v230 offset:0
    s_add_u32 s33, s31, 589952
    s_add_u32 m0, s32, 8192
    s_nop 0
    buffer_load_dwordx4 v216, s[4:7], s33 offen lds
    s_waitcnt vmcnt(9)
    s_waitcnt lgkmcnt(8)
    v_mfma_f32_32x32x16_bf16 v[8:23], v[176:179], a[128:131], v[8:23]
    ds_read_b64_tr_b16 v[172:173], v193 offset:0
    v_mfma_f32_32x32x16_bf16 v[24:39], v[176:179], v[152:155], v[24:39]
    ds_read_b64_tr_b16 v[174:175], v193 offset:512
    s_waitcnt vmcnt(7)
    s_waitcnt lgkmcnt(8)
    v_mfma_f32_32x32x16_bf16 v[8:23], v[180:183], a[132:135], v[8:23]
    ds_read_b64_tr_b16 v[176:177], v193 offset:2048
    v_mfma_f32_32x32x16_bf16 v[24:39], v[180:183], v[156:159], v[24:39]
    ds_read_b64_tr_b16 v[178:179], v193 offset:2560
    s_add_u32 s33, s31, 128
    s_add_u32 m0, s32, 12288
    s_nop 0
    buffer_load_dwordx4 v217, s[8:11], s33 offen lds
    s_waitcnt vmcnt(6)
    s_waitcnt lgkmcnt(8)
    v_mfma_f32_32x32x16_bf16 v[8:23], v[184:187], a[136:139], v[8:23]
    ds_read_b64_tr_b16 v[180:181], v193 offset:4096
    v_mfma_f32_32x32x16_bf16 v[24:39], v[184:187], v[160:163], v[24:39]
    ds_read_b64_tr_b16 v[182:183], v193 offset:4608
    s_add_u32 s33, s31, 295040
    s_add_u32 m0, s32, 16384
    s_nop 0
    buffer_load_dwordx4 v217, s[8:11], s33 offen lds
    s_waitcnt vmcnt(5)
    s_waitcnt lgkmcnt(8)
    v_mfma_f32_32x32x16_bf16 v[8:23], v[188:191], a[140:143], v[8:23]
    ds_read_b64_tr_b16 v[184:185], v193 offset:6144
    v_mfma_f32_32x32x16_bf16 v[24:39], v[188:191], v[164:167], v[24:39]
    ds_read_b64_tr_b16 v[186:187], v193 offset:6656
    s_add_u32 s33, s31, 589952
    s_add_u32 m0, s32, 20480
    s_nop 0
    buffer_load_dwordx4 v217, s[8:11], s33 offen lds
    s_waitcnt lgkmcnt(8)
    v_mfma_f32_32x32x16_bf16 v[8:23], v[168:171], v[220:223], v[8:23]
    ds_read_b64_tr_b16 v[188:189], v193 offset:8192
    v_mfma_f32_32x32x16_bf16 v[24:39], v[168:171], v[224:227], v[24:39]
    ds_read_b64_tr_b16 v[190:191], v193 offset:8704
    s_add_u32 s33, s31, 884864
    s_add_u32 m0, s32, 24576
    s_nop 0
    buffer_load_dwordx4 v216, s[4:7], s33 offen lds
    s_waitcnt lgkmcnt(8)
    v_mfma_f32_32x32x16_bf16 v[40:55], v[172:175], a[96:99], v[40:55]
    ds_read_b64_tr_b16 v[168:169], v193 offset:10240
    v_mfma_f32_32x32x16_bf16 v[56:71], v[172:175], a[240:243], v[56:71]
    ds_read_b64_tr_b16 v[170:171], v193 offset:10752
    s_waitcnt lgkmcnt(8)
    v_mfma_f32_32x32x16_bf16 v[40:55], v[176:179], a[100:103], v[40:55]
    ds_read_b64_tr_b16 v[172:173], v193 offset:24576
    v_mul_f32 v200, v228, v8
    v_mul_f32 v201, v228, v9
    v_mul_f32 v202, v228, v10
    v_mfma_f32_32x32x16_bf16 v[56:71], v[176:179], a[244:247], v[56:71]
    ds_read_b64_tr_b16 v[174:175], v193 offset:25088
    v_mul_f32 v203, v228, v11
    v_exp_f32 v200, v200
    s_add_u32 s33, s31, 1179776
    s_add_u32 m0, s32, 28672
    s_nop 0
    buffer_load_dwordx4 v216, s[4:7], s33 offen lds
    s_waitcnt lgkmcnt(8)
    v_mfma_f32_32x32x16_bf16 v[40:55], v[180:183], a[104:107], v[40:55]
    ds_read_b64_tr_b16 v[176:177], v193 offset:26624
    v_exp_f32 v201, v201
    v_exp_f32 v202, v202
    v_mfma_f32_32x32x16_bf16 v[56:71], v[180:183], a[248:251], v[56:71]
    ds_read_b64_tr_b16 v[178:179], v193 offset:27136
    v_exp_f32 v203, v203
    v_mul_f32 v8, v8, v16
    s_add_u32 s33, s31, 1474688
    s_add_u32 m0, s32, 32768
    s_nop 0
    buffer_load_dwordx4 v216, s[4:7], s33 offen lds
    s_waitcnt lgkmcnt(8)
    v_mfma_f32_32x32x16_bf16 v[40:55], v[184:187], a[108:111], v[40:55]
    ds_read_b64_tr_b16 v[180:181], v193 offset:28672
    v_mul_f32 v9, v9, v17
    v_mul_f32 v10, v10, v18
    v_mul_f32 v11, v11, v19
    v_mfma_f32_32x32x16_bf16 v[56:71], v[184:187], a[252:255], v[56:71]
    ds_read_b64_tr_b16 v[182:183], v193 offset:29184
    v_add_f32 v200, 1.0, v200
    v_add_f32 v201, 1.0, v201
    v_add_f32 v202, 1.0, v202
    s_add_u32 s33, s31, 884864
    s_add_u32 m0, s32, 36864
    s_nop 0
    buffer_load_dwordx4 v217, s[8:11], s33 offen lds
    s_waitcnt lgkmcnt(8)
    v_mfma_f32_32x32x16_bf16 v[40:55], v[188:191], a[112:115], v[40:55]
    ds_read_b64_tr_b16 v[184:185], v193 offset:30720
    v_add_f32 v203, 1.0, v203
    v_rcp_f32 v200, v200
    v_mfma_f32_32x32x16_bf16 v[56:71], v[188:191], v[136:139], v[56:71]
    ds_read_b64_tr_b16 v[186:187], v193 offset:31232
    v_rcp_f32 v201, v201
    v_rcp_f32 v202, v202
    s_add_u32 s33, s31, 1179776
    s_add_u32 m0, s32, 40960
    s_nop 0
    buffer_load_dwordx4 v217, s[8:11], s33 offen lds
    s_waitcnt lgkmcnt(8)
    v_mfma_f32_32x32x16_bf16 v[40:55], v[168:171], a[116:119], v[40:55]
    ds_read_b64_tr_b16 v[188:189], v193 offset:32768
    v_rcp_f32 v203, v203
    v_mul_f32 v8, v8, v200
    v_mfma_f32_32x32x16_bf16 v[56:71], v[168:171], v[140:143], v[56:71]
    ds_read_b64_tr_b16 v[190:191], v193 offset:33280
    v_mul_f32 v9, v9, v201
    v_mul_f32 v10, v10, v202
    v_mul_f32 v11, v11, v203
    s_waitcnt lgkmcnt(8)
    v_mfma_f32_32x32x16_bf16 v[40:55], v[172:175], a[120:123], v[40:55]
    ds_read_b64_tr_b16 v[168:169], v193 offset:34816
    v_cvt_pk_bf16_f32 v204, v8, v9
    v_cvt_pk_bf16_f32 v205, v10, v11
    v_mul_f32 v200, v228, v12
    v_mfma_f32_32x32x16_bf16 v[56:71], v[172:175], v[144:147], v[56:71]
    ds_read_b64_tr_b16 v[170:171], v193 offset:35328
    v_mul_f32 v201, v228, v13
    v_mul_f32 v202, v228, v14
    v_mul_f32 v203, v228, v15
    s_add_u32 s33, s31, 1474688
    s_add_u32 m0, s32, 45056
    s_nop 0
    buffer_load_dwordx4 v217, s[8:11], s33 offen lds
    s_waitcnt lgkmcnt(8)
    v_mfma_f32_32x32x16_bf16 v[40:55], v[176:179], a[124:127], v[40:55]
    ds_read_b64_tr_b16 v[172:173], v230 offset:32
    v_exp_f32 v200, v200
    v_exp_f32 v201, v201
    v_mfma_f32_32x32x16_bf16 v[56:71], v[176:179], v[148:151], v[56:71]
    ds_read_b64_tr_b16 v[174:175], v230 offset:32
    v_exp_f32 v202, v202
    v_exp_f32 v203, v203
    s_waitcnt lgkmcnt(8)
    v_mfma_f32_32x32x16_bf16 v[40:55], v[180:183], a[128:131], v[40:55]
    ds_read_b64_tr_b16 v[176:177], v194 offset:0
    v_mul_f32 v12, v12, v20
    v_mul_f32 v13, v13, v21
    v_mul_f32 v14, v14, v22
    v_mfma_f32_32x32x16_bf16 v[56:71], v[180:183], v[152:155], v[56:71]
    ds_read_b64_tr_b16 v[178:179], v194 offset:512
    v_mul_f32 v15, v15, v23
    v_add_f32 v200, 1.0, v200
    v_add_f32 v201, 1.0, v201
    s_waitcnt lgkmcnt(8)
    v_mfma_f32_32x32x16_bf16 v[40:55], v[184:187], a[132:135], v[40:55]
    ds_read_b64_tr_b16 v[180:181], v194 offset:2048
    v_add_f32 v202, 1.0, v202
    v_add_f32 v203, 1.0, v203
    v_rcp_f32 v200, v200
    v_mfma_f32_32x32x16_bf16 v[56:71], v[184:187], v[156:159], v[56:71]
    ds_read_b64_tr_b16 v[182:183], v194 offset:2560
    v_rcp_f32 v201, v201
    v_rcp_f32 v202, v202
    s_waitcnt lgkmcnt(8)
    v_mfma_f32_32x32x16_bf16 v[40:55], v[188:191], a[136:139], v[40:55]
    ds_read_b64_tr_b16 v[184:185], v194 offset:4096
    v_rcp_f32 v203, v203
    v_mul_f32 v12, v12, v200
    v_mfma_f32_32x32x16_bf16 v[56:71], v[188:191], v[160:163], v[56:71]
    ds_read_b64_tr_b16 v[186:187], v194 offset:4608
    v_mul_f32 v13, v13, v201
    v_mul_f32 v14, v14, v202
    v_mul_f32 v15, v15, v203
    s_waitcnt lgkmcnt(8)
    v_mfma_f32_32x32x16_bf16 v[40:55], v[168:171], a[140:143], v[40:55]
    ds_read_b64_tr_b16 v[188:189], v194 offset:6144
    v_cvt_pk_bf16_f32 v206, v12, v13
    v_cvt_pk_bf16_f32 v207, v14, v15
    s_add_u32 s33, s35, 0
    buffer_store_dwordx4 v[204:207], v218, s[44:47], s33 offen sc1
    v_mfma_f32_32x32x16_bf16 v[56:71], v[168:171], v[164:167], v[56:71]
    ds_read_b64_tr_b16 v[190:191], v194 offset:6656
    v_mul_f32 v208, v229, v24
    v_mul_f32 v209, v229, v25
    v_mul_f32 v210, v229, v26
    s_waitcnt lgkmcnt(8)
    v_mfma_f32_32x32x16_bf16 v[40:55], v[172:175], v[220:223], v[40:55]
    ds_read_b64_tr_b16 v[168:169], v194 offset:8192
    v_mul_f32 v211, v229, v27
    v_exp_f32 v208, v208
    v_mfma_f32_32x32x16_bf16 v[56:71], v[172:175], v[224:227], v[56:71]
    ds_read_b64_tr_b16 v[170:171], v194 offset:8704
    v_exp_f32 v209, v209
    v_exp_f32 v210, v210
    s_waitcnt lgkmcnt(8)
    v_mfma_f32_32x32x16_bf16 v[72:87], v[176:179], a[96:99], v[72:87]
    ds_read_b64_tr_b16 v[172:173], v194 offset:10240
    v_exp_f32 v211, v211
    v_mul_f32 v24, v24, v32
    v_mfma_f32_32x32x16_bf16 v[88:103], v[176:179], a[240:243], v[88:103]
    ds_read_b64_tr_b16 v[174:175], v194 offset:10752
    v_mul_f32 v25, v25, v33
    v_mul_f32 v26, v26, v34
    v_mul_f32 v27, v27, v35
    s_waitcnt vmcnt(1)
    s_barrier
    s_waitcnt lgkmcnt(8)
    v_mfma_f32_32x32x16_bf16 v[72:87], v[180:183], a[100:103], v[72:87]
    ds_read_b64_tr_b16 v[176:177], v194 offset:24576
    v_add_f32 v208, 1.0, v208
    v_add_f32 v209, 1.0, v209
    v_add_f32 v210, 1.0, v210
    v_mfma_f32_32x32x16_bf16 v[88:103], v[180:183], a[244:247], v[88:103]
    ds_read_b64_tr_b16 v[178:179], v194 offset:25088
    v_add_f32 v211, 1.0, v211
    v_rcp_f32 v208, v208
    s_add_u32 s33, s31, 1769600
    s_add_u32 m0, s32, 49152
    s_nop 0
    buffer_load_dwordx4 v216, s[4:7], s33 offen lds
    s_add_u32 s33, s31, 2064512
    s_add_u32 m0, s32, 53248
    s_nop 0
    buffer_load_dwordx4 v216, s[4:7], s33 offen lds
    s_waitcnt lgkmcnt(8)
    v_mfma_f32_32x32x16_bf16 v[72:87], v[184:187], a[104:107], v[72:87]
    ds_read_b64_tr_b16 v[180:181], v194 offset:26624
    v_rcp_f32 v209, v209
    v_rcp_f32 v210, v210
    v_mfma_f32_32x32x16_bf16 v[88:103], v[184:187], a[248:251], v[88:103]
    ds_read_b64_tr_b16 v[182:183], v194 offset:27136
    v_rcp_f32 v211, v211
    v_mul_f32 v24, v24, v208
    s_add_u32 s33, s31, 2359424
    s_add_u32 m0, s32, 57344
    s_nop 0
    buffer_load_dwordx4 v216, s[4:7], s33 offen lds
    s_waitcnt lgkmcnt(8)
    v_mfma_f32_32x32x16_bf16 v[72:87], v[188:191], a[108:111], v[72:87]
    ds_read_b64_tr_b16 v[184:185], v194 offset:28672
    v_mul_f32 v25, v25, v209
    v_mul_f32 v26, v26, v210
    v_mul_f32 v27, v27, v211
    v_mfma_f32_32x32x16_bf16 v[88:103], v[188:191], a[252:255], v[88:103]
    ds_read_b64_tr_b16 v[186:187], v194 offset:29184
    v_cvt_pk_bf16_f32 v212, v24, v25
    v_cvt_pk_bf16_f32 v213, v26, v27
    v_mul_f32 v208, v229, v28
    s_add_u32 s33, s31, 1769600
    s_add_u32 m0, s32, 61440
    s_nop 0
    buffer_load_dwordx4 v217, s[8:11], s33 offen lds
    s_waitcnt lgkmcnt(8)
    v_mfma_f32_32x32x16_bf16 v[72:87], v[168:171], a[112:115], v[72:87]
    ds_read_b64_tr_b16 v[188:189], v194 offset:30720
    v_mul_f32 v209, v229, v29
    v_mul_f32 v210, v229, v30
    v_mul_f32 v211, v229, v31
    v_mfma_f32_32x32x16_bf16 v[88:103], v[168:171], v[136:139], v[88:103]
    ds_read_b64_tr_b16 v[190:191], v194 offset:31232
    v_exp_f32 v208, v208
    v_exp_f32 v209, v209
    s_add_u32 s33, s31, 2064512
    s_add_u32 m0, s32, 65536
    s_nop 0
    buffer_load_dwordx4 v217, s[8:11], s33 offen lds
    s_waitcnt lgkmcnt(8)
    v_mfma_f32_32x32x16_bf16 v[72:87], v[172:175], a[116:119], v[72:87]
    ds_read_b64_tr_b16 v[168:169], v194 offset:32768
    v_exp_f32 v210, v210
    v_exp_f32 v211, v211
    v_mfma_f32_32x32x16_bf16 v[88:103], v[172:175], v[140:143], v[88:103]
    ds_read_b64_tr_b16 v[170:171], v194 offset:33280
    v_mul_f32 v28, v28, v36
    v_mul_f32 v29, v29, v37
    v_mul_f32 v30, v30, v38
    s_add_u32 s33, s31, 2359424
    s_add_u32 m0, s32, 69632
    s_nop 0
    buffer_load_dwordx4 v217, s[8:11], s33 offen lds
    s_waitcnt lgkmcnt(8)
    v_mfma_f32_32x32x16_bf16 v[72:87], v[176:179], a[120:123], v[72:87]
    ds_read_b64_tr_b16 v[172:173], v194 offset:34816
    v_mul_f32 v31, v31, v39
    v_add_f32 v208, 1.0, v208
    v_add_f32 v209, 1.0, v209
    v_mfma_f32_32x32x16_bf16 v[88:103], v[176:179], v[144:147], v[88:103]
    ds_read_b64_tr_b16 v[174:175], v194 offset:35328
    v_add_f32 v210, 1.0, v210
    v_add_f32 v211, 1.0, v211
    v_rcp_f32 v208, v208
    s_waitcnt lgkmcnt(8)
    v_mfma_f32_32x32x16_bf16 v[72:87], v[180:183], a[124:127], v[72:87]
    ds_read_b64_tr_b16 v[176:177], v230 offset:64
    v_rcp_f32 v209, v209
    v_rcp_f32 v210, v210
    v_mfma_f32_32x32x16_bf16 v[88:103], v[180:183], v[148:151], v[88:103]
    ds_read_b64_tr_b16 v[178:179], v230 offset:64
    v_rcp_f32 v211, v211
    v_mul_f32 v28, v28, v208
    s_add_u32 s33, s31, 2654336
    s_add_u32 m0, s32, 73728
    s_nop 0
    buffer_load_dwordx4 v216, s[4:7], s33 offen lds
    s_waitcnt lgkmcnt(8)
    v_mfma_f32_32x32x16_bf16 v[72:87], v[184:187], a[128:131], v[72:87]
    ds_read_b64_tr_b16 v[180:181], v195 offset:0
    v_mul_f32 v29, v29, v209
    v_mul_f32 v30, v30, v210
    v_mul_f32 v31, v31, v211
    v_mfma_f32_32x32x16_bf16 v[88:103], v[184:187], v[152:155], v[88:103]
    ds_read_b64_tr_b16 v[182:183], v195 offset:512
    v_cvt_pk_bf16_f32 v214, v28, v29
    v_cvt_pk_bf16_f32 v215, v30, v31
    s_add_u32 s33, s35, 1024
    buffer_store_dwordx4 v[212:215], v218, s[44:47], s33 offen sc1
    s_add_u32 s33, s31, 2949248
    s_add_u32 m0, s32, 77824
    s_nop 0
    buffer_load_dwordx4 v216, s[4:7], s33 offen lds
    s_waitcnt lgkmcnt(8)
    v_mfma_f32_32x32x16_bf16 v[72:87], v[188:191], a[132:135], v[72:87]
    ds_read_b64_tr_b16 v[184:185], v195 offset:2048
    v_mul_f32 v200, v228, v40
    v_mul_f32 v201, v228, v41
    v_mul_f32 v202, v228, v42
    v_mfma_f32_32x32x16_bf16 v[88:103], v[188:191], v[156:159], v[88:103]
    ds_read_b64_tr_b16 v[186:187], v195 offset:2560
    v_mul_f32 v203, v228, v43
    v_exp_f32 v200, v200
    s_add_u32 s33, s31, 3244160
    s_add_u32 m0, s32, 81920
    s_nop 0
    buffer_load_dwordx4 v216, s[4:7], s33 offen lds
    s_waitcnt lgkmcnt(8)
    v_mfma_f32_32x32x16_bf16 v[72:87], v[168:171], a[136:139], v[72:87]
    ds_read_b64_tr_b16 v[188:189], v195 offset:4096
    v_exp_f32 v201, v201
    v_exp_f32 v202, v202
    v_mfma_f32_32x32x16_bf16 v[88:103], v[168:171], v[160:163], v[88:103]
    ds_read_b64_tr_b16 v[190:191], v195 offset:4608
    v_exp_f32 v203, v203
    v_mul_f32 v40, v40, v48
    s_add_u32 s33, s31, 2654336
    s_add_u32 m0, s32, 86016
    s_nop 0
    buffer_load_dwordx4 v217, s[8:11], s33 offen lds
    s_waitcnt lgkmcnt(8)
    v_mfma_f32_32x32x16_bf16 v[72:87], v[172:175], a[140:143], v[72:87]
    ds_read_b64_tr_b16 v[168:169], v195 offset:6144
    v_mul_f32 v41, v41, v49
    v_mul_f32 v42, v42, v50
    v_mul_f32 v43, v43, v51
    v_mfma_f32_32x32x16_bf16 v[88:103], v[172:175], v[164:167], v[88:103]
    ds_read_b64_tr_b16 v[170:171], v195 offset:6656
    v_add_f32 v200, 1.0, v200
    v_add_f32 v201, 1.0, v201
    v_add_f32 v202, 1.0, v202
    s_waitcnt lgkmcnt(8)
    v_mfma_f32_32x32x16_bf16 v[72:87], v[176:179], v[220:223], v[72:87]
    ds_read_b64_tr_b16 v[172:173], v195 offset:8192
    v_add_f32 v203, 1.0, v203
    v_rcp_f32 v200, v200
    v_mfma_f32_32x32x16_bf16 v[88:103], v[176:179], v[224:227], v[88:103]
    ds_read_b64_tr_b16 v[174:175], v195 offset:8704
    v_rcp_f32 v201, v201
    v_rcp_f32 v202, v202
    s_add_u32 s33, s31, 2949248
    s_add_u32 m0, s32, 90112
    s_nop 0
    buffer_load_dwordx4 v217, s[8:11], s33 offen lds
    s_waitcnt lgkmcnt(8)
    v_mfma_f32_32x32x16_bf16 v[104:119], v[180:183], a[96:99], v[104:119]
    ds_read_b64_tr_b16 v[176:177], v195 offset:10240
    v_rcp_f32 v203, v203
    v_mul_f32 v40, v40, v200
    v_mfma_f32_32x32x16_bf16 v[120:135], v[180:183], a[240:243], v[120:135]
    ds_read_b64_tr_b16 v[178:179], v195 offset:10752
    v_mul_f32 v41, v41, v201
    v_mul_f32 v42, v42, v202
    v_mul_f32 v43, v43, v203
    s_add_u32 s33, s31, 3244160
    s_add_u32 m0, s32, 94208
    s_nop 0
    buffer_load_dwordx4 v217, s[8:11], s33 offen lds
    s_waitcnt lgkmcnt(8)
    v_mfma_f32_32x32x16_bf16 v[104:119], v[184:187], a[100:103], v[104:119]
    ds_read_b64_tr_b16 v[180:181], v195 offset:24576
    v_cvt_pk_bf16_f32 v204, v40, v41
    v_cvt_pk_bf16_f32 v205, v42, v43
    v_mul_f32 v200, v228, v44
    v_mfma_f32_32x32x16_bf16 v[120:135], v[184:187], a[244:247], v[120:135]
    ds_read_b64_tr_b16 v[182:183], v195 offset:25088
    v_mul_f32 v201, v228, v45
    v_mul_f32 v202, v228, v46
    v_mul_f32 v203, v228, v47
    s_waitcnt lgkmcnt(8)
    v_mfma_f32_32x32x16_bf16 v[104:119], v[188:191], a[104:107], v[104:119]
    ds_read_b64_tr_b16 v[184:185], v195 offset:26624
    v_exp_f32 v200, v200
    v_exp_f32 v201, v201
    v_mfma_f32_32x32x16_bf16 v[120:135], v[188:191], a[248:251], v[120:135]
    ds_read_b64_tr_b16 v[186:187], v195 offset:27136
    v_exp_f32 v202, v202
    v_exp_f32 v203, v203
    s_waitcnt lgkmcnt(8)
    v_mfma_f32_32x32x16_bf16 v[104:119], v[168:171], a[108:111], v[104:119]
    ds_read_b64_tr_b16 v[188:189], v195 offset:28672
    v_mul_f32 v44, v44, v52
    v_mul_f32 v45, v45, v53
    v_mul_f32 v46, v46, v54
    v_mfma_f32_32x32x16_bf16 v[120:135], v[168:171], a[252:255], v[120:135]
    ds_read_b64_tr_b16 v[190:191], v195 offset:29184
    v_mul_f32 v47, v47, v55
    v_add_f32 v200, 1.0, v200
    v_add_f32 v201, 1.0, v201
    s_waitcnt lgkmcnt(8)
    v_mfma_f32_32x32x16_bf16 v[104:119], v[172:175], a[112:115], v[104:119]
    ds_read_b64_tr_b16 v[168:169], v195 offset:30720
    v_add_f32 v202, 1.0, v202
    v_add_f32 v203, 1.0, v203
    v_rcp_f32 v200, v200
    v_mfma_f32_32x32x16_bf16 v[120:135], v[172:175], v[136:139], v[120:135]
    ds_read_b64_tr_b16 v[170:171], v195 offset:31232
    v_rcp_f32 v201, v201
    v_rcp_f32 v202, v202
    s_waitcnt lgkmcnt(8)
    v_mfma_f32_32x32x16_bf16 v[104:119], v[176:179], a[116:119], v[104:119]
    ds_read_b64_tr_b16 v[172:173], v195 offset:32768
    v_rcp_f32 v203, v203
    v_mul_f32 v44, v44, v200
    v_mfma_f32_32x32x16_bf16 v[120:135], v[176:179], v[140:143], v[120:135]
    ds_read_b64_tr_b16 v[174:175], v195 offset:33280
    v_mul_f32 v45, v45, v201
    v_mul_f32 v46, v46, v202
    v_mul_f32 v47, v47, v203
    s_waitcnt lgkmcnt(8)
    v_mfma_f32_32x32x16_bf16 v[104:119], v[180:183], a[120:123], v[104:119]
    ds_read_b64_tr_b16 v[176:177], v195 offset:34816
    v_cvt_pk_bf16_f32 v206, v44, v45
    v_cvt_pk_bf16_f32 v207, v46, v47
    s_add_u32 s33, s35, 65536
    buffer_store_dwordx4 v[204:207], v218, s[44:47], s33 offen sc1
    v_mfma_f32_32x32x16_bf16 v[120:135], v[180:183], v[144:147], v[120:135]
    ds_read_b64_tr_b16 v[178:179], v195 offset:35328
    v_mul_f32 v208, v229, v56
    v_mul_f32 v209, v229, v57
    v_mul_f32 v210, v229, v58
    s_waitcnt lgkmcnt(8)
    v_mfma_f32_32x32x16_bf16 v[104:119], v[184:187], a[124:127], v[104:119]
    ds_read_b64_tr_b16 v[180:181], v230 offset:96
    v_mul_f32 v211, v229, v59
    v_exp_f32 v208, v208
    v_mfma_f32_32x32x16_bf16 v[120:135], v[184:187], v[148:151], v[120:135]
    ds_read_b64_tr_b16 v[182:183], v230 offset:96
    v_exp_f32 v209, v209
    v_exp_f32 v210, v210
    s_waitcnt lgkmcnt(8)
    v_mfma_f32_32x32x16_bf16 v[104:119], v[188:191], a[128:131], v[104:119]
    v_add_u32 v192, 0xfffe8000, v192
    v_add_u32 v193, 0xfffe8000, v193
    v_add_u32 v194, 0xfffe8000, v194
    v_add_u32 v195, 0xfffe8000, v195
    v_add_u32 v196, 0xfffe8000, v196
    ds_read_b64_tr_b16 v[184:185], v192 offset:0
    v_exp_f32 v211, v211
    v_mul_f32 v56, v56, v64
    v_mfma_f32_32x32x16_bf16 v[120:135], v[188:191], v[152:155], v[120:135]
    ds_read_b64_tr_b16 v[186:187], v192 offset:512
    v_mul_f32 v57, v57, v65
    v_mul_f32 v58, v58, v66
    v_mul_f32 v59, v59, v67
    s_waitcnt lgkmcnt(8)
    v_mfma_f32_32x32x16_bf16 v[104:119], v[168:171], a[132:135], v[104:119]
    ds_read_b64_tr_b16 v[188:189], v192 offset:2048
    v_add_f32 v208, 1.0, v208
    v_add_f32 v209, 1.0, v209
    v_add_f32 v210, 1.0, v210
    v_mfma_f32_32x32x16_bf16 v[120:135], v[168:171], v[156:159], v[120:135]
    ds_read_b64_tr_b16 v[190:191], v192 offset:2560
    v_add_f32 v211, 1.0, v211
    v_rcp_f32 v208, v208
    s_waitcnt lgkmcnt(8)
    v_mfma_f32_32x32x16_bf16 v[104:119], v[172:175], a[136:139], v[104:119]
    ds_read_b64_tr_b16 v[168:169], v192 offset:4096
    v_rcp_f32 v209, v209
    v_rcp_f32 v210, v210
    v_mfma_f32_32x32x16_bf16 v[120:135], v[172:175], v[160:163], v[120:135]
    ds_read_b64_tr_b16 v[170:171], v192 offset:4608
    v_rcp_f32 v211, v211
    v_mul_f32 v56, v56, v208
    s_waitcnt lgkmcnt(8)
    v_mfma_f32_32x32x16_bf16 v[104:119], v[176:179], a[140:143], v[104:119]
    ds_read_b64_tr_b16 v[172:173], v192 offset:6144
    v_mul_f32 v57, v57, v209
    v_mul_f32 v58, v58, v210
    v_mul_f32 v59, v59, v211
    v_mfma_f32_32x32x16_bf16 v[120:135], v[176:179], v[164:167], v[120:135]
    ds_read_b64_tr_b16 v[174:175], v192 offset:6656
    v_cvt_pk_bf16_f32 v212, v56, v57
    v_cvt_pk_bf16_f32 v213, v58, v59
    v_mul_f32 v208, v229, v60
    s_waitcnt lgkmcnt(8)
    v_mfma_f32_32x32x16_bf16 v[104:119], v[180:183], v[220:223], v[104:119]
    ds_read_b64_tr_b16 v[176:177], v192 offset:8192
    v_mul_f32 v209, v229, v61
    v_mul_f32 v210, v229, v62
    v_mul_f32 v211, v229, v63
    v_mfma_f32_32x32x16_bf16 v[120:135], v[180:183], v[224:227], v[120:135]
    ds_read_b64_tr_b16 v[178:179], v192 offset:8704
    v_exp_f32 v208, v208
    v_exp_f32 v209, v209
    s_waitcnt lgkmcnt(8)
    v_mfma_f32_32x32x16_bf16 v[8:23], v[184:187], a[0:3], 0
    ds_read_b64_tr_b16 v[180:181], v192 offset:10240
    v_exp_f32 v210, v210
    v_exp_f32 v211, v211
    v_mfma_f32_32x32x16_bf16 v[24:39], v[184:187], a[144:147], 0
    ds_read_b64_tr_b16 v[182:183], v192 offset:10752
    v_mul_f32 v60, v60, v68
    v_mul_f32 v61, v61, v69
    v_mul_f32 v62, v62, v70
    s_waitcnt vmcnt(1)
    s_barrier
    s_waitcnt lgkmcnt(8)
    v_mfma_f32_32x32x16_bf16 v[8:23], v[188:191], a[4:7], v[8:23]
    ds_read_b64_tr_b16 v[184:185], v192 offset:24576
    v_mul_f32 v63, v63, v71
    v_add_f32 v208, 1.0, v208
    v_add_f32 v209, 1.0, v209
    v_mfma_f32_32x32x16_bf16 v[24:39], v[188:191], a[148:151], v[24:39]
    ds_read_b64_tr_b16 v[186:187], v192 offset:25088
    v_add_f32 v210, 1.0, v210
    v_add_f32 v211, 1.0, v211
    v_rcp_f32 v208, v208
    s_add_u32 s33, s31, 3539072
    s_add_u32 m0, s32, 98304
    s_nop 0
    buffer_load_dwordx4 v216, s[4:7], s33 offen lds
    s_add_u32 s33, s31, 3833984
    s_add_u32 m0, s32, 102400
    s_nop 0
    buffer_load_dwordx4 v216, s[4:7], s33 offen lds
    s_waitcnt lgkmcnt(8)
    v_mfma_f32_32x32x16_bf16 v[8:23], v[168:171], a[8:11], v[8:23]
    ds_read_b64_tr_b16 v[188:189], v192 offset:26624
    v_rcp_f32 v209, v209
    v_rcp_f32 v210, v210
    v_mfma_f32_32x32x16_bf16 v[24:39], v[168:171], a[152:155], v[24:39]
    ds_read_b64_tr_b16 v[190:191], v192 offset:27136
    v_rcp_f32 v211, v211
    v_mul_f32 v60, v60, v208
    s_add_u32 s33, s31, 4128896
    s_add_u32 m0, s32, 106496
    s_nop 0
    buffer_load_dwordx4 v216, s[4:7], s33 offen lds
    s_waitcnt lgkmcnt(8)
    v_mfma_f32_32x32x16_bf16 v[8:23], v[172:175], a[12:15], v[8:23]
    ds_read_b64_tr_b16 v[168:169], v192 offset:28672
    v_mul_f32 v61, v61, v209
    v_mul_f32 v62, v62, v210
    v_mul_f32 v63, v63, v211
    v_mfma_f32_32x32x16_bf16 v[24:39], v[172:175], a[156:159], v[24:39]
    ds_read_b64_tr_b16 v[170:171], v192 offset:29184
    v_cvt_pk_bf16_f32 v214, v60, v61
    v_cvt_pk_bf16_f32 v215, v62, v63
    s_add_u32 s33, s35, 66560
    buffer_store_dwordx4 v[212:215], v218, s[44:47], s33 offen sc1
    s_add_u32 s33, s31, 3539072
    s_add_u32 m0, s32, 110592
    s_nop 0
    buffer_load_dwordx4 v217, s[8:11], s33 offen lds
    s_waitcnt lgkmcnt(8)
    v_mfma_f32_32x32x16_bf16 v[8:23], v[176:179], a[16:19], v[8:23]
    ds_read_b64_tr_b16 v[172:173], v192 offset:30720
    v_mul_f32 v200, v228, v72
    v_mul_f32 v201, v228, v73
    v_mul_f32 v202, v228, v74
    v_mfma_f32_32x32x16_bf16 v[24:39], v[176:179], a[160:163], v[24:39]
    ds_read_b64_tr_b16 v[174:175], v192 offset:31232
    v_mul_f32 v203, v228, v75
    v_exp_f32 v200, v200
    s_add_u32 s33, s31, 3833984
    s_add_u32 m0, s32, 114688
    s_nop 0
    buffer_load_dwordx4 v217, s[8:11], s33 offen lds
    s_waitcnt lgkmcnt(8)
    v_mfma_f32_32x32x16_bf16 v[8:23], v[180:183], a[20:23], v[8:23]
    ds_read_b64_tr_b16 v[176:177], v192 offset:32768
    v_exp_f32 v201, v201
    v_exp_f32 v202, v202
    v_mfma_f32_32x32x16_bf16 v[24:39], v[180:183], a[164:167], v[24:39]
    ds_read_b64_tr_b16 v[178:179], v192 offset:33280
    v_exp_f32 v203, v203
    v_mul_f32 v72, v72, v80
    s_add_u32 s33, s31, 4128896
    s_add_u32 m0, s32, 118784
    s_nop 0
    buffer_load_dwordx4 v217, s[8:11], s33 offen lds
    s_waitcnt lgkmcnt(8)
    v_mfma_f32_32x32x16_bf16 v[8:23], v[184:187], a[24:27], v[8:23]
    ds_read_b64_tr_b16 v[180:181], v192 offset:34816
    v_mul_f32 v73, v73, v81
    v_mul_f32 v74, v74, v82
    v_mul_f32 v75, v75, v83
    v_mfma_f32_32x32x16_bf16 v[24:39], v[184:187], a[168:171], v[24:39]
    ds_read_b64_tr_b16 v[182:183], v192 offset:35328
    v_add_f32 v200, 1.0, v200
    v_add_f32 v201, 1.0, v201
    v_add_f32 v202, 1.0, v202
    s_waitcnt lgkmcnt(8)
    v_mfma_f32_32x32x16_bf16 v[8:23], v[188:191], a[28:31], v[8:23]
    ds_read_b64_tr_b16 v[184:185], v193 offset:0
    v_add_f32 v203, 1.0, v203
    v_rcp_f32 v200, v200
    v_mfma_f32_32x32x16_bf16 v[24:39], v[188:191], a[172:175], v[24:39]
    ds_read_b64_tr_b16 v[186:187], v193 offset:512
    v_rcp_f32 v201, v201
    v_rcp_f32 v202, v202
    s_add_u32 s33, s31, 4423808
    s_add_u32 m0, s32, 122880
    s_nop 0
    buffer_load_dwordx4 v216, s[4:7], s33 offen lds
    s_waitcnt lgkmcnt(8)
    v_mfma_f32_32x32x16_bf16 v[8:23], v[168:171], a[32:35], v[8:23]
    ds_read_b64_tr_b16 v[188:189], v193 offset:2048
    v_rcp_f32 v203, v203
    v_mul_f32 v72, v72, v200
    v_mfma_f32_32x32x16_bf16 v[24:39], v[168:171], a[176:179], v[24:39]
    ds_read_b64_tr_b16 v[190:191], v193 offset:2560
    v_mul_f32 v73, v73, v201
    v_mul_f32 v74, v74, v202
    v_mul_f32 v75, v75, v203
    s_add_u32 s33, s31, 4718720
    s_add_u32 m0, s32, 126976
    s_nop 0
    buffer_load_dwordx4 v216, s[4:7], s33 offen lds
    s_waitcnt lgkmcnt(8)
    v_mfma_f32_32x32x16_bf16 v[8:23], v[172:175], a[36:39], v[8:23]
    ds_read_b64_tr_b16 v[168:169], v193 offset:4096
    v_cvt_pk_bf16_f32 v204, v72, v73
    v_cvt_pk_bf16_f32 v205, v74, v75
    v_mul_f32 v200, v228, v76
    v_mfma_f32_32x32x16_bf16 v[24:39], v[172:175], a[180:183], v[24:39]
    ds_read_b64_tr_b16 v[170:171], v193 offset:4608
    v_mul_f32 v201, v228, v77
    v_mul_f32 v202, v228, v78
    v_mul_f32 v203, v228, v79
    s_add_u32 s33, s31, 5013632
    s_add_u32 m0, s32, 131072
    s_nop 0
    buffer_load_dwordx4 v216, s[4:7], s33 offen lds
    s_waitcnt lgkmcnt(8)
    v_mfma_f32_32x32x16_bf16 v[8:23], v[176:179], a[40:43], v[8:23]
    ds_read_b64_tr_b16 v[172:173], v193 offset:6144
    v_exp_f32 v200, v200
    v_exp_f32 v201, v201
    v_mfma_f32_32x32x16_bf16 v[24:39], v[176:179], a[184:187], v[24:39]
    ds_read_b64_tr_b16 v[174:175], v193 offset:6656
    v_exp_f32 v202, v202
    v_exp_f32 v203, v203
    s_add_u32 s33, s31, 4423808
    s_add_u32 m0, s32, 135168
    s_nop 0
    buffer_load_dwordx4 v217, s[8:11], s33 offen lds
    s_waitcnt lgkmcnt(8)
    v_mfma_f32_32x32x16_bf16 v[8:23], v[180:183], a[44:47], v[8:23]
    ds_read_b64_tr_b16 v[176:177], v193 offset:8192
    v_mul_f32 v76, v76, v84
    v_mul_f32 v77, v77, v85
    v_mul_f32 v78, v78, v86
    v_mfma_f32_32x32x16_bf16 v[24:39], v[180:183], a[188:191], v[24:39]
    ds_read_b64_tr_b16 v[178:179], v193 offset:8704
    v_mul_f32 v79, v79, v87
    v_add_f32 v200, 1.0, v200
    v_add_f32 v201, 1.0, v201
    s_waitcnt lgkmcnt(8)
    v_mfma_f32_32x32x16_bf16 v[40:55], v[184:187], a[0:3], 0
    ds_read_b64_tr_b16 v[180:181], v193 offset:10240
    v_add_f32 v202, 1.0, v202
    v_add_f32 v203, 1.0, v203
    v_rcp_f32 v200, v200
    v_mfma_f32_32x32x16_bf16 v[56:71], v[184:187], a[144:147], 0
    ds_read_b64_tr_b16 v[182:183], v193 offset:10752
    v_rcp_f32 v201, v201
    v_rcp_f32 v202, v202
    s_add_u32 s33, s31, 4718720
    s_add_u32 m0, s32, 139264
    s_nop 0
    buffer_load_dwordx4 v217, s[8:11], s33 offen lds
    s_waitcnt lgkmcnt(8)
    v_mfma_f32_32x32x16_bf16 v[40:55], v[188:191], a[4:7], v[40:55]
    ds_read_b64_tr_b16 v[184:185], v193 offset:24576
    v_rcp_f32 v203, v203
    v_mul_f32 v76, v76, v200
    v_mfma_f32_32x32x16_bf16 v[56:71], v[188:191], a[148:151], v[56:71]
    ds_read_b64_tr_b16 v[186:187], v193 offset:25088
    v_mul_f32 v77, v77, v201
    v_mul_f32 v78, v78, v202
    v_mul_f32 v79, v79, v203
    s_add_u32 s33, s31, 5013632
    s_add_u32 m0, s32, 143360
    s_nop 0
    buffer_load_dwordx4 v217, s[8:11], s33 offen lds
    s_waitcnt lgkmcnt(8)
    v_mfma_f32_32x32x16_bf16 v[40:55], v[168:171], a[8:11], v[40:55]
    ds_read_b64_tr_b16 v[188:189], v193 offset:26624
    v_cvt_pk_bf16_f32 v206, v76, v77
    v_cvt_pk_bf16_f32 v207, v78, v79
    s_add_u32 s33, s35, 131072
    buffer_store_dwordx4 v[204:207], v218, s[44:47], s33 offen sc1
    v_mfma_f32_32x32x16_bf16 v[56:71], v[168:171], a[152:155], v[56:71]
    ds_read_b64_tr_b16 v[190:191], v193 offset:27136
    v_mul_f32 v208, v229, v88
    v_mul_f32 v209, v229, v89
    v_mul_f32 v210, v229, v90
    s_waitcnt lgkmcnt(8)
    v_mfma_f32_32x32x16_bf16 v[40:55], v[172:175], a[12:15], v[40:55]
    ds_read_b64_tr_b16 v[168:169], v193 offset:28672
    v_mul_f32 v211, v229, v91
    v_exp_f32 v208, v208
    v_mfma_f32_32x32x16_bf16 v[56:71], v[172:175], a[156:159], v[56:71]
    ds_read_b64_tr_b16 v[170:171], v193 offset:29184
    v_exp_f32 v209, v209
    v_exp_f32 v210, v210
    s_waitcnt lgkmcnt(8)
    v_mfma_f32_32x32x16_bf16 v[40:55], v[176:179], a[16:19], v[40:55]
    ds_read_b64_tr_b16 v[172:173], v193 offset:30720
    v_exp_f32 v211, v211
    v_mul_f32 v88, v88, v96
    v_mfma_f32_32x32x16_bf16 v[56:71], v[176:179], a[160:163], v[56:71]
    ds_read_b64_tr_b16 v[174:175], v193 offset:31232
    v_mul_f32 v89, v89, v97
    v_mul_f32 v90, v90, v98
    v_mul_f32 v91, v91, v99
    s_waitcnt lgkmcnt(8)
    v_mfma_f32_32x32x16_bf16 v[40:55], v[180:183], a[20:23], v[40:55]
    ds_read_b64_tr_b16 v[176:177], v193 offset:32768
    v_add_f32 v208, 1.0, v208
    v_add_f32 v209, 1.0, v209
    v_add_f32 v210, 1.0, v210
    v_mfma_f32_32x32x16_bf16 v[56:71], v[180:183], a[164:167], v[56:71]
    ds_read_b64_tr_b16 v[178:179], v193 offset:33280
    v_add_f32 v211, 1.0, v211
    v_rcp_f32 v208, v208
    s_waitcnt lgkmcnt(8)
    v_mfma_f32_32x32x16_bf16 v[40:55], v[184:187], a[24:27], v[40:55]
    ds_read_b64_tr_b16 v[180:181], v193 offset:34816
    v_rcp_f32 v209, v209
    v_rcp_f32 v210, v210
    v_mfma_f32_32x32x16_bf16 v[56:71], v[184:187], a[168:171], v[56:71]
    ds_read_b64_tr_b16 v[182:183], v193 offset:35328
    v_rcp_f32 v211, v211
    v_mul_f32 v88, v88, v208
    s_waitcnt lgkmcnt(8)
    v_mfma_f32_32x32x16_bf16 v[40:55], v[188:191], a[28:31], v[40:55]
    ds_read_b64_tr_b16 v[184:185], v194 offset:0
    v_mul_f32 v89, v89, v209
    v_mul_f32 v90, v90, v210
    v_mul_f32 v91, v91, v211
    v_mfma_f32_32x32x16_bf16 v[56:71], v[188:191], a[172:175], v[56:71]
    ds_read_b64_tr_b16 v[186:187], v194 offset:512
    v_cvt_pk_bf16_f32 v212, v88, v89
    v_cvt_pk_bf16_f32 v213, v90, v91
    v_mul_f32 v208, v229, v92
    s_waitcnt lgkmcnt(8)
    v_mfma_f32_32x32x16_bf16 v[40:55], v[168:171], a[32:35], v[40:55]
    ds_read_b64_tr_b16 v[188:189], v194 offset:2048
    v_mul_f32 v209, v229, v93
    v_mul_f32 v210, v229, v94
    v_mul_f32 v211, v229, v95
    v_mfma_f32_32x32x16_bf16 v[56:71], v[168:171], a[176:179], v[56:71]
    ds_read_b64_tr_b16 v[190:191], v194 offset:2560
    v_exp_f32 v208, v208
    v_exp_f32 v209, v209
    s_waitcnt lgkmcnt(8)
    v_mfma_f32_32x32x16_bf16 v[40:55], v[172:175], a[36:39], v[40:55]
    ds_read_b64_tr_b16 v[168:169], v194 offset:4096
    v_exp_f32 v210, v210
    v_exp_f32 v211, v211
    v_mfma_f32_32x32x16_bf16 v[56:71], v[172:175], a[180:183], v[56:71]
    ds_read_b64_tr_b16 v[170:171], v194 offset:4608
    v_mul_f32 v92, v92, v100
    v_mul_f32 v93, v93, v101
    v_mul_f32 v94, v94, v102
    s_waitcnt lgkmcnt(8)
    v_mfma_f32_32x32x16_bf16 v[40:55], v[176:179], a[40:43], v[40:55]
    ds_read_b64_tr_b16 v[172:173], v194 offset:6144
    v_mul_f32 v95, v95, v103
    v_add_f32 v208, 1.0, v208
    v_add_f32 v209, 1.0, v209
    v_mfma_f32_32x32x16_bf16 v[56:71], v[176:179], a[184:187], v[56:71]
    ds_read_b64_tr_b16 v[174:175], v194 offset:6656
    v_add_f32 v210, 1.0, v210
    v_add_f32 v211, 1.0, v211
    v_rcp_f32 v208, v208
    s_waitcnt lgkmcnt(8)
    v_mfma_f32_32x32x16_bf16 v[40:55], v[180:183], a[44:47], v[40:55]
    ds_read_b64_tr_b16 v[176:177], v194 offset:8192
    v_rcp_f32 v209, v209
    v_rcp_f32 v210, v210
    v_mfma_f32_32x32x16_bf16 v[56:71], v[180:183], a[188:191], v[56:71]
    ds_read_b64_tr_b16 v[178:179], v194 offset:8704
    v_rcp_f32 v211, v211
    v_mul_f32 v92, v92, v208
    v_mul_f32 v93, v93, v209
    v_mul_f32 v94, v94, v210
    v_mul_f32 v95, v95, v211
    v_cvt_pk_bf16_f32 v214, v92, v93
    v_cvt_pk_bf16_f32 v215, v94, v95
    s_add_u32 s33, s35, 132096
    buffer_store_dwordx4 v[212:215], v218, s[44:47], s33 offen sc1
    s_waitcnt lgkmcnt(8)
    v_mfma_f32_32x32x16_bf16 v[72:87], v[184:187], a[0:3], 0
    ds_read_b64_tr_b16 v[180:181], v194 offset:10240
    v_mul_f32 v200, v228, v104
    v_mul_f32 v201, v228, v105
    v_mul_f32 v202, v228, v106
    v_mfma_f32_32x32x16_bf16 v[88:103], v[184:187], a[144:147], 0
    ds_read_b64_tr_b16 v[182:183], v194 offset:10752
    v_mul_f32 v203, v228, v107
    v_exp_f32 v200, v200
    s_waitcnt lgkmcnt(8)
    v_mfma_f32_32x32x16_bf16 v[72:87], v[188:191], a[4:7], v[72:87]
    ds_read_b64_tr_b16 v[184:185], v194 offset:24576
    v_exp_f32 v201, v201
    v_exp_f32 v202, v202
    v_mfma_f32_32x32x16_bf16 v[88:103], v[188:191], a[148:151], v[88:103]
    ds_read_b64_tr_b16 v[186:187], v194 offset:25088
    v_exp_f32 v203, v203
    v_mul_f32 v104, v104, v112
    s_waitcnt lgkmcnt(8)
    v_mfma_f32_32x32x16_bf16 v[72:87], v[168:171], a[8:11], v[72:87]
    ds_read_b64_tr_b16 v[188:189], v194 offset:26624
    v_mul_f32 v105, v105, v113
    v_mul_f32 v106, v106, v114
    v_mul_f32 v107, v107, v115
    v_mfma_f32_32x32x16_bf16 v[88:103], v[168:171], a[152:155], v[88:103]
    ds_read_b64_tr_b16 v[190:191], v194 offset:27136
    v_add_f32 v200, 1.0, v200
    v_add_f32 v201, 1.0, v201
    v_add_f32 v202, 1.0, v202
    s_waitcnt lgkmcnt(8)
    v_mfma_f32_32x32x16_bf16 v[72:87], v[172:175], a[12:15], v[72:87]
    ds_read_b64_tr_b16 v[168:169], v194 offset:28672
    v_add_f32 v203, 1.0, v203
    v_rcp_f32 v200, v200
    v_mfma_f32_32x32x16_bf16 v[88:103], v[172:175], a[156:159], v[88:103]
    ds_read_b64_tr_b16 v[170:171], v194 offset:29184
    v_rcp_f32 v201, v201
    v_rcp_f32 v202, v202
    s_waitcnt lgkmcnt(8)
    v_mfma_f32_32x32x16_bf16 v[72:87], v[176:179], a[16:19], v[72:87]
    ds_read_b64_tr_b16 v[172:173], v194 offset:30720
    v_rcp_f32 v203, v203
    v_mul_f32 v104, v104, v200
    v_mfma_f32_32x32x16_bf16 v[88:103], v[176:179], a[160:163], v[88:103]
    ds_read_b64_tr_b16 v[174:175], v194 offset:31232
    v_mul_f32 v105, v105, v201
    v_mul_f32 v106, v106, v202
    v_mul_f32 v107, v107, v203
    s_waitcnt lgkmcnt(8)
    v_mfma_f32_32x32x16_bf16 v[72:87], v[180:183], a[20:23], v[72:87]
    ds_read_b64_tr_b16 v[176:177], v194 offset:32768
    v_cvt_pk_bf16_f32 v204, v104, v105
    v_cvt_pk_bf16_f32 v205, v106, v107
    v_mul_f32 v200, v228, v108
    v_mfma_f32_32x32x16_bf16 v[88:103], v[180:183], a[164:167], v[88:103]
    ds_read_b64_tr_b16 v[178:179], v194 offset:33280
    v_mul_f32 v201, v228, v109
    v_mul_f32 v202, v228, v110
    v_mul_f32 v203, v228, v111
    s_waitcnt lgkmcnt(8)
    v_mfma_f32_32x32x16_bf16 v[72:87], v[184:187], a[24:27], v[72:87]
    ds_read_b64_tr_b16 v[180:181], v194 offset:34816
    v_exp_f32 v200, v200
    v_exp_f32 v201, v201
    v_mfma_f32_32x32x16_bf16 v[88:103], v[184:187], a[168:171], v[88:103]
    ds_read_b64_tr_b16 v[182:183], v194 offset:35328
    v_exp_f32 v202, v202
    v_exp_f32 v203, v203
    s_waitcnt lgkmcnt(8)
    v_mfma_f32_32x32x16_bf16 v[72:87], v[188:191], a[28:31], v[72:87]
    ds_read_b64_tr_b16 v[184:185], v195 offset:0
    v_mul_f32 v108, v108, v116
    v_mul_f32 v109, v109, v117
    v_mul_f32 v110, v110, v118
    v_mfma_f32_32x32x16_bf16 v[88:103], v[188:191], a[172:175], v[88:103]
    ds_read_b64_tr_b16 v[186:187], v195 offset:512
    v_mul_f32 v111, v111, v119
    v_add_f32 v200, 1.0, v200
    v_add_f32 v201, 1.0, v201
    s_waitcnt lgkmcnt(8)
    v_mfma_f32_32x32x16_bf16 v[72:87], v[168:171], a[32:35], v[72:87]
    ds_read_b64_tr_b16 v[188:189], v195 offset:2048
    v_add_f32 v202, 1.0, v202
    v_add_f32 v203, 1.0, v203
    v_rcp_f32 v200, v200
    v_mfma_f32_32x32x16_bf16 v[88:103], v[168:171], a[176:179], v[88:103]
    ds_read_b64_tr_b16 v[190:191], v195 offset:2560
    v_rcp_f32 v201, v201
    v_rcp_f32 v202, v202
    s_waitcnt lgkmcnt(8)
    v_mfma_f32_32x32x16_bf16 v[72:87], v[172:175], a[36:39], v[72:87]
    ds_read_b64_tr_b16 v[168:169], v195 offset:4096
    v_rcp_f32 v203, v203
    v_mul_f32 v108, v108, v200
    v_mfma_f32_32x32x16_bf16 v[88:103], v[172:175], a[180:183], v[88:103]
    ds_read_b64_tr_b16 v[170:171], v195 offset:4608
    v_mul_f32 v109, v109, v201
    v_mul_f32 v110, v110, v202
    v_mul_f32 v111, v111, v203
    s_waitcnt lgkmcnt(8)
    v_mfma_f32_32x32x16_bf16 v[72:87], v[176:179], a[40:43], v[72:87]
    ds_read_b64_tr_b16 v[172:173], v195 offset:6144
    v_cvt_pk_bf16_f32 v206, v108, v109
    v_cvt_pk_bf16_f32 v207, v110, v111
    s_add_u32 s33, s35, 196608
    buffer_store_dwordx4 v[204:207], v218, s[44:47], s33 offen sc1
    v_mfma_f32_32x32x16_bf16 v[88:103], v[176:179], a[184:187], v[88:103]
    ds_read_b64_tr_b16 v[174:175], v195 offset:6656
    v_mul_f32 v208, v229, v120
    v_mul_f32 v209, v229, v121
    v_mul_f32 v210, v229, v122
    s_waitcnt lgkmcnt(8)
    v_mfma_f32_32x32x16_bf16 v[72:87], v[180:183], a[44:47], v[72:87]
    ds_read_b64_tr_b16 v[176:177], v195 offset:8192
    v_mul_f32 v211, v229, v123
    v_exp_f32 v208, v208
    v_mfma_f32_32x32x16_bf16 v[88:103], v[180:183], a[188:191], v[88:103]
    ds_read_b64_tr_b16 v[178:179], v195 offset:8704
    v_exp_f32 v209, v209
    v_exp_f32 v210, v210
    v_exp_f32 v211, v211
    v_mul_f32 v120, v120, v128
    v_mul_f32 v121, v121, v129
    v_mul_f32 v122, v122, v130
    v_mul_f32 v123, v123, v131
    v_add_f32 v208, 1.0, v208
    v_add_f32 v209, 1.0, v209
    v_add_f32 v210, 1.0, v210
    v_add_f32 v211, 1.0, v211
    v_rcp_f32 v208, v208
    v_rcp_f32 v209, v209
    v_rcp_f32 v210, v210
    v_rcp_f32 v211, v211
    v_mul_f32 v120, v120, v208
    v_mul_f32 v121, v121, v209
    v_mul_f32 v122, v122, v210
    v_mul_f32 v123, v123, v211
    v_cvt_pk_bf16_f32 v212, v120, v121
    v_cvt_pk_bf16_f32 v213, v122, v123
    v_mul_f32 v208, v229, v124
    v_mul_f32 v209, v229, v125
    v_mul_f32 v210, v229, v126
    v_mul_f32 v211, v229, v127
    v_exp_f32 v208, v208
    v_exp_f32 v209, v209
    v_exp_f32 v210, v210
    v_exp_f32 v211, v211
    v_mul_f32 v124, v124, v132
    v_mul_f32 v125, v125, v133
    v_mul_f32 v126, v126, v134
    v_mul_f32 v127, v127, v135
    v_add_f32 v208, 1.0, v208
    v_add_f32 v209, 1.0, v209
    v_add_f32 v210, 1.0, v210
    v_add_f32 v211, 1.0, v211
    v_rcp_f32 v208, v208
    v_rcp_f32 v209, v209
    v_rcp_f32 v210, v210
    v_rcp_f32 v211, v211
    v_mul_f32 v124, v124, v208
    v_mul_f32 v125, v125, v209
    v_mul_f32 v126, v126, v210
    v_mul_f32 v127, v127, v211
    v_cvt_pk_bf16_f32 v214, v124, v125
    v_cvt_pk_bf16_f32 v215, v126, v127
    s_add_u32 s33, s35, 197632
    buffer_store_dwordx4 v[212:215], v218, s[44:47], s33 offen sc1
    s_waitcnt lgkmcnt(8)
    v_mfma_f32_32x32x16_bf16 v[104:119], v[184:187], a[0:3], 0
    ds_read_b64_tr_b16 v[180:181], v195 offset:10240
    v_mfma_f32_32x32x16_bf16 v[120:135], v[184:187], a[144:147], 0
    ds_read_b64_tr_b16 v[182:183], v195 offset:10752
    s_waitcnt lgkmcnt(8)
    v_mfma_f32_32x32x16_bf16 v[104:119], v[188:191], a[4:7], v[104:119]
    ds_read_b64_tr_b16 v[184:185], v195 offset:24576
    v_mfma_f32_32x32x16_bf16 v[120:135], v[188:191], a[148:151], v[120:135]
    ds_read_b64_tr_b16 v[186:187], v195 offset:25088
    s_waitcnt lgkmcnt(8)
    v_mfma_f32_32x32x16_bf16 v[104:119], v[168:171], a[8:11], v[104:119]
    ds_read_b64_tr_b16 v[188:189], v195 offset:26624
    v_mfma_f32_32x32x16_bf16 v[120:135], v[168:171], a[152:155], v[120:135]
    ds_read_b64_tr_b16 v[190:191], v195 offset:27136
    s_waitcnt lgkmcnt(8)
    v_mfma_f32_32x32x16_bf16 v[104:119], v[172:175], a[12:15], v[104:119]
    ds_read_b64_tr_b16 v[168:169], v195 offset:28672
    v_mfma_f32_32x32x16_bf16 v[120:135], v[172:175], a[156:159], v[120:135]
    ds_read_b64_tr_b16 v[170:171], v195 offset:29184
    s_waitcnt lgkmcnt(8)
    v_mfma_f32_32x32x16_bf16 v[104:119], v[176:179], a[16:19], v[104:119]
    ds_read_b64_tr_b16 v[172:173], v195 offset:30720
    v_mfma_f32_32x32x16_bf16 v[120:135], v[176:179], a[160:163], v[120:135]
    ds_read_b64_tr_b16 v[174:175], v195 offset:31232
    s_waitcnt lgkmcnt(8)
    v_mfma_f32_32x32x16_bf16 v[104:119], v[180:183], a[20:23], v[104:119]
    ds_read_b64_tr_b16 v[176:177], v195 offset:32768
    v_mfma_f32_32x32x16_bf16 v[120:135], v[180:183], a[164:167], v[120:135]
    ds_read_b64_tr_b16 v[178:179], v195 offset:33280
    s_waitcnt lgkmcnt(8)
    v_mfma_f32_32x32x16_bf16 v[104:119], v[184:187], a[24:27], v[104:119]
    ds_read_b64_tr_b16 v[180:181], v195 offset:34816
    v_mfma_f32_32x32x16_bf16 v[120:135], v[184:187], a[168:171], v[120:135]
    ds_read_b64_tr_b16 v[182:183], v195 offset:35328
    s_waitcnt lgkmcnt(8)
    v_mfma_f32_32x32x16_bf16 v[104:119], v[188:191], a[28:31], v[104:119]
    v_add_u32 v192, 0xc000, v192
    v_add_u32 v193, 0xc000, v193
    v_add_u32 v194, 0xc000, v194
    v_add_u32 v195, 0xc000, v195
    v_add_u32 v196, 0xc000, v196
    ds_read_b64_tr_b16 v[184:185], v192 offset:0
    v_mfma_f32_32x32x16_bf16 v[120:135], v[188:191], a[172:175], v[120:135]
    ds_read_b64_tr_b16 v[186:187], v192 offset:512
    s_waitcnt lgkmcnt(8)
    v_mfma_f32_32x32x16_bf16 v[104:119], v[168:171], a[32:35], v[104:119]
    ds_read_b64_tr_b16 v[188:189], v192 offset:2048
    v_mfma_f32_32x32x16_bf16 v[120:135], v[168:171], a[176:179], v[120:135]
    ds_read_b64_tr_b16 v[190:191], v192 offset:2560
    s_waitcnt lgkmcnt(8)
    v_mfma_f32_32x32x16_bf16 v[104:119], v[172:175], a[36:39], v[104:119]
    ds_read_b64_tr_b16 v[168:169], v192 offset:4096
    v_mfma_f32_32x32x16_bf16 v[120:135], v[172:175], a[180:183], v[120:135]
    ds_read_b64_tr_b16 v[170:171], v192 offset:4608
    s_waitcnt lgkmcnt(8)
    v_mfma_f32_32x32x16_bf16 v[104:119], v[176:179], a[40:43], v[104:119]
    ds_read_b64_tr_b16 v[172:173], v192 offset:6144
    v_mfma_f32_32x32x16_bf16 v[120:135], v[176:179], a[184:187], v[120:135]
    ds_read_b64_tr_b16 v[174:175], v192 offset:6656
    s_waitcnt lgkmcnt(8)
    v_mfma_f32_32x32x16_bf16 v[104:119], v[180:183], a[44:47], v[104:119]
    ds_read_b64_tr_b16 v[176:177], v192 offset:8192
    v_mfma_f32_32x32x16_bf16 v[120:135], v[180:183], a[188:191], v[120:135]
    ds_read_b64_tr_b16 v[178:179], v192 offset:8704
    s_waitcnt lgkmcnt(8)
    v_mfma_f32_32x32x16_bf16 v[8:23], v[184:187], a[48:51], v[8:23]
    ds_read_b64_tr_b16 v[180:181], v192 offset:10240
    v_mfma_f32_32x32x16_bf16 v[24:39], v[184:187], a[192:195], v[24:39]
    ds_read_b64_tr_b16 v[182:183], v192 offset:10752
    s_waitcnt vmcnt(4)
    s_barrier
    s_waitcnt lgkmcnt(8)
    v_mfma_f32_32x32x16_bf16 v[8:23], v[188:191], a[52:55], v[8:23]
    ds_read_b64_tr_b16 v[184:185], v193 offset:0
    v_mfma_f32_32x32x16_bf16 v[24:39], v[188:191], a[196:199], v[24:39]
    ds_read_b64_tr_b16 v[186:187], v193 offset:512
    s_add_u32 s33, s29, 0
    s_add_u32 m0, s32, 0
    s_nop 0
    buffer_load_dwordx4 v216, s[4:7], s33 offen lds
    s_add_u32 s33, s29, 294912
    s_add_u32 m0, s32, 4096
    s_nop 0
    buffer_load_dwordx4 v216, s[4:7], s33 offen lds
    s_waitcnt lgkmcnt(8)
    v_mfma_f32_32x32x16_bf16 v[8:23], v[168:171], a[56:59], v[8:23]
    ds_read_b64_tr_b16 v[188:189], v193 offset:2048
    v_mfma_f32_32x32x16_bf16 v[24:39], v[168:171], a[200:203], v[24:39]
    ds_read_b64_tr_b16 v[190:191], v193 offset:2560
    s_add_u32 s33, s29, 589824
    s_add_u32 m0, s32, 8192
    s_nop 0
    buffer_load_dwordx4 v216, s[4:7], s33 offen lds
    s_waitcnt lgkmcnt(8)
    v_mfma_f32_32x32x16_bf16 v[8:23], v[172:175], a[60:63], v[8:23]
    ds_read_b64_tr_b16 v[168:169], v193 offset:4096
    v_mfma_f32_32x32x16_bf16 v[24:39], v[172:175], a[204:207], v[24:39]
    ds_read_b64_tr_b16 v[170:171], v193 offset:4608
    s_add_u32 s33, s29, 0
    s_add_u32 m0, s32, 12288
    s_nop 0
    buffer_load_dwordx4 v217, s[8:11], s33 offen lds
    s_waitcnt lgkmcnt(8)
    v_mfma_f32_32x32x16_bf16 v[8:23], v[176:179], a[64:67], v[8:23]
    ds_read_b64_tr_b16 v[172:173], v193 offset:6144
    v_mfma_f32_32x32x16_bf16 v[24:39], v[176:179], a[208:211], v[24:39]
    ds_read_b64_tr_b16 v[174:175], v193 offset:6656
    s_add_u32 s33, s29, 294912
    s_add_u32 m0, s32, 16384
    s_nop 0
    buffer_load_dwordx4 v217, s[8:11], s33 offen lds
    s_waitcnt lgkmcnt(8)
    v_mfma_f32_32x32x16_bf16 v[8:23], v[180:183], a[68:71], v[8:23]
    ds_read_b64_tr_b16 v[176:177], v193 offset:8192
    v_mfma_f32_32x32x16_bf16 v[24:39], v[180:183], a[212:215], v[24:39]
    ds_read_b64_tr_b16 v[178:179], v193 offset:8704
    s_add_u32 s33, s29, 589824
    s_add_u32 m0, s32, 20480
    s_nop 0
    buffer_load_dwordx4 v217, s[8:11], s33 offen lds
    s_waitcnt lgkmcnt(8)
    v_mfma_f32_32x32x16_bf16 v[40:55], v[184:187], a[48:51], v[40:55]
    ds_read_b64_tr_b16 v[180:181], v193 offset:10240
    v_mfma_f32_32x32x16_bf16 v[56:71], v[184:187], a[192:195], v[56:71]
    ds_read_b64_tr_b16 v[182:183], v193 offset:10752
    s_waitcnt lgkmcnt(8)
    v_mfma_f32_32x32x16_bf16 v[40:55], v[188:191], a[52:55], v[40:55]
    ds_read_b64_tr_b16 v[184:185], v194 offset:0
    v_mfma_f32_32x32x16_bf16 v[56:71], v[188:191], a[196:199], v[56:71]
    ds_read_b64_tr_b16 v[186:187], v194 offset:512
    s_add_u32 s33, s29, 884736
    s_add_u32 m0, s32, 24576
    s_nop 0
    buffer_load_dwordx4 v216, s[4:7], s33 offen lds
    s_waitcnt lgkmcnt(8)
    v_mfma_f32_32x32x16_bf16 v[40:55], v[168:171], a[56:59], v[40:55]
    ds_read_b64_tr_b16 v[188:189], v194 offset:2048
    v_mfma_f32_32x32x16_bf16 v[56:71], v[168:171], a[200:203], v[56:71]
    ds_read_b64_tr_b16 v[190:191], v194 offset:2560
    s_add_u32 s33, s29, 1179648
    s_add_u32 m0, s32, 28672
    s_nop 0
    buffer_load_dwordx4 v216, s[4:7], s33 offen lds
    s_waitcnt lgkmcnt(8)
    v_mfma_f32_32x32x16_bf16 v[40:55], v[172:175], a[60:63], v[40:55]
    ds_read_b64_tr_b16 v[168:169], v194 offset:4096
    v_mfma_f32_32x32x16_bf16 v[56:71], v[172:175], a[204:207], v[56:71]
    ds_read_b64_tr_b16 v[170:171], v194 offset:4608
    s_add_u32 s33, s29, 1474560
    s_add_u32 m0, s32, 32768
    s_nop 0
    buffer_load_dwordx4 v216, s[4:7], s33 offen lds
    s_waitcnt lgkmcnt(8)
    v_mfma_f32_32x32x16_bf16 v[40:55], v[176:179], a[64:67], v[40:55]
    ds_read_b64_tr_b16 v[172:173], v194 offset:6144
    v_mfma_f32_32x32x16_bf16 v[56:71], v[176:179], a[208:211], v[56:71]
    ds_read_b64_tr_b16 v[174:175], v194 offset:6656
    s_add_u32 s33, s29, 884736
    s_add_u32 m0, s32, 36864
    s_nop 0
    buffer_load_dwordx4 v217, s[8:11], s33 offen lds
    s_waitcnt lgkmcnt(8)
    v_mfma_f32_32x32x16_bf16 v[40:55], v[180:183], a[68:71], v[40:55]
    ds_read_b64_tr_b16 v[176:177], v194 offset:8192
    v_mfma_f32_32x32x16_bf16 v[56:71], v[180:183], a[212:215], v[56:71]
    ds_read_b64_tr_b16 v[178:179], v194 offset:8704
    s_waitcnt lgkmcnt(8)
    v_mfma_f32_32x32x16_bf16 v[72:87], v[184:187], a[48:51], v[72:87]
    ds_read_b64_tr_b16 v[180:181], v194 offset:10240
    v_mfma_f32_32x32x16_bf16 v[88:103], v[184:187], a[192:195], v[88:103]
    ds_read_b64_tr_b16 v[182:183], v194 offset:10752
    s_add_u32 s33, s29, 1179648
    s_add_u32 m0, s32, 40960
    s_nop 0
    buffer_load_dwordx4 v217, s[8:11], s33 offen lds
    s_waitcnt lgkmcnt(8)
    v_mfma_f32_32x32x16_bf16 v[72:87], v[188:191], a[52:55], v[72:87]
    ds_read_b64_tr_b16 v[184:185], v195 offset:0
    v_mfma_f32_32x32x16_bf16 v[88:103], v[188:191], a[196:199], v[88:103]
    ds_read_b64_tr_b16 v[186:187], v195 offset:512
    s_add_u32 s33, s29, 1474560
    s_add_u32 m0, s32, 45056
    s_nop 0
    buffer_load_dwordx4 v217, s[8:11], s33 offen lds
    s_waitcnt lgkmcnt(8)
    v_mfma_f32_32x32x16_bf16 v[72:87], v[168:171], a[56:59], v[72:87]
    ds_read_b64_tr_b16 v[188:189], v195 offset:2048
    v_mfma_f32_32x32x16_bf16 v[88:103], v[168:171], a[200:203], v[88:103]
    ds_read_b64_tr_b16 v[190:191], v195 offset:2560
    s_waitcnt lgkmcnt(8)
    v_mfma_f32_32x32x16_bf16 v[72:87], v[172:175], a[60:63], v[72:87]
    ds_read_b64_tr_b16 v[168:169], v195 offset:4096
    v_mfma_f32_32x32x16_bf16 v[88:103], v[172:175], a[204:207], v[88:103]
    ds_read_b64_tr_b16 v[170:171], v195 offset:4608
    s_waitcnt lgkmcnt(8)
    v_mfma_f32_32x32x16_bf16 v[72:87], v[176:179], a[64:67], v[72:87]
    ds_read_b64_tr_b16 v[172:173], v195 offset:6144
    v_mfma_f32_32x32x16_bf16 v[88:103], v[176:179], a[208:211], v[88:103]
    ds_read_b64_tr_b16 v[174:175], v195 offset:6656
    s_waitcnt lgkmcnt(8)
    v_mfma_f32_32x32x16_bf16 v[72:87], v[180:183], a[68:71], v[72:87]
    ds_read_b64_tr_b16 v[176:177], v195 offset:8192
    v_mfma_f32_32x32x16_bf16 v[88:103], v[180:183], a[212:215], v[88:103]
    ds_read_b64_tr_b16 v[178:179], v195 offset:8704
    s_waitcnt lgkmcnt(8)
    v_mfma_f32_32x32x16_bf16 v[104:119], v[184:187], a[48:51], v[104:119]
    ds_read_b64_tr_b16 v[180:181], v195 offset:10240
    v_mfma_f32_32x32x16_bf16 v[120:135], v[184:187], a[192:195], v[120:135]
    ds_read_b64_tr_b16 v[182:183], v195 offset:10752
    s_waitcnt lgkmcnt(8)
    v_mfma_f32_32x32x16_bf16 v[104:119], v[188:191], a[52:55], v[104:119]
    ds_read_b64_tr_b16 v[184:185], v192 offset:24576
    v_mfma_f32_32x32x16_bf16 v[120:135], v[188:191], a[196:199], v[120:135]
    ds_read_b64_tr_b16 v[186:187], v192 offset:25088
    s_waitcnt lgkmcnt(8)
    v_mfma_f32_32x32x16_bf16 v[104:119], v[168:171], a[56:59], v[104:119]
    ds_read_b64_tr_b16 v[188:189], v192 offset:26624
    v_mfma_f32_32x32x16_bf16 v[120:135], v[168:171], a[200:203], v[120:135]
    ds_read_b64_tr_b16 v[190:191], v192 offset:27136
    s_waitcnt lgkmcnt(8)
    v_mfma_f32_32x32x16_bf16 v[104:119], v[172:175], a[60:63], v[104:119]
    ds_read_b64_tr_b16 v[168:169], v192 offset:28672
    v_mfma_f32_32x32x16_bf16 v[120:135], v[172:175], a[204:207], v[120:135]
    ds_read_b64_tr_b16 v[170:171], v192 offset:29184
    s_waitcnt lgkmcnt(8)
    v_mfma_f32_32x32x16_bf16 v[104:119], v[176:179], a[64:67], v[104:119]
    ds_read_b64_tr_b16 v[172:173], v192 offset:30720
    v_mfma_f32_32x32x16_bf16 v[120:135], v[176:179], a[208:211], v[120:135]
    ds_read_b64_tr_b16 v[174:175], v192 offset:31232
    s_waitcnt lgkmcnt(8)
    v_mfma_f32_32x32x16_bf16 v[104:119], v[180:183], a[68:71], v[104:119]
    ds_read_b64_tr_b16 v[176:177], v192 offset:32768
    v_mfma_f32_32x32x16_bf16 v[120:135], v[180:183], a[212:215], v[120:135]
    ds_read_b64_tr_b16 v[178:179], v192 offset:33280
    s_waitcnt lgkmcnt(8)
    v_mfma_f32_32x32x16_bf16 v[8:23], v[184:187], a[72:75], v[8:23]
    ds_read_b64_tr_b16 v[180:181], v192 offset:34816
    v_mfma_f32_32x32x16_bf16 v[24:39], v[184:187], a[216:219], v[24:39]
    ds_read_b64_tr_b16 v[182:183], v192 offset:35328
    s_waitcnt lgkmcnt(8)
    v_mfma_f32_32x32x16_bf16 v[8:23], v[188:191], a[76:79], v[8:23]
    ds_read_b64_tr_b16 v[184:185], v193 offset:24576
    v_mfma_f32_32x32x16_bf16 v[24:39], v[188:191], a[220:223], v[24:39]
    ds_read_b64_tr_b16 v[186:187], v193 offset:25088
    s_waitcnt lgkmcnt(8)
    v_mfma_f32_32x32x16_bf16 v[8:23], v[168:171], a[80:83], v[8:23]
    ds_read_b64_tr_b16 v[188:189], v193 offset:26624
    v_mfma_f32_32x32x16_bf16 v[24:39], v[168:171], a[224:227], v[24:39]
    ds_read_b64_tr_b16 v[190:191], v193 offset:27136
    s_waitcnt lgkmcnt(8)
    v_mfma_f32_32x32x16_bf16 v[8:23], v[172:175], a[84:87], v[8:23]
    ds_read_b64_tr_b16 v[168:169], v193 offset:28672
    v_mfma_f32_32x32x16_bf16 v[24:39], v[172:175], a[228:231], v[24:39]
    ds_read_b64_tr_b16 v[170:171], v193 offset:29184
    s_waitcnt lgkmcnt(8)
    v_mfma_f32_32x32x16_bf16 v[8:23], v[176:179], a[88:91], v[8:23]
    ds_read_b64_tr_b16 v[172:173], v193 offset:30720
    v_mfma_f32_32x32x16_bf16 v[24:39], v[176:179], a[232:235], v[24:39]
    ds_read_b64_tr_b16 v[174:175], v193 offset:31232
    s_waitcnt lgkmcnt(8)
    v_mfma_f32_32x32x16_bf16 v[8:23], v[180:183], a[92:95], v[8:23]
    ds_read_b64_tr_b16 v[176:177], v193 offset:32768
    v_mfma_f32_32x32x16_bf16 v[24:39], v[180:183], a[236:239], v[24:39]
    ds_read_b64_tr_b16 v[178:179], v193 offset:33280
    s_waitcnt lgkmcnt(8)
    v_mfma_f32_32x32x16_bf16 v[40:55], v[184:187], a[72:75], v[40:55]
    ds_read_b64_tr_b16 v[180:181], v193 offset:34816
    v_mfma_f32_32x32x16_bf16 v[56:71], v[184:187], a[216:219], v[56:71]
    ds_read_b64_tr_b16 v[182:183], v193 offset:35328
    s_waitcnt lgkmcnt(8)
    v_mfma_f32_32x32x16_bf16 v[40:55], v[188:191], a[76:79], v[40:55]
    ds_read_b64_tr_b16 v[184:185], v194 offset:24576
    v_mfma_f32_32x32x16_bf16 v[56:71], v[188:191], a[220:223], v[56:71]
    ds_read_b64_tr_b16 v[186:187], v194 offset:25088
    s_waitcnt lgkmcnt(8)
    v_mfma_f32_32x32x16_bf16 v[40:55], v[168:171], a[80:83], v[40:55]
    ds_read_b64_tr_b16 v[188:189], v194 offset:26624
    v_mfma_f32_32x32x16_bf16 v[56:71], v[168:171], a[224:227], v[56:71]
    ds_read_b64_tr_b16 v[190:191], v194 offset:27136
    s_waitcnt lgkmcnt(8)
    v_mfma_f32_32x32x16_bf16 v[40:55], v[172:175], a[84:87], v[40:55]
    ds_read_b64_tr_b16 v[168:169], v194 offset:28672
    v_mfma_f32_32x32x16_bf16 v[56:71], v[172:175], a[228:231], v[56:71]
    ds_read_b64_tr_b16 v[170:171], v194 offset:29184
    s_waitcnt lgkmcnt(8)
    v_mfma_f32_32x32x16_bf16 v[40:55], v[176:179], a[88:91], v[40:55]
    ds_read_b64_tr_b16 v[172:173], v194 offset:30720
    v_mfma_f32_32x32x16_bf16 v[56:71], v[176:179], a[232:235], v[56:71]
    ds_read_b64_tr_b16 v[174:175], v194 offset:31232
    s_waitcnt lgkmcnt(8)
    v_mfma_f32_32x32x16_bf16 v[40:55], v[180:183], a[92:95], v[40:55]
    ds_read_b64_tr_b16 v[176:177], v194 offset:32768
    v_mfma_f32_32x32x16_bf16 v[56:71], v[180:183], a[236:239], v[56:71]
    ds_read_b64_tr_b16 v[178:179], v194 offset:33280
    s_waitcnt lgkmcnt(8)
    v_mfma_f32_32x32x16_bf16 v[72:87], v[184:187], a[72:75], v[72:87]
    ds_read_b64_tr_b16 v[180:181], v194 offset:34816
    v_mfma_f32_32x32x16_bf16 v[88:103], v[184:187], a[216:219], v[88:103]
    ds_read_b64_tr_b16 v[182:183], v194 offset:35328
    s_waitcnt lgkmcnt(8)
    v_mfma_f32_32x32x16_bf16 v[72:87], v[188:191], a[76:79], v[72:87]
    ds_read_b64_tr_b16 v[184:185], v195 offset:24576
    v_mfma_f32_32x32x16_bf16 v[88:103], v[188:191], a[220:223], v[88:103]
    ds_read_b64_tr_b16 v[186:187], v195 offset:25088
    s_waitcnt lgkmcnt(8)
    v_mfma_f32_32x32x16_bf16 v[72:87], v[168:171], a[80:83], v[72:87]
    ds_read_b64_tr_b16 v[188:189], v195 offset:26624
    v_mfma_f32_32x32x16_bf16 v[88:103], v[168:171], a[224:227], v[88:103]
    ds_read_b64_tr_b16 v[190:191], v195 offset:27136
    s_waitcnt lgkmcnt(8)
    v_mfma_f32_32x32x16_bf16 v[72:87], v[172:175], a[84:87], v[72:87]
    ds_read_b64_tr_b16 v[168:169], v195 offset:28672
    v_mfma_f32_32x32x16_bf16 v[88:103], v[172:175], a[228:231], v[88:103]
    ds_read_b64_tr_b16 v[170:171], v195 offset:29184
    s_waitcnt lgkmcnt(8)
    v_mfma_f32_32x32x16_bf16 v[72:87], v[176:179], a[88:91], v[72:87]
    ds_read_b64_tr_b16 v[172:173], v195 offset:30720
    v_mfma_f32_32x32x16_bf16 v[88:103], v[176:179], a[232:235], v[88:103]
    ds_read_b64_tr_b16 v[174:175], v195 offset:31232
    s_waitcnt lgkmcnt(8)
    v_mfma_f32_32x32x16_bf16 v[72:87], v[180:183], a[92:95], v[72:87]
    ds_read_b64_tr_b16 v[176:177], v195 offset:32768
    v_mfma_f32_32x32x16_bf16 v[88:103], v[180:183], a[236:239], v[88:103]
    ds_read_b64_tr_b16 v[178:179], v195 offset:33280
    s_waitcnt lgkmcnt(8)
    v_mfma_f32_32x32x16_bf16 v[104:119], v[184:187], a[72:75], v[104:119]
    ds_read_b64_tr_b16 v[180:181], v195 offset:34816
    v_mfma_f32_32x32x16_bf16 v[120:135], v[184:187], a[216:219], v[120:135]
    ds_read_b64_tr_b16 v[182:183], v195 offset:35328
    s_waitcnt lgkmcnt(8)
    v_mfma_f32_32x32x16_bf16 v[104:119], v[188:191], a[76:79], v[104:119]
    v_add_u32 v192, 0xc000, v192
    v_add_u32 v193, 0xc000, v193
    v_add_u32 v194, 0xc000, v194
    v_add_u32 v195, 0xc000, v195
    v_add_u32 v196, 0xc000, v196
    ds_read_b64_tr_b16 v[184:185], v192 offset:0
    v_mfma_f32_32x32x16_bf16 v[120:135], v[188:191], a[220:223], v[120:135]
    ds_read_b64_tr_b16 v[186:187], v192 offset:512
    s_waitcnt lgkmcnt(8)
    v_mfma_f32_32x32x16_bf16 v[104:119], v[168:171], a[80:83], v[104:119]
    ds_read_b64_tr_b16 v[188:189], v192 offset:2048
    v_mfma_f32_32x32x16_bf16 v[120:135], v[168:171], a[224:227], v[120:135]
    ds_read_b64_tr_b16 v[190:191], v192 offset:2560
    s_waitcnt lgkmcnt(8)
    v_mfma_f32_32x32x16_bf16 v[104:119], v[172:175], a[84:87], v[104:119]
    ds_read_b64_tr_b16 v[168:169], v192 offset:4096
    v_mfma_f32_32x32x16_bf16 v[120:135], v[172:175], a[228:231], v[120:135]
    ds_read_b64_tr_b16 v[170:171], v192 offset:4608
    s_waitcnt lgkmcnt(8)
    v_mfma_f32_32x32x16_bf16 v[104:119], v[176:179], a[88:91], v[104:119]
    ds_read_b64_tr_b16 v[172:173], v192 offset:6144
    v_mfma_f32_32x32x16_bf16 v[120:135], v[176:179], a[232:235], v[120:135]
    ds_read_b64_tr_b16 v[174:175], v192 offset:6656
    s_waitcnt lgkmcnt(8)
    v_mfma_f32_32x32x16_bf16 v[104:119], v[180:183], a[92:95], v[104:119]
    ds_read_b64_tr_b16 v[176:177], v192 offset:8192
    v_mfma_f32_32x32x16_bf16 v[120:135], v[180:183], a[236:239], v[120:135]
    ds_read_b64_tr_b16 v[178:179], v192 offset:8704
    s_waitcnt lgkmcnt(8)
    v_mfma_f32_32x32x16_bf16 v[8:23], v[184:187], a[96:99], v[8:23]
    ds_read_b64_tr_b16 v[180:181], v192 offset:10240
    v_mfma_f32_32x32x16_bf16 v[24:39], v[184:187], a[240:243], v[24:39]
    ds_read_b64_tr_b16 v[182:183], v192 offset:10752
    s_waitcnt vmcnt(0)
    s_barrier
    s_waitcnt lgkmcnt(8)
    v_mfma_f32_32x32x16_bf16 v[8:23], v[188:191], a[100:103], v[8:23]
    ds_read_b64_tr_b16 v[184:185], v192 offset:24576
    v_mfma_f32_32x32x16_bf16 v[24:39], v[188:191], a[244:247], v[24:39]
    ds_read_b64_tr_b16 v[186:187], v192 offset:25088
    s_add_u32 s33, s29, 1769472
    s_add_u32 m0, s32, 49152
    s_nop 0
    buffer_load_dwordx4 v216, s[4:7], s33 offen lds
    s_add_u32 s33, s29, 2064384
    s_add_u32 m0, s32, 53248
    s_nop 0
    buffer_load_dwordx4 v216, s[4:7], s33 offen lds
    s_waitcnt lgkmcnt(8)
    v_mfma_f32_32x32x16_bf16 v[8:23], v[168:171], a[104:107], v[8:23]
    ds_read_b64_tr_b16 v[188:189], v192 offset:26624
    v_mfma_f32_32x32x16_bf16 v[24:39], v[168:171], a[248:251], v[24:39]
    ds_read_b64_tr_b16 v[190:191], v192 offset:27136
    s_add_u32 s33, s29, 2359296
    s_add_u32 m0, s32, 57344
    s_nop 0
    buffer_load_dwordx4 v216, s[4:7], s33 offen lds
    s_waitcnt lgkmcnt(8)
    v_mfma_f32_32x32x16_bf16 v[8:23], v[172:175], a[108:111], v[8:23]
    ds_read_b64_tr_b16 v[168:169], v192 offset:28672
    v_mfma_f32_32x32x16_bf16 v[24:39], v[172:175], a[252:255], v[24:39]
    ds_read_b64_tr_b16 v[170:171], v192 offset:29184
    s_add_u32 s33, s29, 1769472
    s_add_u32 m0, s32, 61440
    s_nop 0
    buffer_load_dwordx4 v217, s[8:11], s33 offen lds
    s_waitcnt lgkmcnt(8)
    v_mfma_f32_32x32x16_bf16 v[8:23], v[176:179], a[112:115], v[8:23]
    ds_read_b64_tr_b16 v[172:173], v192 offset:30720
    v_mfma_f32_32x32x16_bf16 v[24:39], v[176:179], v[136:139], v[24:39]
    ds_read_b64_tr_b16 v[174:175], v192 offset:31232
    s_add_u32 s33, s29, 2064384
    s_add_u32 m0, s32, 65536
    s_nop 0
    buffer_load_dwordx4 v217, s[8:11], s33 offen lds
    s_waitcnt lgkmcnt(8)
    v_mfma_f32_32x32x16_bf16 v[8:23], v[180:183], a[116:119], v[8:23]
    ds_read_b64_tr_b16 v[176:177], v192 offset:32768
    v_mfma_f32_32x32x16_bf16 v[24:39], v[180:183], v[140:143], v[24:39]
    ds_read_b64_tr_b16 v[178:179], v192 offset:33280
    s_add_u32 s33, s29, 2359296
    s_add_u32 m0, s32, 69632
    s_nop 0
    buffer_load_dwordx4 v217, s[8:11], s33 offen lds
    s_waitcnt lgkmcnt(8)
    v_mfma_f32_32x32x16_bf16 v[8:23], v[184:187], a[120:123], v[8:23]
    ds_read_b64_tr_b16 v[180:181], v192 offset:34816
    v_mfma_f32_32x32x16_bf16 v[24:39], v[184:187], v[144:147], v[24:39]
    ds_read_b64_tr_b16 v[182:183], v192 offset:35328
    s_waitcnt lgkmcnt(8)
    v_mfma_f32_32x32x16_bf16 v[8:23], v[188:191], a[124:127], v[8:23]
    ds_read_b64_tr_b16 v[184:185], v230 offset:1024
    v_mfma_f32_32x32x16_bf16 v[24:39], v[188:191], v[148:151], v[24:39]
    ds_read_b64_tr_b16 v[186:187], v230 offset:1024
    s_add_u32 s33, s29, 2654208
    s_add_u32 m0, s32, 73728
    s_nop 0
    buffer_load_dwordx4 v216, s[4:7], s33 offen lds
    s_waitcnt lgkmcnt(8)
    v_mfma_f32_32x32x16_bf16 v[8:23], v[168:171], a[128:131], v[8:23]
    ds_read_b64_tr_b16 v[188:189], v193 offset:0
    v_mfma_f32_32x32x16_bf16 v[24:39], v[168:171], v[152:155], v[24:39]
    ds_read_b64_tr_b16 v[190:191], v193 offset:512
    s_add_u32 s33, s29, 2949120
    s_add_u32 m0, s32, 77824
    s_nop 0
    buffer_load_dwordx4 v216, s[4:7], s33 offen lds
    s_waitcnt lgkmcnt(8)
    v_mfma_f32_32x32x16_bf16 v[8:23], v[172:175], a[132:135], v[8:23]
    ds_read_b64_tr_b16 v[168:169], v193 offset:2048
    v_mfma_f32_32x32x16_bf16 v[24:39], v[172:175], v[156:159], v[24:39]
    ds_read_b64_tr_b16 v[170:171], v193 offset:2560
    s_add_u32 s33, s29, 3244032
    s_add_u32 m0, s32, 81920
    s_nop 0
    buffer_load_dwordx4 v216, s[4:7], s33 offen lds
    s_waitcnt lgkmcnt(8)
    v_mfma_f32_32x32x16_bf16 v[8:23], v[176:179], a[136:139], v[8:23]
    ds_read_b64_tr_b16 v[172:173], v193 offset:4096
    v_mfma_f32_32x32x16_bf16 v[24:39], v[176:179], v[160:163], v[24:39]
    ds_read_b64_tr_b16 v[174:175], v193 offset:4608
    s_add_u32 s33, s29, 2654208
    s_add_u32 m0, s32, 86016
    s_nop 0
    buffer_load_dwordx4 v217, s[8:11], s33 offen lds
    s_waitcnt lgkmcnt(8)
    v_mfma_f32_32x32x16_bf16 v[8:23], v[180:183], a[140:143], v[8:23]
    ds_read_b64_tr_b16 v[176:177], v193 offset:6144
    v_mfma_f32_32x32x16_bf16 v[24:39], v[180:183], v[164:167], v[24:39]
    ds_read_b64_tr_b16 v[178:179], v193 offset:6656
    s_waitcnt lgkmcnt(8)
    v_mfma_f32_32x32x16_bf16 v[8:23], v[184:187], v[220:223], v[8:23]
    ds_read_b64_tr_b16 v[180:181], v193 offset:8192
    v_mfma_f32_32x32x16_bf16 v[24:39], v[184:187], v[224:227], v[24:39]
    ds_read_b64_tr_b16 v[182:183], v193 offset:8704
    s_add_u32 s33, s29, 2949120
    s_add_u32 m0, s32, 90112
    s_nop 0
    buffer_load_dwordx4 v217, s[8:11], s33 offen lds
    s_waitcnt lgkmcnt(8)
    v_mfma_f32_32x32x16_bf16 v[40:55], v[188:191], a[96:99], v[40:55]
    ds_read_b64_tr_b16 v[184:185], v193 offset:10240
    v_mfma_f32_32x32x16_bf16 v[56:71], v[188:191], a[240:243], v[56:71]
    ds_read_b64_tr_b16 v[186:187], v193 offset:10752
    s_add_u32 s33, s29, 3244032
    s_add_u32 m0, s32, 94208
    s_nop 0
    buffer_load_dwordx4 v217, s[8:11], s33 offen lds
    s_waitcnt lgkmcnt(8)
    v_mfma_f32_32x32x16_bf16 v[40:55], v[168:171], a[100:103], v[40:55]
    ds_read_b64_tr_b16 v[188:189], v193 offset:24576
    v_mul_f32 v200, v228, v8
    v_mul_f32 v201, v228, v9
    v_mul_f32 v202, v228, v10
    v_mfma_f32_32x32x16_bf16 v[56:71], v[168:171], a[244:247], v[56:71]
    ds_read_b64_tr_b16 v[190:191], v193 offset:25088
    v_mul_f32 v203, v228, v11
    v_exp_f32 v200, v200
    s_waitcnt lgkmcnt(8)
    v_mfma_f32_32x32x16_bf16 v[40:55], v[172:175], a[104:107], v[40:55]
    ds_read_b64_tr_b16 v[168:169], v193 offset:26624
    v_exp_f32 v201, v201
    v_exp_f32 v202, v202
    v_mfma_f32_32x32x16_bf16 v[56:71], v[172:175], a[248:251], v[56:71]
    ds_read_b64_tr_b16 v[170:171], v193 offset:27136
    v_exp_f32 v203, v203
    v_mul_f32 v8, v8, v16
    s_waitcnt lgkmcnt(8)
    v_mfma_f32_32x32x16_bf16 v[40:55], v[176:179], a[108:111], v[40:55]
    ds_read_b64_tr_b16 v[172:173], v193 offset:28672
    v_mul_f32 v9, v9, v17
    v_mul_f32 v10, v10, v18
    v_mul_f32 v11, v11, v19
    v_mfma_f32_32x32x16_bf16 v[56:71], v[176:179], a[252:255], v[56:71]
    ds_read_b64_tr_b16 v[174:175], v193 offset:29184
    v_add_f32 v200, 1.0, v200
    v_add_f32 v201, 1.0, v201
    v_add_f32 v202, 1.0, v202
    s_waitcnt lgkmcnt(8)
    v_mfma_f32_32x32x16_bf16 v[40:55], v[180:183], a[112:115], v[40:55]
    ds_read_b64_tr_b16 v[176:177], v193 offset:30720
    v_add_f32 v203, 1.0, v203
    v_rcp_f32 v200, v200
    v_mfma_f32_32x32x16_bf16 v[56:71], v[180:183], v[136:139], v[56:71]
    ds_read_b64_tr_b16 v[178:179], v193 offset:31232
    v_rcp_f32 v201, v201
    v_rcp_f32 v202, v202
    s_waitcnt lgkmcnt(8)
    v_mfma_f32_32x32x16_bf16 v[40:55], v[184:187], a[116:119], v[40:55]
    ds_read_b64_tr_b16 v[180:181], v193 offset:32768
    v_rcp_f32 v203, v203
    v_mul_f32 v8, v8, v200
    v_mfma_f32_32x32x16_bf16 v[56:71], v[184:187], v[140:143], v[56:71]
    ds_read_b64_tr_b16 v[182:183], v193 offset:33280
    v_mul_f32 v9, v9, v201
    v_mul_f32 v10, v10, v202
    v_mul_f32 v11, v11, v203
    s_waitcnt lgkmcnt(8)
    v_mfma_f32_32x32x16_bf16 v[40:55], v[188:191], a[120:123], v[40:55]
    ds_read_b64_tr_b16 v[184:185], v193 offset:34816
    v_cvt_pk_bf16_f32 v204, v8, v9
    v_cvt_pk_bf16_f32 v205, v10, v11
    v_mul_f32 v200, v228, v12
    v_mfma_f32_32x32x16_bf16 v[56:71], v[188:191], v[144:147], v[56:71]
    ds_read_b64_tr_b16 v[186:187], v193 offset:35328
    v_mul_f32 v201, v228, v13
    v_mul_f32 v202, v228, v14
    v_mul_f32 v203, v228, v15
    s_waitcnt lgkmcnt(8)
    v_mfma_f32_32x32x16_bf16 v[40:55], v[168:171], a[124:127], v[40:55]
    ds_read_b64_tr_b16 v[188:189], v230 offset:1056
    v_exp_f32 v200, v200
    v_exp_f32 v201, v201
    v_mfma_f32_32x32x16_bf16 v[56:71], v[168:171], v[148:151], v[56:71]
    ds_read_b64_tr_b16 v[190:191], v230 offset:1056
    v_exp_f32 v202, v202
    v_exp_f32 v203, v203
    s_waitcnt lgkmcnt(8)
    v_mfma_f32_32x32x16_bf16 v[40:55], v[172:175], a[128:131], v[40:55]
    ds_read_b64_tr_b16 v[168:169], v194 offset:0
    v_mul_f32 v12, v12, v20
    v_mul_f32 v13, v13, v21
    v_mul_f32 v14, v14, v22
    v_mfma_f32_32x32x16_bf16 v[56:71], v[172:175], v[152:155], v[56:71]
    ds_read_b64_tr_b16 v[170:171], v194 offset:512
    v_mul_f32 v15, v15, v23
    v_add_f32 v200, 1.0, v200
    v_add_f32 v201, 1.0, v201
    s_waitcnt lgkmcnt(8)
    v_mfma_f32_32x32x16_bf16 v[40:55], v[176:179], a[132:135], v[40:55]
    ds_read_b64_tr_b16 v[172:173], v194 offset:2048
    v_add_f32 v202, 1.0, v202
    v_add_f32 v203, 1.0, v203
    v_rcp_f32 v200, v200
    v_mfma_f32_32x32x16_bf16 v[56:71], v[176:179], v[156:159], v[56:71]
    ds_read_b64_tr_b16 v[174:175], v194 offset:2560
    v_rcp_f32 v201, v201
    v_rcp_f32 v202, v202
    s_waitcnt lgkmcnt(8)
    v_mfma_f32_32x32x16_bf16 v[40:55], v[180:183], a[136:139], v[40:55]
    ds_read_b64_tr_b16 v[176:177], v194 offset:4096
    v_rcp_f32 v203, v203
    v_mul_f32 v12, v12, v200
    v_mfma_f32_32x32x16_bf16 v[56:71], v[180:183], v[160:163], v[56:71]
    ds_read_b64_tr_b16 v[178:179], v194 offset:4608
    v_mul_f32 v13, v13, v201
    v_mul_f32 v14, v14, v202
    v_mul_f32 v15, v15, v203
    s_waitcnt lgkmcnt(8)
    v_mfma_f32_32x32x16_bf16 v[40:55], v[184:187], a[140:143], v[40:55]
    ds_read_b64_tr_b16 v[180:181], v194 offset:6144
    v_cvt_pk_bf16_f32 v206, v12, v13
    v_cvt_pk_bf16_f32 v207, v14, v15
    s_add_u32 s33, s35, 262144
    buffer_store_dwordx4 v[204:207], v218, s[44:47], s33 offen sc1
    v_mfma_f32_32x32x16_bf16 v[56:71], v[184:187], v[164:167], v[56:71]
    ds_read_b64_tr_b16 v[182:183], v194 offset:6656
    v_mul_f32 v208, v229, v24
    v_mul_f32 v209, v229, v25
    v_mul_f32 v210, v229, v26
    s_waitcnt lgkmcnt(8)
    v_mfma_f32_32x32x16_bf16 v[40:55], v[188:191], v[220:223], v[40:55]
    ds_read_b64_tr_b16 v[184:185], v194 offset:8192
    v_mul_f32 v211, v229, v27
    v_exp_f32 v208, v208
    v_mfma_f32_32x32x16_bf16 v[56:71], v[188:191], v[224:227], v[56:71]
    ds_read_b64_tr_b16 v[186:187], v194 offset:8704
    v_exp_f32 v209, v209
    v_exp_f32 v210, v210
    s_waitcnt lgkmcnt(8)
    v_mfma_f32_32x32x16_bf16 v[72:87], v[168:171], a[96:99], v[72:87]
    ds_read_b64_tr_b16 v[188:189], v194 offset:10240
    v_exp_f32 v211, v211
    v_mul_f32 v24, v24, v32
    v_mfma_f32_32x32x16_bf16 v[88:103], v[168:171], a[240:243], v[88:103]
    ds_read_b64_tr_b16 v[190:191], v194 offset:10752
    v_mul_f32 v25, v25, v33
    v_mul_f32 v26, v26, v34
    v_mul_f32 v27, v27, v35
    s_waitcnt lgkmcnt(8)
    v_mfma_f32_32x32x16_bf16 v[72:87], v[172:175], a[100:103], v[72:87]
    ds_read_b64_tr_b16 v[168:169], v194 offset:24576
    v_add_f32 v208, 1.0, v208
    v_add_f32 v209, 1.0, v209
    v_add_f32 v210, 1.0, v210
    v_mfma_f32_32x32x16_bf16 v[88:103], v[172:175], a[244:247], v[88:103]
    ds_read_b64_tr_b16 v[170:171], v194 offset:25088
    v_add_f32 v211, 1.0, v211
    v_rcp_f32 v208, v208
    s_waitcnt lgkmcnt(8)
    v_mfma_f32_32x32x16_bf16 v[72:87], v[176:179], a[104:107], v[72:87]
    ds_read_b64_tr_b16 v[172:173], v194 offset:26624
    v_rcp_f32 v209, v209
    v_rcp_f32 v210, v210
    v_mfma_f32_32x32x16_bf16 v[88:103], v[176:179], a[248:251], v[88:103]
    ds_read_b64_tr_b16 v[174:175], v194 offset:27136
    v_rcp_f32 v211, v211
    v_mul_f32 v24, v24, v208
    s_waitcnt lgkmcnt(8)
    v_mfma_f32_32x32x16_bf16 v[72:87], v[180:183], a[108:111], v[72:87]
    ds_read_b64_tr_b16 v[176:177], v194 offset:28672
    v_mul_f32 v25, v25, v209
    v_mul_f32 v26, v26, v210
    v_mul_f32 v27, v27, v211
    v_mfma_f32_32x32x16_bf16 v[88:103], v[180:183], a[252:255], v[88:103]
    ds_read_b64_tr_b16 v[178:179], v194 offset:29184
    v_cvt_pk_bf16_f32 v212, v24, v25
    v_cvt_pk_bf16_f32 v213, v26, v27
    v_mul_f32 v208, v229, v28
    s_waitcnt lgkmcnt(8)
    v_mfma_f32_32x32x16_bf16 v[72:87], v[184:187], a[112:115], v[72:87]
    ds_read_b64_tr_b16 v[180:181], v194 offset:30720
    v_mul_f32 v209, v229, v29
    v_mul_f32 v210, v229, v30
    v_mul_f32 v211, v229, v31
    v_mfma_f32_32x32x16_bf16 v[88:103], v[184:187], v[136:139], v[88:103]
    ds_read_b64_tr_b16 v[182:183], v194 offset:31232
    v_exp_f32 v208, v208
    v_exp_f32 v209, v209
    s_waitcnt lgkmcnt(8)
    v_mfma_f32_32x32x16_bf16 v[72:87], v[188:191], a[116:119], v[72:87]
    ds_read_b64_tr_b16 v[184:185], v194 offset:32768
    v_exp_f32 v210, v210
    v_exp_f32 v211, v211
    v_mfma_f32_32x32x16_bf16 v[88:103], v[188:191], v[140:143], v[88:103]
    ds_read_b64_tr_b16 v[186:187], v194 offset:33280
    v_mul_f32 v28, v28, v36
    v_mul_f32 v29, v29, v37
    v_mul_f32 v30, v30, v38
    s_waitcnt lgkmcnt(8)
    v_mfma_f32_32x32x16_bf16 v[72:87], v[168:171], a[120:123], v[72:87]
    ds_read_b64_tr_b16 v[188:189], v194 offset:34816
    v_mul_f32 v31, v31, v39
    v_add_f32 v208, 1.0, v208
    v_add_f32 v209, 1.0, v209
    v_mfma_f32_32x32x16_bf16 v[88:103], v[168:171], v[144:147], v[88:103]
    ds_read_b64_tr_b16 v[190:191], v194 offset:35328
    v_add_f32 v210, 1.0, v210
    v_add_f32 v211, 1.0, v211
    v_rcp_f32 v208, v208
    s_waitcnt lgkmcnt(8)
    v_mfma_f32_32x32x16_bf16 v[72:87], v[172:175], a[124:127], v[72:87]
    ds_read_b64_tr_b16 v[168:169], v230 offset:1088
    v_rcp_f32 v209, v209
    v_rcp_f32 v210, v210
    v_mfma_f32_32x32x16_bf16 v[88:103], v[172:175], v[148:151], v[88:103]
    ds_read_b64_tr_b16 v[170:171], v230 offset:1088
    v_rcp_f32 v211, v211
    v_mul_f32 v28, v28, v208
    s_waitcnt lgkmcnt(8)
    v_mfma_f32_32x32x16_bf16 v[72:87], v[176:179], a[128:131], v[72:87]
    ds_read_b64_tr_b16 v[172:173], v195 offset:0
    v_mul_f32 v29, v29, v209
    v_mul_f32 v30, v30, v210
    v_mul_f32 v31, v31, v211
    v_mfma_f32_32x32x16_bf16 v[88:103], v[176:179], v[152:155], v[88:103]
    ds_read_b64_tr_b16 v[174:175], v195 offset:512
    v_cvt_pk_bf16_f32 v214, v28, v29
    v_cvt_pk_bf16_f32 v215, v30, v31
    s_add_u32 s33, s35, 263168
    buffer_store_dwordx4 v[212:215], v218, s[44:47], s33 offen sc1
    s_waitcnt lgkmcnt(8)
    v_mfma_f32_32x32x16_bf16 v[72:87], v[180:183], a[132:135], v[72:87]
    ds_read_b64_tr_b16 v[176:177], v195 offset:2048
    v_mul_f32 v200, v228, v40
    v_mul_f32 v201, v228, v41
    v_mul_f32 v202, v228, v42
    v_mfma_f32_32x32x16_bf16 v[88:103], v[180:183], v[156:159], v[88:103]
    ds_read_b64_tr_b16 v[178:179], v195 offset:2560
    v_mul_f32 v203, v228, v43
    v_exp_f32 v200, v200
    s_waitcnt lgkmcnt(8)
    v_mfma_f32_32x32x16_bf16 v[72:87], v[184:187], a[136:139], v[72:87]
    ds_read_b64_tr_b16 v[180:181], v195 offset:4096
    v_exp_f32 v201, v201
    v_exp_f32 v202, v202
    v_mfma_f32_32x32x16_bf16 v[88:103], v[184:187], v[160:163], v[88:103]
    ds_read_b64_tr_b16 v[182:183], v195 offset:4608
    v_exp_f32 v203, v203
    v_mul_f32 v40, v40, v48
    s_waitcnt lgkmcnt(8)
    v_mfma_f32_32x32x16_bf16 v[72:87], v[188:191], a[140:143], v[72:87]
    ds_read_b64_tr_b16 v[184:185], v195 offset:6144
    v_mul_f32 v41, v41, v49
    v_mul_f32 v42, v42, v50
    v_mul_f32 v43, v43, v51
    v_mfma_f32_32x32x16_bf16 v[88:103], v[188:191], v[164:167], v[88:103]
    ds_read_b64_tr_b16 v[186:187], v195 offset:6656
    v_add_f32 v200, 1.0, v200
    v_add_f32 v201, 1.0, v201
    v_add_f32 v202, 1.0, v202
    s_waitcnt lgkmcnt(8)
    v_mfma_f32_32x32x16_bf16 v[72:87], v[168:171], v[220:223], v[72:87]
    ds_read_b64_tr_b16 v[188:189], v195 offset:8192
    v_add_f32 v203, 1.0, v203
    v_rcp_f32 v200, v200
    v_mfma_f32_32x32x16_bf16 v[88:103], v[168:171], v[224:227], v[88:103]
    ds_read_b64_tr_b16 v[190:191], v195 offset:8704
    v_rcp_f32 v201, v201
    v_rcp_f32 v202, v202
    s_waitcnt lgkmcnt(8)
    v_mfma_f32_32x32x16_bf16 v[104:119], v[172:175], a[96:99], v[104:119]
    ds_read_b64_tr_b16 v[168:169], v195 offset:10240
    v_rcp_f32 v203, v203
    v_mul_f32 v40, v40, v200
    v_mfma_f32_32x32x16_bf16 v[120:135], v[172:175], a[240:243], v[120:135]
    ds_read_b64_tr_b16 v[170:171], v195 offset:10752
    v_mul_f32 v41, v41, v201
    v_mul_f32 v42, v42, v202
    v_mul_f32 v43, v43, v203
    s_waitcnt lgkmcnt(8)
    v_mfma_f32_32x32x16_bf16 v[104:119], v[176:179], a[100:103], v[104:119]
    ds_read_b64_tr_b16 v[172:173], v195 offset:24576
    v_cvt_pk_bf16_f32 v204, v40, v41
    v_cvt_pk_bf16_f32 v205, v42, v43
    v_mul_f32 v200, v228, v44
    v_mfma_f32_32x32x16_bf16 v[120:135], v[176:179], a[244:247], v[120:135]
    ds_read_b64_tr_b16 v[174:175], v195 offset:25088
    v_mul_f32 v201, v228, v45
    v_mul_f32 v202, v228, v46
    v_mul_f32 v203, v228, v47
    s_waitcnt lgkmcnt(8)
    v_mfma_f32_32x32x16_bf16 v[104:119], v[180:183], a[104:107], v[104:119]
    ds_read_b64_tr_b16 v[176:177], v195 offset:26624
    v_exp_f32 v200, v200
    v_exp_f32 v201, v201
    v_mfma_f32_32x32x16_bf16 v[120:135], v[180:183], a[248:251], v[120:135]
    ds_read_b64_tr_b16 v[178:179], v195 offset:27136
    v_exp_f32 v202, v202
    v_exp_f32 v203, v203
    s_waitcnt lgkmcnt(8)
    v_mfma_f32_32x32x16_bf16 v[104:119], v[184:187], a[108:111], v[104:119]
    ds_read_b64_tr_b16 v[180:181], v195 offset:28672
    v_mul_f32 v44, v44, v52
    v_mul_f32 v45, v45, v53
    v_mul_f32 v46, v46, v54
    v_mfma_f32_32x32x16_bf16 v[120:135], v[184:187], a[252:255], v[120:135]
    ds_read_b64_tr_b16 v[182:183], v195 offset:29184
    v_mul_f32 v47, v47, v55
    v_add_f32 v200, 1.0, v200
    v_add_f32 v201, 1.0, v201
    s_waitcnt lgkmcnt(8)
    v_mfma_f32_32x32x16_bf16 v[104:119], v[188:191], a[112:115], v[104:119]
    ds_read_b64_tr_b16 v[184:185], v195 offset:30720
    v_add_f32 v202, 1.0, v202
    v_add_f32 v203, 1.0, v203
    v_rcp_f32 v200, v200
    v_mfma_f32_32x32x16_bf16 v[120:135], v[188:191], v[136:139], v[120:135]
    ds_read_b64_tr_b16 v[186:187], v195 offset:31232
    v_rcp_f32 v201, v201
    v_rcp_f32 v202, v202
    s_waitcnt lgkmcnt(8)
    v_mfma_f32_32x32x16_bf16 v[104:119], v[168:171], a[116:119], v[104:119]
    ds_read_b64_tr_b16 v[188:189], v195 offset:32768
    v_rcp_f32 v203, v203
    v_mul_f32 v44, v44, v200
    v_mfma_f32_32x32x16_bf16 v[120:135], v[168:171], v[140:143], v[120:135]
    ds_read_b64_tr_b16 v[190:191], v195 offset:33280
    v_mul_f32 v45, v45, v201
    v_mul_f32 v46, v46, v202
    v_mul_f32 v47, v47, v203
    s_waitcnt lgkmcnt(8)
    v_mfma_f32_32x32x16_bf16 v[104:119], v[172:175], a[120:123], v[104:119]
    ds_read_b64_tr_b16 v[168:169], v195 offset:34816
    v_cvt_pk_bf16_f32 v206, v44, v45
    v_cvt_pk_bf16_f32 v207, v46, v47
    s_add_u32 s33, s35, 327680
    buffer_store_dwordx4 v[204:207], v218, s[44:47], s33 offen sc1
    v_mfma_f32_32x32x16_bf16 v[120:135], v[172:175], v[144:147], v[120:135]
    ds_read_b64_tr_b16 v[170:171], v195 offset:35328
    v_mul_f32 v208, v229, v56
    v_mul_f32 v209, v229, v57
    v_mul_f32 v210, v229, v58
    s_waitcnt lgkmcnt(8)
    v_mfma_f32_32x32x16_bf16 v[104:119], v[176:179], a[124:127], v[104:119]
    ds_read_b64_tr_b16 v[172:173], v230 offset:1120
    v_mul_f32 v211, v229, v59
    v_exp_f32 v208, v208
    v_mfma_f32_32x32x16_bf16 v[120:135], v[176:179], v[148:151], v[120:135]
    ds_read_b64_tr_b16 v[174:175], v230 offset:1120
    v_exp_f32 v209, v209
    v_exp_f32 v210, v210
    s_waitcnt lgkmcnt(8)
    v_mfma_f32_32x32x16_bf16 v[104:119], v[180:183], a[128:131], v[104:119]
    v_add_u32 v196, 0xfffe8000, v196
    ds_read_b64_tr_b16 v[176:177], v196 offset:0
    v_exp_f32 v211, v211
    v_mul_f32 v56, v56, v64
    v_mfma_f32_32x32x16_bf16 v[120:135], v[180:183], v[152:155], v[120:135]
    ds_read_b64_tr_b16 v[178:179], v196 offset:512
    v_mul_f32 v57, v57, v65
    v_mul_f32 v58, v58, v66
    v_mul_f32 v59, v59, v67
    s_waitcnt lgkmcnt(8)
    v_mfma_f32_32x32x16_bf16 v[104:119], v[184:187], a[132:135], v[104:119]
    ds_read_b64_tr_b16 v[180:181], v196 offset:2048
    v_add_f32 v208, 1.0, v208
    v_add_f32 v209, 1.0, v209
    v_add_f32 v210, 1.0, v210
    v_mfma_f32_32x32x16_bf16 v[120:135], v[184:187], v[156:159], v[120:135]
    ds_read_b64_tr_b16 v[182:183], v196 offset:2560
    v_add_f32 v211, 1.0, v211
    v_rcp_f32 v208, v208
    s_waitcnt lgkmcnt(8)
    v_mfma_f32_32x32x16_bf16 v[104:119], v[188:191], a[136:139], v[104:119]
    ds_read_b64_tr_b16 v[184:185], v196 offset:4096
    v_rcp_f32 v209, v209
    v_rcp_f32 v210, v210
    v_mfma_f32_32x32x16_bf16 v[120:135], v[188:191], v[160:163], v[120:135]
    ds_read_b64_tr_b16 v[186:187], v196 offset:4608
    v_rcp_f32 v211, v211
    v_mul_f32 v56, v56, v208
    s_waitcnt lgkmcnt(8)
    v_mfma_f32_32x32x16_bf16 v[104:119], v[168:171], a[140:143], v[104:119]
    ds_read_b64_tr_b16 v[188:189], v196 offset:6144
    v_mul_f32 v57, v57, v209
    v_mul_f32 v58, v58, v210
    v_mul_f32 v59, v59, v211
    v_mfma_f32_32x32x16_bf16 v[120:135], v[168:171], v[164:167], v[120:135]
    ds_read_b64_tr_b16 v[190:191], v196 offset:6656
    v_cvt_pk_bf16_f32 v212, v56, v57
    v_cvt_pk_bf16_f32 v213, v58, v59
    v_mul_f32 v208, v229, v60
    s_waitcnt lgkmcnt(8)
    v_mfma_f32_32x32x16_bf16 v[104:119], v[172:175], v[220:223], v[104:119]
    ds_read_b64_tr_b16 v[168:169], v196 offset:8192
    v_mul_f32 v209, v229, v61
    v_mul_f32 v210, v229, v62
    v_mul_f32 v211, v229, v63
    v_mfma_f32_32x32x16_bf16 v[120:135], v[172:175], v[224:227], v[120:135]
    ds_read_b64_tr_b16 v[170:171], v196 offset:8704
    v_exp_f32 v208, v208
    v_exp_f32 v209, v209
    s_waitcnt lgkmcnt(8)
    v_mfma_f32_32x32x16_bf16 v[8:23], v[176:179], a[0:3], 0
    ds_read_b64_tr_b16 v[172:173], v196 offset:10240
    v_exp_f32 v210, v210
    v_exp_f32 v211, v211
    v_mfma_f32_32x32x16_bf16 v[24:39], v[176:179], a[144:147], 0
    ds_read_b64_tr_b16 v[174:175], v196 offset:10752
    v_mul_f32 v60, v60, v68
    v_mul_f32 v61, v61, v69
    v_mul_f32 v62, v62, v70
    s_waitcnt vmcnt(3)
    s_barrier
    s_waitcnt lgkmcnt(8)
    v_mfma_f32_32x32x16_bf16 v[8:23], v[180:183], a[4:7], v[8:23]
    ds_read_b64_tr_b16 v[176:177], v196 offset:24576
    v_mul_f32 v63, v63, v71
    v_add_f32 v208, 1.0, v208
    v_add_f32 v209, 1.0, v209
    v_mfma_f32_32x32x16_bf16 v[24:39], v[180:183], a[148:151], v[24:39]
    ds_read_b64_tr_b16 v[178:179], v196 offset:25088
    v_add_f32 v210, 1.0, v210
    v_add_f32 v211, 1.0, v211
    v_rcp_f32 v208, v208
    s_add_u32 s33, s29, 3538944
    s_add_u32 m0, s32, 98304
    s_nop 0
    buffer_load_dwordx4 v216, s[4:7], s33 offen lds
    s_add_u32 s33, s29, 3833856
    s_add_u32 m0, s32, 102400
    s_nop 0
    buffer_load_dwordx4 v216, s[4:7], s33 offen lds
    s_waitcnt lgkmcnt(8)
    v_mfma_f32_32x32x16_bf16 v[8:23], v[184:187], a[8:11], v[8:23]
    ds_read_b64_tr_b16 v[180:181], v196 offset:26624
    v_rcp_f32 v209, v209
    v_rcp_f32 v210, v210
    v_mfma_f32_32x32x16_bf16 v[24:39], v[184:187], a[152:155], v[24:39]
    ds_read_b64_tr_b16 v[182:183], v196 offset:27136
    v_rcp_f32 v211, v211
    v_mul_f32 v60, v60, v208
    s_add_u32 s33, s29, 4128768
    s_add_u32 m0, s32, 106496
    s_nop 0
    buffer_load_dwordx4 v216, s[4:7], s33 offen lds
    s_waitcnt lgkmcnt(8)
    v_mfma_f32_32x32x16_bf16 v[8:23], v[188:191], a[12:15], v[8:23]
    ds_read_b64_tr_b16 v[184:185], v196 offset:28672
    v_mul_f32 v61, v61, v209
    v_mul_f32 v62, v62, v210
    v_mul_f32 v63, v63, v211
    v_mfma_f32_32x32x16_bf16 v[24:39], v[188:191], a[156:159], v[24:39]
    ds_read_b64_tr_b16 v[186:187], v196 offset:29184
    v_cvt_pk_bf16_f32 v214, v60, v61
    v_cvt_pk_bf16_f32 v215, v62, v63
    s_add_u32 s33, s35, 328704
    buffer_store_dwordx4 v[212:215], v218, s[44:47], s33 offen sc1
    s_add_u32 s33, s29, 3538944
    s_add_u32 m0, s32, 110592
    s_nop 0
    buffer_load_dwordx4 v217, s[8:11], s33 offen lds
    s_waitcnt lgkmcnt(8)
    v_mfma_f32_32x32x16_bf16 v[8:23], v[168:171], a[16:19], v[8:23]
    ds_read_b64_tr_b16 v[188:189], v196 offset:30720
    v_mul_f32 v200, v228, v72
    v_mul_f32 v201, v228, v73
    v_mul_f32 v202, v228, v74
    v_mfma_f32_32x32x16_bf16 v[24:39], v[168:171], a[160:163], v[24:39]
    ds_read_b64_tr_b16 v[190:191], v196 offset:31232
    v_mul_f32 v203, v228, v75
    v_exp_f32 v200, v200
    s_add_u32 s33, s29, 3833856
    s_add_u32 m0, s32, 114688
    s_nop 0
    buffer_load_dwordx4 v217, s[8:11], s33 offen lds
    s_waitcnt lgkmcnt(8)
    v_mfma_f32_32x32x16_bf16 v[8:23], v[172:175], a[20:23], v[8:23]
    ds_read_b64_tr_b16 v[168:169], v196 offset:32768
    v_exp_f32 v201, v201
    v_exp_f32 v202, v202
    v_mfma_f32_32x32x16_bf16 v[24:39], v[172:175], a[164:167], v[24:39]
    ds_read_b64_tr_b16 v[170:171], v196 offset:33280
    v_exp_f32 v203, v203
    v_mul_f32 v72, v72, v80
    s_add_u32 s33, s29, 4128768
    s_add_u32 m0, s32, 118784
    s_nop 0
    buffer_load_dwordx4 v217, s[8:11], s33 offen lds
    s_waitcnt lgkmcnt(8)
    v_mfma_f32_32x32x16_bf16 v[8:23], v[176:179], a[24:27], v[8:23]
    ds_read_b64_tr_b16 v[172:173], v196 offset:34816
    v_mul_f32 v73, v73, v81
    v_mul_f32 v74, v74, v82
    v_mul_f32 v75, v75, v83
    v_mfma_f32_32x32x16_bf16 v[24:39], v[176:179], a[168:171], v[24:39]
    ds_read_b64_tr_b16 v[174:175], v196 offset:35328
    v_add_f32 v200, 1.0, v200
    v_add_f32 v201, 1.0, v201
    v_add_f32 v202, 1.0, v202
    s_waitcnt lgkmcnt(8)
    v_mfma_f32_32x32x16_bf16 v[8:23], v[180:183], a[28:31], v[8:23]
    v_add_u32 v196, 0xc000, v196
    ds_read_b64_tr_b16 v[176:177], v196 offset:0
    v_add_f32 v203, 1.0, v203
    v_rcp_f32 v200, v200
    v_mfma_f32_32x32x16_bf16 v[24:39], v[180:183], a[172:175], v[24:39]
    ds_read_b64_tr_b16 v[178:179], v196 offset:512
    v_rcp_f32 v201, v201
    v_rcp_f32 v202, v202
    s_add_u32 s33, s29, 4423680
    s_add_u32 m0, s32, 122880
    s_nop 0
    buffer_load_dwordx4 v216, s[4:7], s33 offen lds
    s_waitcnt lgkmcnt(8)
    v_mfma_f32_32x32x16_bf16 v[8:23], v[184:187], a[32:35], v[8:23]
    ds_read_b64_tr_b16 v[180:181], v196 offset:2048
    v_rcp_f32 v203, v203
    v_mul_f32 v72, v72, v200
    v_mfma_f32_32x32x16_bf16 v[24:39], v[184:187], a[176:179], v[24:39]
    ds_read_b64_tr_b16 v[182:183], v196 offset:2560
    v_mul_f32 v73, v73, v201
    v_mul_f32 v74, v74, v202
    v_mul_f32 v75, v75, v203
    s_add_u32 s33, s29, 4718592
    s_add_u32 m0, s32, 126976
    s_nop 0
    buffer_load_dwordx4 v216, s[4:7], s33 offen lds
    s_waitcnt lgkmcnt(8)
    v_mfma_f32_32x32x16_bf16 v[8:23], v[188:191], a[36:39], v[8:23]
    ds_read_b64_tr_b16 v[184:185], v196 offset:4096
    v_cvt_pk_bf16_f32 v204, v72, v73
    v_cvt_pk_bf16_f32 v205, v74, v75
    v_mul_f32 v200, v228, v76
    v_mfma_f32_32x32x16_bf16 v[24:39], v[188:191], a[180:183], v[24:39]
    ds_read_b64_tr_b16 v[186:187], v196 offset:4608
    v_mul_f32 v201, v228, v77
    v_mul_f32 v202, v228, v78
    v_mul_f32 v203, v228, v79
    s_add_u32 s33, s29, 5013504
    s_add_u32 m0, s32, 131072
    s_nop 0
    buffer_load_dwordx4 v216, s[4:7], s33 offen lds
    s_waitcnt lgkmcnt(8)
    v_mfma_f32_32x32x16_bf16 v[8:23], v[168:171], a[40:43], v[8:23]
    ds_read_b64_tr_b16 v[188:189], v196 offset:6144
    v_exp_f32 v200, v200
    v_exp_f32 v201, v201
    v_mfma_f32_32x32x16_bf16 v[24:39], v[168:171], a[184:187], v[24:39]
    ds_read_b64_tr_b16 v[190:191], v196 offset:6656
    v_exp_f32 v202, v202
    v_exp_f32 v203, v203
    s_add_u32 s33, s29, 4423680
    s_add_u32 m0, s32, 135168
    s_nop 0
    buffer_load_dwordx4 v217, s[8:11], s33 offen lds
    s_waitcnt lgkmcnt(8)
    v_mfma_f32_32x32x16_bf16 v[8:23], v[172:175], a[44:47], v[8:23]
    ds_read_b64_tr_b16 v[168:169], v196 offset:8192
    v_mul_f32 v76, v76, v84
    v_mul_f32 v77, v77, v85
    v_mul_f32 v78, v78, v86
    v_mfma_f32_32x32x16_bf16 v[24:39], v[172:175], a[188:191], v[24:39]
    ds_read_b64_tr_b16 v[170:171], v196 offset:8704
    v_mul_f32 v79, v79, v87
    v_add_f32 v200, 1.0, v200
    v_add_f32 v201, 1.0, v201
    s_waitcnt lgkmcnt(8)
    v_mfma_f32_32x32x16_bf16 v[8:23], v[176:179], a[48:51], v[8:23]
    ds_read_b64_tr_b16 v[172:173], v196 offset:10240
    v_add_f32 v202, 1.0, v202
    v_add_f32 v203, 1.0, v203
    v_rcp_f32 v200, v200
    v_mfma_f32_32x32x16_bf16 v[24:39], v[176:179], a[192:195], v[24:39]
    ds_read_b64_tr_b16 v[174:175], v196 offset:10752
    v_rcp_f32 v201, v201
    v_rcp_f32 v202, v202
    s_add_u32 s33, s29, 4718592
    s_add_u32 m0, s32, 139264
    s_nop 0
    buffer_load_dwordx4 v217, s[8:11], s33 offen lds
    s_add_u32 s33, s29, 5013504
    s_add_u32 m0, s32, 143360
    s_nop 0
    buffer_load_dwordx4 v217, s[8:11], s33 offen lds
    s_waitcnt vmcnt(0)
    s_barrier
    s_waitcnt lgkmcnt(8)
    v_mfma_f32_32x32x16_bf16 v[8:23], v[180:183], a[52:55], v[8:23]
    ds_read_b64_tr_b16 v[176:177], v196 offset:24576
    v_rcp_f32 v203, v203
    v_mul_f32 v76, v76, v200
    v_mfma_f32_32x32x16_bf16 v[24:39], v[180:183], a[196:199], v[24:39]
    ds_read_b64_tr_b16 v[178:179], v196 offset:25088
    v_mul_f32 v77, v77, v201
    v_mul_f32 v78, v78, v202
    v_mul_f32 v79, v79, v203
    s_waitcnt lgkmcnt(8)
    v_mfma_f32_32x32x16_bf16 v[8:23], v[184:187], a[56:59], v[8:23]
    ds_read_b64_tr_b16 v[180:181], v196 offset:26624
    v_cvt_pk_bf16_f32 v206, v76, v77
    v_cvt_pk_bf16_f32 v207, v78, v79
    s_add_u32 s33, s35, 393216
    buffer_store_dwordx4 v[204:207], v218, s[44:47], s33 offen sc1
    v_mfma_f32_32x32x16_bf16 v[24:39], v[184:187], a[200:203], v[24:39]
    ds_read_b64_tr_b16 v[182:183], v196 offset:27136
    v_mul_f32 v208, v229, v88
    v_mul_f32 v209, v229, v89
    v_mul_f32 v210, v229, v90
    s_waitcnt lgkmcnt(8)
    v_mfma_f32_32x32x16_bf16 v[8:23], v[188:191], a[60:63], v[8:23]
    ds_read_b64_tr_b16 v[184:185], v196 offset:28672
    v_mul_f32 v211, v229, v91
    v_exp_f32 v208, v208
    v_mfma_f32_32x32x16_bf16 v[24:39], v[188:191], a[204:207], v[24:39]
    ds_read_b64_tr_b16 v[186:187], v196 offset:29184
    v_exp_f32 v209, v209
    v_exp_f32 v210, v210
    s_waitcnt lgkmcnt(8)
    v_mfma_f32_32x32x16_bf16 v[8:23], v[168:171], a[64:67], v[8:23]
    ds_read_b64_tr_b16 v[188:189], v196 offset:30720
    v_exp_f32 v211, v211
    v_mul_f32 v88, v88, v96
    v_mfma_f32_32x32x16_bf16 v[24:39], v[168:171], a[208:211], v[24:39]
    ds_read_b64_tr_b16 v[190:191], v196 offset:31232
    v_mul_f32 v89, v89, v97
    v_mul_f32 v90, v90, v98
    v_mul_f32 v91, v91, v99
    s_waitcnt lgkmcnt(8)
    v_mfma_f32_32x32x16_bf16 v[8:23], v[172:175], a[68:71], v[8:23]
    ds_read_b64_tr_b16 v[168:169], v196 offset:32768
    v_add_f32 v208, 1.0, v208
    v_add_f32 v209, 1.0, v209
    v_add_f32 v210, 1.0, v210
    v_mfma_f32_32x32x16_bf16 v[24:39], v[172:175], a[212:215], v[24:39]
    ds_read_b64_tr_b16 v[170:171], v196 offset:33280
    v_add_f32 v211, 1.0, v211
    v_rcp_f32 v208, v208
    s_waitcnt lgkmcnt(8)
    v_mfma_f32_32x32x16_bf16 v[8:23], v[176:179], a[72:75], v[8:23]
    ds_read_b64_tr_b16 v[172:173], v196 offset:34816
    v_rcp_f32 v209, v209
    v_rcp_f32 v210, v210
    v_mfma_f32_32x32x16_bf16 v[24:39], v[176:179], a[216:219], v[24:39]
    ds_read_b64_tr_b16 v[174:175], v196 offset:35328
    v_rcp_f32 v211, v211
    v_mul_f32 v88, v88, v208
    s_waitcnt lgkmcnt(8)
    v_mfma_f32_32x32x16_bf16 v[8:23], v[180:183], a[76:79], v[8:23]
    v_add_u32 v196, 0xc000, v196
    ds_read_b64_tr_b16 v[176:177], v196 offset:0
    v_mul_f32 v89, v89, v209
    v_mul_f32 v90, v90, v210
    v_mul_f32 v91, v91, v211
    v_mfma_f32_32x32x16_bf16 v[24:39], v[180:183], a[220:223], v[24:39]
    ds_read_b64_tr_b16 v[178:179], v196 offset:512
    v_cvt_pk_bf16_f32 v212, v88, v89
    v_cvt_pk_bf16_f32 v213, v90, v91
    v_mul_f32 v208, v229, v92
    s_waitcnt lgkmcnt(8)
    v_mfma_f32_32x32x16_bf16 v[8:23], v[184:187], a[80:83], v[8:23]
    ds_read_b64_tr_b16 v[180:181], v196 offset:2048
    v_mul_f32 v209, v229, v93
    v_mul_f32 v210, v229, v94
    v_mul_f32 v211, v229, v95
    v_mfma_f32_32x32x16_bf16 v[24:39], v[184:187], a[224:227], v[24:39]
    ds_read_b64_tr_b16 v[182:183], v196 offset:2560
    v_exp_f32 v208, v208
    v_exp_f32 v209, v209
    s_waitcnt lgkmcnt(8)
    v_mfma_f32_32x32x16_bf16 v[8:23], v[188:191], a[84:87], v[8:23]
    ds_read_b64_tr_b16 v[184:185], v196 offset:4096
    v_exp_f32 v210, v210
    v_exp_f32 v211, v211
    v_mfma_f32_32x32x16_bf16 v[24:39], v[188:191], a[228:231], v[24:39]
    ds_read_b64_tr_b16 v[186:187], v196 offset:4608
    v_mul_f32 v92, v92, v100
    v_mul_f32 v93, v93, v101
    v_mul_f32 v94, v94, v102
    s_waitcnt lgkmcnt(8)
    v_mfma_f32_32x32x16_bf16 v[8:23], v[168:171], a[88:91], v[8:23]
    ds_read_b64_tr_b16 v[188:189], v196 offset:6144
    v_mul_f32 v95, v95, v103
    v_add_f32 v208, 1.0, v208
    v_add_f32 v209, 1.0, v209
    v_mfma_f32_32x32x16_bf16 v[24:39], v[168:171], a[232:235], v[24:39]
    ds_read_b64_tr_b16 v[190:191], v196 offset:6656
    v_add_f32 v210, 1.0, v210
    v_add_f32 v211, 1.0, v211
    v_rcp_f32 v208, v208
    s_waitcnt lgkmcnt(8)
    v_mfma_f32_32x32x16_bf16 v[8:23], v[172:175], a[92:95], v[8:23]
    ds_read_b64_tr_b16 v[168:169], v196 offset:8192
    v_rcp_f32 v209, v209
    v_rcp_f32 v210, v210
    v_mfma_f32_32x32x16_bf16 v[24:39], v[172:175], a[236:239], v[24:39]
    ds_read_b64_tr_b16 v[170:171], v196 offset:8704
    v_rcp_f32 v211, v211
    v_mul_f32 v92, v92, v208
    s_waitcnt lgkmcnt(8)
    v_mfma_f32_32x32x16_bf16 v[8:23], v[176:179], a[96:99], v[8:23]
    ds_read_b64_tr_b16 v[172:173], v196 offset:10240
    v_mul_f32 v93, v93, v209
    v_mul_f32 v94, v94, v210
    v_mul_f32 v95, v95, v211
    v_mfma_f32_32x32x16_bf16 v[24:39], v[176:179], a[240:243], v[24:39]
    ds_read_b64_tr_b16 v[174:175], v196 offset:10752
    v_cvt_pk_bf16_f32 v214, v92, v93
    v_cvt_pk_bf16_f32 v215, v94, v95
    s_add_u32 s33, s35, 394240
    buffer_store_dwordx4 v[212:215], v218, s[44:47], s33 offen sc1
    s_waitcnt lgkmcnt(8)
    v_mfma_f32_32x32x16_bf16 v[8:23], v[180:183], a[100:103], v[8:23]
    ds_read_b64_tr_b16 v[176:177], v196 offset:24576
    v_mul_f32 v200, v228, v104
    v_mul_f32 v201, v228, v105
    v_mul_f32 v202, v228, v106
    v_mfma_f32_32x32x16_bf16 v[24:39], v[180:183], a[244:247], v[24:39]
    ds_read_b64_tr_b16 v[178:179], v196 offset:25088
    v_mul_f32 v203, v228, v107
    v_exp_f32 v200, v200
    s_waitcnt lgkmcnt(8)
    v_mfma_f32_32x32x16_bf16 v[8:23], v[184:187], a[104:107], v[8:23]
    ds_read_b64_tr_b16 v[180:181], v196 offset:26624
    v_exp_f32 v201, v201
    v_exp_f32 v202, v202
    v_mfma_f32_32x32x16_bf16 v[24:39], v[184:187], a[248:251], v[24:39]
    ds_read_b64_tr_b16 v[182:183], v196 offset:27136
    v_exp_f32 v203, v203
    v_mul_f32 v104, v104, v112
    s_waitcnt lgkmcnt(8)
    v_mfma_f32_32x32x16_bf16 v[8:23], v[188:191], a[108:111], v[8:23]
    ds_read_b64_tr_b16 v[184:185], v196 offset:28672
    v_mul_f32 v105, v105, v113
    v_mul_f32 v106, v106, v114
    v_mul_f32 v107, v107, v115
    v_mfma_f32_32x32x16_bf16 v[24:39], v[188:191], a[252:255], v[24:39]
    ds_read_b64_tr_b16 v[186:187], v196 offset:29184
    v_add_f32 v200, 1.0, v200
    v_add_f32 v201, 1.0, v201
    v_add_f32 v202, 1.0, v202
    s_waitcnt lgkmcnt(8)
    v_mfma_f32_32x32x16_bf16 v[8:23], v[168:171], a[112:115], v[8:23]
    ds_read_b64_tr_b16 v[188:189], v196 offset:30720
    v_add_f32 v203, 1.0, v203
    v_rcp_f32 v200, v200
    v_mfma_f32_32x32x16_bf16 v[24:39], v[168:171], v[136:139], v[24:39]
    ds_read_b64_tr_b16 v[190:191], v196 offset:31232
    v_rcp_f32 v201, v201
    v_rcp_f32 v202, v202
    s_waitcnt lgkmcnt(8)
    v_mfma_f32_32x32x16_bf16 v[8:23], v[172:175], a[116:119], v[8:23]
    ds_read_b64_tr_b16 v[168:169], v196 offset:32768
    v_rcp_f32 v203, v203
    v_mul_f32 v104, v104, v200
    v_mfma_f32_32x32x16_bf16 v[24:39], v[172:175], v[140:143], v[24:39]
    ds_read_b64_tr_b16 v[170:171], v196 offset:33280
    v_mul_f32 v105, v105, v201
    v_mul_f32 v106, v106, v202
    v_mul_f32 v107, v107, v203
    s_waitcnt lgkmcnt(8)
    v_mfma_f32_32x32x16_bf16 v[8:23], v[176:179], a[120:123], v[8:23]
    ds_read_b64_tr_b16 v[172:173], v196 offset:34816
    v_cvt_pk_bf16_f32 v204, v104, v105
    v_cvt_pk_bf16_f32 v205, v106, v107
    v_mul_f32 v200, v228, v108
    v_mfma_f32_32x32x16_bf16 v[24:39], v[176:179], v[144:147], v[24:39]
    ds_read_b64_tr_b16 v[174:175], v196 offset:35328
    v_mul_f32 v201, v228, v109
    v_mul_f32 v202, v228, v110
    v_mul_f32 v203, v228, v111
    s_waitcnt lgkmcnt(8)
    v_mfma_f32_32x32x16_bf16 v[8:23], v[180:183], a[124:127], v[8:23]
    ds_read_b64_tr_b16 v[176:177], v231 offset:2048
    v_exp_f32 v200, v200
    v_exp_f32 v201, v201
    v_mfma_f32_32x32x16_bf16 v[24:39], v[180:183], v[148:151], v[24:39]
    ds_read_b64_tr_b16 v[178:179], v231 offset:2048
    v_exp_f32 v202, v202
    v_exp_f32 v203, v203
    s_waitcnt lgkmcnt(8)
    v_mfma_f32_32x32x16_bf16 v[8:23], v[184:187], a[128:131], v[8:23]
    v_mul_f32 v108, v108, v116
    v_mul_f32 v109, v109, v117
    v_mul_f32 v110, v110, v118
    v_mfma_f32_32x32x16_bf16 v[24:39], v[184:187], v[152:155], v[24:39]
    v_mul_f32 v111, v111, v119
    v_add_f32 v200, 1.0, v200
    v_add_f32 v201, 1.0, v201
    s_waitcnt lgkmcnt(6)
    v_mfma_f32_32x32x16_bf16 v[8:23], v[188:191], a[132:135], v[8:23]
    v_add_f32 v202, 1.0, v202
    v_add_f32 v203, 1.0, v203
    v_rcp_f32 v200, v200
    v_mfma_f32_32x32x16_bf16 v[24:39], v[188:191], v[156:159], v[24:39]
    v_rcp_f32 v201, v201
    v_rcp_f32 v202, v202
    s_waitcnt lgkmcnt(4)
    v_mfma_f32_32x32x16_bf16 v[8:23], v[168:171], a[136:139], v[8:23]
    v_rcp_f32 v203, v203
    v_mul_f32 v108, v108, v200
    v_mfma_f32_32x32x16_bf16 v[24:39], v[168:171], v[160:163], v[24:39]
    v_mul_f32 v109, v109, v201
    v_mul_f32 v110, v110, v202
    v_mul_f32 v111, v111, v203
    s_waitcnt lgkmcnt(2)
    v_mfma_f32_32x32x16_bf16 v[8:23], v[172:175], a[140:143], v[8:23]
    v_cvt_pk_bf16_f32 v206, v108, v109
    v_cvt_pk_bf16_f32 v207, v110, v111
    s_add_u32 s33, s35, 458752
    buffer_store_dwordx4 v[204:207], v218, s[44:47], s33 offen sc1
    v_mfma_f32_32x32x16_bf16 v[24:39], v[172:175], v[164:167], v[24:39]
    v_mul_f32 v208, v229, v120
    v_mul_f32 v209, v229, v121
    v_mul_f32 v210, v229, v122
    s_waitcnt lgkmcnt(0)
    v_mfma_f32_32x32x16_bf16 v[8:23], v[176:179], v[220:223], v[8:23]
    v_mul_f32 v211, v229, v123
    v_exp_f32 v208, v208
    v_mfma_f32_32x32x16_bf16 v[24:39], v[176:179], v[224:227], v[24:39]
    v_exp_f32 v209, v209
    v_exp_f32 v210, v210
    v_exp_f32 v211, v211
    v_mul_f32 v120, v120, v128
    v_mul_f32 v121, v121, v129
    v_mul_f32 v122, v122, v130
    v_mul_f32 v123, v123, v131
    v_add_f32 v208, 1.0, v208
    v_add_f32 v209, 1.0, v209
    v_add_f32 v210, 1.0, v210
    v_add_f32 v211, 1.0, v211
    v_rcp_f32 v208, v208
    v_rcp_f32 v209, v209
    v_rcp_f32 v210, v210
    v_rcp_f32 v211, v211
    v_mul_f32 v120, v120, v208
    v_mul_f32 v121, v121, v209
    v_mul_f32 v122, v122, v210
    v_mul_f32 v123, v123, v211
    v_cvt_pk_bf16_f32 v212, v120, v121
    v_cvt_pk_bf16_f32 v213, v122, v123
    v_mul_f32 v208, v229, v124
    v_mul_f32 v209, v229, v125
    v_mul_f32 v210, v229, v126
    v_mul_f32 v211, v229, v127
    v_exp_f32 v208, v208
    v_exp_f32 v209, v209
    v_exp_f32 v210, v210
    v_exp_f32 v211, v211
    v_mul_f32 v124, v124, v132
    v_mul_f32 v125, v125, v133
    v_mul_f32 v126, v126, v134
    v_mul_f32 v127, v127, v135
    v_add_f32 v208, 1.0, v208
    v_add_f32 v209, 1.0, v209
    v_add_f32 v210, 1.0, v210
    v_add_f32 v211, 1.0, v211
    v_rcp_f32 v208, v208
    v_rcp_f32 v209, v209
    v_rcp_f32 v210, v210
    v_rcp_f32 v211, v211
    v_mul_f32 v124, v124, v208
    v_mul_f32 v125, v125, v209
    v_mul_f32 v126, v126, v210
    v_mul_f32 v127, v127, v211
    v_cvt_pk_bf16_f32 v214, v124, v125
    v_cvt_pk_bf16_f32 v215, v126, v127
    s_add_u32 s33, s35, 459776
    buffer_store_dwordx4 v[212:215], v218, s[44:47], s33 offen sc1
    v_mul_f32 v200, v228, v8
    v_mul_f32 v201, v228, v9
    v_mul_f32 v202, v228, v10
    v_mul_f32 v203, v228, v11
    v_exp_f32 v200, v200
    v_exp_f32 v201, v201
    v_exp_f32 v202, v202
    v_exp_f32 v203, v203
    v_mul_f32 v8, v8, v16
    v_mul_f32 v9, v9, v17
    v_mul_f32 v10, v10, v18
    v_mul_f32 v11, v11, v19
    v_add_f32 v200, 1.0, v200
    v_add_f32 v201, 1.0, v201
    v_add_f32 v202, 1.0, v202
    v_add_f32 v203, 1.0, v203
    v_rcp_f32 v200, v200
    v_rcp_f32 v201, v201
    v_rcp_f32 v202, v202
    v_rcp_f32 v203, v203
    v_mul_f32 v8, v8, v200
    v_mul_f32 v9, v9, v201
    v_mul_f32 v10, v10, v202
    v_mul_f32 v11, v11, v203
    v_cvt_pk_bf16_f32 v204, v8, v9
    v_cvt_pk_bf16_f32 v205, v10, v11
    v_mul_f32 v200, v228, v12
    v_mul_f32 v201, v228, v13
    v_mul_f32 v202, v228, v14
    v_mul_f32 v203, v228, v15
    v_exp_f32 v200, v200
    v_exp_f32 v201, v201
    v_exp_f32 v202, v202
    v_exp_f32 v203, v203
    v_mul_f32 v12, v12, v20
    v_mul_f32 v13, v13, v21
    v_mul_f32 v14, v14, v22
    v_mul_f32 v15, v15, v23
    v_add_f32 v200, 1.0, v200
    v_add_f32 v201, 1.0, v201
    v_add_f32 v202, 1.0, v202
    v_add_f32 v203, 1.0, v203
    v_rcp_f32 v200, v200
    v_rcp_f32 v201, v201
    v_rcp_f32 v202, v202
    v_rcp_f32 v203, v203
    v_mul_f32 v12, v12, v200
    v_mul_f32 v13, v13, v201
    v_mul_f32 v14, v14, v202
    v_mul_f32 v15, v15, v203
    v_cvt_pk_bf16_f32 v206, v12, v13
    v_cvt_pk_bf16_f32 v207, v14, v15
    s_add_u32 s33, s34, 0
    buffer_store_dwordx4 v[204:207], v218, s[44:47], s33 offen sc1
    v_mul_f32 v208, v229, v24
    v_mul_f32 v209, v229, v25
    v_mul_f32 v210, v229, v26
    v_mul_f32 v211, v229, v27
    v_exp_f32 v208, v208
    v_exp_f32 v209, v209
    v_exp_f32 v210, v210
    v_exp_f32 v211, v211
    v_mul_f32 v24, v24, v32
    v_mul_f32 v25, v25, v33
    v_mul_f32 v26, v26, v34
    v_mul_f32 v27, v27, v35
    v_add_f32 v208, 1.0, v208
    v_add_f32 v209, 1.0, v209
    v_add_f32 v210, 1.0, v210
    v_add_f32 v211, 1.0, v211
    v_rcp_f32 v208, v208
    v_rcp_f32 v209, v209
    v_rcp_f32 v210, v210
    v_rcp_f32 v211, v211
    v_mul_f32 v24, v24, v208
    v_mul_f32 v25, v25, v209
    v_mul_f32 v26, v26, v210
    v_mul_f32 v27, v27, v211
    v_cvt_pk_bf16_f32 v212, v24, v25
    v_cvt_pk_bf16_f32 v213, v26, v27
    v_mul_f32 v208, v229, v28
    v_mul_f32 v209, v229, v29
    v_mul_f32 v210, v229, v30
    v_mul_f32 v211, v229, v31
    v_exp_f32 v208, v208
    v_exp_f32 v209, v209
    v_exp_f32 v210, v210
    v_exp_f32 v211, v211
    v_mul_f32 v28, v28, v36
    v_mul_f32 v29, v29, v37
    v_mul_f32 v30, v30, v38
    v_mul_f32 v31, v31, v39
    v_add_f32 v208, 1.0, v208
    v_add_f32 v209, 1.0, v209
    v_add_f32 v210, 1.0, v210
    v_add_f32 v211, 1.0, v211
    v_rcp_f32 v208, v208
    v_rcp_f32 v209, v209
    v_rcp_f32 v210, v210
    v_rcp_f32 v211, v211
    v_mul_f32 v28, v28, v208
    v_mul_f32 v29, v29, v209
    v_mul_f32 v30, v30, v210
    v_mul_f32 v31, v31, v211
    v_cvt_pk_bf16_f32 v214, v28, v29
    v_cvt_pk_bf16_f32 v215, v30, v31
    s_add_u32 s33, s34, 1024
    buffer_store_dwordx4 v[212:215], v218, s[44:47], s33 offen sc1
K5_END:
    s_endpgm
.globl k6_kernel
.p2align 8
.type k6_kernel,@function
k6_kernel:
    s_cmp_ge_u32 s2, 256
    s_cbranch_scc1 K6_END
    s_load_dwordx2 s[12:13], s[0:1], 104
    s_load_dwordx2 s[4:5], s[0:1], 64
    s_load_dwordx2 s[40:41], s[0:1], 88
    s_mov_b32 s30, 0xffff0000
    v_and_b32 v1, 63, v0
    v_lshrrev_b32 v2, 6, v0
    s_nop 0
    v_readfirstlane_b32 s55, v2
    s_nop 0
    s_and_b32 s20, s55, 3
    s_and_b32 s21, s2, 7
    s_lshr_b32 s22, s21, 1
    s_and_b32 s21, s21, 1
    s_lshr_b32 s23, s2, 3
    s_and_b32 s24, s23, 3
    s_lshr_b32 s23, s23, 2
    s_lshl_b32 s21, s21, 3
    s_add_u32 s23, s23, s21
    s_lshl_b32 s25, s23, 2
    s_add_u32 s25, s25, s20
    s_lshl_b32 s26, s25, 10
    s_mul_i32 s27, s22, 4718592
    s_add_u32 s26, s26, s27
    v_lshlrev_b32 v5, 4, v1
    s_lshr_b32 s28, s24, 1
    s_mul_i32 s28, s28, 576
    s_and_b32 s29, s24, 1
    s_mul_i32 s31, s29, 320
    s_add_u32 s31, s31, s28
    s_mul_i32 s27, s22, 1152
    s_lshl_b32 s28, s20, 4
    s_add_u32 s27, s27, s28
    s_mul_i32 s27, s27, 1152
    s_add_u32 s27, s27, s31
    v_lshrrev_b32 v2, 5, v1
    v_bfe_u32 v3, v1, 4, 1
    v_bfe_u32 v4, v1, 2, 2
    v_lshl_add_u32 v4, v2, 2, v4
    v_lshlrev_b32 v6, 1, v3
    v_bfe_u32 v7, v1, 1, 1
    v_add_u32 v6, v6, v7
    v_add_u32 v6, s22, v6
    v_and_b32 v6, 3, v6
    v_and_b32 v7, 1, v1
    v_lshlrev_b32 v7, 3, v7
    v_lshl_add_u32 v6, v6, 4, v7
    s_waitcnt lgkmcnt(0)
    s_add_u32 s4, s12, 50331648
    s_addc_u32 s5, s13, 0
    s_mov_b32 s6, 5308416
    s_mov_b32 s7, 0x20000
    s_add_u32 s8, s12, 17825792
    s_addc_u32 s9, s13, 0
    s_mov_b32 s10, 18874368
    s_mov_b32 s11, 0x20000
    s_cmp_lg_u32 s29, 0
    s_cbranch_scc1 K6_NARROW
    s_mul_i32 s28, s20, 5120
    s_mul_i32 s27, s22, 1327104
    s_lshr_b32 s33, s24, 1
    s_mul_i32 s33, s33, 663552
    s_add_u32 s27, s27, s33
    s_add_u32 s27, s27, s28
    s_and_b32 s63, s23, 7
    s_mul_i32 s63, s63, 0
    s_mul_i32 s37, s63, 20480
    s_lshl_b32 s63, s63, 18
    s_lshl_b32 s35, s20, 12
    s_add_u32 s35, s35, 81920
    s_cmp_lt_u32 s55, 4
    s_cbranch_scc1 K6_COMP5
    s_add_u32 m0, s28, 0
    s_add_u32 s33, s27, 0
    buffer_load_dwordx4 v5, s[4:7], s33 offen lds
    s_add_u32 m0, s28, 1024
    s_add_u32 s33, s27, 1024
    buffer_load_dwordx4 v5, s[4:7], s33 offen lds
    s_add_u32 m0, s28, 2048
    s_add_u32 s33, s27, 2048
    buffer_load_dwordx4 v5, s[4:7], s33 offen lds
    s_add_u32 m0, s28, 3072
    s_add_u32 s33, s27, 3072
    buffer_load_dwordx4 v5, s[4:7], s33 offen lds
    s_add_u32 m0, s28, 4096
    s_add_u32 s33, s27, 4096
    buffer_load_dwordx4 v5, s[4:7], s33 offen lds
    s_add_u32 m0, s28, 20480
    s_add_u32 s33, s27, 20480
    buffer_load_dwordx4 v5, s[4:7], s33 offen lds
    s_add_u32 m0, s28, 21504
    s_add_u32 s33, s27, 21504
    buffer_load_dwordx4 v5, s[4:7], s33 offen lds
    s_add_u32 m0, s28, 22528
    s_add_u32 s33, s27, 22528
    buffer_load_dwordx4 v5, s[4:7], s33 offen lds
    s_add_u32 m0, s28, 23552
    s_add_u32 s33, s27, 23552
    buffer_load_dwordx4 v5, s[4:7], s33 offen lds
    s_add_u32 m0, s28, 24576
    s_add_u32 s33, s27, 24576
    buffer_load_dwordx4 v5, s[4:7], s33 offen lds
    s_add_u32 m0, s28, 40960
    s_add_u32 s33, s27, 40960
    buffer_load_dwordx4 v5, s[4:7], s33 offen lds
    s_add_u32 m0, s28, 41984
    s_add_u32 s33, s27, 41984
    buffer_load_dwordx4 v5, s[4:7], s33 offen lds
    s_add_u32 m0, s28, 43008
    s_add_u32 s33, s27, 43008
    buffer_load_dwordx4 v5, s[4:7], s33 offen lds
    s_add_u32 m0, s28, 44032
    s_add_u32 s33, s27, 44032
    buffer_load_dwordx4 v5, s[4:7], s33 offen lds
    s_add_u32 m0, s28, 45056
    s_add_u32 s33, s27, 45056
    buffer_load_dwordx4 v5, s[4:7], s33 offen lds
    s_add_u32 m0, s28, 61440
    s_add_u32 s33, s27, 61440
    buffer_load_dwordx4 v5, s[4:7], s33 offen lds
    s_add_u32 m0, s28, 62464
    s_add_u32 s33, s27, 62464
    buffer_load_dwordx4 v5, s[4:7], s33 offen lds
    s_add_u32 m0, s28, 63488
    s_add_u32 s33, s27, 63488
    buffer_load_dwordx4 v5, s[4:7], s33 offen lds
    s_add_u32 m0, s28, 64512
    s_add_u32 s33, s27, 64512
    buffer_load_dwordx4 v5, s[4:7], s33 offen lds
    s_add_u32 m0, s28, 65536
    s_add_u32 s33, s27, 65536
    buffer_load_dwordx4 v5, s[4:7], s33 offen lds
    s_waitcnt vmcnt(15)
    s_barrier
    s_add_u32 m0, s28, 81920
    s_add_u32 s33, s27, 81920
    buffer_load_dwordx4 v5, s[4:7], s33 offen lds
    s_add_u32 m0, s28, 82944
    s_add_u32 s33, s27, 82944
    buffer_load_dwordx4 v5, s[4:7], s33 offen lds
    s_add_u32 m0, s28, 83968
    s_add_u32 s33, s27, 83968
    buffer_load_dwordx4 v5, s[4:7], s33 offen lds
    s_add_u32 m0, s28, 84992
    s_add_u32 s33, s27, 84992
    buffer_load_dwordx4 v5, s[4:7], s33 offen lds
    s_add_u32 m0, s28, 86016
    s_add_u32 s33, s27, 86016
    buffer_load_dwordx4 v5, s[4:7], s33 offen lds
    s_add_u32 m0, s28, 102400
    s_add_u32 s33, s27, 102400
    buffer_load_dwordx4 v5, s[4:7], s33 offen lds
    s_add_u32 m0, s28, 103424
    s_add_u32 s33, s27, 103424
    buffer_load_dwordx4 v5, s[4:7], s33 offen lds
    s_add_u32 m0, s28, 104448
    s_add_u32 s33, s27, 104448
    buffer_load_dwordx4 v5, s[4:7], s33 offen lds
    s_add_u32 m0, s28, 105472
    s_add_u32 s33, s27, 105472
    buffer_load_dwordx4 v5, s[4:7], s33 offen lds
    s_add_u32 m0, s28, 106496
    s_add_u32 s33, s27, 106496
    buffer_load_dwordx4 v5, s[4:7], s33 offen lds
    s_waitcnt vmcnt(20)
    s_barrier
    s_add_u32 m0, s28, 122880
    s_add_u32 s33, s27, 122880
    buffer_load_dwordx4 v5, s[4:7], s33 offen lds
    s_add_u32 m0, s28, 123904
    s_add_u32 s33, s27, 123904
    buffer_load_dwordx4 v5, s[4:7], s33 offen lds
    s_add_u32 m0, s28, 124928
    s_add_u32 s33, s27, 124928
    buffer_load_dwordx4 v5, s[4:7], s33 offen lds
    s_add_u32 m0, s28, 125952
    s_add_u32 s33, s27, 125952
    buffer_load_dwordx4 v5, s[4:7], s33 offen lds
    s_add_u32 m0, s28, 126976
    s_add_u32 s33, s27, 126976
    buffer_load_dwordx4 v5, s[4:7], s33 offen lds
    s_waitcnt vmcnt(20)
    s_barrier
    s_add_u32 m0, s28, 0
    s_add_u32 s33, s27, 143360
    buffer_load_dwordx4 v5, s[4:7], s33 offen lds
    s_add_u32 m0, s28, 1024
    s_add_u32 s33, s27, 144384
    buffer_load_dwordx4 v5, s[4:7], s33 offen lds
    s_add_u32 m0, s28, 2048
    s_add_u32 s33, s27, 145408
    buffer_load_dwordx4 v5, s[4:7], s33 offen lds
    s_add_u32 m0, s28, 3072
    s_add_u32 s33, s27, 146432
    buffer_load_dwordx4 v5, s[4:7], s33 offen lds
    s_add_u32 m0, s28, 4096
    s_add_u32 s33, s27, 147456
    buffer_load_dwordx4 v5, s[4:7], s33 offen lds
    s_waitcnt vmcnt(20)
    s_barrier
    s_add_u32 m0, s28, 20480
    s_add_u32 s33, s27, 163840
    buffer_load_dwordx4 v5, s[4:7], s33 offen lds
    s_add_u32 m0, s28, 21504
    s_add_u32 s33, s27, 164864
    buffer_load_dwordx4 v5, s[4:7], s33 offen lds
    s_add_u32 m0, s28, 22528
    s_add_u32 s33, s27, 165888
    buffer_load_dwordx4 v5, s[4:7], s33 offen lds
    s_add_u32 m0, s28, 23552
    s_add_u32 s33, s27, 166912
    buffer_load_dwordx4 v5, s[4:7], s33 offen lds
    s_add_u32 m0, s28, 24576
    s_add_u32 s33, s27, 167936
    buffer_load_dwordx4 v5, s[4:7], s33 offen lds
    s_waitcnt vmcnt(20)
    s_barrier
    s_add_u32 m0, s28, 40960
    s_add_u32 s33, s27, 184320
    buffer_load_dwordx4 v5, s[4:7], s33 offen lds
    s_add_u32 m0, s28, 41984
    s_add_u32 s33, s27, 185344
    buffer_load_dwordx4 v5, s[4:7], s33 offen lds
    s_add_u32 m0, s28, 43008
    s_add_u32 s33, s27, 186368
    buffer_load_dwordx4 v5, s[4:7], s33 offen lds
    s_add_u32 m0, s28, 44032
    s_add_u32 s33, s27, 187392
    buffer_load_dwordx4 v5, s[4:7], s33 offen lds
    s_add_u32 m0, s28, 45056
    s_add_u32 s33, s27, 188416
    buffer_load_dwordx4 v5, s[4:7], s33 offen lds
    s_waitcnt vmcnt(20)
    s_barrier
    s_add_u32 m0, s28, 61440
    s_add_u32 s33, s27, 204800
    buffer_load_dwordx4 v5, s[4:7], s33 offen lds
    s_add_u32 m0, s28, 62464
    s_add_u32 s33, s27, 205824
    buffer_load_dwordx4 v5, s[4:7], s33 offen lds
    s_add_u32 m0, s28, 63488
    s_add_u32 s33, s27, 206848
    buffer_load_dwordx4 v5, s[4:7], s33 offen lds
    s_add_u32 m0, s28, 64512
    s_add_u32 s33, s27, 207872
    buffer_load_dwordx4 v5, s[4:7], s33 offen lds
    s_add_u32 m0, s28, 65536
    s_add_u32 s33, s27, 208896
    buffer_load_dwordx4 v5, s[4:7], s33 offen lds
    s_waitcnt vmcnt(20)
    s_barrier
    s_add_u32 m0, s28, 81920
    s_add_u32 s33, s27, 225280
    buffer_load_dwordx4 v5, s[4:7], s33 offen lds
    s_add_u32 m0, s28, 82944
    s_add_u32 s33, s27, 226304
    buffer_load_dwordx4 v5, s[4:7], s33 offen lds
    s_add_u32 m0, s28, 83968
    s_add_u32 s33, s27, 227328
    buffer_load_dwordx4 v5, s[4:7], s33 offen lds
    s_add_u32 m0, s28, 84992
    s_add_u32 s33, s27, 228352
    buffer_load_dwordx4 v5, s[4:7], s33 offen lds
    s_add_u32 m0, s28, 86016
    s_add_u32 s33, s27, 229376
    buffer_load_dwordx4 v5, s[4:7], s33 offen lds
    s_waitcnt vmcnt(20)
    s_barrier
    s_add_u32 m0, s28, 102400
    s_add_u32 s33, s27, 245760
    buffer_load_dwordx4 v5, s[4:7], s33 offen lds
    s_add_u32 m0, s28, 103424
    s_add_u32 s33, s27, 246784
    buffer_load_dwordx4 v5, s[4:7], s33 offen lds
    s_add_u32 m0, s28, 104448
    s_add_u32 s33, s27, 247808
    buffer_load_dwordx4 v5, s[4:7], s33 offen lds
    s_add_u32 m0, s28, 105472
    s_add_u32 s33, s27, 248832
    buffer_load_dwordx4 v5, s[4:7], s33 offen lds
    s_add_u32 m0, s28, 106496
    s_add_u32 s33, s27, 249856
    buffer_load_dwordx4 v5, s[4:7], s33 offen lds
    s_waitcnt vmcnt(20)
    s_barrier
    s_add_u32 m0, s28, 122880
    s_add_u32 s33, s27, 266240
    buffer_load_dwordx4 v5, s[4:7], s33 offen lds
    s_add_u32 m0, s28, 123904
    s_add_u32 s33, s27, 267264
    buffer_load_dwordx4 v5, s[4:7], s33 offen lds
    s_add_u32 m0, s28, 124928
    s_add_u32 s33, s27, 268288
    buffer_load_dwordx4 v5, s[4:7], s33 offen lds
    s_add_u32 m0, s28, 125952
    s_add_u32 s33, s27, 269312
    buffer_load_dwordx4 v5, s[4:7], s33 offen lds
    s_add_u32 m0, s28, 126976
    s_add_u32 s33, s27, 270336
    buffer_load_dwordx4 v5, s[4:7], s33 offen lds
    s_waitcnt vmcnt(20)
    s_barrier
    s_add_u32 m0, s28, 0
    s_add_u32 s33, s27, 286720
    buffer_load_dwordx4 v5, s[4:7], s33 offen lds
    s_add_u32 m0, s28, 1024
    s_add_u32 s33, s27, 287744
    buffer_load_dwordx4 v5, s[4:7], s33 offen lds
    s_add_u32 m0, s28, 2048
    s_add_u32 s33, s27, 288768
    buffer_load_dwordx4 v5, s[4:7], s33 offen lds
    s_add_u32 m0, s28, 3072
    s_add_u32 s33, s27, 289792
    buffer_load_dwordx4 v5, s[4:7], s33 offen lds
    s_add_u32 m0, s28, 4096
    s_add_u32 s33, s27, 290816
    buffer_load_dwordx4 v5, s[4:7], s33 offen lds
    s_waitcnt vmcnt(20)
    s_barrier
    s_add_u32 m0, s28, 20480
    s_add_u32 s33, s27, 307200
    buffer_load_dwordx4 v5, s[4:7], s33 offen lds
    s_add_u32 m0, s28, 21504
    s_add_u32 s33, s27, 308224
    buffer_load_dwordx4 v5, s[4:7], s33 offen lds
    s_add_u32 m0, s28, 22528
    s_add_u32 s33, s27, 309248
    buffer_load_dwordx4 v5, s[4:7], s33 offen lds
    s_add_u32 m0, s28, 23552
    s_add_u32 s33, s27, 310272
    buffer_load_dwordx4 v5, s[4:7], s33 offen lds
    s_add_u32 m0, s28, 24576
    s_add_u32 s33, s27, 311296
    buffer_load_dwordx4 v5, s[4:7], s33 offen lds
    s_waitcnt vmcnt(20)
    s_barrier
    s_add_u32 m0, s28, 40960
    s_add_u32 s33, s27, 327680
    buffer_load_dwordx4 v5, s[4:7], s33 offen lds
    s_add_u32 m0, s28, 41984
    s_add_u32 s33, s27, 328704
    buffer_load_dwordx4 v5, s[4:7], s33 offen lds
    s_add_u32 m0, s28, 43008
    s_add_u32 s33, s27, 329728
    buffer_load_dwordx4 v5, s[4:7], s33 offen lds
    s_add_u32 m0, s28, 44032
    s_add_u32 s33, s27, 330752
    buffer_load_dwordx4 v5, s[4:7], s33 offen lds
    s_add_u32 m0, s28, 45056
    s_add_u32 s33, s27, 331776
    buffer_load_dwordx4 v5, s[4:7], s33 offen lds
    s_waitcnt vmcnt(20)
    s_barrier
    s_add_u32 m0, s28, 61440
    s_add_u32 s33, s27, 348160
    buffer_load_dwordx4 v5, s[4:7], s33 offen lds
    s_add_u32 m0, s28, 62464
    s_add_u32 s33, s27, 349184
    buffer_load_dwordx4 v5, s[4:7], s33 offen lds
    s_add_u32 m0, s28, 63488
    s_add_u32 s33, s27, 350208
    buffer_load_dwordx4 v5, s[4:7], s33 offen lds
    s_add_u32 m0, s28, 64512
    s_add_u32 s33, s27, 351232
    buffer_load_dwordx4 v5, s[4:7], s33 offen lds
    s_add_u32 m0, s28, 65536
    s_add_u32 s33, s27, 352256
    buffer_load_dwordx4 v5, s[4:7], s33 offen lds
    s_waitcnt vmcnt(20)
    s_barrier
    s_waitcnt vmcnt(15)
    s_barrier
    s_waitcnt vmcnt(10)
    s_barrier
    s_waitcnt vmcnt(0)
    s_barrier
    s_endpgm
K6_COMP5:
    s_add_u32 s34, s26, 0
    buffer_load_dwordx4 v[88:91], v5, s[8:11], s34 offen
    s_add_u32 s34, s26, 65536
    buffer_load_dwordx4 v[92:95], v5, s[8:11], s34 offen
    s_add_u32 s34, s26, 131072
    buffer_load_dwordx4 v[96:99], v5, s[8:11], s34 offen
    s_add_u32 s34, s26, 196608
    buffer_load_dwordx4 v[100:103], v5, s[8:11], s34 offen
    s_add_u32 s34, s26, 262144
    buffer_load_dwordx4 v[104:107], v5, s[8:11], s34 offen
    s_add_u32 s34, s26, 327680
    buffer_load_dwordx4 v[108:111], v5, s[8:11], s34 offen
    s_add_u32 s34, s26, 393216
    buffer_load_dwordx4 v[112:115], v5, s[8:11], s34 offen
    s_add_u32 s34, s26, 458752
    buffer_load_dwordx4 v[116:119], v5, s[8:11], s34 offen
    v_mov_b32 v248, v5
    s_add_u32 s16, s12, 37748736
    s_addc_u32 s17, s13, 0
    s_mov_b32 s18, 10485760
    s_mov_b32 s19, 0x20000
    s_add_u32 s44, s12, 11534336
    s_addc_u32 s45, s13, 0
    s_mov_b32 s46, 2359296
    s_mov_b32 s47, 0x20000
    s_mov_b32 s42, 2359296
    s_mov_b32 s43, 0x20000
    s_add_u32 s48, s12, 65536
    s_addc_u32 s49, s13, 0
    s_mov_b32 s50, 13824
    s_mov_b32 s51, 0x20000
    s_lshl_b32 s35, s23, 2
    s_add_u32 s35, s35, s24
    s_mul_i32 s32, s35, 163840
    s_mul_i32 s33, s20, 2560
    s_add_u32 s32, s32, s33
    s_mul_i32 s35, s22, 10240
    s_add_u32 s35, s35, s32
    s_mul_i32 s39, s22, 40960
    s_add_u32 s39, s39, s32
    s_add_u32 s33, s22, 1
    s_and_b32 s33, s33, 3
    s_mul_i32 s56, s33, 10240
    s_add_u32 s56, s56, s39
    s_mul_i32 s60, s33, 40960
    s_add_u32 s60, s60, s35
    s_add_u32 s33, s22, 2
    s_and_b32 s33, s33, 3
    s_mul_i32 s57, s33, 10240
    s_add_u32 s57, s57, s39
    s_mul_i32 s61, s33, 40960
    s_add_u32 s61, s61, s35
    s_add_u32 s33, s22, 3
    s_and_b32 s33, s33, 3
    s_mul_i32 s58, s33, 10240
    s_add_u32 s58, s58, s39
    s_mul_i32 s62, s33, 40960
    s_add_u32 s62, s62, s35
    v_lshlrev_b32 v7, 3, v1
    v_and_b32 v3, 31, v1
    v_mul_u32_u24 v3, 1152, v3
    v_lshl_add_u32 v3, v2, 3, v3
    v_lshlrev_b32 v4, 4, v2
    s_mul_i32 s36, s25, 36864
    s_add_u32 s36, s36, s31
    s_lshl_b32 s37, s22, 4
    s_add_u32 s36, s36, s37
    s_add_u32 s38, s31, s37
    s_lshl_b32 s38, s38, 1
    s_add_u32 s38, s38, 11520
    s_add_u32 s52, s12, 131072
    s_addc_u32 s53, s13, 0
    s_mov_b32 s54, 131072
    s_mov_b32 s55, 0x20000
    v_and_b32 v6, 31, v1
    v_lshlrev_b32 v6, 6, v6
    s_lshl_b32 s33, s25, 11
    s_barrier
    ds_read_b128 v[216:219], v248 offset:0
    ds_read_b128 v[220:223], v248 offset:1024
    ds_read_b128 v[224:227], v248 offset:2048
    ds_read_b128 v[228:231], v248 offset:3072
    ds_read_b128 v[232:235], v248 offset:4096
    ds_read_b128 v[236:239], v248 offset:5120
    ds_read_b128 v[240:243], v248 offset:6144
    s_waitcnt vmcnt(7)
    s_waitcnt lgkmcnt(6)
    v_mfma_f32_32x32x16_bf16 v[8:23], v[216:219], v[88:91], 0
    ds_read_b128 v[244:247], v248 offset:7168
    s_waitcnt lgkmcnt(6)
    v_mfma_f32_32x32x16_bf16 v[24:39], v[220:223], v[88:91], 0
    s_barrier
    ds_read_b128 v[216:219], v248 offset:8192
    s_waitcnt lgkmcnt(6)
    v_mfma_f32_32x32x16_bf16 v[40:55], v[224:227], v[88:91], 0
    ds_read_b128 v[220:223], v248 offset:9216
    s_waitcnt lgkmcnt(6)
    v_mfma_f32_32x32x16_bf16 v[56:71], v[228:231], v[88:91], 0
    s_add_u32 s34, s26, 524288
    buffer_load_dwordx4 v[120:123], v5, s[8:11], s34 offen
    ds_read_b128 v[224:227], v248 offset:10240
    s_waitcnt lgkmcnt(6)
    v_mfma_f32_32x32x16_bf16 v[72:87], v[232:235], v[88:91], 0
    ds_read_b128 v[228:231], v248 offset:11264
    s_waitcnt vmcnt(7)
    s_waitcnt lgkmcnt(6)
    v_mfma_f32_32x32x16_bf16 v[8:23], v[236:239], v[92:95], v[8:23]
    ds_read_b128 v[232:235], v248 offset:12288
    s_waitcnt lgkmcnt(6)
    v_mfma_f32_32x32x16_bf16 v[24:39], v[240:243], v[92:95], v[24:39]
    s_add_u32 s34, s26, 589824
    buffer_load_dwordx4 v[124:127], v5, s[8:11], s34 offen
    ds_read_b128 v[236:239], v248 offset:13312
    s_waitcnt lgkmcnt(6)
    v_mfma_f32_32x32x16_bf16 v[40:55], v[244:247], v[92:95], v[40:55]
    ds_read_b128 v[240:243], v248 offset:14336
    s_waitcnt lgkmcnt(6)
    v_mfma_f32_32x32x16_bf16 v[56:71], v[216:219], v[92:95], v[56:71]
    ds_read_b128 v[244:247], v248 offset:15360
    s_waitcnt lgkmcnt(6)
    v_mfma_f32_32x32x16_bf16 v[72:87], v[220:223], v[92:95], v[72:87]
    ds_read_b128 v[216:219], v248 offset:16384
    s_waitcnt vmcnt(7)
    s_waitcnt lgkmcnt(6)
    v_mfma_f32_32x32x16_bf16 v[8:23], v[224:227], v[96:99], v[8:23]
    s_add_u32 s34, s26, 655360
    buffer_load_dwordx4 v[128:131], v5, s[8:11], s34 offen
    ds_read_b128 v[220:223], v248 offset:17408
    s_waitcnt lgkmcnt(6)
    v_mfma_f32_32x32x16_bf16 v[24:39], v[228:231], v[96:99], v[24:39]
    ds_read_b128 v[224:227], v248 offset:18432
    s_waitcnt lgkmcnt(6)
    v_mfma_f32_32x32x16_bf16 v[40:55], v[232:235], v[96:99], v[40:55]
    ds_read_b128 v[228:231], v248 offset:19456
    s_waitcnt lgkmcnt(6)
    v_mfma_f32_32x32x16_bf16 v[56:71], v[236:239], v[96:99], v[56:71]
    s_add_u32 s34, s26, 720896
    buffer_load_dwordx4 v[132:135], v5, s[8:11], s34 offen
    ds_read_b128 v[232:235], v248 offset:20480
    s_waitcnt lgkmcnt(6)
    v_mfma_f32_32x32x16_bf16 v[72:87], v[240:243], v[96:99], v[72:87]
    ds_read_b128 v[236:239], v248 offset:21504
    s_waitcnt vmcnt(8)
    s_waitcnt lgkmcnt(6)
    v_mfma_f32_32x32x16_bf16 v[8:23], v[244:247], v[100:103], v[8:23]
    ds_read_b128 v[240:243], v248 offset:22528
    s_waitcnt lgkmcnt(6)
    v_mfma_f32_32x32x16_bf16 v[24:39], v[216:219], v[100:103], v[24:39]
    s_add_u32 s34, s26, 786432
    buffer_load_dwordx4 v[136:139], v5, s[8:11], s34 offen
    ds_read_b128 v[244:247], v248 offset:23552
    s_waitcnt lgkmcnt(6)
    v_mfma_f32_32x32x16_bf16 v[40:55], v[220:223], v[100:103], v[40:55]
    ds_read_b128 v[216:219], v248 offset:24576
    s_waitcnt lgkmcnt(6)
    v_mfma_f32_32x32x16_bf16 v[56:71], v[224:227], v[100:103], v[56:71]
    ds_read_b128 v[220:223], v248 offset:25600
    s_waitcnt lgkmcnt(6)
    v_mfma_f32_32x32x16_bf16 v[72:87], v[228:231], v[100:103], v[72:87]
    ds_read_b128 v[224:227], v248 offset:26624
    s_waitcnt vmcnt(8)
    s_waitcnt lgkmcnt(6)
    v_mfma_f32_32x32x16_bf16 v[8:23], v[232:235], v[104:107], v[8:23]
    s_add_u32 s34, s26, 851968
    buffer_load_dwordx4 v[140:143], v5, s[8:11], s34 offen
    ds_read_b128 v[228:231], v248 offset:27648
    s_waitcnt lgkmcnt(6)
    v_mfma_f32_32x32x16_bf16 v[24:39], v[236:239], v[104:107], v[24:39]
    s_barrier
    ds_read_b128 v[232:235], v248 offset:28672
    s_waitcnt lgkmcnt(6)
    v_mfma_f32_32x32x16_bf16 v[40:55], v[240:243], v[104:107], v[40:55]
    ds_read_b128 v[236:239], v248 offset:29696
    s_waitcnt lgkmcnt(6)
    v_mfma_f32_32x32x16_bf16 v[56:71], v[244:247], v[104:107], v[56:71]
    s_add_u32 s34, s26, 917504
    buffer_load_dwordx4 v[144:147], v5, s[8:11], s34 offen
    ds_read_b128 v[240:243], v248 offset:30720
    s_waitcnt lgkmcnt(6)
    v_mfma_f32_32x32x16_bf16 v[72:87], v[216:219], v[104:107], v[72:87]
    ds_read_b128 v[244:247], v248 offset:31744
    s_waitcnt vmcnt(9)
    s_waitcnt lgkmcnt(6)
    v_mfma_f32_32x32x16_bf16 v[8:23], v[220:223], v[108:111], v[8:23]
    ds_read_b128 v[216:219], v248 offset:32768
    s_waitcnt lgkmcnt(6)
    v_mfma_f32_32x32x16_bf16 v[24:39], v[224:227], v[108:111], v[24:39]
    s_add_u32 s34, s26, 983040
    buffer_load_dwordx4 v[148:151], v5, s[8:11], s34 offen
    ds_read_b128 v[220:223], v248 offset:33792
    s_waitcnt lgkmcnt(6)
    v_mfma_f32_32x32x16_bf16 v[40:55], v[228:231], v[108:111], v[40:55]
    ds_read_b128 v[224:227], v248 offset:34816
    s_waitcnt lgkmcnt(6)
    v_mfma_f32_32x32x16_bf16 v[56:71], v[232:235], v[108:111], v[56:71]
    ds_read_b128 v[228:231], v248 offset:35840
    s_waitcnt lgkmcnt(6)
    v_mfma_f32_32x32x16_bf16 v[72:87], v[236:239], v[108:111], v[72:87]
    ds_read_b128 v[232:235], v248 offset:36864
    s_waitcnt vmcnt(9)
    s_waitcnt lgkmcnt(6)
    v_mfma_f32_32x32x16_bf16 v[8:23], v[240:243], v[112:115], v[8:23]
    s_add_u32 s34, s26, 1048576
    buffer_load_dwordx4 v[152:155], v5, s[8:11], s34 offen
    ds_read_b128 v[236:239], v248 offset:37888
    s_waitcnt lgkmcnt(6)
    v_mfma_f32_32x32x16_bf16 v[24:39], v[244:247], v[112:115], v[24:39]
    ds_read_b128 v[240:243], v248 offset:38912
    s_waitcnt lgkmcnt(6)
    v_mfma_f32_32x32x16_bf16 v[40:55], v[216:219], v[112:115], v[40:55]
    ds_read_b128 v[244:247], v248 offset:39936
    s_waitcnt lgkmcnt(6)
    v_mfma_f32_32x32x16_bf16 v[56:71], v[220:223], v[112:115], v[56:71]
    s_add_u32 s34, s26, 1114112
    buffer_load_dwordx4 v[156:159], v5, s[8:11], s34 offen
    ds_read_b128 v[216:219], v248 offset:40960
    s_waitcnt lgkmcnt(6)
    v_mfma_f32_32x32x16_bf16 v[72:87], v[224:227], v[112:115], v[72:87]
    ds_read_b128 v[220:223], v248 offset:41984
    s_waitcnt vmcnt(10)
    s_waitcnt lgkmcnt(6)
    v_mfma_f32_32x32x16_bf16 v[8:23], v[228:231], v[116:119], v[8:23]
    ds_read_b128 v[224:227], v248 offset:43008
    s_waitcnt lgkmcnt(6)
    v_mfma_f32_32x32x16_bf16 v[24:39], v[232:235], v[116:119], v[24:39]
    s_add_u32 s34, s26, 1179648
    buffer_load_dwordx4 v[160:163], v5, s[8:11], s34 offen
    ds_read_b128 v[228:231], v248 offset:44032
    s_waitcnt lgkmcnt(6)
    v_mfma_f32_32x32x16_bf16 v[40:55], v[236:239], v[116:119], v[40:55]
    ds_read_b128 v[232:235], v248 offset:45056
    s_waitcnt lgkmcnt(6)
    v_mfma_f32_32x32x16_bf16 v[56:71], v[240:243], v[116:119], v[56:71]
    ds_read_b128 v[236:239], v248 offset:46080
    s_waitcnt lgkmcnt(6)
    v_mfma_f32_32x32x16_bf16 v[72:87], v[244:247], v[116:119], v[72:87]
    ds_read_b128 v[240:243], v248 offset:47104
    s_waitcnt vmcnt(10)
    s_waitcnt lgkmcnt(6)
    v_mfma_f32_32x32x16_bf16 v[8:23], v[216:219], v[120:123], v[8:23]
    s_add_u32 s34, s26, 1245184
    buffer_load_dwordx4 v[164:167], v5, s[8:11], s34 offen
    ds_read_b128 v[244:247], v248 offset:48128
    s_waitcnt lgkmcnt(6)
    v_mfma_f32_32x32x16_bf16 v[24:39], v[220:223], v[120:123], v[24:39]
    s_barrier
    ds_read_b128 v[216:219], v248 offset:49152
    s_waitcnt lgkmcnt(6)
    v_mfma_f32_32x32x16_bf16 v[40:55], v[224:227], v[120:123], v[40:55]
    ds_read_b128 v[220:223], v248 offset:50176
    s_waitcnt lgkmcnt(6)
    v_mfma_f32_32x32x16_bf16 v[56:71], v[228:231], v[120:123], v[56:71]
    s_add_u32 s34, s26, 1310720
    buffer_load_dwordx4 v[168:171], v5, s[8:11], s34 offen
    ds_read_b128 v[224:227], v248 offset:51200
    s_waitcnt lgkmcnt(6)
    v_mfma_f32_32x32x16_bf16 v[72:87], v[232:235], v[120:123], v[72:87]
    ds_read_b128 v[228:231], v248 offset:52224
    s_waitcnt vmcnt(11)
    s_waitcnt lgkmcnt(6)
    v_mfma_f32_32x32x16_bf16 v[8:23], v[236:239], v[124:127], v[8:23]
    ds_read_b128 v[232:235], v248 offset:53248
    s_waitcnt lgkmcnt(6)
    v_mfma_f32_32x32x16_bf16 v[24:39], v[240:243], v[124:127], v[24:39]
    s_add_u32 s34, s26, 1376256
    buffer_load_dwordx4 v[172:175], v5, s[8:11], s34 offen
    ds_read_b128 v[236:239], v248 offset:54272
    s_waitcnt lgkmcnt(6)
    v_mfma_f32_32x32x16_bf16 v[40:55], v[244:247], v[124:127], v[40:55]
    ds_read_b128 v[240:243], v248 offset:55296
    s_waitcnt lgkmcnt(6)
    v_mfma_f32_32x32x16_bf16 v[56:71], v[216:219], v[124:127], v[56:71]
    ds_read_b128 v[244:247], v248 offset:56320
    s_waitcnt lgkmcnt(6)
    v_mfma_f32_32x32x16_bf16 v[72:87], v[220:223], v[124:127], v[72:87]
    ds_read_b128 v[216:219], v248 offset:57344
    s_waitcnt vmcnt(11)
    s_waitcnt lgkmcnt(6)
    v_mfma_f32_32x32x16_bf16 v[8:23], v[224:227], v[128:131], v[8:23]
    s_add_u32 s34, s26, 1441792
    buffer_load_dwordx4 v[176:179], v5, s[8:11], s34 offen
    ds_read_b128 v[220:223], v248 offset:58368
    s_waitcnt lgkmcnt(6)
    v_mfma_f32_32x32x16_bf16 v[24:39], v[228:231], v[128:131], v[24:39]
    ds_read_b128 v[224:227], v248 offset:59392
    s_waitcnt lgkmcnt(6)
    v_mfma_f32_32x32x16_bf16 v[40:55], v[232:235], v[128:131], v[40:55]
    ds_read_b128 v[228:231], v248 offset:60416
    s_waitcnt lgkmcnt(6)
    v_mfma_f32_32x32x16_bf16 v[56:71], v[236:239], v[128:131], v[56:71]
    s_add_u32 s34, s26, 1507328
    buffer_load_dwordx4 v[180:183], v5, s[8:11], s34 offen
    v_add_u32 v248, 0xf000, v248
    ds_read_b128 v[232:235], v248 offset:0
    s_waitcnt lgkmcnt(6)
    v_mfma_f32_32x32x16_bf16 v[72:87], v[240:243], v[128:131], v[72:87]
    ds_read_b128 v[236:239], v248 offset:1024
    s_waitcnt vmcnt(12)
    s_waitcnt lgkmcnt(6)
    v_mfma_f32_32x32x16_bf16 v[8:23], v[244:247], v[132:135], v[8:23]
    ds_read_b128 v[240:243], v248 offset:2048
    s_waitcnt lgkmcnt(6)
    v_mfma_f32_32x32x16_bf16 v[24:39], v[216:219], v[132:135], v[24:39]
    s_add_u32 s34, s26, 1572864
    buffer_load_dwordx4 v[88:91], v5, s[8:11], s34 offen
    ds_read_b128 v[244:247], v248 offset:3072
    s_waitcnt lgkmcnt(6)
    v_mfma_f32_32x32x16_bf16 v[40:55], v[220:223], v[132:135], v[40:55]
    ds_read_b128 v[216:219], v248 offset:4096
    s_waitcnt lgkmcnt(6)
    v_mfma_f32_32x32x16_bf16 v[56:71], v[224:227], v[132:135], v[56:71]
    ds_read_b128 v[220:223], v248 offset:5120
    s_waitcnt lgkmcnt(6)
    v_mfma_f32_32x32x16_bf16 v[72:87], v[228:231], v[132:135], v[72:87]
    ds_read_b128 v[224:227], v248 offset:6144
    s_waitcnt vmcnt(12)
    s_waitcnt lgkmcnt(6)
    v_mfma_f32_32x32x16_bf16 v[8:23], v[232:235], v[136:139], v[8:23]
    s_add_u32 s34, s26, 1638400
    buffer_load_dwordx4 v[92:95], v5, s[8:11], s34 offen
    ds_read_b128 v[228:231], v248 offset:7168
    s_waitcnt lgkmcnt(6)
    v_mfma_f32_32x32x16_bf16 v[24:39], v[236:239], v[136:139], v[24:39]
    s_barrier
    ds_read_b128 v[232:235], v248 offset:8192
    s_waitcnt lgkmcnt(6)
    v_mfma_f32_32x32x16_bf16 v[40:55], v[240:243], v[136:139], v[40:55]
    ds_read_b128 v[236:239], v248 offset:9216
    s_waitcnt lgkmcnt(6)
    v_mfma_f32_32x32x16_bf16 v[56:71], v[244:247], v[136:139], v[56:71]
    s_add_u32 s34, s26, 1703936
    buffer_load_dwordx4 v[96:99], v5, s[8:11], s34 offen
    ds_read_b128 v[240:243], v248 offset:10240
    s_waitcnt lgkmcnt(6)
    v_mfma_f32_32x32x16_bf16 v[72:87], v[216:219], v[136:139], v[72:87]
    ds_read_b128 v[244:247], v248 offset:11264
    s_waitcnt vmcnt(13)
    s_waitcnt lgkmcnt(6)
    v_mfma_f32_32x32x16_bf16 v[8:23], v[220:223], v[140:143], v[8:23]
    ds_read_b128 v[216:219], v248 offset:12288
    s_waitcnt lgkmcnt(6)
    v_mfma_f32_32x32x16_bf16 v[24:39], v[224:227], v[140:143], v[24:39]
    s_add_u32 s34, s26, 1769472
    buffer_load_dwordx4 v[100:103], v5, s[8:11], s34 offen
    ds_read_b128 v[220:223], v248 offset:13312
    s_waitcnt lgkmcnt(6)
    v_mfma_f32_32x32x16_bf16 v[40:55], v[228:231], v[140:143], v[40:55]
    ds_read_b128 v[224:227], v248 offset:14336
    s_waitcnt lgkmcnt(6)
    v_mfma_f32_32x32x16_bf16 v[56:71], v[232:235], v[140:143], v[56:71]
    ds_read_b128 v[228:231], v248 offset:15360
    s_waitcnt lgkmcnt(6)
    v_mfma_f32_32x32x16_bf16 v[72:87], v[236:239], v[140:143], v[72:87]
    ds_read_b128 v[232:235], v248 offset:16384
    s_waitcnt vmcnt(13)
    s_waitcnt lgkmcnt(6)
    v_mfma_f32_32x32x16_bf16 v[8:23], v[240:243], v[144:147], v[8:23]
    s_add_u32 s34, s26, 1835008
    buffer_load_dwordx4 v[104:107], v5, s[8:11], s34 offen
    ds_read_b128 v[236:239], v248 offset:17408
    s_waitcnt lgkmcnt(6)
    v_mfma_f32_32x32x16_bf16 v[24:39], v[244:247], v[144:147], v[24:39]
    ds_read_b128 v[240:243], v248 offset:18432
    s_waitcnt lgkmcnt(6)
    v_mfma_f32_32x32x16_bf16 v[40:55], v[216:219], v[144:147], v[40:55]
    ds_read_b128 v[244:247], v248 offset:19456
    s_waitcnt lgkmcnt(6)
    v_mfma_f32_32x32x16_bf16 v[56:71], v[220:223], v[144:147], v[56:71]
    s_add_u32 s34, s26, 1900544
    buffer_load_dwordx4 v[108:111], v5, s[8:11], s34 offen
    ds_read_b128 v[216:219], v248 offset:20480
    s_waitcnt lgkmcnt(6)
    v_mfma_f32_32x32x16_bf16 v[72:87], v[224:227], v[144:147], v[72:87]
    ds_read_b128 v[220:223], v248 offset:21504
    s_waitcnt vmcnt(14)
    s_waitcnt lgkmcnt(6)
    v_mfma_f32_32x32x16_bf16 v[8:23], v[228:231], v[148:151], v[8:23]
    ds_read_b128 v[224:227], v248 offset:22528
    s_waitcnt lgkmcnt(6)
    v_mfma_f32_32x32x16_bf16 v[24:39], v[232:235], v[148:151], v[24:39]
    s_add_u32 s34, s26, 1966080
    buffer_load_dwordx4 v[112:115], v5, s[8:11], s34 offen
    ds_read_b128 v[228:231], v248 offset:23552
    s_waitcnt lgkmcnt(6)
    v_mfma_f32_32x32x16_bf16 v[40:55], v[236:239], v[148:151], v[40:55]
    ds_read_b128 v[232:235], v248 offset:24576
    s_waitcnt lgkmcnt(6)
    v_mfma_f32_32x32x16_bf16 v[56:71], v[240:243], v[148:151], v[56:71]
    ds_read_b128 v[236:239], v248 offset:25600
    s_waitcnt lgkmcnt(6)
    v_mfma_f32_32x32x16_bf16 v[72:87], v[244:247], v[148:151], v[72:87]
    ds_read_b128 v[240:243], v248 offset:26624
    s_waitcnt vmcnt(14)
    s_waitcnt lgkmcnt(6)
    v_mfma_f32_32x32x16_bf16 v[8:23], v[216:219], v[152:155], v[8:23]
    s_add_u32 s34, s26, 2031616
    buffer_load_dwordx4 v[116:119], v5, s[8:11], s34 offen
    ds_read_b128 v[244:247], v248 offset:27648
    s_waitcnt lgkmcnt(6)
    v_mfma_f32_32x32x16_bf16 v[24:39], v[220:223], v[152:155], v[24:39]
    s_barrier
    ds_read_b128 v[216:219], v248 offset:28672
    s_waitcnt lgkmcnt(6)
    v_mfma_f32_32x32x16_bf16 v[40:55], v[224:227], v[152:155], v[40:55]
    ds_read_b128 v[220:223], v248 offset:29696
    s_waitcnt lgkmcnt(6)
    v_mfma_f32_32x32x16_bf16 v[56:71], v[228:231], v[152:155], v[56:71]
    s_add_u32 s34, s26, 2097152
    buffer_load_dwordx4 v[120:123], v5, s[8:11], s34 offen
    ds_read_b128 v[224:227], v248 offset:30720
    s_waitcnt lgkmcnt(6)
    v_mfma_f32_32x32x16_bf16 v[72:87], v[232:235], v[152:155], v[72:87]
    ds_read_b128 v[228:231], v248 offset:31744
    s_waitcnt vmcnt(15)
    s_waitcnt lgkmcnt(6)
    v_mfma_f32_32x32x16_bf16 v[8:23], v[236:239], v[156:159], v[8:23]
    ds_read_b128 v[232:235], v248 offset:32768
    s_waitcnt lgkmcnt(6)
    v_mfma_f32_32x32x16_bf16 v[24:39], v[240:243], v[156:159], v[24:39]
    s_add_u32 s34, s26, 2162688
    buffer_load_dwordx4 v[124:127], v5, s[8:11], s34 offen
    ds_read_b128 v[236:239], v248 offset:33792
    s_waitcnt lgkmcnt(6)
    v_mfma_f32_32x32x16_bf16 v[40:55], v[244:247], v[156:159], v[40:55]
    ds_read_b128 v[240:243], v248 offset:34816
    s_waitcnt lgkmcnt(6)
    v_mfma_f32_32x32x16_bf16 v[56:71], v[216:219], v[156:159], v[56:71]
    ds_read_b128 v[244:247], v248 offset:35840
    s_waitcnt lgkmcnt(6)
    v_mfma_f32_32x32x16_bf16 v[72:87], v[220:223], v[156:159], v[72:87]
    ds_read_b128 v[216:219], v248 offset:36864
    s_waitcnt vmcnt(15)
    s_waitcnt lgkmcnt(6)
    v_mfma_f32_32x32x16_bf16 v[8:23], v[224:227], v[160:163], v[8:23]
    s_add_u32 s34, s26, 2228224
    buffer_load_dwordx4 v[128:131], v5, s[8:11], s34 offen
    ds_read_b128 v[220:223], v248 offset:37888
    s_waitcnt lgkmcnt(6)
    v_mfma_f32_32x32x16_bf16 v[24:39], v[228:231], v[160:163], v[24:39]
    ds_read_b128 v[224:227], v248 offset:38912
    s_waitcnt lgkmcnt(6)
    v_mfma_f32_32x32x16_bf16 v[40:55], v[232:235], v[160:163], v[40:55]
    ds_read_b128 v[228:231], v248 offset:39936
    s_waitcnt lgkmcnt(6)
    v_mfma_f32_32x32x16_bf16 v[56:71], v[236:239], v[160:163], v[56:71]
    s_add_u32 s34, s26, 2293760
    buffer_load_dwordx4 v[132:135], v5, s[8:11], s34 offen
    ds_read_b128 v[232:235], v248 offset:40960
    s_waitcnt lgkmcnt(6)
    v_mfma_f32_32x32x16_bf16 v[72:87], v[240:243], v[160:163], v[72:87]
    ds_read_b128 v[236:239], v248 offset:41984
    s_waitcnt vmcnt(16)
    s_waitcnt lgkmcnt(6)
    v_mfma_f32_32x32x16_bf16 v[8:23], v[244:247], v[164:167], v[8:23]
    ds_read_b128 v[240:243], v248 offset:43008
    s_waitcnt lgkmcnt(6)
    v_mfma_f32_32x32x16_bf16 v[24:39], v[216:219], v[164:167], v[24:39]
    s_add_u32 s34, s26, 2359296
    buffer_load_dwordx4 v[136:139], v5, s[8:11], s34 offen
    ds_read_b128 v[244:247], v248 offset:44032
    s_waitcnt lgkmcnt(6)
    v_mfma_f32_32x32x16_bf16 v[40:55], v[220:223], v[164:167], v[40:55]
    ds_read_b128 v[216:219], v248 offset:45056
    s_waitcnt lgkmcnt(6)
    v_mfma_f32_32x32x16_bf16 v[56:71], v[224:227], v[164:167], v[56:71]
    ds_read_b128 v[220:223], v248 offset:46080
    s_waitcnt lgkmcnt(6)
    v_mfma_f32_32x32x16_bf16 v[72:87], v[228:231], v[164:167], v[72:87]
    ds_read_b128 v[224:227], v248 offset:47104
    s_waitcnt vmcnt(16)
    s_waitcnt lgkmcnt(6)
    v_mfma_f32_32x32x16_bf16 v[8:23], v[232:235], v[168:171], v[8:23]
    s_add_u32 s34, s26, 2424832
    buffer_load_dwordx4 v[140:143], v5, s[8:11], s34 offen
    ds_read_b128 v[228:231], v248 offset:48128
    s_waitcnt lgkmcnt(6)
    v_mfma_f32_32x32x16_bf16 v[24:39], v[236:239], v[168:171], v[24:39]
    s_barrier
    ds_read_b128 v[232:235], v248 offset:49152
    s_waitcnt lgkmcnt(6)
    v_mfma_f32_32x32x16_bf16 v[40:55], v[240:243], v[168:171], v[40:55]
    ds_read_b128 v[236:239], v248 offset:50176
    s_waitcnt lgkmcnt(6)
    v_mfma_f32_32x32x16_bf16 v[56:71], v[244:247], v[168:171], v[56:71]
    s_add_u32 s34, s26, 2490368
    buffer_load_dwordx4 v[144:147], v5, s[8:11], s34 offen
    ds_read_b128 v[240:243], v248 offset:51200
    s_waitcnt lgkmcnt(6)
    v_mfma_f32_32x32x16_bf16 v[72:87], v[216:219], v[168:171], v[72:87]
    ds_read_b128 v[244:247], v248 offset:52224
    s_waitcnt vmcnt(17)
    s_waitcnt lgkmcnt(6)
    v_mfma_f32_32x32x16_bf16 v[8:23], v[220:223], v[172:175], v[8:23]
    ds_read_b128 v[216:219], v248 offset:53248
    s_waitcnt lgkmcnt(6)
    v_mfma_f32_32x32x16_bf16 v[24:39], v[224:227], v[172:175], v[24:39]
    s_add_u32 s34, s26, 2555904
    buffer_load_dwordx4 v[148:151], v5, s[8:11], s34 offen
    ds_read_b128 v[220:223], v248 offset:54272
    s_waitcnt lgkmcnt(6)
    v_mfma_f32_32x32x16_bf16 v[40:55], v[228:231], v[172:175], v[40:55]
    ds_read_b128 v[224:227], v248 offset:55296
    s_waitcnt lgkmcnt(6)
    v_mfma_f32_32x32x16_bf16 v[56:71], v[232:235], v[172:175], v[56:71]
    ds_read_b128 v[228:231], v248 offset:56320
    s_waitcnt lgkmcnt(6)
    v_mfma_f32_32x32x16_bf16 v[72:87], v[236:239], v[172:175], v[72:87]
    ds_read_b128 v[232:235], v248 offset:57344
    s_waitcnt vmcnt(17)
    s_waitcnt lgkmcnt(6)
    v_mfma_f32_32x32x16_bf16 v[8:23], v[240:243], v[176:179], v[8:23]
    s_add_u32 s34, s26, 2621440
    buffer_load_dwordx4 v[152:155], v5, s[8:11], s34 offen
    ds_read_b128 v[236:239], v248 offset:58368
    s_waitcnt lgkmcnt(6)
    v_mfma_f32_32x32x16_bf16 v[24:39], v[244:247], v[176:179], v[24:39]
    ds_read_b128 v[240:243], v248 offset:59392
    s_waitcnt lgkmcnt(6)
    v_mfma_f32_32x32x16_bf16 v[40:55], v[216:219], v[176:179], v[40:55]
    ds_read_b128 v[244:247], v248 offset:60416
    s_waitcnt lgkmcnt(6)
    v_mfma_f32_32x32x16_bf16 v[56:71], v[220:223], v[176:179], v[56:71]
    buffer_load_dwordx2 v[184:185], v3, s[44:47], s36 offen offset:0
    v_add_u32 v248, 0xf000, v248
    ds_read_b128 v[216:219], v248 offset:0
    s_waitcnt lgkmcnt(6)
    v_mfma_f32_32x32x16_bf16 v[72:87], v[224:227], v[176:179], v[72:87]
    ds_read_b128 v[220:223], v248 offset:1024
    s_waitcnt vmcnt(18)
    s_waitcnt lgkmcnt(6)
    v_mfma_f32_32x32x16_bf16 v[8:23], v[228:231], v[180:183], v[8:23]
    ds_read_b128 v[224:227], v248 offset:2048
    s_waitcnt lgkmcnt(6)
    v_mfma_f32_32x32x16_bf16 v[24:39], v[232:235], v[180:183], v[24:39]
    buffer_load_dwordx4 v[196:199], v4, s[48:51], s38 offen offset:0
    ds_read_b128 v[228:231], v248 offset:3072
    s_waitcnt lgkmcnt(6)
    v_mfma_f32_32x32x16_bf16 v[40:55], v[236:239], v[180:183], v[40:55]
    ds_read_b128 v[232:235], v248 offset:4096
    s_waitcnt lgkmcnt(6)
    v_mfma_f32_32x32x16_bf16 v[56:71], v[240:243], v[180:183], v[56:71]
    ds_read_b128 v[236:239], v248 offset:5120
    s_waitcnt lgkmcnt(6)
    v_mfma_f32_32x32x16_bf16 v[72:87], v[244:247], v[180:183], v[72:87]
    ds_read_b128 v[240:243], v248 offset:6144
    s_waitcnt vmcnt(18)
    s_waitcnt lgkmcnt(6)
    v_mfma_f32_32x32x16_bf16 v[8:23], v[216:219], v[88:91], v[8:23]
    s_add_u32 s34, s26, 2686976
    buffer_load_dwordx4 v[156:159], v5, s[8:11], s34 offen
    ds_read_b128 v[244:247], v248 offset:7168
    s_waitcnt lgkmcnt(6)
    v_mfma_f32_32x32x16_bf16 v[24:39], v[220:223], v[88:91], v[24:39]
    s_barrier
    ds_read_b128 v[216:219], v248 offset:8192
    s_waitcnt lgkmcnt(6)
    v_mfma_f32_32x32x16_bf16 v[40:55], v[224:227], v[88:91], v[40:55]
    ds_read_b128 v[220:223], v248 offset:9216
    s_waitcnt lgkmcnt(6)
    v_mfma_f32_32x32x16_bf16 v[56:71], v[228:231], v[88:91], v[56:71]
    s_add_u32 s34, s26, 2752512
    buffer_load_dwordx4 v[160:163], v5, s[8:11], s34 offen
    ds_read_b128 v[224:227], v248 offset:10240
    s_waitcnt lgkmcnt(6)
    v_mfma_f32_32x32x16_bf16 v[72:87], v[232:235], v[88:91], v[72:87]
    ds_read_b128 v[228:231], v248 offset:11264
    s_waitcnt vmcnt(19)
    s_waitcnt lgkmcnt(6)
    v_mfma_f32_32x32x16_bf16 v[8:23], v[236:239], v[92:95], v[8:23]
    ds_read_b128 v[232:235], v248 offset:12288
    s_waitcnt lgkmcnt(6)
    v_mfma_f32_32x32x16_bf16 v[24:39], v[240:243], v[92:95], v[24:39]
    s_add_u32 s34, s26, 2818048
    buffer_load_dwordx4 v[164:167], v5, s[8:11], s34 offen
    ds_read_b128 v[236:239], v248 offset:13312
    s_waitcnt lgkmcnt(6)
    v_mfma_f32_32x32x16_bf16 v[40:55], v[244:247], v[92:95], v[40:55]
    ds_read_b128 v[240:243], v248 offset:14336
    s_waitcnt lgkmcnt(6)
    v_mfma_f32_32x32x16_bf16 v[56:71], v[216:219], v[92:95], v[56:71]
    ds_read_b128 v[244:247], v248 offset:15360
    s_waitcnt lgkmcnt(6)
    v_mfma_f32_32x32x16_bf16 v[72:87], v[220:223], v[92:95], v[72:87]
    ds_read_b128 v[216:219], v248 offset:16384
    s_waitcnt vmcnt(19)
    s_waitcnt lgkmcnt(6)
    v_mfma_f32_32x32x16_bf16 v[8:23], v[224:227], v[96:99], v[8:23]
    s_add_u32 s34, s26, 2883584
    buffer_load_dwordx4 v[168:171], v5, s[8:11], s34 offen
    ds_read_b128 v[220:223], v248 offset:17408
    s_waitcnt lgkmcnt(6)
    v_mfma_f32_32x32x16_bf16 v[24:39], v[228:231], v[96:99], v[24:39]
    ds_read_b128 v[224:227], v248 offset:18432
    s_waitcnt lgkmcnt(6)
    v_mfma_f32_32x32x16_bf16 v[40:55], v[232:235], v[96:99], v[40:55]
    ds_read_b128 v[228:231], v248 offset:19456
    s_waitcnt lgkmcnt(6)
    v_mfma_f32_32x32x16_bf16 v[56:71], v[236:239], v[96:99], v[56:71]
    buffer_load_dwordx2 v[186:187], v3, s[44:47], s36 offen offset:64
    v_add_u32 v248, 0xfffe2000, v248
    ds_read_b128 v[232:235], v248 offset:0
    s_waitcnt lgkmcnt(6)
    v_mfma_f32_32x32x16_bf16 v[72:87], v[240:243], v[96:99], v[72:87]
    ds_read_b128 v[236:239], v248 offset:1024
    s_waitcnt vmcnt(20)
    s_waitcnt lgkmcnt(6)
    v_mfma_f32_32x32x16_bf16 v[8:23], v[244:247], v[100:103], v[8:23]
    ds_read_b128 v[240:243], v248 offset:2048
    s_waitcnt lgkmcnt(6)
    v_mfma_f32_32x32x16_bf16 v[24:39], v[216:219], v[100:103], v[24:39]
    buffer_load_dwordx4 v[200:203], v4, s[48:51], s38 offen offset:128
    ds_read_b128 v[244:247], v248 offset:3072
    s_waitcnt lgkmcnt(6)
    v_mfma_f32_32x32x16_bf16 v[40:55], v[220:223], v[100:103], v[40:55]
    ds_read_b128 v[216:219], v248 offset:4096
    s_waitcnt lgkmcnt(6)
    v_mfma_f32_32x32x16_bf16 v[56:71], v[224:227], v[100:103], v[56:71]
    ds_read_b128 v[220:223], v248 offset:5120
    s_waitcnt lgkmcnt(6)
    v_mfma_f32_32x32x16_bf16 v[72:87], v[228:231], v[100:103], v[72:87]
    ds_read_b128 v[224:227], v248 offset:6144
    s_waitcnt vmcnt(20)
    s_waitcnt lgkmcnt(6)
    v_mfma_f32_32x32x16_bf16 v[8:23], v[232:235], v[104:107], v[8:23]
    s_add_u32 s34, s26, 2949120
    buffer_load_dwordx4 v[172:175], v5, s[8:11], s34 offen
    ds_read_b128 v[228:231], v248 offset:7168
    s_waitcnt lgkmcnt(6)
    v_mfma_f32_32x32x16_bf16 v[24:39], v[236:239], v[104:107], v[24:39]
    s_barrier
    ds_read_b128 v[232:235], v248 offset:8192
    s_waitcnt lgkmcnt(6)
    v_mfma_f32_32x32x16_bf16 v[40:55], v[240:243], v[104:107], v[40:55]
    ds_read_b128 v[236:239], v248 offset:9216
    s_waitcnt lgkmcnt(6)
    v_mfma_f32_32x32x16_bf16 v[56:71], v[244:247], v[104:107], v[56:71]
    s_add_u32 s34, s26, 3014656
    buffer_load_dwordx4 v[176:179], v5, s[8:11], s34 offen
    ds_read_b128 v[240:243], v248 offset:10240
    s_waitcnt lgkmcnt(6)
    v_mfma_f32_32x32x16_bf16 v[72:87], v[216:219], v[104:107], v[72:87]
    ds_read_b128 v[244:247], v248 offset:11264
    s_waitcnt vmcnt(21)
    s_waitcnt lgkmcnt(6)
    v_mfma_f32_32x32x16_bf16 v[8:23], v[220:223], v[108:111], v[8:23]
    ds_read_b128 v[216:219], v248 offset:12288
    s_waitcnt lgkmcnt(6)
    v_mfma_f32_32x32x16_bf16 v[24:39], v[224:227], v[108:111], v[24:39]
    s_add_u32 s34, s26, 3080192
    buffer_load_dwordx4 v[180:183], v5, s[8:11], s34 offen
    ds_read_b128 v[220:223], v248 offset:13312
    s_waitcnt lgkmcnt(6)
    v_mfma_f32_32x32x16_bf16 v[40:55], v[228:231], v[108:111], v[40:55]
    ds_read_b128 v[224:227], v248 offset:14336
    s_waitcnt lgkmcnt(6)
    v_mfma_f32_32x32x16_bf16 v[56:71], v[232:235], v[108:111], v[56:71]
    ds_read_b128 v[228:231], v248 offset:15360
    s_waitcnt lgkmcnt(6)
    v_mfma_f32_32x32x16_bf16 v[72:87], v[236:239], v[108:111], v[72:87]
    ds_read_b128 v[232:235], v248 offset:16384
    s_waitcnt vmcnt(21)
    s_waitcnt lgkmcnt(6)
    v_mfma_f32_32x32x16_bf16 v[8:23], v[240:243], v[112:115], v[8:23]
    s_add_u32 s34, s26, 3145728
    buffer_load_dwordx4 v[88:91], v5, s[8:11], s34 offen
    ds_read_b128 v[236:239], v248 offset:17408
    s_waitcnt lgkmcnt(6)
    v_mfma_f32_32x32x16_bf16 v[24:39], v[244:247], v[112:115], v[24:39]
    ds_read_b128 v[240:243], v248 offset:18432
    s_waitcnt lgkmcnt(6)
    v_mfma_f32_32x32x16_bf16 v[40:55], v[216:219], v[112:115], v[40:55]
    ds_read_b128 v[244:247], v248 offset:19456
    s_waitcnt lgkmcnt(6)
    v_mfma_f32_32x32x16_bf16 v[56:71], v[220:223], v[112:115], v[56:71]
    buffer_load_dwordx2 v[188:189], v3, s[44:47], s36 offen offset:128
    ds_read_b128 v[216:219], v248 offset:20480
    s_waitcnt lgkmcnt(6)
    v_mfma_f32_32x32x16_bf16 v[72:87], v[224:227], v[112:115], v[72:87]
    ds_read_b128 v[220:223], v248 offset:21504
    s_waitcnt vmcnt(22)
    s_waitcnt lgkmcnt(6)
    v_mfma_f32_32x32x16_bf16 v[8:23], v[228:231], v[116:119], v[8:23]
    ds_read_b128 v[224:227], v248 offset:22528
    s_waitcnt lgkmcnt(6)
    v_mfma_f32_32x32x16_bf16 v[24:39], v[232:235], v[116:119], v[24:39]
    buffer_load_dwordx4 v[204:207], v4, s[48:51], s38 offen offset:256
    ds_read_b128 v[228:231], v248 offset:23552
    s_waitcnt lgkmcnt(6)
    v_mfma_f32_32x32x16_bf16 v[40:55], v[236:239], v[116:119], v[40:55]
    ds_read_b128 v[232:235], v248 offset:24576
    s_waitcnt lgkmcnt(6)
    v_mfma_f32_32x32x16_bf16 v[56:71], v[240:243], v[116:119], v[56:71]
    ds_read_b128 v[236:239], v248 offset:25600
    s_waitcnt lgkmcnt(6)
    v_mfma_f32_32x32x16_bf16 v[72:87], v[244:247], v[116:119], v[72:87]
    ds_read_b128 v[240:243], v248 offset:26624
    s_waitcnt vmcnt(22)
    s_waitcnt lgkmcnt(6)
    v_mfma_f32_32x32x16_bf16 v[8:23], v[216:219], v[120:123], v[8:23]
    s_add_u32 s34, s26, 3211264
    buffer_load_dwordx4 v[92:95], v5, s[8:11], s34 offen
    ds_read_b128 v[244:247], v248 offset:27648
    s_waitcnt lgkmcnt(6)
    v_mfma_f32_32x32x16_bf16 v[24:39], v[220:223], v[120:123], v[24:39]
    s_barrier
    ds_read_b128 v[216:219], v248 offset:28672
    s_waitcnt lgkmcnt(6)
    v_mfma_f32_32x32x16_bf16 v[40:55], v[224:227], v[120:123], v[40:55]
    ds_read_b128 v[220:223], v248 offset:29696
    s_waitcnt lgkmcnt(6)
    v_mfma_f32_32x32x16_bf16 v[56:71], v[228:231], v[120:123], v[56:71]
    s_add_u32 s34, s26, 3276800
    buffer_load_dwordx4 v[96:99], v5, s[8:11], s34 offen
    ds_read_b128 v[224:227], v248 offset:30720
    s_waitcnt lgkmcnt(6)
    v_mfma_f32_32x32x16_bf16 v[72:87], v[232:235], v[120:123], v[72:87]
    ds_read_b128 v[228:231], v248 offset:31744
    s_waitcnt vmcnt(23)
    s_waitcnt lgkmcnt(6)
    v_mfma_f32_32x32x16_bf16 v[8:23], v[236:239], v[124:127], v[8:23]
    ds_read_b128 v[232:235], v248 offset:32768
    s_waitcnt lgkmcnt(6)
    v_mfma_f32_32x32x16_bf16 v[24:39], v[240:243], v[124:127], v[24:39]
    s_add_u32 s34, s26, 3342336
    buffer_load_dwordx4 v[100:103], v5, s[8:11], s34 offen
    ds_read_b128 v[236:239], v248 offset:33792
    s_waitcnt lgkmcnt(6)
    v_mfma_f32_32x32x16_bf16 v[40:55], v[244:247], v[124:127], v[40:55]
    ds_read_b128 v[240:243], v248 offset:34816
    s_waitcnt lgkmcnt(6)
    v_mfma_f32_32x32x16_bf16 v[56:71], v[216:219], v[124:127], v[56:71]
    ds_read_b128 v[244:247], v248 offset:35840
    s_waitcnt lgkmcnt(6)
    v_mfma_f32_32x32x16_bf16 v[72:87], v[220:223], v[124:127], v[72:87]
    ds_read_b128 v[216:219], v248 offset:36864
    s_waitcnt vmcnt(23)
    s_waitcnt lgkmcnt(6)
    v_mfma_f32_32x32x16_bf16 v[8:23], v[224:227], v[128:131], v[8:23]
    s_add_u32 s34, s26, 3407872
    buffer_load_dwordx4 v[104:107], v5, s[8:11], s34 offen
    ds_read_b128 v[220:223], v248 offset:37888
    s_waitcnt lgkmcnt(6)
    v_mfma_f32_32x32x16_bf16 v[24:39], v[228:231], v[128:131], v[24:39]
    ds_read_b128 v[224:227], v248 offset:38912
    s_waitcnt lgkmcnt(6)
    v_mfma_f32_32x32x16_bf16 v[40:55], v[232:235], v[128:131], v[40:55]
    ds_read_b128 v[228:231], v248 offset:39936
    s_waitcnt lgkmcnt(6)
    v_mfma_f32_32x32x16_bf16 v[56:71], v[236:239], v[128:131], v[56:71]
    buffer_load_dwordx2 v[190:191], v3, s[44:47], s36 offen offset:192
    ds_read_b128 v[232:235], v248 offset:40960
    s_waitcnt lgkmcnt(6)
    v_mfma_f32_32x32x16_bf16 v[72:87], v[240:243], v[128:131], v[72:87]
    ds_read_b128 v[236:239], v248 offset:41984
    s_waitcnt vmcnt(24)
    s_waitcnt lgkmcnt(6)
    v_mfma_f32_32x32x16_bf16 v[8:23], v[244:247], v[132:135], v[8:23]
    ds_read_b128 v[240:243], v248 offset:43008
    s_waitcnt lgkmcnt(6)
    v_mfma_f32_32x32x16_bf16 v[24:39], v[216:219], v[132:135], v[24:39]
    buffer_load_dwordx4 v[208:211], v4, s[48:51], s38 offen offset:384
    ds_read_b128 v[244:247], v248 offset:44032
    s_waitcnt lgkmcnt(6)
    v_mfma_f32_32x32x16_bf16 v[40:55], v[220:223], v[132:135], v[40:55]
    ds_read_b128 v[216:219], v248 offset:45056
    s_waitcnt lgkmcnt(6)
    v_mfma_f32_32x32x16_bf16 v[56:71], v[224:227], v[132:135], v[56:71]
    ds_read_b128 v[220:223], v248 offset:46080
    s_waitcnt lgkmcnt(6)
    v_mfma_f32_32x32x16_bf16 v[72:87], v[228:231], v[132:135], v[72:87]
    ds_read_b128 v[224:227], v248 offset:47104
    s_waitcnt vmcnt(24)
    s_waitcnt lgkmcnt(6)
    v_mfma_f32_32x32x16_bf16 v[8:23], v[232:235], v[136:139], v[8:23]
    s_add_u32 s34, s26, 3473408
    buffer_load_dwordx4 v[108:111], v5, s[8:11], s34 offen
    ds_read_b128 v[228:231], v248 offset:48128
    s_waitcnt lgkmcnt(6)
    v_mfma_f32_32x32x16_bf16 v[24:39], v[236:239], v[136:139], v[24:39]
    s_barrier
    ds_read_b128 v[232:235], v248 offset:49152
    s_waitcnt lgkmcnt(6)
    v_mfma_f32_32x32x16_bf16 v[40:55], v[240:243], v[136:139], v[40:55]
    ds_read_b128 v[236:239], v248 offset:50176
    s_waitcnt lgkmcnt(6)
    v_mfma_f32_32x32x16_bf16 v[56:71], v[244:247], v[136:139], v[56:71]
    s_add_u32 s34, s26, 3538944
    buffer_load_dwordx4 v[112:115], v5, s[8:11], s34 offen
    ds_read_b128 v[240:243], v248 offset:51200
    s_waitcnt lgkmcnt(6)
    v_mfma_f32_32x32x16_bf16 v[72:87], v[216:219], v[136:139], v[72:87]
    ds_read_b128 v[244:247], v248 offset:52224
    s_waitcnt vmcnt(25)
    s_waitcnt lgkmcnt(6)
    v_mfma_f32_32x32x16_bf16 v[8:23], v[220:223], v[140:143], v[8:23]
    ds_read_b128 v[216:219], v248 offset:53248
    s_waitcnt lgkmcnt(6)
    v_mfma_f32_32x32x16_bf16 v[24:39], v[224:227], v[140:143], v[24:39]
    s_add_u32 s34, s26, 3604480
    buffer_load_dwordx4 v[116:119], v5, s[8:11], s34 offen
    ds_read_b128 v[220:223], v248 offset:54272
    s_waitcnt lgkmcnt(6)
    v_mfma_f32_32x32x16_bf16 v[40:55], v[228:231], v[140:143], v[40:55]
    ds_read_b128 v[224:227], v248 offset:55296
    s_waitcnt lgkmcnt(6)
    v_mfma_f32_32x32x16_bf16 v[56:71], v[232:235], v[140:143], v[56:71]
    ds_read_b128 v[228:231], v248 offset:56320
    s_waitcnt lgkmcnt(6)
    v_mfma_f32_32x32x16_bf16 v[72:87], v[236:239], v[140:143], v[72:87]
    ds_read_b128 v[232:235], v248 offset:57344
    s_waitcnt vmcnt(25)
    s_waitcnt lgkmcnt(6)
    v_mfma_f32_32x32x16_bf16 v[8:23], v[240:243], v[144:147], v[8:23]
    s_add_u32 s34, s26, 3670016
    buffer_load_dwordx4 v[120:123], v5, s[8:11], s34 offen
    ds_read_b128 v[236:239], v248 offset:58368
    s_waitcnt lgkmcnt(6)
    v_mfma_f32_32x32x16_bf16 v[24:39], v[244:247], v[144:147], v[24:39]
    ds_read_b128 v[240:243], v248 offset:59392
    s_waitcnt lgkmcnt(6)
    v_mfma_f32_32x32x16_bf16 v[40:55], v[216:219], v[144:147], v[40:55]
    ds_read_b128 v[244:247], v248 offset:60416
    s_waitcnt lgkmcnt(6)
    v_mfma_f32_32x32x16_bf16 v[56:71], v[220:223], v[144:147], v[56:71]
    buffer_load_dwordx2 v[192:193], v3, s[44:47], s36 offen offset:256
    v_add_u32 v248, 0xf000, v248
    ds_read_b128 v[216:219], v248 offset:0
    s_waitcnt lgkmcnt(6)
    v_mfma_f32_32x32x16_bf16 v[72:87], v[224:227], v[144:147], v[72:87]
    ds_read_b128 v[220:223], v248 offset:1024
    s_waitcnt vmcnt(26)
    s_waitcnt lgkmcnt(6)
    v_mfma_f32_32x32x16_bf16 v[8:23], v[228:231], v[148:151], v[8:23]
    ds_read_b128 v[224:227], v248 offset:2048
    s_waitcnt lgkmcnt(6)
    v_mfma_f32_32x32x16_bf16 v[24:39], v[232:235], v[148:151], v[24:39]
    buffer_load_dwordx4 v[212:215], v4, s[48:51], s38 offen offset:512
    ds_read_b128 v[228:231], v248 offset:3072
    s_waitcnt lgkmcnt(6)
    v_mfma_f32_32x32x16_bf16 v[40:55], v[236:239], v[148:151], v[40:55]
    ds_read_b128 v[232:235], v248 offset:4096
    s_waitcnt lgkmcnt(6)
    v_mfma_f32_32x32x16_bf16 v[56:71], v[240:243], v[148:151], v[56:71]
    ds_read_b128 v[236:239], v248 offset:5120
    s_waitcnt lgkmcnt(6)
    v_mfma_f32_32x32x16_bf16 v[72:87], v[244:247], v[148:151], v[72:87]
    ds_read_b128 v[240:243], v248 offset:6144
    s_waitcnt vmcnt(26)
    s_waitcnt lgkmcnt(6)
    v_mfma_f32_32x32x16_bf16 v[8:23], v[216:219], v[152:155], v[8:23]
    s_add_u32 s34, s26, 3735552
    buffer_load_dwordx4 v[124:127], v5, s[8:11], s34 offen
    ds_read_b128 v[244:247], v248 offset:7168
    s_waitcnt lgkmcnt(6)
    v_mfma_f32_32x32x16_bf16 v[24:39], v[220:223], v[152:155], v[24:39]
    s_barrier
    ds_read_b128 v[216:219], v248 offset:8192
    s_waitcnt lgkmcnt(6)
    v_mfma_f32_32x32x16_bf16 v[40:55], v[224:227], v[152:155], v[40:55]
    ds_read_b128 v[220:223], v248 offset:9216
    s_waitcnt lgkmcnt(6)
    v_mfma_f32_32x32x16_bf16 v[56:71], v[228:231], v[152:155], v[56:71]
    s_add_u32 s34, s26, 3801088
    buffer_load_dwordx4 v[128:131], v5, s[8:11], s34 offen
    ds_read_b128 v[224:227], v248 offset:10240
    s_waitcnt lgkmcnt(6)
    v_mfma_f32_32x32x16_bf16 v[72:87], v[232:235], v[152:155], v[72:87]
    ds_read_b128 v[228:231], v248 offset:11264
    s_waitcnt vmcnt(25)
    s_waitcnt lgkmcnt(6)
    v_mfma_f32_32x32x16_bf16 v[8:23], v[236:239], v[156:159], v[8:23]
    ds_read_b128 v[232:235], v248 offset:12288
    s_waitcnt lgkmcnt(6)
    v_mfma_f32_32x32x16_bf16 v[24:39], v[240:243], v[156:159], v[24:39]
    s_add_u32 s34, s26, 3866624
    buffer_load_dwordx4 v[132:135], v5, s[8:11], s34 offen
    ds_read_b128 v[236:239], v248 offset:13312
    s_waitcnt lgkmcnt(6)
    v_mfma_f32_32x32x16_bf16 v[40:55], v[244:247], v[156:159], v[40:55]
    ds_read_b128 v[240:243], v248 offset:14336
    s_waitcnt lgkmcnt(6)
    v_mfma_f32_32x32x16_bf16 v[56:71], v[216:219], v[156:159], v[56:71]
    ds_read_b128 v[244:247], v248 offset:15360
    s_waitcnt lgkmcnt(6)
    v_mfma_f32_32x32x16_bf16 v[72:87], v[220:223], v[156:159], v[72:87]
    ds_read_b128 v[216:219], v248 offset:16384
    s_waitcnt vmcnt(25)
    s_waitcnt lgkmcnt(6)
    v_mfma_f32_32x32x16_bf16 v[8:23], v[224:227], v[160:163], v[8:23]
    s_add_u32 s34, s26, 3932160
    buffer_load_dwordx4 v[136:139], v5, s[8:11], s34 offen
    ds_read_b128 v[220:223], v248 offset:17408
    s_waitcnt lgkmcnt(6)
    v_mfma_f32_32x32x16_bf16 v[24:39], v[228:231], v[160:163], v[24:39]
    ds_read_b128 v[224:227], v248 offset:18432
    s_waitcnt lgkmcnt(6)
    v_mfma_f32_32x32x16_bf16 v[40:55], v[232:235], v[160:163], v[40:55]
    ds_read_b128 v[228:231], v248 offset:19456
    s_waitcnt lgkmcnt(6)
    v_mfma_f32_32x32x16_bf16 v[56:71], v[236:239], v[160:163], v[56:71]
    s_add_u32 s34, s26, 3997696
    buffer_load_dwordx4 v[140:143], v5, s[8:11], s34 offen
    ds_read_b128 v[232:235], v248 offset:20480
    s_waitcnt lgkmcnt(6)
    v_mfma_f32_32x32x16_bf16 v[72:87], v[240:243], v[160:163], v[72:87]
    ds_read_b128 v[236:239], v248 offset:21504
    s_waitcnt vmcnt(26)
    s_waitcnt lgkmcnt(6)
    v_mfma_f32_32x32x16_bf16 v[8:23], v[244:247], v[164:167], v[8:23]
    ds_read_b128 v[240:243], v248 offset:22528
    s_waitcnt lgkmcnt(6)
    v_mfma_f32_32x32x16_bf16 v[24:39], v[216:219], v[164:167], v[24:39]
    s_add_u32 s34, s26, 4063232
    buffer_load_dwordx4 v[144:147], v5, s[8:11], s34 offen
    ds_read_b128 v[244:247], v248 offset:23552
    s_waitcnt lgkmcnt(6)
    v_mfma_f32_32x32x16_bf16 v[40:55], v[220:223], v[164:167], v[40:55]
    ds_read_b128 v[216:219], v248 offset:24576
    s_waitcnt lgkmcnt(6)
    v_mfma_f32_32x32x16_bf16 v[56:71], v[224:227], v[164:167], v[56:71]
    ds_read_b128 v[220:223], v248 offset:25600
    s_waitcnt lgkmcnt(6)
    v_mfma_f32_32x32x16_bf16 v[72:87], v[228:231], v[164:167], v[72:87]
    ds_read_b128 v[224:227], v248 offset:26624
    s_waitcnt vmcnt(26)
    s_waitcnt lgkmcnt(6)
    v_mfma_f32_32x32x16_bf16 v[8:23], v[232:235], v[168:171], v[8:23]
    s_add_u32 s34, s26, 4128768
    buffer_load_dwordx4 v[148:151], v5, s[8:11], s34 offen
    ds_read_b128 v[228:231], v248 offset:27648
    s_waitcnt lgkmcnt(6)
    v_mfma_f32_32x32x16_bf16 v[24:39], v[236:239], v[168:171], v[24:39]
    s_barrier
    ds_read_b128 v[232:235], v248 offset:28672
    s_waitcnt lgkmcnt(6)
    v_mfma_f32_32x32x16_bf16 v[40:55], v[240:243], v[168:171], v[40:55]
    ds_read_b128 v[236:239], v248 offset:29696
    s_waitcnt lgkmcnt(6)
    v_mfma_f32_32x32x16_bf16 v[56:71], v[244:247], v[168:171], v[56:71]
    s_add_u32 s34, s26, 4194304
    buffer_load_dwordx4 v[152:155], v5, s[8:11], s34 offen
    ds_read_b128 v[240:243], v248 offset:30720
    s_waitcnt lgkmcnt(6)
    v_mfma_f32_32x32x16_bf16 v[72:87], v[216:219], v[168:171], v[72:87]
    ds_read_b128 v[244:247], v248 offset:31744
    s_waitcnt vmcnt(25)
    s_waitcnt lgkmcnt(6)
    v_mfma_f32_32x32x16_bf16 v[8:23], v[220:223], v[172:175], v[8:23]
    ds_read_b128 v[216:219], v248 offset:32768
    s_waitcnt lgkmcnt(6)
    v_mfma_f32_32x32x16_bf16 v[24:39], v[224:227], v[172:175], v[24:39]
    s_add_u32 s34, s26, 4259840
    buffer_load_dwordx4 v[156:159], v5, s[8:11], s34 offen
    ds_read_b128 v[220:223], v248 offset:33792
    s_waitcnt lgkmcnt(6)
    v_mfma_f32_32x32x16_bf16 v[40:55], v[228:231], v[172:175], v[40:55]
    ds_read_b128 v[224:227], v248 offset:34816
    s_waitcnt lgkmcnt(6)
    v_mfma_f32_32x32x16_bf16 v[56:71], v[232:235], v[172:175], v[56:71]
    ds_read_b128 v[228:231], v248 offset:35840
    s_waitcnt lgkmcnt(6)
    v_mfma_f32_32x32x16_bf16 v[72:87], v[236:239], v[172:175], v[72:87]
    ds_read_b128 v[232:235], v248 offset:36864
    s_waitcnt vmcnt(25)
    s_waitcnt lgkmcnt(6)
    v_mfma_f32_32x32x16_bf16 v[8:23], v[240:243], v[176:179], v[8:23]
    s_add_u32 s34, s26, 4325376
    buffer_load_dwordx4 v[160:163], v5, s[8:11], s34 offen
    ds_read_b128 v[236:239], v248 offset:37888
    s_waitcnt lgkmcnt(6)
    v_mfma_f32_32x32x16_bf16 v[24:39], v[244:247], v[176:179], v[24:39]
    ds_read_b128 v[240:243], v248 offset:38912
    s_waitcnt lgkmcnt(6)
    v_mfma_f32_32x32x16_bf16 v[40:55], v[216:219], v[176:179], v[40:55]
    ds_read_b128 v[244:247], v248 offset:39936
    s_waitcnt lgkmcnt(6)
    v_mfma_f32_32x32x16_bf16 v[56:71], v[220:223], v[176:179], v[56:71]
    s_add_u32 s34, s26, 4390912
    buffer_load_dwordx4 v[164:167], v5, s[8:11], s34 offen
    ds_read_b128 v[216:219], v248 offset:40960
    s_waitcnt lgkmcnt(6)
    v_mfma_f32_32x32x16_bf16 v[72:87], v[224:227], v[176:179], v[72:87]
    ds_read_b128 v[220:223], v248 offset:41984
    s_waitcnt vmcnt(26)
    s_waitcnt lgkmcnt(6)
    v_mfma_f32_32x32x16_bf16 v[8:23], v[228:231], v[180:183], v[8:23]
    ds_read_b128 v[224:227], v248 offset:43008
    s_waitcnt lgkmcnt(6)
    v_mfma_f32_32x32x16_bf16 v[24:39], v[232:235], v[180:183], v[24:39]
    s_add_u32 s34, s26, 4456448
    buffer_load_dwordx4 v[168:171], v5, s[8:11], s34 offen
    ds_read_b128 v[228:231], v248 offset:44032
    s_waitcnt lgkmcnt(6)
    v_mfma_f32_32x32x16_bf16 v[40:55], v[236:239], v[180:183], v[40:55]
    ds_read_b128 v[232:235], v248 offset:45056
    s_waitcnt lgkmcnt(6)
    v_mfma_f32_32x32x16_bf16 v[56:71], v[240:243], v[180:183], v[56:71]
    ds_read_b128 v[236:239], v248 offset:46080
    s_waitcnt lgkmcnt(6)
    v_mfma_f32_32x32x16_bf16 v[72:87], v[244:247], v[180:183], v[72:87]
    ds_read_b128 v[240:243], v248 offset:47104
    s_waitcnt vmcnt(26)
    s_waitcnt lgkmcnt(6)
    v_mfma_f32_32x32x16_bf16 v[8:23], v[216:219], v[88:91], v[8:23]
    s_add_u32 s34, s26, 4521984
    buffer_load_dwordx4 v[172:175], v5, s[8:11], s34 offen
    ds_read_b128 v[244:247], v248 offset:48128
    s_waitcnt lgkmcnt(6)
    v_mfma_f32_32x32x16_bf16 v[24:39], v[220:223], v[88:91], v[24:39]
    s_barrier
    ds_read_b128 v[216:219], v248 offset:49152
    s_waitcnt lgkmcnt(6)
    v_mfma_f32_32x32x16_bf16 v[40:55], v[224:227], v[88:91], v[40:55]
    ds_read_b128 v[220:223], v248 offset:50176
    s_waitcnt lgkmcnt(6)
    v_mfma_f32_32x32x16_bf16 v[56:71], v[228:231], v[88:91], v[56:71]
    s_add_u32 s34, s26, 4587520
    buffer_load_dwordx4 v[176:179], v5, s[8:11], s34 offen
    ds_read_b128 v[224:227], v248 offset:51200
    s_waitcnt lgkmcnt(6)
    v_mfma_f32_32x32x16_bf16 v[72:87], v[232:235], v[88:91], v[72:87]
    ds_read_b128 v[228:231], v248 offset:52224
    s_waitcnt vmcnt(25)
    s_waitcnt lgkmcnt(6)
    v_mfma_f32_32x32x16_bf16 v[8:23], v[236:239], v[92:95], v[8:23]
    ds_read_b128 v[232:235], v248 offset:53248
    s_waitcnt lgkmcnt(6)
    v_mfma_f32_32x32x16_bf16 v[24:39], v[240:243], v[92:95], v[24:39]
    s_add_u32 s34, s26, 4653056
    buffer_load_dwordx4 v[180:183], v5, s[8:11], s34 offen
    ds_read_b128 v[236:239], v248 offset:54272
    s_waitcnt lgkmcnt(6)
    v_mfma_f32_32x32x16_bf16 v[40:55], v[244:247], v[92:95], v[40:55]
    ds_read_b128 v[240:243], v248 offset:55296
    s_waitcnt lgkmcnt(6)
    v_mfma_f32_32x32x16_bf16 v[56:71], v[216:219], v[92:95], v[56:71]
    ds_read_b128 v[244:247], v248 offset:56320
    s_waitcnt lgkmcnt(6)
    v_mfma_f32_32x32x16_bf16 v[72:87], v[220:223], v[92:95], v[72:87]
    ds_read_b128 v[216:219], v248 offset:57344
    s_waitcnt vmcnt(25)
    s_waitcnt lgkmcnt(6)
    v_mfma_f32_32x32x16_bf16 v[8:23], v[224:227], v[96:99], v[8:23]
    ds_read_b128 v[220:223], v248 offset:58368
    s_waitcnt lgkmcnt(6)
    v_mfma_f32_32x32x16_bf16 v[24:39], v[228:231], v[96:99], v[24:39]
    ds_read_b128 v[224:227], v248 offset:59392
    s_waitcnt lgkmcnt(6)
    v_mfma_f32_32x32x16_bf16 v[40:55], v[232:235], v[96:99], v[40:55]
    ds_read_b128 v[228:231], v248 offset:60416
    s_waitcnt lgkmcnt(6)
    v_mfma_f32_32x32x16_bf16 v[56:71], v[236:239], v[96:99], v[56:71]
    v_add_u32 v248, 0xf000, v248
    ds_read_b128 v[232:235], v248 offset:0
    s_waitcnt lgkmcnt(6)
    v_mfma_f32_32x32x16_bf16 v[72:87], v[240:243], v[96:99], v[72:87]
    ds_read_b128 v[236:239], v248 offset:1024
    s_waitcnt vmcnt(24)
    s_waitcnt lgkmcnt(6)
    v_mfma_f32_32x32x16_bf16 v[8:23], v[244:247], v[100:103], v[8:23]
    ds_read_b128 v[240:243], v248 offset:2048
    s_waitcnt lgkmcnt(6)
    v_mfma_f32_32x32x16_bf16 v[24:39], v[216:219], v[100:103], v[24:39]
    ds_read_b128 v[244:247], v248 offset:3072
    s_waitcnt lgkmcnt(6)
    v_mfma_f32_32x32x16_bf16 v[40:55], v[220:223], v[100:103], v[40:55]
    ds_read_b128 v[216:219], v248 offset:4096
    s_waitcnt lgkmcnt(6)
    v_mfma_f32_32x32x16_bf16 v[56:71], v[224:227], v[100:103], v[56:71]
    ds_read_b128 v[220:223], v248 offset:5120
    s_waitcnt lgkmcnt(6)
    v_mfma_f32_32x32x16_bf16 v[72:87], v[228:231], v[100:103], v[72:87]
    ds_read_b128 v[224:227], v248 offset:6144
    s_waitcnt vmcnt(23)
    s_waitcnt lgkmcnt(6)
    v_mfma_f32_32x32x16_bf16 v[8:23], v[232:235], v[104:107], v[8:23]
    ds_read_b128 v[228:231], v248 offset:7168
    s_waitcnt lgkmcnt(6)
    v_mfma_f32_32x32x16_bf16 v[24:39], v[236:239], v[104:107], v[24:39]
    s_barrier
    ds_read_b128 v[232:235], v248 offset:8192
    s_waitcnt lgkmcnt(6)
    v_mfma_f32_32x32x16_bf16 v[40:55], v[240:243], v[104:107], v[40:55]
    ds_read_b128 v[236:239], v248 offset:9216
    s_waitcnt lgkmcnt(6)
    v_mfma_f32_32x32x16_bf16 v[56:71], v[244:247], v[104:107], v[56:71]
    ds_read_b128 v[240:243], v248 offset:10240
    s_waitcnt lgkmcnt(6)
    v_mfma_f32_32x32x16_bf16 v[72:87], v[216:219], v[104:107], v[72:87]
    ds_read_b128 v[244:247], v248 offset:11264
    s_waitcnt vmcnt(20)
    s_waitcnt lgkmcnt(6)
    v_mfma_f32_32x32x16_bf16 v[8:23], v[220:223], v[108:111], v[8:23]
    ds_read_b128 v[216:219], v248 offset:12288
    s_waitcnt lgkmcnt(6)
    v_mfma_f32_32x32x16_bf16 v[24:39], v[224:227], v[108:111], v[24:39]
    ds_read_b128 v[220:223], v248 offset:13312
    s_waitcnt lgkmcnt(6)
    v_mfma_f32_32x32x16_bf16 v[40:55], v[228:231], v[108:111], v[40:55]
    ds_read_b128 v[224:227], v248 offset:14336
    s_waitcnt lgkmcnt(6)
    v_mfma_f32_32x32x16_bf16 v[56:71], v[232:235], v[108:111], v[56:71]
    ds_read_b128 v[228:231], v248 offset:15360
    s_waitcnt lgkmcnt(6)
    v_mfma_f32_32x32x16_bf16 v[72:87], v[236:239], v[108:111], v[72:87]
    ds_read_b128 v[232:235], v248 offset:16384
    s_waitcnt vmcnt(19)
    s_waitcnt lgkmcnt(6)
    v_mfma_f32_32x32x16_bf16 v[8:23], v[240:243], v[112:115], v[8:23]
    ds_read_b128 v[236:239], v248 offset:17408
    s_waitcnt lgkmcnt(6)
    v_mfma_f32_32x32x16_bf16 v[24:39], v[244:247], v[112:115], v[24:39]
    ds_read_b128 v[240:243], v248 offset:18432
    s_waitcnt lgkmcnt(6)
    v_mfma_f32_32x32x16_bf16 v[40:55], v[216:219], v[112:115], v[40:55]
    ds_read_b128 v[244:247], v248 offset:19456
    s_waitcnt lgkmcnt(6)
    v_mfma_f32_32x32x16_bf16 v[56:71], v[220:223], v[112:115], v[56:71]
    v_add_u32 v248, 0xfffe2000, v248
    ds_read_b128 v[216:219], v248 offset:0
    s_waitcnt lgkmcnt(6)
    v_mfma_f32_32x32x16_bf16 v[72:87], v[224:227], v[112:115], v[72:87]
    ds_read_b128 v[220:223], v248 offset:1024
    s_waitcnt vmcnt(18)
    s_waitcnt lgkmcnt(6)
    v_mfma_f32_32x32x16_bf16 v[8:23], v[228:231], v[116:119], v[8:23]
    ds_read_b128 v[224:227], v248 offset:2048
    s_waitcnt lgkmcnt(6)
    v_mfma_f32_32x32x16_bf16 v[24:39], v[232:235], v[116:119], v[24:39]
    ds_read_b128 v[228:231], v248 offset:3072
    s_waitcnt lgkmcnt(6)
    v_mfma_f32_32x32x16_bf16 v[40:55], v[236:239], v[116:119], v[40:55]
    ds_read_b128 v[232:235], v248 offset:4096
    s_waitcnt lgkmcnt(6)
    v_mfma_f32_32x32x16_bf16 v[56:71], v[240:243], v[116:119], v[56:71]
    ds_read_b128 v[236:239], v248 offset:5120
    s_waitcnt lgkmcnt(6)
    v_mfma_f32_32x32x16_bf16 v[72:87], v[244:247], v[116:119], v[72:87]
    ds_read_b128 v[240:243], v248 offset:6144
    s_waitcnt vmcnt(17)
    s_waitcnt lgkmcnt(6)
    v_mfma_f32_32x32x16_bf16 v[8:23], v[216:219], v[120:123], v[8:23]
    ds_read_b128 v[244:247], v248 offset:7168
    s_waitcnt lgkmcnt(6)
    v_mfma_f32_32x32x16_bf16 v[24:39], v[220:223], v[120:123], v[24:39]
    s_barrier
    ds_read_b128 v[216:219], v248 offset:8192
    s_waitcnt lgkmcnt(6)
    v_mfma_f32_32x32x16_bf16 v[40:55], v[224:227], v[120:123], v[40:55]
    ds_read_b128 v[220:223], v248 offset:9216
    s_waitcnt lgkmcnt(6)
    v_mfma_f32_32x32x16_bf16 v[56:71], v[228:231], v[120:123], v[56:71]
    ds_read_b128 v[224:227], v248 offset:10240
    s_waitcnt lgkmcnt(6)
    v_mfma_f32_32x32x16_bf16 v[72:87], v[232:235], v[120:123], v[72:87]
    ds_read_b128 v[228:231], v248 offset:11264
    s_waitcnt vmcnt(14)
    s_waitcnt lgkmcnt(6)
    v_mfma_f32_32x32x16_bf16 v[8:23], v[236:239], v[124:127], v[8:23]
    ds_read_b128 v[232:235], v248 offset:12288
    s_waitcnt lgkmcnt(6)
    v_mfma_f32_32x32x16_bf16 v[24:39], v[240:243], v[124:127], v[24:39]
    ds_read_b128 v[236:239], v248 offset:13312
    s_waitcnt lgkmcnt(6)
    v_mfma_f32_32x32x16_bf16 v[40:55], v[244:247], v[124:127], v[40:55]
    ds_read_b128 v[240:243], v248 offset:14336
    s_waitcnt lgkmcnt(6)
    v_mfma_f32_32x32x16_bf16 v[56:71], v[216:219], v[124:127], v[56:71]
    ds_read_b128 v[244:247], v248 offset:15360
    s_waitcnt lgkmcnt(6)
    v_mfma_f32_32x32x16_bf16 v[72:87], v[220:223], v[124:127], v[72:87]
    ds_read_b128 v[216:219], v248 offset:16384
    s_waitcnt vmcnt(13)
    s_waitcnt lgkmcnt(6)
    v_mfma_f32_32x32x16_bf16 v[8:23], v[224:227], v[128:131], v[8:23]
    ds_read_b128 v[220:223], v248 offset:17408
    s_waitcnt lgkmcnt(6)
    v_mfma_f32_32x32x16_bf16 v[24:39], v[228:231], v[128:131], v[24:39]
    ds_read_b128 v[224:227], v248 offset:18432
    s_waitcnt lgkmcnt(6)
    v_mfma_f32_32x32x16_bf16 v[40:55], v[232:235], v[128:131], v[40:55]
    ds_read_b128 v[228:231], v248 offset:19456
    s_waitcnt lgkmcnt(6)
    v_mfma_f32_32x32x16_bf16 v[56:71], v[236:239], v[128:131], v[56:71]
    ds_read_b128 v[232:235], v248 offset:20480
    s_waitcnt lgkmcnt(6)
    v_mfma_f32_32x32x16_bf16 v[72:87], v[240:243], v[128:131], v[72:87]
    ds_read_b128 v[236:239], v248 offset:21504
    s_waitcnt vmcnt(12)
    s_waitcnt lgkmcnt(6)
    v_mfma_f32_32x32x16_bf16 v[8:23], v[244:247], v[132:135], v[8:23]
    ds_read_b128 v[240:243], v248 offset:22528
    s_waitcnt lgkmcnt(6)
    v_mfma_f32_32x32x16_bf16 v[24:39], v[216:219], v[132:135], v[24:39]
    ds_read_b128 v[244:247], v248 offset:23552
    s_waitcnt lgkmcnt(6)
    v_mfma_f32_32x32x16_bf16 v[40:55], v[220:223], v[132:135], v[40:55]
    ds_read_b128 v[216:219], v248 offset:24576
    s_waitcnt lgkmcnt(6)
    v_mfma_f32_32x32x16_bf16 v[56:71], v[224:227], v[132:135], v[56:71]
    ds_read_b128 v[220:223], v248 offset:25600
    s_waitcnt lgkmcnt(6)
    v_mfma_f32_32x32x16_bf16 v[72:87], v[228:231], v[132:135], v[72:87]
    ds_read_b128 v[224:227], v248 offset:26624
    s_waitcnt vmcnt(11)
    s_waitcnt lgkmcnt(6)
    v_mfma_f32_32x32x16_bf16 v[8:23], v[232:235], v[136:139], v[8:23]
    ds_read_b128 v[228:231], v248 offset:27648
    s_waitcnt lgkmcnt(6)
    v_mfma_f32_32x32x16_bf16 v[24:39], v[236:239], v[136:139], v[24:39]
    s_barrier
    ds_read_b128 v[232:235], v248 offset:28672
    s_waitcnt lgkmcnt(6)
    v_mfma_f32_32x32x16_bf16 v[40:55], v[240:243], v[136:139], v[40:55]
    ds_read_b128 v[236:239], v248 offset:29696
    s_waitcnt lgkmcnt(6)
    v_mfma_f32_32x32x16_bf16 v[56:71], v[244:247], v[136:139], v[56:71]
    ds_read_b128 v[240:243], v248 offset:30720
    s_waitcnt lgkmcnt(6)
    v_mfma_f32_32x32x16_bf16 v[72:87], v[216:219], v[136:139], v[72:87]
    ds_read_b128 v[244:247], v248 offset:31744
    s_waitcnt vmcnt(10)
    s_waitcnt lgkmcnt(6)
    v_mfma_f32_32x32x16_bf16 v[8:23], v[220:223], v[140:143], v[8:23]
    ds_read_b128 v[216:219], v248 offset:32768
    s_waitcnt lgkmcnt(6)
    v_mfma_f32_32x32x16_bf16 v[24:39], v[224:227], v[140:143], v[24:39]
    ds_read_b128 v[220:223], v248 offset:33792
    s_waitcnt lgkmcnt(6)
    v_mfma_f32_32x32x16_bf16 v[40:55], v[228:231], v[140:143], v[40:55]
    ds_read_b128 v[224:227], v248 offset:34816
    s_waitcnt lgkmcnt(6)
    v_mfma_f32_32x32x16_bf16 v[56:71], v[232:235], v[140:143], v[56:71]
    ds_read_b128 v[228:231], v248 offset:35840
    s_waitcnt lgkmcnt(6)
    v_mfma_f32_32x32x16_bf16 v[72:87], v[236:239], v[140:143], v[72:87]
    ds_read_b128 v[232:235], v248 offset:36864
    s_waitcnt vmcnt(9)
    s_waitcnt lgkmcnt(6)
    v_mfma_f32_32x32x16_bf16 v[8:23], v[240:243], v[144:147], v[8:23]
    ds_read_b128 v[236:239], v248 offset:37888
    s_waitcnt lgkmcnt(6)
    v_mfma_f32_32x32x16_bf16 v[24:39], v[244:247], v[144:147], v[24:39]
    ds_read_b128 v[240:243], v248 offset:38912
    s_waitcnt lgkmcnt(6)
    v_mfma_f32_32x32x16_bf16 v[40:55], v[216:219], v[144:147], v[40:55]
    ds_read_b128 v[244:247], v248 offset:39936
    s_waitcnt lgkmcnt(6)
    v_mfma_f32_32x32x16_bf16 v[56:71], v[220:223], v[144:147], v[56:71]
    ds_read_b128 v[216:219], v248 offset:40960
    s_waitcnt lgkmcnt(6)
    v_mfma_f32_32x32x16_bf16 v[72:87], v[224:227], v[144:147], v[72:87]
    ds_read_b128 v[220:223], v248 offset:46080
    s_waitcnt vmcnt(8)
    s_waitcnt lgkmcnt(6)
    v_mfma_f32_32x32x16_bf16 v[8:23], v[228:231], v[148:151], v[8:23]
    ds_read_b128 v[224:227], v248 offset:51200
    s_waitcnt lgkmcnt(6)
    v_mfma_f32_32x32x16_bf16 v[24:39], v[232:235], v[148:151], v[24:39]
    ds_read_b128 v[228:231], v248 offset:56320
    s_waitcnt lgkmcnt(6)
    v_mfma_f32_32x32x16_bf16 v[40:55], v[236:239], v[148:151], v[40:55]
    v_add_u32 v248, 0xf000, v248
    ds_read_b128 v[232:235], v248 offset:0
    s_waitcnt lgkmcnt(6)
    v_mfma_f32_32x32x16_bf16 v[56:71], v[240:243], v[148:151], v[56:71]
    ds_read_b128 v[236:239], v248 offset:5120
    s_waitcnt lgkmcnt(6)
    v_mfma_f32_32x32x16_bf16 v[72:87], v[244:247], v[148:151], v[72:87]
    ds_read_b128 v[240:243], v248 offset:10240
    s_waitcnt vmcnt(7)
    s_waitcnt lgkmcnt(6)
    v_mfma_f32_32x32x16_bf16 v[8:23], v[216:219], v[152:155], v[8:23]
    ds_read_b128 v[244:247], v248 offset:15360
    s_waitcnt vmcnt(6)
    s_waitcnt lgkmcnt(6)
    v_mfma_f32_32x32x16_bf16 v[8:23], v[220:223], v[156:159], v[8:23]
    v_add_u32 v248, 0xffff1000, v248
    ds_read_b128 v[216:219], v248 offset:41984
    s_waitcnt vmcnt(5)
    s_waitcnt lgkmcnt(6)
    v_mfma_f32_32x32x16_bf16 v[8:23], v[224:227], v[160:163], v[8:23]
    ds_read_b128 v[220:223], v248 offset:47104
    s_waitcnt vmcnt(4)
    s_waitcnt lgkmcnt(6)
    v_mfma_f32_32x32x16_bf16 v[8:23], v[228:231], v[164:167], v[8:23]
    ds_read_b128 v[224:227], v248 offset:52224
    s_waitcnt vmcnt(3)
    s_waitcnt lgkmcnt(6)
    v_mfma_f32_32x32x16_bf16 v[8:23], v[232:235], v[168:171], v[8:23]
    ds_read_b128 v[228:231], v248 offset:57344
    s_waitcnt vmcnt(2)
    s_waitcnt lgkmcnt(6)
    v_mfma_f32_32x32x16_bf16 v[8:23], v[236:239], v[172:175], v[8:23]
    v_add_u32 v248, 0xf000, v248
    ds_read_b128 v[232:235], v248 offset:1024
    s_waitcnt vmcnt(1)
    s_waitcnt lgkmcnt(6)
    v_mfma_f32_32x32x16_bf16 v[8:23], v[240:243], v[176:179], v[8:23]
    ds_read_b128 v[236:239], v248 offset:6144
    s_waitcnt vmcnt(0)
    s_waitcnt lgkmcnt(6)
    v_mfma_f32_32x32x16_bf16 v[8:23], v[244:247], v[180:183], v[8:23]
    ds_read_b128 v[240:243], v248 offset:11264
    s_waitcnt lgkmcnt(6)
    v_mfma_f32_32x32x16_bf16 v[24:39], v[216:219], v[152:155], v[24:39]
    ds_read_b128 v[244:247], v248 offset:16384
    s_waitcnt lgkmcnt(6)
    v_mfma_f32_32x32x16_bf16 v[24:39], v[220:223], v[156:159], v[24:39]
    v_add_u32 v248, 0xffff1000, v248
    ds_read_b128 v[216:219], v248 offset:43008
    s_nop 3
    v_cvt_pk_bf16_f32 v12, v12, v13
    v_cvt_pk_bf16_f32 v13, v14, v15
    v_cvt_pk_bf16_f32 v16, v16, v17
    s_waitcnt lgkmcnt(6)
    v_mfma_f32_32x32x16_bf16 v[24:39], v[224:227], v[160:163], v[24:39]
    ds_read_b128 v[220:223], v248 offset:48128
    v_cvt_pk_bf16_f32 v17, v18, v19
    v_cvt_pk_bf16_f32 v20, v20, v21
    v_cvt_pk_bf16_f32 v21, v22, v23
    s_waitcnt lgkmcnt(6)
    v_mfma_f32_32x32x16_bf16 v[24:39], v[228:231], v[164:167], v[24:39]
    ds_read_b128 v[224:227], v248 offset:53248
    s_waitcnt lgkmcnt(6)
    v_mfma_f32_32x32x16_bf16 v[24:39], v[232:235], v[168:171], v[24:39]
    ds_read_b128 v[228:231], v248 offset:58368
    s_waitcnt lgkmcnt(6)
    v_mfma_f32_32x32x16_bf16 v[24:39], v[236:239], v[172:175], v[24:39]
    v_add_u32 v248, 0xf000, v248
    ds_read_b128 v[232:235], v248 offset:2048
    s_waitcnt lgkmcnt(6)
    v_mfma_f32_32x32x16_bf16 v[24:39], v[240:243], v[176:179], v[24:39]
    ds_read_b128 v[236:239], v248 offset:7168
    s_waitcnt lgkmcnt(6)
    v_mfma_f32_32x32x16_bf16 v[24:39], v[244:247], v[180:183], v[24:39]
    ds_read_b128 v[240:243], v248 offset:12288
    s_waitcnt lgkmcnt(6)
    v_mfma_f32_32x32x16_bf16 v[40:55], v[216:219], v[152:155], v[40:55]
    ds_read_b128 v[244:247], v248 offset:17408
    s_waitcnt lgkmcnt(6)
    v_mfma_f32_32x32x16_bf16 v[40:55], v[220:223], v[156:159], v[40:55]
    v_add_u32 v248, 0xffff1000, v248
    ds_read_b128 v[216:219], v248 offset:44032
    s_nop 3
    v_cvt_pk_bf16_f32 v14, v28, v29
    v_cvt_pk_bf16_f32 v15, v30, v31
    buffer_store_dwordx4 v[12:15], v5, s[16:19], s60 offen offset:0 sc1
    s_waitcnt lgkmcnt(6)
    v_mfma_f32_32x32x16_bf16 v[40:55], v[224:227], v[160:163], v[40:55]
    ds_read_b128 v[220:223], v248 offset:49152
    v_cvt_pk_bf16_f32 v18, v32, v33
    v_cvt_pk_bf16_f32 v19, v34, v35
    buffer_store_dwordx4 v[16:19], v5, s[16:19], s61 offen offset:0 sc1
    s_waitcnt lgkmcnt(6)
    v_mfma_f32_32x32x16_bf16 v[40:55], v[228:231], v[164:167], v[40:55]
    ds_read_b128 v[224:227], v248 offset:54272
    v_cvt_pk_bf16_f32 v22, v36, v37
    v_cvt_pk_bf16_f32 v23, v38, v39
    buffer_store_dwordx4 v[20:23], v5, s[16:19], s62 offen offset:0 sc1
    s_waitcnt lgkmcnt(6)
    v_mfma_f32_32x32x16_bf16 v[40:55], v[232:235], v[168:171], v[40:55]
    ds_read_b128 v[228:231], v248 offset:59392
    s_waitcnt lgkmcnt(6)
    v_mfma_f32_32x32x16_bf16 v[40:55], v[236:239], v[172:175], v[40:55]
    v_add_u32 v248, 0xf000, v248
    ds_read_b128 v[232:235], v248 offset:3072
    s_waitcnt lgkmcnt(6)
    v_mfma_f32_32x32x16_bf16 v[40:55], v[240:243], v[176:179], v[40:55]
    ds_read_b128 v[236:239], v248 offset:8192
    s_waitcnt lgkmcnt(6)
    v_mfma_f32_32x32x16_bf16 v[40:55], v[244:247], v[180:183], v[40:55]
    ds_read_b128 v[240:243], v248 offset:13312
    s_waitcnt lgkmcnt(6)
    v_mfma_f32_32x32x16_bf16 v[56:71], v[216:219], v[152:155], v[56:71]
    ds_read_b128 v[244:247], v248 offset:18432
    s_waitcnt lgkmcnt(6)
    v_mfma_f32_32x32x16_bf16 v[56:71], v[220:223], v[156:159], v[56:71]
    v_add_u32 v248, 0xffff1000, v248
    ds_read_b128 v[216:219], v248 offset:45056
    s_nop 3
    v_cvt_pk_bf16_f32 v44, v44, v45
    v_cvt_pk_bf16_f32 v45, v46, v47
    v_cvt_pk_bf16_f32 v48, v48, v49
    s_waitcnt lgkmcnt(6)
    v_mfma_f32_32x32x16_bf16 v[56:71], v[224:227], v[160:163], v[56:71]
    ds_read_b128 v[220:223], v248 offset:50176
    v_cvt_pk_bf16_f32 v49, v50, v51
    v_cvt_pk_bf16_f32 v52, v52, v53
    v_cvt_pk_bf16_f32 v53, v54, v55
    s_waitcnt lgkmcnt(6)
    v_mfma_f32_32x32x16_bf16 v[56:71], v[228:231], v[164:167], v[56:71]
    ds_read_b128 v[224:227], v248 offset:55296
    s_waitcnt lgkmcnt(6)
    v_mfma_f32_32x32x16_bf16 v[56:71], v[232:235], v[168:171], v[56:71]
    ds_read_b128 v[228:231], v248 offset:60416
    s_waitcnt lgkmcnt(6)
    v_mfma_f32_32x32x16_bf16 v[56:71], v[236:239], v[172:175], v[56:71]
    v_add_u32 v248, 0xf000, v248
    ds_read_b128 v[232:235], v248 offset:4096
    s_waitcnt lgkmcnt(6)
    v_mfma_f32_32x32x16_bf16 v[56:71], v[240:243], v[176:179], v[56:71]
    ds_read_b128 v[236:239], v248 offset:9216
    s_waitcnt lgkmcnt(6)
    v_mfma_f32_32x32x16_bf16 v[56:71], v[244:247], v[180:183], v[56:71]
    ds_read_b128 v[240:243], v248 offset:14336
    s_waitcnt lgkmcnt(6)
    v_mfma_f32_32x32x16_bf16 v[72:87], v[216:219], v[152:155], v[72:87]
    ds_read_b128 v[244:247], v248 offset:19456
    s_waitcnt lgkmcnt(6)
    v_mfma_f32_32x32x16_bf16 v[72:87], v[220:223], v[156:159], v[72:87]
    s_nop 5
    v_cvt_pk_bf16_f32 v46, v60, v61
    v_cvt_pk_bf16_f32 v47, v62, v63
    buffer_store_dwordx4 v[44:47], v5, s[16:19], s60 offen offset:1024 sc1
    s_waitcnt lgkmcnt(5)
    v_mfma_f32_32x32x16_bf16 v[72:87], v[224:227], v[160:163], v[72:87]
    v_cvt_pk_bf16_f32 v50, v64, v65
    v_cvt_pk_bf16_f32 v51, v66, v67
    buffer_store_dwordx4 v[48:51], v5, s[16:19], s61 offen offset:1024 sc1
    s_waitcnt lgkmcnt(4)
    v_mfma_f32_32x32x16_bf16 v[72:87], v[228:231], v[164:167], v[72:87]
    v_cvt_pk_bf16_f32 v54, v68, v69
    v_cvt_pk_bf16_f32 v55, v70, v71
    buffer_store_dwordx4 v[52:55], v5, s[16:19], s62 offen offset:1024 sc1
    s_waitcnt lgkmcnt(3)
    v_mfma_f32_32x32x16_bf16 v[72:87], v[232:235], v[168:171], v[72:87]
    s_waitcnt lgkmcnt(2)
    v_mfma_f32_32x32x16_bf16 v[72:87], v[236:239], v[172:175], v[72:87]
    s_waitcnt lgkmcnt(1)
    v_mfma_f32_32x32x16_bf16 v[72:87], v[240:243], v[176:179], v[72:87]
    s_waitcnt lgkmcnt(0)
    v_mfma_f32_32x32x16_bf16 v[72:87], v[244:247], v[180:183], v[72:87]
    s_nop 11
    v_cvt_pk_bf16_f32 v76, v76, v77
    v_cvt_pk_bf16_f32 v77, v78, v79
    buffer_store_dwordx2 v[76:77], v7, s[16:19], s60 offen offset:2048 sc1
    v_cvt_pk_bf16_f32 v80, v80, v81
    v_cvt_pk_bf16_f32 v81, v82, v83
    buffer_store_dwordx2 v[80:81], v7, s[16:19], s61 offen offset:2048 sc1
    v_cvt_pk_bf16_f32 v84, v84, v85
    v_cvt_pk_bf16_f32 v85, v86, v87
    buffer_store_dwordx2 v[84:85], v7, s[16:19], s62 offen offset:2048 sc1
    s_lshl_b32 s33, s25, 11
    buffer_load_dwordx4 v[120:123], v6, s[52:55], s33 offen offset:0
    buffer_load_dwordx4 v[124:127], v6, s[52:55], s33 offen offset:16
    buffer_load_dwordx4 v[128:131], v6, s[52:55], s33 offen offset:32
    s_mov_b32 s63, 0
K6_POLL5:
    buffer_load_dwordx4 v[88:91], v5, s[16:19], s56 offen offset:0 sc1
    buffer_load_dwordx4 v[92:95], v5, s[16:19], s56 offen offset:1024 sc1
    buffer_load_dwordx2 v[96:97], v7, s[16:19], s56 offen offset:2048 sc1
    buffer_load_dwordx4 v[98:101], v5, s[16:19], s57 offen offset:0 sc1
    buffer_load_dwordx4 v[102:105], v5, s[16:19], s57 offen offset:1024 sc1
    buffer_load_dwordx2 v[106:107], v7, s[16:19], s57 offen offset:2048 sc1
    buffer_load_dwordx4 v[108:111], v5, s[16:19], s58 offen offset:0 sc1
    buffer_load_dwordx4 v[112:115], v5, s[16:19], s58 offen offset:1024 sc1
    buffer_load_dwordx2 v[116:117], v7, s[16:19], s58 offen offset:2048 sc1
    s_waitcnt vmcnt(0)
    v_max_u32 v250, v88, v89
    v_max3_u32 v250, v250, v90, v91
    v_max3_u32 v250, v250, v92, v93
    v_max3_u32 v250, v250, v94, v95
    v_max3_u32 v250, v250, v96, v97
    v_max3_u32 v250, v250, v98, v99
    v_max3_u32 v250, v250, v100, v101
    v_max3_u32 v250, v250, v102, v103
    v_max3_u32 v250, v250, v104, v105
    v_max3_u32 v250, v250, v106, v107
    v_max3_u32 v250, v250, v108, v109
    v_max3_u32 v250, v250, v110, v111
    v_max3_u32 v250, v250, v112, v113
    v_max3_u32 v250, v250, v114, v115
    v_max3_u32 v250, v250, v116, v117
    v_cmp_eq_u32 vcc, -1, v250
    s_cbranch_vccz K6_GO5
    s_sleep 2
    s_add_u32 s63, s63, 1
    s_cmp_lt_u32 s63, 0x8000
    s_cbranch_scc1 K6_POLL5
K6_GO5:
    v_add_f32 v144, v120, v122
    v_add_f32 v144, v144, v124
    v_add_f32 v144, v144, v126
    v_add_f32 v144, v144, v128
    v_add_f32 v144, v144, v130
    v_mul_f32 v144, 0xbe2aaaab, v144
    v_add_f32 v145, v121, v123
    v_add_f32 v145, v145, v125
    v_add_f32 v145, v145, v127
    v_add_f32 v145, v145, v129
    v_add_f32 v145, v145, v131
    v_mov_b32 v146, 0
    v_add_f32 v120, v120, v144
    v_fmac_f32 v146, v120, v120
    v_add_f32 v122, v122, v144
    v_fmac_f32 v146, v122, v122
    v_add_f32 v124, v124, v144
    v_fmac_f32 v146, v124, v124
    v_add_f32 v126, v126, v144
    v_fmac_f32 v146, v126, v126
    v_add_f32 v128, v128, v144
    v_fmac_f32 v146, v128, v128
    v_add_f32 v130, v130, v144
    v_fmac_f32 v146, v130, v130
    v_fmac_f32 v145, 0x42c00000, v146
    v_mul_f32 v145, 0x3ae38e39, v145
    v_cvt_pk_bf16_f32 v145, v145, v145
    v_lshlrev_b32 v145, 16, v145
    v_add_f32 v145, 0x3727c5ac, v145
    v_cvt_pk_bf16_f32 v145, v145, v145
    v_lshlrev_b32 v145, 16, v145
    v_sqrt_f32 v145, v145
    s_nop 0
    v_cvt_pk_bf16_f32 v145, v145, v145
    v_lshlrev_b32 v145, 16, v145
    v_rcp_f32 v146, v145
    v_cvt_pk_bf16_f32 v144, v144, v144
    v_lshlrev_b32 v144, 16, v144
    v_mul_f32 v146, v146, v146
    v_lshlrev_b32 v12, 16, v88
    v_and_b32 v13, s30, v88
    v_pk_add_f32 v[8:9], v[8:9], v[12:13]
    v_lshlrev_b32 v12, 16, v98
    v_and_b32 v13, s30, v98
    v_pk_add_f32 v[8:9], v[8:9], v[12:13]
    v_lshlrev_b32 v12, 16, v108
    v_and_b32 v13, s30, v108
    v_pk_add_f32 v[8:9], v[8:9], v[12:13]
    v_pk_mul_f32 v[8:9], v[8:9], v[146:147] op_sel_hi:[1,0]
    v_lshlrev_b32 v12, 16, v184
    v_and_b32 v13, s30, v184
    v_pk_fma_f32 v[12:13], v[8:9], v[196:197], v[12:13]
    v_cvt_pk_bf16_f32 v184, v12, v13
    v_lshlrev_b32 v12, 16, v89
    v_and_b32 v13, s30, v89
    v_pk_add_f32 v[10:11], v[10:11], v[12:13]
    v_lshlrev_b32 v12, 16, v99
    v_and_b32 v13, s30, v99
    v_pk_add_f32 v[10:11], v[10:11], v[12:13]
    v_lshlrev_b32 v12, 16, v109
    v_and_b32 v13, s30, v109
    v_pk_add_f32 v[10:11], v[10:11], v[12:13]
    v_pk_mul_f32 v[10:11], v[10:11], v[146:147] op_sel_hi:[1,0]
    v_lshlrev_b32 v12, 16, v185
    v_and_b32 v13, s30, v185
    v_pk_fma_f32 v[12:13], v[10:11], v[198:199], v[12:13]
    v_cvt_pk_bf16_f32 v185, v12, v13
    buffer_store_dwordx2 v[184:185], v3, s[40:43], s36 offen offset:0
    v_lshlrev_b32 v28, 16, v90
    v_and_b32 v29, s30, v90
    v_pk_add_f32 v[24:25], v[24:25], v[28:29]
    v_lshlrev_b32 v28, 16, v100
    v_and_b32 v29, s30, v100
    v_pk_add_f32 v[24:25], v[24:25], v[28:29]
    v_lshlrev_b32 v28, 16, v110
    v_and_b32 v29, s30, v110
    v_pk_add_f32 v[24:25], v[24:25], v[28:29]
    v_pk_mul_f32 v[24:25], v[24:25], v[146:147] op_sel_hi:[1,0]
    v_lshlrev_b32 v28, 16, v186
    v_and_b32 v29, s30, v186
    v_pk_fma_f32 v[28:29], v[24:25], v[200:201], v[28:29]
    v_cvt_pk_bf16_f32 v186, v28, v29
    v_lshlrev_b32 v28, 16, v91
    v_and_b32 v29, s30, v91
    v_pk_add_f32 v[26:27], v[26:27], v[28:29]
    v_lshlrev_b32 v28, 16, v101
    v_and_b32 v29, s30, v101
    v_pk_add_f32 v[26:27], v[26:27], v[28:29]
    v_lshlrev_b32 v28, 16, v111
    v_and_b32 v29, s30, v111
    v_pk_add_f32 v[26:27], v[26:27], v[28:29]
    v_pk_mul_f32 v[26:27], v[26:27], v[146:147] op_sel_hi:[1,0]
    v_lshlrev_b32 v28, 16, v187
    v_and_b32 v29, s30, v187
    v_pk_fma_f32 v[28:29], v[26:27], v[202:203], v[28:29]
    v_cvt_pk_bf16_f32 v187, v28, v29
    buffer_store_dwordx2 v[186:187], v3, s[40:43], s36 offen offset:64
    v_lshlrev_b32 v44, 16, v92
    v_and_b32 v45, s30, v92
    v_pk_add_f32 v[40:41], v[40:41], v[44:45]
    v_lshlrev_b32 v44, 16, v102
    v_and_b32 v45, s30, v102
    v_pk_add_f32 v[40:41], v[40:41], v[44:45]
    v_lshlrev_b32 v44, 16, v112
    v_and_b32 v45, s30, v112
    v_pk_add_f32 v[40:41], v[40:41], v[44:45]
    v_pk_mul_f32 v[40:41], v[40:41], v[146:147] op_sel_hi:[1,0]
    v_lshlrev_b32 v44, 16, v188
    v_and_b32 v45, s30, v188
    v_pk_fma_f32 v[44:45], v[40:41], v[204:205], v[44:45]
    v_cvt_pk_bf16_f32 v188, v44, v45
    v_lshlrev_b32 v44, 16, v93
    v_and_b32 v45, s30, v93
    v_pk_add_f32 v[42:43], v[42:43], v[44:45]
    v_lshlrev_b32 v44, 16, v103
    v_and_b32 v45, s30, v103
    v_pk_add_f32 v[42:43], v[42:43], v[44:45]
    v_lshlrev_b32 v44, 16, v113
    v_and_b32 v45, s30, v113
    v_pk_add_f32 v[42:43], v[42:43], v[44:45]
    v_pk_mul_f32 v[42:43], v[42:43], v[146:147] op_sel_hi:[1,0]
    v_lshlrev_b32 v44, 16, v189
    v_and_b32 v45, s30, v189
    v_pk_fma_f32 v[44:45], v[42:43], v[206:207], v[44:45]
    v_cvt_pk_bf16_f32 v189, v44, v45
    buffer_store_dwordx2 v[188:189], v3, s[40:43], s36 offen offset:128
    v_lshlrev_b32 v60, 16, v94
    v_and_b32 v61, s30, v94
    v_pk_add_f32 v[56:57], v[56:57], v[60:61]
    v_lshlrev_b32 v60, 16, v104
    v_and_b32 v61, s30, v104
    v_pk_add_f32 v[56:57], v[56:57], v[60:61]
    v_lshlrev_b32 v60, 16, v114
    v_and_b32 v61, s30, v114
    v_pk_add_f32 v[56:57], v[56:57], v[60:61]
    v_pk_mul_f32 v[56:57], v[56:57], v[146:147] op_sel_hi:[1,0]
    v_lshlrev_b32 v60, 16, v190
    v_and_b32 v61, s30, v190
    v_pk_fma_f32 v[60:61], v[56:57], v[208:209], v[60:61]
    v_cvt_pk_bf16_f32 v190, v60, v61
    v_lshlrev_b32 v60, 16, v95
    v_and_b32 v61, s30, v95
    v_pk_add_f32 v[58:59], v[58:59], v[60:61]
    v_lshlrev_b32 v60, 16, v105
    v_and_b32 v61, s30, v105
    v_pk_add_f32 v[58:59], v[58:59], v[60:61]
    v_lshlrev_b32 v60, 16, v115
    v_and_b32 v61, s30, v115
    v_pk_add_f32 v[58:59], v[58:59], v[60:61]
    v_pk_mul_f32 v[58:59], v[58:59], v[146:147] op_sel_hi:[1,0]
    v_lshlrev_b32 v60, 16, v191
    v_and_b32 v61, s30, v191
    v_pk_fma_f32 v[60:61], v[58:59], v[210:211], v[60:61]
    v_cvt_pk_bf16_f32 v191, v60, v61
    buffer_store_dwordx2 v[190:191], v3, s[40:43], s36 offen offset:192
    v_lshlrev_b32 v76, 16, v96
    v_and_b32 v77, s30, v96
    v_pk_add_f32 v[72:73], v[72:73], v[76:77]
    v_lshlrev_b32 v76, 16, v106
    v_and_b32 v77, s30, v106
    v_pk_add_f32 v[72:73], v[72:73], v[76:77]
    v_lshlrev_b32 v76, 16, v116
    v_and_b32 v77, s30, v116
    v_pk_add_f32 v[72:73], v[72:73], v[76:77]
    v_pk_mul_f32 v[72:73], v[72:73], v[146:147] op_sel_hi:[1,0]
    v_lshlrev_b32 v76, 16, v192
    v_and_b32 v77, s30, v192
    v_pk_fma_f32 v[76:77], v[72:73], v[212:213], v[76:77]
    v_cvt_pk_bf16_f32 v192, v76, v77
    v_lshlrev_b32 v76, 16, v97
    v_and_b32 v77, s30, v97
    v_pk_add_f32 v[74:75], v[74:75], v[76:77]
    v_lshlrev_b32 v76, 16, v107
    v_and_b32 v77, s30, v107
    v_pk_add_f32 v[74:75], v[74:75], v[76:77]
    v_lshlrev_b32 v76, 16, v117
    v_and_b32 v77, s30, v117
    v_pk_add_f32 v[74:75], v[74:75], v[76:77]
    v_pk_mul_f32 v[74:75], v[74:75], v[146:147] op_sel_hi:[1,0]
    v_lshlrev_b32 v76, 16, v193
    v_and_b32 v77, s30, v193
    v_pk_fma_f32 v[76:77], v[74:75], v[214:215], v[76:77]
    v_cvt_pk_bf16_f32 v193, v76, v77
    buffer_store_dwordx2 v[192:193], v3, s[40:43], s36 offen offset:256
    s_endpgm
K6_NARROW:
    s_mul_i32 s28, s20, 4096
    s_mul_i32 s27, s22, 1327104
    s_lshr_b32 s33, s24, 1
    s_mul_i32 s33, s33, 663552
    s_add_u32 s27, s27, s33
    s_add_u32 s27, s27, 368640
    s_add_u32 s27, s27, s28
    s_and_b32 s63, s23, 7
    s_mul_i32 s63, s63, 0
    s_mul_i32 s37, s63, 16384
    s_lshl_b32 s63, s63, 18
    s_lshl_b32 s35, s20, 12
    s_add_u32 s35, s35, 81920
    s_cmp_lt_u32 s55, 4
    s_cbranch_scc1 K6_COMP4
    s_add_u32 m0, s28, 0
    s_add_u32 s33, s27, 0
    buffer_load_dwordx4 v5, s[4:7], s33 offen lds
    s_add_u32 m0, s28, 1024
    s_add_u32 s33, s27, 1024
    buffer_load_dwordx4 v5, s[4:7], s33 offen lds
    s_add_u32 m0, s28, 2048
    s_add_u32 s33, s27, 2048
    buffer_load_dwordx4 v5, s[4:7], s33 offen lds
    s_add_u32 m0, s28, 3072
    s_add_u32 s33, s27, 3072
    buffer_load_dwordx4 v5, s[4:7], s33 offen lds
    s_add_u32 m0, s28, 16384
    s_add_u32 s33, s27, 16384
    buffer_load_dwordx4 v5, s[4:7], s33 offen lds
    s_add_u32 m0, s28, 17408
    s_add_u32 s33, s27, 17408
    buffer_load_dwordx4 v5, s[4:7], s33 offen lds
    s_add_u32 m0, s28, 18432
    s_add_u32 s33, s27, 18432
    buffer_load_dwordx4 v5, s[4:7], s33 offen lds
    s_add_u32 m0, s28, 19456
    s_add_u32 s33, s27, 19456
    buffer_load_dwordx4 v5, s[4:7], s33 offen lds
    s_add_u32 m0, s28, 32768
    s_add_u32 s33, s27, 32768
    buffer_load_dwordx4 v5, s[4:7], s33 offen lds
    s_add_u32 m0, s28, 33792
    s_add_u32 s33, s27, 33792
    buffer_load_dwordx4 v5, s[4:7], s33 offen lds
    s_add_u32 m0, s28, 34816
    s_add_u32 s33, s27, 34816
    buffer_load_dwordx4 v5, s[4:7], s33 offen lds
    s_add_u32 m0, s28, 35840
    s_add_u32 s33, s27, 35840
    buffer_load_dwordx4 v5, s[4:7], s33 offen lds
    s_add_u32 m0, s28, 49152
    s_add_u32 s33, s27, 49152
    buffer_load_dwordx4 v5, s[4:7], s33 offen lds
    s_add_u32 m0, s28, 50176
    s_add_u32 s33, s27, 50176
    buffer_load_dwordx4 v5, s[4:7], s33 offen lds
    s_add_u32 m0, s28, 51200
    s_add_u32 s33, s27, 51200
    buffer_load_dwordx4 v5, s[4:7], s33 offen lds
    s_add_u32 m0, s28, 52224
    s_add_u32 s33, s27, 52224
    buffer_load_dwordx4 v5, s[4:7], s33 offen lds
    s_waitcnt vmcnt(12)
    s_barrier
    s_add_u32 m0, s28, 65536
    s_add_u32 s33, s27, 65536
    buffer_load_dwordx4 v5, s[4:7], s33 offen lds
    s_add_u32 m0, s28, 66560
    s_add_u32 s33, s27, 66560
    buffer_load_dwordx4 v5, s[4:7], s33 offen lds
    s_add_u32 m0, s28, 67584
    s_add_u32 s33, s27, 67584
    buffer_load_dwordx4 v5, s[4:7], s33 offen lds
    s_add_u32 m0, s28, 68608
    s_add_u32 s33, s27, 68608
    buffer_load_dwordx4 v5, s[4:7], s33 offen lds
    s_add_u32 m0, s28, 81920
    s_add_u32 s33, s27, 81920
    buffer_load_dwordx4 v5, s[4:7], s33 offen lds
    s_add_u32 m0, s28, 82944
    s_add_u32 s33, s27, 82944
    buffer_load_dwordx4 v5, s[4:7], s33 offen lds
    s_add_u32 m0, s28, 83968
    s_add_u32 s33, s27, 83968
    buffer_load_dwordx4 v5, s[4:7], s33 offen lds
    s_add_u32 m0, s28, 84992
    s_add_u32 s33, s27, 84992
    buffer_load_dwordx4 v5, s[4:7], s33 offen lds
    s_waitcnt vmcnt(16)
    s_barrier
    s_add_u32 m0, s28, 98304
    s_add_u32 s33, s27, 98304
    buffer_load_dwordx4 v5, s[4:7], s33 offen lds
    s_add_u32 m0, s28, 99328
    s_add_u32 s33, s27, 99328
    buffer_load_dwordx4 v5, s[4:7], s33 offen lds
    s_add_u32 m0, s28, 100352
    s_add_u32 s33, s27, 100352
    buffer_load_dwordx4 v5, s[4:7], s33 offen lds
    s_add_u32 m0, s28, 101376
    s_add_u32 s33, s27, 101376
    buffer_load_dwordx4 v5, s[4:7], s33 offen lds
    s_waitcnt vmcnt(16)
    s_barrier
    s_add_u32 m0, s28, 0
    s_add_u32 s33, s27, 114688
    buffer_load_dwordx4 v5, s[4:7], s33 offen lds
    s_add_u32 m0, s28, 1024
    s_add_u32 s33, s27, 115712
    buffer_load_dwordx4 v5, s[4:7], s33 offen lds
    s_add_u32 m0, s28, 2048
    s_add_u32 s33, s27, 116736
    buffer_load_dwordx4 v5, s[4:7], s33 offen lds
    s_add_u32 m0, s28, 3072
    s_add_u32 s33, s27, 117760
    buffer_load_dwordx4 v5, s[4:7], s33 offen lds
    s_waitcnt vmcnt(16)
    s_barrier
    s_add_u32 m0, s28, 16384
    s_add_u32 s33, s27, 131072
    buffer_load_dwordx4 v5, s[4:7], s33 offen lds
    s_add_u32 m0, s28, 17408
    s_add_u32 s33, s27, 132096
    buffer_load_dwordx4 v5, s[4:7], s33 offen lds
    s_add_u32 m0, s28, 18432
    s_add_u32 s33, s27, 133120
    buffer_load_dwordx4 v5, s[4:7], s33 offen lds
    s_add_u32 m0, s28, 19456
    s_add_u32 s33, s27, 134144
    buffer_load_dwordx4 v5, s[4:7], s33 offen lds
    s_waitcnt vmcnt(16)
    s_barrier
    s_add_u32 m0, s28, 32768
    s_add_u32 s33, s27, 147456
    buffer_load_dwordx4 v5, s[4:7], s33 offen lds
    s_add_u32 m0, s28, 33792
    s_add_u32 s33, s27, 148480
    buffer_load_dwordx4 v5, s[4:7], s33 offen lds
    s_add_u32 m0, s28, 34816
    s_add_u32 s33, s27, 149504
    buffer_load_dwordx4 v5, s[4:7], s33 offen lds
    s_add_u32 m0, s28, 35840
    s_add_u32 s33, s27, 150528
    buffer_load_dwordx4 v5, s[4:7], s33 offen lds
    s_waitcnt vmcnt(16)
    s_barrier
    s_add_u32 m0, s28, 49152
    s_add_u32 s33, s27, 163840
    buffer_load_dwordx4 v5, s[4:7], s33 offen lds
    s_add_u32 m0, s28, 50176
    s_add_u32 s33, s27, 164864
    buffer_load_dwordx4 v5, s[4:7], s33 offen lds
    s_add_u32 m0, s28, 51200
    s_add_u32 s33, s27, 165888
    buffer_load_dwordx4 v5, s[4:7], s33 offen lds
    s_add_u32 m0, s28, 52224
    s_add_u32 s33, s27, 166912
    buffer_load_dwordx4 v5, s[4:7], s33 offen lds
    s_waitcnt vmcnt(16)
    s_barrier
    s_add_u32 m0, s28, 65536
    s_add_u32 s33, s27, 180224
    buffer_load_dwordx4 v5, s[4:7], s33 offen lds
    s_add_u32 m0, s28, 66560
    s_add_u32 s33, s27, 181248
    buffer_load_dwordx4 v5, s[4:7], s33 offen lds
    s_add_u32 m0, s28, 67584
    s_add_u32 s33, s27, 182272
    buffer_load_dwordx4 v5, s[4:7], s33 offen lds
    s_add_u32 m0, s28, 68608
    s_add_u32 s33, s27, 183296
    buffer_load_dwordx4 v5, s[4:7], s33 offen lds
    s_waitcnt vmcnt(16)
    s_barrier
    s_add_u32 m0, s28, 81920
    s_add_u32 s33, s27, 196608
    buffer_load_dwordx4 v5, s[4:7], s33 offen lds
    s_add_u32 m0, s28, 82944
    s_add_u32 s33, s27, 197632
    buffer_load_dwordx4 v5, s[4:7], s33 offen lds
    s_add_u32 m0, s28, 83968
    s_add_u32 s33, s27, 198656
    buffer_load_dwordx4 v5, s[4:7], s33 offen lds
    s_add_u32 m0, s28, 84992
    s_add_u32 s33, s27, 199680
    buffer_load_dwordx4 v5, s[4:7], s33 offen lds
    s_waitcnt vmcnt(16)
    s_barrier
    s_add_u32 m0, s28, 98304
    s_add_u32 s33, s27, 212992
    buffer_load_dwordx4 v5, s[4:7], s33 offen lds
    s_add_u32 m0, s28, 99328
    s_add_u32 s33, s27, 214016
    buffer_load_dwordx4 v5, s[4:7], s33 offen lds
    s_add_u32 m0, s28, 100352
    s_add_u32 s33, s27, 215040
    buffer_load_dwordx4 v5, s[4:7], s33 offen lds
    s_add_u32 m0, s28, 101376
    s_add_u32 s33, s27, 216064
    buffer_load_dwordx4 v5, s[4:7], s33 offen lds
    s_waitcnt vmcnt(16)
    s_barrier
    s_add_u32 m0, s28, 0
    s_add_u32 s33, s27, 229376
    buffer_load_dwordx4 v5, s[4:7], s33 offen lds
    s_add_u32 m0, s28, 1024
    s_add_u32 s33, s27, 230400
    buffer_load_dwordx4 v5, s[4:7], s33 offen lds
    s_add_u32 m0, s28, 2048
    s_add_u32 s33, s27, 231424
    buffer_load_dwordx4 v5, s[4:7], s33 offen lds
    s_add_u32 m0, s28, 3072
    s_add_u32 s33, s27, 232448
    buffer_load_dwordx4 v5, s[4:7], s33 offen lds
    s_waitcnt vmcnt(16)
    s_barrier
    s_add_u32 m0, s28, 16384
    s_add_u32 s33, s27, 245760
    buffer_load_dwordx4 v5, s[4:7], s33 offen lds
    s_add_u32 m0, s28, 17408
    s_add_u32 s33, s27, 246784
    buffer_load_dwordx4 v5, s[4:7], s33 offen lds
    s_add_u32 m0, s28, 18432
    s_add_u32 s33, s27, 247808
    buffer_load_dwordx4 v5, s[4:7], s33 offen lds
    s_add_u32 m0, s28, 19456
    s_add_u32 s33, s27, 248832
    buffer_load_dwordx4 v5, s[4:7], s33 offen lds
    s_waitcnt vmcnt(16)
    s_barrier
    s_add_u32 m0, s28, 32768
    s_add_u32 s33, s27, 262144
    buffer_load_dwordx4 v5, s[4:7], s33 offen lds
    s_add_u32 m0, s28, 33792
    s_add_u32 s33, s27, 263168
    buffer_load_dwordx4 v5, s[4:7], s33 offen lds
    s_add_u32 m0, s28, 34816
    s_add_u32 s33, s27, 264192
    buffer_load_dwordx4 v5, s[4:7], s33 offen lds
    s_add_u32 m0, s28, 35840
    s_add_u32 s33, s27, 265216
    buffer_load_dwordx4 v5, s[4:7], s33 offen lds
    s_waitcnt vmcnt(16)
    s_barrier
    s_add_u32 m0, s28, 49152
    s_add_u32 s33, s27, 278528
    buffer_load_dwordx4 v5, s[4:7], s33 offen lds
    s_add_u32 m0, s28, 50176
    s_add_u32 s33, s27, 279552
    buffer_load_dwordx4 v5, s[4:7], s33 offen lds
    s_add_u32 m0, s28, 51200
    s_add_u32 s33, s27, 280576
    buffer_load_dwordx4 v5, s[4:7], s33 offen lds
    s_add_u32 m0, s28, 52224
    s_add_u32 s33, s27, 281600
    buffer_load_dwordx4 v5, s[4:7], s33 offen lds
    s_waitcnt vmcnt(16)
    s_barrier
    s_waitcnt vmcnt(12)
    s_barrier
    s_waitcnt vmcnt(8)
    s_barrier
    s_waitcnt vmcnt(0)
    s_barrier
    s_endpgm
K6_COMP4:
    s_add_u32 s34, s26, 0
    buffer_load_dwordx4 v[88:91], v5, s[8:11], s34 offen
    s_add_u32 s34, s26, 65536
    buffer_load_dwordx4 v[92:95], v5, s[8:11], s34 offen
    s_add_u32 s34, s26, 131072
    buffer_load_dwordx4 v[96:99], v5, s[8:11], s34 offen
    s_add_u32 s34, s26, 196608
    buffer_load_dwordx4 v[100:103], v5, s[8:11], s34 offen
    s_add_u32 s34, s26, 262144
    buffer_load_dwordx4 v[104:107], v5, s[8:11], s34 offen
    s_add_u32 s34, s26, 327680
    buffer_load_dwordx4 v[108:111], v5, s[8:11], s34 offen
    s_add_u32 s34, s26, 393216
    buffer_load_dwordx4 v[112:115], v5, s[8:11], s34 offen
    s_add_u32 s34, s26, 458752
    buffer_load_dwordx4 v[116:119], v5, s[8:11], s34 offen
    v_mov_b32 v248, v5
    s_add_u32 s16, s12, 37748736
    s_addc_u32 s17, s13, 0
    s_mov_b32 s18, 10485760
    s_mov_b32 s19, 0x20000
    s_add_u32 s44, s12, 11534336
    s_addc_u32 s45, s13, 0
    s_mov_b32 s46, 2359296
    s_mov_b32 s47, 0x20000
    s_mov_b32 s42, 2359296
    s_mov_b32 s43, 0x20000
    s_add_u32 s48, s12, 65536
    s_addc_u32 s49, s13, 0
    s_mov_b32 s50, 13824
    s_mov_b32 s51, 0x20000
    s_lshl_b32 s35, s23, 2
    s_add_u32 s35, s35, s24
    s_mul_i32 s32, s35, 163840
    s_mul_i32 s33, s20, 2560
    s_add_u32 s32, s32, s33
    s_mul_i32 s35, s22, 10240
    s_add_u32 s35, s35, s32
    s_mul_i32 s39, s22, 40960
    s_add_u32 s39, s39, s32
    s_add_u32 s33, s22, 1
    s_and_b32 s33, s33, 3
    s_mul_i32 s56, s33, 10240
    s_add_u32 s56, s56, s39
    s_mul_i32 s60, s33, 40960
    s_add_u32 s60, s60, s35
    s_add_u32 s33, s22, 2
    s_and_b32 s33, s33, 3
    s_mul_i32 s57, s33, 10240
    s_add_u32 s57, s57, s39
    s_mul_i32 s61, s33, 40960
    s_add_u32 s61, s61, s35
    s_add_u32 s33, s22, 3
    s_and_b32 s33, s33, 3
    s_mul_i32 s58, s33, 10240
    s_add_u32 s58, s58, s39
    s_mul_i32 s62, s33, 40960
    s_add_u32 s62, s62, s35
    v_lshlrev_b32 v7, 3, v1
    v_and_b32 v3, 31, v1
    v_mul_u32_u24 v3, 1152, v3
    v_lshl_add_u32 v3, v2, 3, v3
    v_lshlrev_b32 v4, 4, v2
    s_mul_i32 s36, s25, 36864
    s_add_u32 s36, s36, s31
    s_lshl_b32 s37, s22, 4
    s_add_u32 s36, s36, s37
    s_add_u32 s38, s31, s37
    s_lshl_b32 s38, s38, 1
    s_add_u32 s38, s38, 11520
    s_add_u32 s52, s12, 131072
    s_addc_u32 s53, s13, 0
    s_mov_b32 s54, 131072
    s_mov_b32 s55, 0x20000
    v_and_b32 v6, 31, v1
    v_lshlrev_b32 v6, 6, v6
    s_lshl_b32 s33, s25, 11
    s_barrier
    ds_read_b128 v[216:219], v248 offset:0
    ds_read_b128 v[220:223], v248 offset:1024
    ds_read_b128 v[224:227], v248 offset:2048
    ds_read_b128 v[228:231], v248 offset:3072
    ds_read_b128 v[232:235], v248 offset:4096
    ds_read_b128 v[236:239], v248 offset:5120
    ds_read_b128 v[240:243], v248 offset:6144
    s_waitcnt vmcnt(7)
    s_waitcnt lgkmcnt(6)
    v_mfma_f32_32x32x16_bf16 v[8:23], v[216:219], v[88:91], 0
    ds_read_b128 v[244:247], v248 offset:7168
    s_waitcnt lgkmcnt(6)
    v_mfma_f32_32x32x16_bf16 v[24:39], v[220:223], v[88:91], 0
    s_barrier
    ds_read_b128 v[216:219], v248 offset:8192
    s_waitcnt lgkmcnt(6)
    v_mfma_f32_32x32x16_bf16 v[40:55], v[224:227], v[88:91], 0
    ds_read_b128 v[220:223], v248 offset:9216
    s_waitcnt lgkmcnt(6)
    v_mfma_f32_32x32x16_bf16 v[56:71], v[228:231], v[88:91], 0
    s_add_u32 s34, s26, 524288
    buffer_load_dwordx4 v[120:123], v5, s[8:11], s34 offen
    ds_read_b128 v[224:227], v248 offset:10240
    s_waitcnt vmcnt(7)
    s_waitcnt lgkmcnt(6)
    v_mfma_f32_32x32x16_bf16 v[8:23], v[232:235], v[92:95], v[8:23]
    ds_read_b128 v[228:231], v248 offset:11264
    s_waitcnt lgkmcnt(6)
    v_mfma_f32_32x32x16_bf16 v[24:39], v[236:239], v[92:95], v[24:39]
    ds_read_b128 v[232:235], v248 offset:12288
    s_waitcnt lgkmcnt(6)
    v_mfma_f32_32x32x16_bf16 v[40:55], v[240:243], v[92:95], v[40:55]
    s_add_u32 s34, s26, 589824
    buffer_load_dwordx4 v[124:127], v5, s[8:11], s34 offen
    ds_read_b128 v[236:239], v248 offset:13312
    s_waitcnt lgkmcnt(6)
    v_mfma_f32_32x32x16_bf16 v[56:71], v[244:247], v[92:95], v[56:71]
    ds_read_b128 v[240:243], v248 offset:14336
    s_waitcnt vmcnt(7)
    s_waitcnt lgkmcnt(6)
    v_mfma_f32_32x32x16_bf16 v[8:23], v[216:219], v[96:99], v[8:23]
    ds_read_b128 v[244:247], v248 offset:15360
    s_waitcnt lgkmcnt(6)
    v_mfma_f32_32x32x16_bf16 v[24:39], v[220:223], v[96:99], v[24:39]
    ds_read_b128 v[216:219], v248 offset:16384
    s_waitcnt lgkmcnt(6)
    v_mfma_f32_32x32x16_bf16 v[40:55], v[224:227], v[96:99], v[40:55]
    s_add_u32 s34, s26, 655360
    buffer_load_dwordx4 v[128:131], v5, s[8:11], s34 offen
    ds_read_b128 v[220:223], v248 offset:17408
    s_waitcnt lgkmcnt(6)
    v_mfma_f32_32x32x16_bf16 v[56:71], v[228:231], v[96:99], v[56:71]
    ds_read_b128 v[224:227], v248 offset:18432
    s_waitcnt vmcnt(7)
    s_waitcnt lgkmcnt(6)
    v_mfma_f32_32x32x16_bf16 v[8:23], v[232:235], v[100:103], v[8:23]
    ds_read_b128 v[228:231], v248 offset:19456
    s_waitcnt lgkmcnt(6)
    v_mfma_f32_32x32x16_bf16 v[24:39], v[236:239], v[100:103], v[24:39]
    s_add_u32 s34, s26, 720896
    buffer_load_dwordx4 v[132:135], v5, s[8:11], s34 offen
    ds_read_b128 v[232:235], v248 offset:20480
    s_waitcnt lgkmcnt(6)
    v_mfma_f32_32x32x16_bf16 v[40:55], v[240:243], v[100:103], v[40:55]
    ds_read_b128 v[236:239], v248 offset:21504
    s_waitcnt lgkmcnt(6)
    v_mfma_f32_32x32x16_bf16 v[56:71], v[244:247], v[100:103], v[56:71]
    ds_read_b128 v[240:243], v248 offset:22528
    s_waitcnt vmcnt(7)
    s_waitcnt lgkmcnt(6)
    v_mfma_f32_32x32x16_bf16 v[8:23], v[216:219], v[104:107], v[8:23]
    s_add_u32 s34, s26, 786432
    buffer_load_dwordx4 v[136:139], v5, s[8:11], s34 offen
    ds_read_b128 v[244:247], v248 offset:23552
    s_waitcnt lgkmcnt(6)
    v_mfma_f32_32x32x16_bf16 v[24:39], v[220:223], v[104:107], v[24:39]
    s_barrier
    ds_read_b128 v[216:219], v248 offset:24576
    s_waitcnt lgkmcnt(6)
    v_mfma_f32_32x32x16_bf16 v[40:55], v[224:227], v[104:107], v[40:55]
    ds_read_b128 v[220:223], v248 offset:25600
    s_waitcnt lgkmcnt(6)
    v_mfma_f32_32x32x16_bf16 v[56:71], v[228:231], v[104:107], v[56:71]
    ds_read_b128 v[224:227], v248 offset:26624
    s_waitcnt vmcnt(7)
    s_waitcnt lgkmcnt(6)
    v_mfma_f32_32x32x16_bf16 v[8:23], v[232:235], v[108:111], v[8:23]
    s_add_u32 s34, s26, 851968
    buffer_load_dwordx4 v[140:143], v5, s[8:11], s34 offen
    ds_read_b128 v[228:231], v248 offset:27648
    s_waitcnt lgkmcnt(6)
    v_mfma_f32_32x32x16_bf16 v[24:39], v[236:239], v[108:111], v[24:39]
    ds_read_b128 v[232:235], v248 offset:28672
    s_waitcnt lgkmcnt(6)
    v_mfma_f32_32x32x16_bf16 v[40:55], v[240:243], v[108:111], v[40:55]
    ds_read_b128 v[236:239], v248 offset:29696
    s_waitcnt lgkmcnt(6)
    v_mfma_f32_32x32x16_bf16 v[56:71], v[244:247], v[108:111], v[56:71]
    s_add_u32 s34, s26, 917504
    buffer_load_dwordx4 v[144:147], v5, s[8:11], s34 offen
    ds_read_b128 v[240:243], v248 offset:30720
    s_waitcnt vmcnt(8)
    s_waitcnt lgkmcnt(6)
    v_mfma_f32_32x32x16_bf16 v[8:23], v[216:219], v[112:115], v[8:23]
    ds_read_b128 v[244:247], v248 offset:31744
    s_waitcnt lgkmcnt(6)
    v_mfma_f32_32x32x16_bf16 v[24:39], v[220:223], v[112:115], v[24:39]
    ds_read_b128 v[216:219], v248 offset:32768
    s_waitcnt lgkmcnt(6)
    v_mfma_f32_32x32x16_bf16 v[40:55], v[224:227], v[112:115], v[40:55]
    s_add_u32 s34, s26, 983040
    buffer_load_dwordx4 v[148:151], v5, s[8:11], s34 offen
    ds_read_b128 v[220:223], v248 offset:33792
    s_waitcnt lgkmcnt(6)
    v_mfma_f32_32x32x16_bf16 v[56:71], v[228:231], v[112:115], v[56:71]
    ds_read_b128 v[224:227], v248 offset:34816
    s_waitcnt vmcnt(8)
    s_waitcnt lgkmcnt(6)
    v_mfma_f32_32x32x16_bf16 v[8:23], v[232:235], v[116:119], v[8:23]
    ds_read_b128 v[228:231], v248 offset:35840
    s_waitcnt lgkmcnt(6)
    v_mfma_f32_32x32x16_bf16 v[24:39], v[236:239], v[116:119], v[24:39]
    ds_read_b128 v[232:235], v248 offset:36864
    s_waitcnt lgkmcnt(6)
    v_mfma_f32_32x32x16_bf16 v[40:55], v[240:243], v[116:119], v[40:55]
    s_add_u32 s34, s26, 1048576
    buffer_load_dwordx4 v[152:155], v5, s[8:11], s34 offen
    ds_read_b128 v[236:239], v248 offset:37888
    s_waitcnt lgkmcnt(6)
    v_mfma_f32_32x32x16_bf16 v[56:71], v[244:247], v[116:119], v[56:71]
    ds_read_b128 v[240:243], v248 offset:38912
    s_waitcnt vmcnt(8)
    s_waitcnt lgkmcnt(6)
    v_mfma_f32_32x32x16_bf16 v[8:23], v[216:219], v[120:123], v[8:23]
    ds_read_b128 v[244:247], v248 offset:39936
    s_waitcnt lgkmcnt(6)
    v_mfma_f32_32x32x16_bf16 v[24:39], v[220:223], v[120:123], v[24:39]
    s_add_u32 s34, s26, 1114112
    buffer_load_dwordx4 v[156:159], v5, s[8:11], s34 offen
    s_barrier
    ds_read_b128 v[216:219], v248 offset:40960
    s_waitcnt lgkmcnt(6)
    v_mfma_f32_32x32x16_bf16 v[40:55], v[224:227], v[120:123], v[40:55]
    ds_read_b128 v[220:223], v248 offset:41984
    s_waitcnt lgkmcnt(6)
    v_mfma_f32_32x32x16_bf16 v[56:71], v[228:231], v[120:123], v[56:71]
    ds_read_b128 v[224:227], v248 offset:43008
    s_waitcnt vmcnt(8)
    s_waitcnt lgkmcnt(6)
    v_mfma_f32_32x32x16_bf16 v[8:23], v[232:235], v[124:127], v[8:23]
    s_add_u32 s34, s26, 1179648
    buffer_load_dwordx4 v[160:163], v5, s[8:11], s34 offen
    ds_read_b128 v[228:231], v248 offset:44032
    s_waitcnt lgkmcnt(6)
    v_mfma_f32_32x32x16_bf16 v[24:39], v[236:239], v[124:127], v[24:39]
    ds_read_b128 v[232:235], v248 offset:45056
    s_waitcnt lgkmcnt(6)
    v_mfma_f32_32x32x16_bf16 v[40:55], v[240:243], v[124:127], v[40:55]
    ds_read_b128 v[236:239], v248 offset:46080
    s_waitcnt lgkmcnt(6)
    v_mfma_f32_32x32x16_bf16 v[56:71], v[244:247], v[124:127], v[56:71]
    ds_read_b128 v[240:243], v248 offset:47104
    s_waitcnt vmcnt(8)
    s_waitcnt lgkmcnt(6)
    v_mfma_f32_32x32x16_bf16 v[8:23], v[216:219], v[128:131], v[8:23]
    s_add_u32 s34, s26, 1245184
    buffer_load_dwordx4 v[164:167], v5, s[8:11], s34 offen
    ds_read_b128 v[244:247], v248 offset:48128
    s_waitcnt lgkmcnt(6)
    v_mfma_f32_32x32x16_bf16 v[24:39], v[220:223], v[128:131], v[24:39]
    v_add_u32 v248, 0xc000, v248
    ds_read_b128 v[216:219], v248 offset:0
    s_waitcnt lgkmcnt(6)
    v_mfma_f32_32x32x16_bf16 v[40:55], v[224:227], v[128:131], v[40:55]
    ds_read_b128 v[220:223], v248 offset:1024
    s_waitcnt lgkmcnt(6)
    v_mfma_f32_32x32x16_bf16 v[56:71], v[228:231], v[128:131], v[56:71]
    s_add_u32 s34, s26, 1310720
    buffer_load_dwordx4 v[168:171], v5, s[8:11], s34 offen
    ds_read_b128 v[224:227], v248 offset:2048
    s_waitcnt vmcnt(9)
    s_waitcnt lgkmcnt(6)
    v_mfma_f32_32x32x16_bf16 v[8:23], v[232:235], v[132:135], v[8:23]
    ds_read_b128 v[228:231], v248 offset:3072
    s_waitcnt lgkmcnt(6)
    v_mfma_f32_32x32x16_bf16 v[24:39], v[236:239], v[132:135], v[24:39]
    ds_read_b128 v[232:235], v248 offset:4096
    s_waitcnt lgkmcnt(6)
    v_mfma_f32_32x32x16_bf16 v[40:55], v[240:243], v[132:135], v[40:55]
    s_add_u32 s34, s26, 1376256
    buffer_load_dwordx4 v[172:175], v5, s[8:11], s34 offen
    ds_read_b128 v[236:239], v248 offset:5120
    s_waitcnt lgkmcnt(6)
    v_mfma_f32_32x32x16_bf16 v[56:71], v[244:247], v[132:135], v[56:71]
    ds_read_b128 v[240:243], v248 offset:6144
    s_waitcnt vmcnt(9)
    s_waitcnt lgkmcnt(6)
    v_mfma_f32_32x32x16_bf16 v[8:23], v[216:219], v[136:139], v[8:23]
    ds_read_b128 v[244:247], v248 offset:7168
    s_waitcnt lgkmcnt(6)
    v_mfma_f32_32x32x16_bf16 v[24:39], v[220:223], v[136:139], v[24:39]
    s_barrier
    ds_read_b128 v[216:219], v248 offset:8192
    s_waitcnt lgkmcnt(6)
    v_mfma_f32_32x32x16_bf16 v[40:55], v[224:227], v[136:139], v[40:55]
    s_add_u32 s34, s26, 1441792
    buffer_load_dwordx4 v[176:179], v5, s[8:11], s34 offen
    ds_read_b128 v[220:223], v248 offset:9216
    s_waitcnt lgkmcnt(6)
    v_mfma_f32_32x32x16_bf16 v[56:71], v[228:231], v[136:139], v[56:71]
    ds_read_b128 v[224:227], v248 offset:10240
    s_waitcnt vmcnt(9)
    s_waitcnt lgkmcnt(6)
    v_mfma_f32_32x32x16_bf16 v[8:23], v[232:235], v[140:143], v[8:23]
    ds_read_b128 v[228:231], v248 offset:11264
    s_waitcnt lgkmcnt(6)
    v_mfma_f32_32x32x16_bf16 v[24:39], v[236:239], v[140:143], v[24:39]
    s_add_u32 s34, s26, 1507328
    buffer_load_dwordx4 v[180:183], v5, s[8:11], s34 offen
    ds_read_b128 v[232:235], v248 offset:12288
    s_waitcnt lgkmcnt(6)
    v_mfma_f32_32x32x16_bf16 v[40:55], v[240:243], v[140:143], v[40:55]
    ds_read_b128 v[236:239], v248 offset:13312
    s_waitcnt lgkmcnt(6)
    v_mfma_f32_32x32x16_bf16 v[56:71], v[244:247], v[140:143], v[56:71]
    ds_read_b128 v[240:243], v248 offset:14336
    s_waitcnt vmcnt(9)
    s_waitcnt lgkmcnt(6)
    v_mfma_f32_32x32x16_bf16 v[8:23], v[216:219], v[144:147], v[8:23]
    s_add_u32 s34, s26, 1572864
    buffer_load_dwordx4 v[88:91], v5, s[8:11], s34 offen
    ds_read_b128 v[244:247], v248 offset:15360
    s_waitcnt lgkmcnt(6)
    v_mfma_f32_32x32x16_bf16 v[24:39], v[220:223], v[144:147], v[24:39]
    ds_read_b128 v[216:219], v248 offset:16384
    s_waitcnt lgkmcnt(6)
    v_mfma_f32_32x32x16_bf16 v[40:55], v[224:227], v[144:147], v[40:55]
    ds_read_b128 v[220:223], v248 offset:17408
    s_waitcnt lgkmcnt(6)
    v_mfma_f32_32x32x16_bf16 v[56:71], v[228:231], v[144:147], v[56:71]
    ds_read_b128 v[224:227], v248 offset:18432
    s_waitcnt vmcnt(9)
    s_waitcnt lgkmcnt(6)
    v_mfma_f32_32x32x16_bf16 v[8:23], v[232:235], v[148:151], v[8:23]
    s_add_u32 s34, s26, 1638400
    buffer_load_dwordx4 v[92:95], v5, s[8:11], s34 offen
    ds_read_b128 v[228:231], v248 offset:19456
    s_waitcnt lgkmcnt(6)
    v_mfma_f32_32x32x16_bf16 v[24:39], v[236:239], v[148:151], v[24:39]
    ds_read_b128 v[232:235], v248 offset:20480
    s_waitcnt lgkmcnt(6)
    v_mfma_f32_32x32x16_bf16 v[40:55], v[240:243], v[148:151], v[40:55]
    ds_read_b128 v[236:239], v248 offset:21504
    s_waitcnt lgkmcnt(6)
    v_mfma_f32_32x32x16_bf16 v[56:71], v[244:247], v[148:151], v[56:71]
    s_add_u32 s34, s26, 1703936
    buffer_load_dwordx4 v[96:99], v5, s[8:11], s34 offen
    ds_read_b128 v[240:243], v248 offset:22528
    s_waitcnt vmcnt(10)
    s_waitcnt lgkmcnt(6)
    v_mfma_f32_32x32x16_bf16 v[8:23], v[216:219], v[152:155], v[8:23]
    ds_read_b128 v[244:247], v248 offset:23552
    s_waitcnt lgkmcnt(6)
    v_mfma_f32_32x32x16_bf16 v[24:39], v[220:223], v[152:155], v[24:39]
    s_barrier
    ds_read_b128 v[216:219], v248 offset:24576
    s_waitcnt lgkmcnt(6)
    v_mfma_f32_32x32x16_bf16 v[40:55], v[224:227], v[152:155], v[40:55]
    s_add_u32 s34, s26, 1769472
    buffer_load_dwordx4 v[100:103], v5, s[8:11], s34 offen
    ds_read_b128 v[220:223], v248 offset:25600
    s_waitcnt lgkmcnt(6)
    v_mfma_f32_32x32x16_bf16 v[56:71], v[228:231], v[152:155], v[56:71]
    ds_read_b128 v[224:227], v248 offset:26624
    s_waitcnt vmcnt(10)
    s_waitcnt lgkmcnt(6)
    v_mfma_f32_32x32x16_bf16 v[8:23], v[232:235], v[156:159], v[8:23]
    ds_read_b128 v[228:231], v248 offset:27648
    s_waitcnt lgkmcnt(6)
    v_mfma_f32_32x32x16_bf16 v[24:39], v[236:239], v[156:159], v[24:39]
    ds_read_b128 v[232:235], v248 offset:28672
    s_waitcnt lgkmcnt(6)
    v_mfma_f32_32x32x16_bf16 v[40:55], v[240:243], v[156:159], v[40:55]
    s_add_u32 s34, s26, 1835008
    buffer_load_dwordx4 v[104:107], v5, s[8:11], s34 offen
    ds_read_b128 v[236:239], v248 offset:29696
    s_waitcnt lgkmcnt(6)
    v_mfma_f32_32x32x16_bf16 v[56:71], v[244:247], v[156:159], v[56:71]
    ds_read_b128 v[240:243], v248 offset:30720
    s_waitcnt vmcnt(10)
    s_waitcnt lgkmcnt(6)
    v_mfma_f32_32x32x16_bf16 v[8:23], v[216:219], v[160:163], v[8:23]
    ds_read_b128 v[244:247], v248 offset:31744
    s_waitcnt lgkmcnt(6)
    v_mfma_f32_32x32x16_bf16 v[24:39], v[220:223], v[160:163], v[24:39]
    s_add_u32 s34, s26, 1900544
    buffer_load_dwordx4 v[108:111], v5, s[8:11], s34 offen
    ds_read_b128 v[216:219], v248 offset:32768
    s_waitcnt lgkmcnt(6)
    v_mfma_f32_32x32x16_bf16 v[40:55], v[224:227], v[160:163], v[40:55]
    ds_read_b128 v[220:223], v248 offset:33792
    s_waitcnt lgkmcnt(6)
    v_mfma_f32_32x32x16_bf16 v[56:71], v[228:231], v[160:163], v[56:71]
    ds_read_b128 v[224:227], v248 offset:34816
    s_waitcnt vmcnt(10)
    s_waitcnt lgkmcnt(6)
    v_mfma_f32_32x32x16_bf16 v[8:23], v[232:235], v[164:167], v[8:23]
    s_add_u32 s34, s26, 1966080
    buffer_load_dwordx4 v[112:115], v5, s[8:11], s34 offen
    ds_read_b128 v[228:231], v248 offset:35840
    s_waitcnt lgkmcnt(6)
    v_mfma_f32_32x32x16_bf16 v[24:39], v[236:239], v[164:167], v[24:39]
    ds_read_b128 v[232:235], v248 offset:36864
    s_waitcnt lgkmcnt(6)
    v_mfma_f32_32x32x16_bf16 v[40:55], v[240:243], v[164:167], v[40:55]
    ds_read_b128 v[236:239], v248 offset:37888
    s_waitcnt lgkmcnt(6)
    v_mfma_f32_32x32x16_bf16 v[56:71], v[244:247], v[164:167], v[56:71]
    ds_read_b128 v[240:243], v248 offset:38912
    s_waitcnt vmcnt(10)
    s_waitcnt lgkmcnt(6)
    v_mfma_f32_32x32x16_bf16 v[8:23], v[216:219], v[168:171], v[8:23]
    s_add_u32 s34, s26, 2031616
    buffer_load_dwordx4 v[116:119], v5, s[8:11], s34 offen
    ds_read_b128 v[244:247], v248 offset:39936
    s_waitcnt lgkmcnt(6)
    v_mfma_f32_32x32x16_bf16 v[24:39], v[220:223], v[168:171], v[24:39]
    s_barrier
    ds_read_b128 v[216:219], v248 offset:40960
    s_waitcnt lgkmcnt(6)
    v_mfma_f32_32x32x16_bf16 v[40:55], v[224:227], v[168:171], v[40:55]
    ds_read_b128 v[220:223], v248 offset:41984
    s_waitcnt lgkmcnt(6)
    v_mfma_f32_32x32x16_bf16 v[56:71], v[228:231], v[168:171], v[56:71]
    s_add_u32 s34, s26, 2097152
    buffer_load_dwordx4 v[120:123], v5, s[8:11], s34 offen
    ds_read_b128 v[224:227], v248 offset:43008
    s_waitcnt vmcnt(11)
    s_waitcnt lgkmcnt(6)
    v_mfma_f32_32x32x16_bf16 v[8:23], v[232:235], v[172:175], v[8:23]
    ds_read_b128 v[228:231], v248 offset:44032
    s_waitcnt lgkmcnt(6)
    v_mfma_f32_32x32x16_bf16 v[24:39], v[236:239], v[172:175], v[24:39]
    ds_read_b128 v[232:235], v248 offset:45056
    s_waitcnt lgkmcnt(6)
    v_mfma_f32_32x32x16_bf16 v[40:55], v[240:243], v[172:175], v[40:55]
    s_add_u32 s34, s26, 2162688
    buffer_load_dwordx4 v[124:127], v5, s[8:11], s34 offen
    ds_read_b128 v[236:239], v248 offset:46080
    s_waitcnt lgkmcnt(6)
    v_mfma_f32_32x32x16_bf16 v[56:71], v[244:247], v[172:175], v[56:71]
    ds_read_b128 v[240:243], v248 offset:47104
    s_waitcnt vmcnt(11)
    s_waitcnt lgkmcnt(6)
    v_mfma_f32_32x32x16_bf16 v[8:23], v[216:219], v[176:179], v[8:23]
    ds_read_b128 v[244:247], v248 offset:48128
    s_waitcnt lgkmcnt(6)
    v_mfma_f32_32x32x16_bf16 v[24:39], v[220:223], v[176:179], v[24:39]
    v_add_u32 v248, 0xc000, v248
    ds_read_b128 v[216:219], v248 offset:0
    s_waitcnt lgkmcnt(6)
    v_mfma_f32_32x32x16_bf16 v[40:55], v[224:227], v[176:179], v[40:55]
    s_add_u32 s34, s26, 2228224
    buffer_load_dwordx4 v[128:131], v5, s[8:11], s34 offen
    ds_read_b128 v[220:223], v248 offset:1024
    s_waitcnt lgkmcnt(6)
    v_mfma_f32_32x32x16_bf16 v[56:71], v[228:231], v[176:179], v[56:71]
    ds_read_b128 v[224:227], v248 offset:2048
    s_waitcnt vmcnt(11)
    s_waitcnt lgkmcnt(6)
    v_mfma_f32_32x32x16_bf16 v[8:23], v[232:235], v[180:183], v[8:23]
    ds_read_b128 v[228:231], v248 offset:3072
    s_waitcnt lgkmcnt(6)
    v_mfma_f32_32x32x16_bf16 v[24:39], v[236:239], v[180:183], v[24:39]
    s_add_u32 s34, s26, 2293760
    buffer_load_dwordx4 v[132:135], v5, s[8:11], s34 offen
    ds_read_b128 v[232:235], v248 offset:4096
    s_waitcnt lgkmcnt(6)
    v_mfma_f32_32x32x16_bf16 v[40:55], v[240:243], v[180:183], v[40:55]
    ds_read_b128 v[236:239], v248 offset:5120
    s_waitcnt lgkmcnt(6)
    v_mfma_f32_32x32x16_bf16 v[56:71], v[244:247], v[180:183], v[56:71]
    ds_read_b128 v[240:243], v248 offset:6144
    s_waitcnt vmcnt(11)
    s_waitcnt lgkmcnt(6)
    v_mfma_f32_32x32x16_bf16 v[8:23], v[216:219], v[88:91], v[8:23]
    s_add_u32 s34, s26, 2359296
    buffer_load_dwordx4 v[136:139], v5, s[8:11], s34 offen
    ds_read_b128 v[244:247], v248 offset:7168
    s_waitcnt lgkmcnt(6)
    v_mfma_f32_32x32x16_bf16 v[24:39], v[220:223], v[88:91], v[24:39]
    s_barrier
    ds_read_b128 v[216:219], v248 offset:8192
    s_waitcnt lgkmcnt(6)
    v_mfma_f32_32x32x16_bf16 v[40:55], v[224:227], v[88:91], v[40:55]
    ds_read_b128 v[220:223], v248 offset:9216
    s_waitcnt lgkmcnt(6)
    v_mfma_f32_32x32x16_bf16 v[56:71], v[228:231], v[88:91], v[56:71]
    ds_read_b128 v[224:227], v248 offset:10240
    s_waitcnt vmcnt(11)
    s_waitcnt lgkmcnt(6)
    v_mfma_f32_32x32x16_bf16 v[8:23], v[232:235], v[92:95], v[8:23]
    s_add_u32 s34, s26, 2424832
    buffer_load_dwordx4 v[140:143], v5, s[8:11], s34 offen
    ds_read_b128 v[228:231], v248 offset:11264
    s_waitcnt lgkmcnt(6)
    v_mfma_f32_32x32x16_bf16 v[24:39], v[236:239], v[92:95], v[24:39]
    ds_read_b128 v[232:235], v248 offset:12288
    s_waitcnt lgkmcnt(6)
    v_mfma_f32_32x32x16_bf16 v[40:55], v[240:243], v[92:95], v[40:55]
    ds_read_b128 v[236:239], v248 offset:13312
    s_waitcnt lgkmcnt(6)
    v_mfma_f32_32x32x16_bf16 v[56:71], v[244:247], v[92:95], v[56:71]
    s_add_u32 s34, s26, 2490368
    buffer_load_dwordx4 v[144:147], v5, s[8:11], s34 offen
    ds_read_b128 v[240:243], v248 offset:14336
    s_waitcnt vmcnt(12)
    s_waitcnt lgkmcnt(6)
    v_mfma_f32_32x32x16_bf16 v[8:23], v[216:219], v[96:99], v[8:23]
    ds_read_b128 v[244:247], v248 offset:15360
    s_waitcnt lgkmcnt(6)
    v_mfma_f32_32x32x16_bf16 v[24:39], v[220:223], v[96:99], v[24:39]
    v_add_u32 v248, 0xfffe8000, v248
    ds_read_b128 v[216:219], v248 offset:0
    s_waitcnt lgkmcnt(6)
    v_mfma_f32_32x32x16_bf16 v[40:55], v[224:227], v[96:99], v[40:55]
    s_add_u32 s34, s26, 2555904
    buffer_load_dwordx4 v[148:151], v5, s[8:11], s34 offen
    ds_read_b128 v[220:223], v248 offset:1024
    s_waitcnt lgkmcnt(6)
    v_mfma_f32_32x32x16_bf16 v[56:71], v[228:231], v[96:99], v[56:71]
    ds_read_b128 v[224:227], v248 offset:2048
    s_waitcnt vmcnt(12)
    s_waitcnt lgkmcnt(6)
    v_mfma_f32_32x32x16_bf16 v[8:23], v[232:235], v[100:103], v[8:23]
    ds_read_b128 v[228:231], v248 offset:3072
    s_waitcnt lgkmcnt(6)
    v_mfma_f32_32x32x16_bf16 v[24:39], v[236:239], v[100:103], v[24:39]
    ds_read_b128 v[232:235], v248 offset:4096
    s_waitcnt lgkmcnt(6)
    v_mfma_f32_32x32x16_bf16 v[40:55], v[240:243], v[100:103], v[40:55]
    s_add_u32 s34, s26, 2621440
    buffer_load_dwordx4 v[152:155], v5, s[8:11], s34 offen
    ds_read_b128 v[236:239], v248 offset:5120
    s_waitcnt lgkmcnt(6)
    v_mfma_f32_32x32x16_bf16 v[56:71], v[244:247], v[100:103], v[56:71]
    ds_read_b128 v[240:243], v248 offset:6144
    s_waitcnt vmcnt(12)
    s_waitcnt lgkmcnt(6)
    v_mfma_f32_32x32x16_bf16 v[8:23], v[216:219], v[104:107], v[8:23]
    ds_read_b128 v[244:247], v248 offset:7168
    s_waitcnt lgkmcnt(6)
    v_mfma_f32_32x32x16_bf16 v[24:39], v[220:223], v[104:107], v[24:39]
    buffer_load_dwordx2 v[184:185], v3, s[44:47], s36 offen offset:0
    s_barrier
    ds_read_b128 v[216:219], v248 offset:8192
    s_waitcnt lgkmcnt(6)
    v_mfma_f32_32x32x16_bf16 v[40:55], v[224:227], v[104:107], v[40:55]
    ds_read_b128 v[220:223], v248 offset:9216
    s_waitcnt lgkmcnt(6)
    v_mfma_f32_32x32x16_bf16 v[56:71], v[228:231], v[104:107], v[56:71]
    ds_read_b128 v[224:227], v248 offset:10240
    s_waitcnt vmcnt(12)
    s_waitcnt lgkmcnt(6)
    v_mfma_f32_32x32x16_bf16 v[8:23], v[232:235], v[108:111], v[8:23]
    buffer_load_dwordx4 v[196:199], v4, s[48:51], s38 offen offset:0
    ds_read_b128 v[228:231], v248 offset:11264
    s_waitcnt lgkmcnt(6)
    v_mfma_f32_32x32x16_bf16 v[24:39], v[236:239], v[108:111], v[24:39]
    ds_read_b128 v[232:235], v248 offset:12288
    s_waitcnt lgkmcnt(6)
    v_mfma_f32_32x32x16_bf16 v[40:55], v[240:243], v[108:111], v[40:55]
    ds_read_b128 v[236:239], v248 offset:13312
    s_waitcnt lgkmcnt(6)
    v_mfma_f32_32x32x16_bf16 v[56:71], v[244:247], v[108:111], v[56:71]
    ds_read_b128 v[240:243], v248 offset:14336
    s_waitcnt vmcnt(12)
    s_waitcnt lgkmcnt(6)
    v_mfma_f32_32x32x16_bf16 v[8:23], v[216:219], v[112:115], v[8:23]
    s_add_u32 s34, s26, 2686976
    buffer_load_dwordx4 v[156:159], v5, s[8:11], s34 offen
    ds_read_b128 v[244:247], v248 offset:15360
    s_waitcnt lgkmcnt(6)
    v_mfma_f32_32x32x16_bf16 v[24:39], v[220:223], v[112:115], v[24:39]
    ds_read_b128 v[216:219], v248 offset:16384
    s_waitcnt lgkmcnt(6)
    v_mfma_f32_32x32x16_bf16 v[40:55], v[224:227], v[112:115], v[40:55]
    ds_read_b128 v[220:223], v248 offset:17408
    s_waitcnt lgkmcnt(6)
    v_mfma_f32_32x32x16_bf16 v[56:71], v[228:231], v[112:115], v[56:71]
    s_add_u32 s34, s26, 2752512
    buffer_load_dwordx4 v[160:163], v5, s[8:11], s34 offen
    ds_read_b128 v[224:227], v248 offset:18432
    s_waitcnt vmcnt(13)
    s_waitcnt lgkmcnt(6)
    v_mfma_f32_32x32x16_bf16 v[8:23], v[232:235], v[116:119], v[8:23]
    ds_read_b128 v[228:231], v248 offset:19456
    s_waitcnt lgkmcnt(6)
    v_mfma_f32_32x32x16_bf16 v[24:39], v[236:239], v[116:119], v[24:39]
    ds_read_b128 v[232:235], v248 offset:20480
    s_waitcnt lgkmcnt(6)
    v_mfma_f32_32x32x16_bf16 v[40:55], v[240:243], v[116:119], v[40:55]
    s_add_u32 s34, s26, 2818048
    buffer_load_dwordx4 v[164:167], v5, s[8:11], s34 offen
    ds_read_b128 v[236:239], v248 offset:21504
    s_waitcnt lgkmcnt(6)
    v_mfma_f32_32x32x16_bf16 v[56:71], v[244:247], v[116:119], v[56:71]
    ds_read_b128 v[240:243], v248 offset:22528
    s_waitcnt vmcnt(13)
    s_waitcnt lgkmcnt(6)
    v_mfma_f32_32x32x16_bf16 v[8:23], v[216:219], v[120:123], v[8:23]
    ds_read_b128 v[244:247], v248 offset:23552
    s_waitcnt lgkmcnt(6)
    v_mfma_f32_32x32x16_bf16 v[24:39], v[220:223], v[120:123], v[24:39]
    s_barrier
    ds_read_b128 v[216:219], v248 offset:24576
    s_waitcnt lgkmcnt(6)
    v_mfma_f32_32x32x16_bf16 v[40:55], v[224:227], v[120:123], v[40:55]
    s_add_u32 s34, s26, 2883584
    buffer_load_dwordx4 v[168:171], v5, s[8:11], s34 offen
    ds_read_b128 v[220:223], v248 offset:25600
    s_waitcnt lgkmcnt(6)
    v_mfma_f32_32x32x16_bf16 v[56:71], v[228:231], v[120:123], v[56:71]
    ds_read_b128 v[224:227], v248 offset:26624
    s_waitcnt vmcnt(13)
    s_waitcnt lgkmcnt(6)
    v_mfma_f32_32x32x16_bf16 v[8:23], v[232:235], v[124:127], v[8:23]
    ds_read_b128 v[228:231], v248 offset:27648
    s_waitcnt lgkmcnt(6)
    v_mfma_f32_32x32x16_bf16 v[24:39], v[236:239], v[124:127], v[24:39]
    buffer_load_dwordx2 v[186:187], v3, s[44:47], s36 offen offset:64
    ds_read_b128 v[232:235], v248 offset:28672
    s_waitcnt lgkmcnt(6)
    v_mfma_f32_32x32x16_bf16 v[40:55], v[240:243], v[124:127], v[40:55]
    ds_read_b128 v[236:239], v248 offset:29696
    s_waitcnt lgkmcnt(6)
    v_mfma_f32_32x32x16_bf16 v[56:71], v[244:247], v[124:127], v[56:71]
    ds_read_b128 v[240:243], v248 offset:30720
    s_waitcnt vmcnt(13)
    s_waitcnt lgkmcnt(6)
    v_mfma_f32_32x32x16_bf16 v[8:23], v[216:219], v[128:131], v[8:23]
    buffer_load_dwordx4 v[200:203], v4, s[48:51], s38 offen offset:128
    ds_read_b128 v[244:247], v248 offset:31744
    s_waitcnt lgkmcnt(6)
    v_mfma_f32_32x32x16_bf16 v[24:39], v[220:223], v[128:131], v[24:39]
    ds_read_b128 v[216:219], v248 offset:32768
    s_waitcnt lgkmcnt(6)
    v_mfma_f32_32x32x16_bf16 v[40:55], v[224:227], v[128:131], v[40:55]
    ds_read_b128 v[220:223], v248 offset:33792
    s_waitcnt lgkmcnt(6)
    v_mfma_f32_32x32x16_bf16 v[56:71], v[228:231], v[128:131], v[56:71]
    ds_read_b128 v[224:227], v248 offset:34816
    s_waitcnt vmcnt(13)
    s_waitcnt lgkmcnt(6)
    v_mfma_f32_32x32x16_bf16 v[8:23], v[232:235], v[132:135], v[8:23]
    s_add_u32 s34, s26, 2949120
    buffer_load_dwordx4 v[172:175], v5, s[8:11], s34 offen
    ds_read_b128 v[228:231], v248 offset:35840
    s_waitcnt lgkmcnt(6)
    v_mfma_f32_32x32x16_bf16 v[24:39], v[236:239], v[132:135], v[24:39]
    ds_read_b128 v[232:235], v248 offset:36864
    s_waitcnt lgkmcnt(6)
    v_mfma_f32_32x32x16_bf16 v[40:55], v[240:243], v[132:135], v[40:55]
    ds_read_b128 v[236:239], v248 offset:37888
    s_waitcnt lgkmcnt(6)
    v_mfma_f32_32x32x16_bf16 v[56:71], v[244:247], v[132:135], v[56:71]
    s_add_u32 s34, s26, 3014656
    buffer_load_dwordx4 v[176:179], v5, s[8:11], s34 offen
    ds_read_b128 v[240:243], v248 offset:38912
    s_waitcnt vmcnt(14)
    s_waitcnt lgkmcnt(6)
    v_mfma_f32_32x32x16_bf16 v[8:23], v[216:219], v[136:139], v[8:23]
    ds_read_b128 v[244:247], v248 offset:39936
    s_waitcnt lgkmcnt(6)
    v_mfma_f32_32x32x16_bf16 v[24:39], v[220:223], v[136:139], v[24:39]
    s_barrier
    ds_read_b128 v[216:219], v248 offset:40960
    s_waitcnt lgkmcnt(6)
    v_mfma_f32_32x32x16_bf16 v[40:55], v[224:227], v[136:139], v[40:55]
    s_add_u32 s34, s26, 3080192
    buffer_load_dwordx4 v[180:183], v5, s[8:11], s34 offen
    ds_read_b128 v[220:223], v248 offset:41984
    s_waitcnt lgkmcnt(6)
    v_mfma_f32_32x32x16_bf16 v[56:71], v[228:231], v[136:139], v[56:71]
    ds_read_b128 v[224:227], v248 offset:43008
    s_waitcnt vmcnt(14)
    s_waitcnt lgkmcnt(6)
    v_mfma_f32_32x32x16_bf16 v[8:23], v[232:235], v[140:143], v[8:23]
    ds_read_b128 v[228:231], v248 offset:44032
    s_waitcnt lgkmcnt(6)
    v_mfma_f32_32x32x16_bf16 v[24:39], v[236:239], v[140:143], v[24:39]
    ds_read_b128 v[232:235], v248 offset:45056
    s_waitcnt lgkmcnt(6)
    v_mfma_f32_32x32x16_bf16 v[40:55], v[240:243], v[140:143], v[40:55]
    s_add_u32 s34, s26, 3145728
    buffer_load_dwordx4 v[88:91], v5, s[8:11], s34 offen
    ds_read_b128 v[236:239], v248 offset:46080
    s_waitcnt lgkmcnt(6)
    v_mfma_f32_32x32x16_bf16 v[56:71], v[244:247], v[140:143], v[56:71]
    ds_read_b128 v[240:243], v248 offset:47104
    s_waitcnt vmcnt(14)
    s_waitcnt lgkmcnt(6)
    v_mfma_f32_32x32x16_bf16 v[8:23], v[216:219], v[144:147], v[8:23]
    ds_read_b128 v[244:247], v248 offset:48128
    s_waitcnt lgkmcnt(6)
    v_mfma_f32_32x32x16_bf16 v[24:39], v[220:223], v[144:147], v[24:39]
    buffer_load_dwordx2 v[188:189], v3, s[44:47], s36 offen offset:128
    v_add_u32 v248, 0xc000, v248
    ds_read_b128 v[216:219], v248 offset:0
    s_waitcnt lgkmcnt(6)
    v_mfma_f32_32x32x16_bf16 v[40:55], v[224:227], v[144:147], v[40:55]
    ds_read_b128 v[220:223], v248 offset:1024
    s_waitcnt lgkmcnt(6)
    v_mfma_f32_32x32x16_bf16 v[56:71], v[228:231], v[144:147], v[56:71]
    ds_read_b128 v[224:227], v248 offset:2048
    s_waitcnt vmcnt(14)
    s_waitcnt lgkmcnt(6)
    v_mfma_f32_32x32x16_bf16 v[8:23], v[232:235], v[148:151], v[8:23]
    buffer_load_dwordx4 v[204:207], v4, s[48:51], s38 offen offset:256
    ds_read_b128 v[228:231], v248 offset:3072
    s_waitcnt lgkmcnt(6)
    v_mfma_f32_32x32x16_bf16 v[24:39], v[236:239], v[148:151], v[24:39]
    ds_read_b128 v[232:235], v248 offset:4096
    s_waitcnt lgkmcnt(6)
    v_mfma_f32_32x32x16_bf16 v[40:55], v[240:243], v[148:151], v[40:55]
    ds_read_b128 v[236:239], v248 offset:5120
    s_waitcnt lgkmcnt(6)
    v_mfma_f32_32x32x16_bf16 v[56:71], v[244:247], v[148:151], v[56:71]
    ds_read_b128 v[240:243], v248 offset:6144
    s_waitcnt vmcnt(14)
    s_waitcnt lgkmcnt(6)
    v_mfma_f32_32x32x16_bf16 v[8:23], v[216:219], v[152:155], v[8:23]
    s_add_u32 s34, s26, 3211264
    buffer_load_dwordx4 v[92:95], v5, s[8:11], s34 offen
    ds_read_b128 v[244:247], v248 offset:7168
    s_waitcnt lgkmcnt(6)
    v_mfma_f32_32x32x16_bf16 v[24:39], v[220:223], v[152:155], v[24:39]
    s_barrier
    ds_read_b128 v[216:219], v248 offset:8192
    s_waitcnt lgkmcnt(6)
    v_mfma_f32_32x32x16_bf16 v[40:55], v[224:227], v[152:155], v[40:55]
    ds_read_b128 v[220:223], v248 offset:9216
    s_waitcnt lgkmcnt(6)
    v_mfma_f32_32x32x16_bf16 v[56:71], v[228:231], v[152:155], v[56:71]
    s_add_u32 s34, s26, 3276800
    buffer_load_dwordx4 v[96:99], v5, s[8:11], s34 offen
    ds_read_b128 v[224:227], v248 offset:10240
    s_waitcnt vmcnt(13)
    s_waitcnt lgkmcnt(6)
    v_mfma_f32_32x32x16_bf16 v[8:23], v[232:235], v[156:159], v[8:23]
    ds_read_b128 v[228:231], v248 offset:11264
    s_waitcnt lgkmcnt(6)
    v_mfma_f32_32x32x16_bf16 v[24:39], v[236:239], v[156:159], v[24:39]
    ds_read_b128 v[232:235], v248 offset:12288
    s_waitcnt lgkmcnt(6)
    v_mfma_f32_32x32x16_bf16 v[40:55], v[240:243], v[156:159], v[40:55]
    s_add_u32 s34, s26, 3342336
    buffer_load_dwordx4 v[100:103], v5, s[8:11], s34 offen
    ds_read_b128 v[236:239], v248 offset:13312
    s_waitcnt lgkmcnt(6)
    v_mfma_f32_32x32x16_bf16 v[56:71], v[244:247], v[156:159], v[56:71]
    ds_read_b128 v[240:243], v248 offset:14336
    s_waitcnt vmcnt(13)
    s_waitcnt lgkmcnt(6)
    v_mfma_f32_32x32x16_bf16 v[8:23], v[216:219], v[160:163], v[8:23]
    ds_read_b128 v[244:247], v248 offset:15360
    s_waitcnt lgkmcnt(6)
    v_mfma_f32_32x32x16_bf16 v[24:39], v[220:223], v[160:163], v[24:39]
    ds_read_b128 v[216:219], v248 offset:16384
    s_waitcnt lgkmcnt(6)
    v_mfma_f32_32x32x16_bf16 v[40:55], v[224:227], v[160:163], v[40:55]
    s_add_u32 s34, s26, 3407872
    buffer_load_dwordx4 v[104:107], v5, s[8:11], s34 offen
    ds_read_b128 v[220:223], v248 offset:17408
    s_waitcnt lgkmcnt(6)
    v_mfma_f32_32x32x16_bf16 v[56:71], v[228:231], v[160:163], v[56:71]
    ds_read_b128 v[224:227], v248 offset:18432
    s_waitcnt vmcnt(13)
    s_waitcnt lgkmcnt(6)
    v_mfma_f32_32x32x16_bf16 v[8:23], v[232:235], v[164:167], v[8:23]
    ds_read_b128 v[228:231], v248 offset:19456
    s_waitcnt lgkmcnt(6)
    v_mfma_f32_32x32x16_bf16 v[24:39], v[236:239], v[164:167], v[24:39]
    buffer_load_dwordx2 v[190:191], v3, s[44:47], s36 offen offset:192
    ds_read_b128 v[232:235], v248 offset:20480
    s_waitcnt lgkmcnt(6)
    v_mfma_f32_32x32x16_bf16 v[40:55], v[240:243], v[164:167], v[40:55]
    ds_read_b128 v[236:239], v248 offset:21504
    s_waitcnt lgkmcnt(6)
    v_mfma_f32_32x32x16_bf16 v[56:71], v[244:247], v[164:167], v[56:71]
    ds_read_b128 v[240:243], v248 offset:22528
    s_waitcnt vmcnt(13)
    s_waitcnt lgkmcnt(6)
    v_mfma_f32_32x32x16_bf16 v[8:23], v[216:219], v[168:171], v[8:23]
    buffer_load_dwordx4 v[208:211], v4, s[48:51], s38 offen offset:384
    ds_read_b128 v[244:247], v248 offset:23552
    s_waitcnt lgkmcnt(6)
    v_mfma_f32_32x32x16_bf16 v[24:39], v[220:223], v[168:171], v[24:39]
    s_barrier
    ds_read_b128 v[216:219], v248 offset:24576
    s_waitcnt lgkmcnt(6)
    v_mfma_f32_32x32x16_bf16 v[40:55], v[224:227], v[168:171], v[40:55]
    ds_read_b128 v[220:223], v248 offset:25600
    s_waitcnt lgkmcnt(6)
    v_mfma_f32_32x32x16_bf16 v[56:71], v[228:231], v[168:171], v[56:71]
    ds_read_b128 v[224:227], v248 offset:26624
    s_waitcnt vmcnt(11)
    s_waitcnt lgkmcnt(6)
    v_mfma_f32_32x32x16_bf16 v[8:23], v[232:235], v[172:175], v[8:23]
    s_add_u32 s34, s26, 3473408
    buffer_load_dwordx4 v[108:111], v5, s[8:11], s34 offen
    ds_read_b128 v[228:231], v248 offset:27648
    s_waitcnt lgkmcnt(6)
    v_mfma_f32_32x32x16_bf16 v[24:39], v[236:239], v[172:175], v[24:39]
    ds_read_b128 v[232:235], v248 offset:28672
    s_waitcnt lgkmcnt(6)
    v_mfma_f32_32x32x16_bf16 v[40:55], v[240:243], v[172:175], v[40:55]
    ds_read_b128 v[236:239], v248 offset:29696
    s_waitcnt lgkmcnt(6)
    v_mfma_f32_32x32x16_bf16 v[56:71], v[244:247], v[172:175], v[56:71]
    s_add_u32 s34, s26, 3538944
    buffer_load_dwordx4 v[112:115], v5, s[8:11], s34 offen
    ds_read_b128 v[240:243], v248 offset:30720
    s_waitcnt vmcnt(12)
    s_waitcnt lgkmcnt(6)
    v_mfma_f32_32x32x16_bf16 v[8:23], v[216:219], v[176:179], v[8:23]
    ds_read_b128 v[244:247], v248 offset:31744
    s_waitcnt lgkmcnt(6)
    v_mfma_f32_32x32x16_bf16 v[24:39], v[220:223], v[176:179], v[24:39]
    ds_read_b128 v[216:219], v248 offset:32768
    s_waitcnt lgkmcnt(6)
    v_mfma_f32_32x32x16_bf16 v[40:55], v[224:227], v[176:179], v[40:55]
    s_add_u32 s34, s26, 3604480
    buffer_load_dwordx4 v[116:119], v5, s[8:11], s34 offen
    ds_read_b128 v[220:223], v248 offset:33792
    s_waitcnt lgkmcnt(6)
    v_mfma_f32_32x32x16_bf16 v[56:71], v[228:231], v[176:179], v[56:71]
    ds_read_b128 v[224:227], v248 offset:34816
    s_waitcnt vmcnt(12)
    s_waitcnt lgkmcnt(6)
    v_mfma_f32_32x32x16_bf16 v[8:23], v[232:235], v[180:183], v[8:23]
    ds_read_b128 v[228:231], v248 offset:35840
    s_waitcnt lgkmcnt(6)
    v_mfma_f32_32x32x16_bf16 v[24:39], v[236:239], v[180:183], v[24:39]
    ds_read_b128 v[232:235], v248 offset:36864
    s_waitcnt lgkmcnt(6)
    v_mfma_f32_32x32x16_bf16 v[40:55], v[240:243], v[180:183], v[40:55]
    s_add_u32 s34, s26, 3670016
    buffer_load_dwordx4 v[120:123], v5, s[8:11], s34 offen
    ds_read_b128 v[236:239], v248 offset:37888
    s_waitcnt lgkmcnt(6)
    v_mfma_f32_32x32x16_bf16 v[56:71], v[244:247], v[180:183], v[56:71]
    ds_read_b128 v[240:243], v248 offset:38912
    s_waitcnt vmcnt(12)
    s_waitcnt lgkmcnt(6)
    v_mfma_f32_32x32x16_bf16 v[8:23], v[216:219], v[88:91], v[8:23]
    ds_read_b128 v[244:247], v248 offset:39936
    s_waitcnt lgkmcnt(6)
    v_mfma_f32_32x32x16_bf16 v[24:39], v[220:223], v[88:91], v[24:39]
    s_add_u32 s34, s26, 3735552
    buffer_load_dwordx4 v[124:127], v5, s[8:11], s34 offen
    s_barrier
    ds_read_b128 v[216:219], v248 offset:40960
    s_waitcnt lgkmcnt(6)
    v_mfma_f32_32x32x16_bf16 v[40:55], v[224:227], v[88:91], v[40:55]
    ds_read_b128 v[220:223], v248 offset:41984
    s_waitcnt lgkmcnt(6)
    v_mfma_f32_32x32x16_bf16 v[56:71], v[228:231], v[88:91], v[56:71]
    ds_read_b128 v[224:227], v248 offset:43008
    s_waitcnt vmcnt(10)
    s_waitcnt lgkmcnt(6)
    v_mfma_f32_32x32x16_bf16 v[8:23], v[232:235], v[92:95], v[8:23]
    s_add_u32 s34, s26, 3801088
    buffer_load_dwordx4 v[128:131], v5, s[8:11], s34 offen
    ds_read_b128 v[228:231], v248 offset:44032
    s_waitcnt lgkmcnt(6)
    v_mfma_f32_32x32x16_bf16 v[24:39], v[236:239], v[92:95], v[24:39]
    ds_read_b128 v[232:235], v248 offset:45056
    s_waitcnt lgkmcnt(6)
    v_mfma_f32_32x32x16_bf16 v[40:55], v[240:243], v[92:95], v[40:55]
    ds_read_b128 v[236:239], v248 offset:46080
    s_waitcnt lgkmcnt(6)
    v_mfma_f32_32x32x16_bf16 v[56:71], v[244:247], v[92:95], v[56:71]
    ds_read_b128 v[240:243], v248 offset:47104
    s_waitcnt vmcnt(10)
    s_waitcnt lgkmcnt(6)
    v_mfma_f32_32x32x16_bf16 v[8:23], v[216:219], v[96:99], v[8:23]
    s_add_u32 s34, s26, 3866624
    buffer_load_dwordx4 v[132:135], v5, s[8:11], s34 offen
    ds_read_b128 v[244:247], v248 offset:48128
    s_waitcnt lgkmcnt(6)
    v_mfma_f32_32x32x16_bf16 v[24:39], v[220:223], v[96:99], v[24:39]
    v_add_u32 v248, 0xc000, v248
    ds_read_b128 v[216:219], v248 offset:0
    s_waitcnt lgkmcnt(6)
    v_mfma_f32_32x32x16_bf16 v[40:55], v[224:227], v[96:99], v[40:55]
    ds_read_b128 v[220:223], v248 offset:1024
    s_waitcnt lgkmcnt(6)
    v_mfma_f32_32x32x16_bf16 v[56:71], v[228:231], v[96:99], v[56:71]
    s_add_u32 s34, s26, 3932160
    buffer_load_dwordx4 v[136:139], v5, s[8:11], s34 offen
    ds_read_b128 v[224:227], v248 offset:2048
    s_waitcnt vmcnt(11)
    s_waitcnt lgkmcnt(6)
    v_mfma_f32_32x32x16_bf16 v[8:23], v[232:235], v[100:103], v[8:23]
    ds_read_b128 v[228:231], v248 offset:3072
    s_waitcnt lgkmcnt(6)
    v_mfma_f32_32x32x16_bf16 v[24:39], v[236:239], v[100:103], v[24:39]
    ds_read_b128 v[232:235], v248 offset:4096
    s_waitcnt lgkmcnt(6)
    v_mfma_f32_32x32x16_bf16 v[40:55], v[240:243], v[100:103], v[40:55]
    s_add_u32 s34, s26, 3997696
    buffer_load_dwordx4 v[140:143], v5, s[8:11], s34 offen
    ds_read_b128 v[236:239], v248 offset:5120
    s_waitcnt lgkmcnt(6)
    v_mfma_f32_32x32x16_bf16 v[56:71], v[244:247], v[100:103], v[56:71]
    ds_read_b128 v[240:243], v248 offset:6144
    s_waitcnt vmcnt(11)
    s_waitcnt lgkmcnt(6)
    v_mfma_f32_32x32x16_bf16 v[8:23], v[216:219], v[104:107], v[8:23]
    ds_read_b128 v[244:247], v248 offset:7168
    s_waitcnt lgkmcnt(6)
    v_mfma_f32_32x32x16_bf16 v[24:39], v[220:223], v[104:107], v[24:39]
    s_barrier
    ds_read_b128 v[216:219], v248 offset:8192
    s_waitcnt lgkmcnt(6)
    v_mfma_f32_32x32x16_bf16 v[40:55], v[224:227], v[104:107], v[40:55]
    s_add_u32 s34, s26, 4063232
    buffer_load_dwordx4 v[144:147], v5, s[8:11], s34 offen
    ds_read_b128 v[220:223], v248 offset:9216
    s_waitcnt lgkmcnt(6)
    v_mfma_f32_32x32x16_bf16 v[56:71], v[228:231], v[104:107], v[56:71]
    ds_read_b128 v[224:227], v248 offset:10240
    s_waitcnt vmcnt(9)
    s_waitcnt lgkmcnt(6)
    v_mfma_f32_32x32x16_bf16 v[8:23], v[232:235], v[108:111], v[8:23]
    ds_read_b128 v[228:231], v248 offset:11264
    s_waitcnt lgkmcnt(6)
    v_mfma_f32_32x32x16_bf16 v[24:39], v[236:239], v[108:111], v[24:39]
    s_add_u32 s34, s26, 4128768
    buffer_load_dwordx4 v[148:151], v5, s[8:11], s34 offen
    ds_read_b128 v[232:235], v248 offset:12288
    s_waitcnt lgkmcnt(6)
    v_mfma_f32_32x32x16_bf16 v[40:55], v[240:243], v[108:111], v[40:55]
    ds_read_b128 v[236:239], v248 offset:13312
    s_waitcnt lgkmcnt(6)
    v_mfma_f32_32x32x16_bf16 v[56:71], v[244:247], v[108:111], v[56:71]
    ds_read_b128 v[240:243], v248 offset:14336
    s_waitcnt vmcnt(9)
    s_waitcnt lgkmcnt(6)
    v_mfma_f32_32x32x16_bf16 v[8:23], v[216:219], v[112:115], v[8:23]
    s_add_u32 s34, s26, 4194304
    buffer_load_dwordx4 v[152:155], v5, s[8:11], s34 offen
    ds_read_b128 v[244:247], v248 offset:15360
    s_waitcnt lgkmcnt(6)
    v_mfma_f32_32x32x16_bf16 v[24:39], v[220:223], v[112:115], v[24:39]
    v_add_u32 v248, 0xfffe8000, v248
    ds_read_b128 v[216:219], v248 offset:0
    s_waitcnt lgkmcnt(6)
    v_mfma_f32_32x32x16_bf16 v[40:55], v[224:227], v[112:115], v[40:55]
    ds_read_b128 v[220:223], v248 offset:1024
    s_waitcnt lgkmcnt(6)
    v_mfma_f32_32x32x16_bf16 v[56:71], v[228:231], v[112:115], v[56:71]
    ds_read_b128 v[224:227], v248 offset:2048
    s_waitcnt vmcnt(9)
    s_waitcnt lgkmcnt(6)
    v_mfma_f32_32x32x16_bf16 v[8:23], v[232:235], v[116:119], v[8:23]
    s_add_u32 s34, s26, 4259840
    buffer_load_dwordx4 v[156:159], v5, s[8:11], s34 offen
    ds_read_b128 v[228:231], v248 offset:3072
    s_waitcnt lgkmcnt(6)
    v_mfma_f32_32x32x16_bf16 v[24:39], v[236:239], v[116:119], v[24:39]
    ds_read_b128 v[232:235], v248 offset:4096
    s_waitcnt lgkmcnt(6)
    v_mfma_f32_32x32x16_bf16 v[40:55], v[240:243], v[116:119], v[40:55]
    ds_read_b128 v[236:239], v248 offset:5120
    s_waitcnt lgkmcnt(6)
    v_mfma_f32_32x32x16_bf16 v[56:71], v[244:247], v[116:119], v[56:71]
    s_add_u32 s34, s26, 4325376
    buffer_load_dwordx4 v[160:163], v5, s[8:11], s34 offen
    ds_read_b128 v[240:243], v248 offset:6144
    s_waitcnt vmcnt(10)
    s_waitcnt lgkmcnt(6)
    v_mfma_f32_32x32x16_bf16 v[8:23], v[216:219], v[120:123], v[8:23]
    ds_read_b128 v[244:247], v248 offset:7168
    s_waitcnt lgkmcnt(6)
    v_mfma_f32_32x32x16_bf16 v[24:39], v[220:223], v[120:123], v[24:39]
    s_barrier
    ds_read_b128 v[216:219], v248 offset:8192
    s_waitcnt lgkmcnt(6)
    v_mfma_f32_32x32x16_bf16 v[40:55], v[224:227], v[120:123], v[40:55]
    s_add_u32 s34, s26, 4390912
    buffer_load_dwordx4 v[164:167], v5, s[8:11], s34 offen
    ds_read_b128 v[220:223], v248 offset:9216
    s_waitcnt lgkmcnt(6)
    v_mfma_f32_32x32x16_bf16 v[56:71], v[228:231], v[120:123], v[56:71]
    ds_read_b128 v[224:227], v248 offset:10240
    s_waitcnt vmcnt(10)
    s_waitcnt lgkmcnt(6)
    v_mfma_f32_32x32x16_bf16 v[8:23], v[232:235], v[124:127], v[8:23]
    ds_read_b128 v[228:231], v248 offset:11264
    s_waitcnt lgkmcnt(6)
    v_mfma_f32_32x32x16_bf16 v[24:39], v[236:239], v[124:127], v[24:39]
    ds_read_b128 v[232:235], v248 offset:12288
    s_waitcnt lgkmcnt(6)
    v_mfma_f32_32x32x16_bf16 v[40:55], v[240:243], v[124:127], v[40:55]
    s_add_u32 s34, s26, 4456448
    buffer_load_dwordx4 v[168:171], v5, s[8:11], s34 offen
    ds_read_b128 v[236:239], v248 offset:13312
    s_waitcnt lgkmcnt(6)
    v_mfma_f32_32x32x16_bf16 v[56:71], v[244:247], v[124:127], v[56:71]
    ds_read_b128 v[240:243], v248 offset:14336
    s_waitcnt vmcnt(10)
    s_waitcnt lgkmcnt(6)
    v_mfma_f32_32x32x16_bf16 v[8:23], v[216:219], v[128:131], v[8:23]
    ds_read_b128 v[244:247], v248 offset:15360
    s_waitcnt lgkmcnt(6)
    v_mfma_f32_32x32x16_bf16 v[24:39], v[220:223], v[128:131], v[24:39]
    s_add_u32 s34, s26, 4521984
    buffer_load_dwordx4 v[172:175], v5, s[8:11], s34 offen
    ds_read_b128 v[216:219], v248 offset:16384
    s_waitcnt lgkmcnt(6)
    v_mfma_f32_32x32x16_bf16 v[40:55], v[224:227], v[128:131], v[40:55]
    ds_read_b128 v[220:223], v248 offset:17408
    s_waitcnt lgkmcnt(6)
    v_mfma_f32_32x32x16_bf16 v[56:71], v[228:231], v[128:131], v[56:71]
    ds_read_b128 v[224:227], v248 offset:18432
    s_waitcnt vmcnt(10)
    s_waitcnt lgkmcnt(6)
    v_mfma_f32_32x32x16_bf16 v[8:23], v[232:235], v[132:135], v[8:23]
    s_add_u32 s34, s26, 4587520
    buffer_load_dwordx4 v[176:179], v5, s[8:11], s34 offen
    ds_read_b128 v[228:231], v248 offset:19456
    s_waitcnt lgkmcnt(6)
    v_mfma_f32_32x32x16_bf16 v[24:39], v[236:239], v[132:135], v[24:39]
    ds_read_b128 v[232:235], v248 offset:20480
    s_waitcnt lgkmcnt(6)
    v_mfma_f32_32x32x16_bf16 v[40:55], v[240:243], v[132:135], v[40:55]
    ds_read_b128 v[236:239], v248 offset:21504
    s_waitcnt lgkmcnt(6)
    v_mfma_f32_32x32x16_bf16 v[56:71], v[244:247], v[132:135], v[56:71]
    ds_read_b128 v[240:243], v248 offset:22528
    s_waitcnt vmcnt(10)
    s_waitcnt lgkmcnt(6)
    v_mfma_f32_32x32x16_bf16 v[8:23], v[216:219], v[136:139], v[8:23]
    s_add_u32 s34, s26, 4653056
    buffer_load_dwordx4 v[180:183], v5, s[8:11], s34 offen
    ds_read_b128 v[244:247], v248 offset:23552
    s_waitcnt lgkmcnt(6)
    v_mfma_f32_32x32x16_bf16 v[24:39], v[220:223], v[136:139], v[24:39]
    s_barrier
    ds_read_b128 v[216:219], v248 offset:24576
    s_waitcnt lgkmcnt(6)
    v_mfma_f32_32x32x16_bf16 v[40:55], v[224:227], v[136:139], v[40:55]
    ds_read_b128 v[220:223], v248 offset:25600
    s_waitcnt lgkmcnt(6)
    v_mfma_f32_32x32x16_bf16 v[56:71], v[228:231], v[136:139], v[56:71]
    ds_read_b128 v[224:227], v248 offset:26624
    s_waitcnt vmcnt(10)
    s_waitcnt lgkmcnt(6)
    v_mfma_f32_32x32x16_bf16 v[8:23], v[232:235], v[140:143], v[8:23]
    ds_read_b128 v[228:231], v248 offset:27648
    s_waitcnt lgkmcnt(6)
    v_mfma_f32_32x32x16_bf16 v[24:39], v[236:239], v[140:143], v[24:39]
    ds_read_b128 v[232:235], v248 offset:28672
    s_waitcnt lgkmcnt(6)
    v_mfma_f32_32x32x16_bf16 v[40:55], v[240:243], v[140:143], v[40:55]
    ds_read_b128 v[236:239], v248 offset:29696
    s_waitcnt lgkmcnt(6)
    v_mfma_f32_32x32x16_bf16 v[56:71], v[244:247], v[140:143], v[56:71]
    ds_read_b128 v[240:243], v248 offset:30720
    s_waitcnt vmcnt(9)
    s_waitcnt lgkmcnt(6)
    v_mfma_f32_32x32x16_bf16 v[8:23], v[216:219], v[144:147], v[8:23]
    ds_read_b128 v[244:247], v248 offset:31744
    s_waitcnt lgkmcnt(6)
    v_mfma_f32_32x32x16_bf16 v[24:39], v[220:223], v[144:147], v[24:39]
    ds_read_b128 v[216:219], v248 offset:32768
    s_waitcnt lgkmcnt(6)
    v_mfma_f32_32x32x16_bf16 v[40:55], v[224:227], v[144:147], v[40:55]
    ds_read_b128 v[220:223], v248 offset:36864
    s_waitcnt lgkmcnt(6)
    v_mfma_f32_32x32x16_bf16 v[56:71], v[228:231], v[144:147], v[56:71]
    ds_read_b128 v[224:227], v248 offset:40960
    s_waitcnt vmcnt(8)
    s_waitcnt lgkmcnt(6)
    v_mfma_f32_32x32x16_bf16 v[8:23], v[232:235], v[148:151], v[8:23]
    ds_read_b128 v[228:231], v248 offset:45056
    s_waitcnt lgkmcnt(6)
    v_mfma_f32_32x32x16_bf16 v[24:39], v[236:239], v[148:151], v[24:39]
    v_add_u32 v248, 0xc000, v248
    ds_read_b128 v[232:235], v248 offset:0
    s_waitcnt lgkmcnt(6)
    v_mfma_f32_32x32x16_bf16 v[40:55], v[240:243], v[148:151], v[40:55]
    ds_read_b128 v[236:239], v248 offset:4096
    s_waitcnt lgkmcnt(6)
    v_mfma_f32_32x32x16_bf16 v[56:71], v[244:247], v[148:151], v[56:71]
    ds_read_b128 v[240:243], v248 offset:8192
    s_waitcnt vmcnt(7)
    s_waitcnt lgkmcnt(6)
    v_mfma_f32_32x32x16_bf16 v[8:23], v[216:219], v[152:155], v[8:23]
    ds_read_b128 v[244:247], v248 offset:12288
    s_waitcnt vmcnt(6)
    s_waitcnt lgkmcnt(6)
    v_mfma_f32_32x32x16_bf16 v[8:23], v[220:223], v[156:159], v[8:23]
    v_add_u32 v248, 0xffff4000, v248
    ds_read_b128 v[216:219], v248 offset:33792
    s_waitcnt vmcnt(5)
    s_waitcnt lgkmcnt(6)
    v_mfma_f32_32x32x16_bf16 v[8:23], v[224:227], v[160:163], v[8:23]
    ds_read_b128 v[220:223], v248 offset:37888
    s_waitcnt vmcnt(4)
    s_waitcnt lgkmcnt(6)
    v_mfma_f32_32x32x16_bf16 v[8:23], v[228:231], v[164:167], v[8:23]
    ds_read_b128 v[224:227], v248 offset:41984
    s_waitcnt vmcnt(3)
    s_waitcnt lgkmcnt(6)
    v_mfma_f32_32x32x16_bf16 v[8:23], v[232:235], v[168:171], v[8:23]
    ds_read_b128 v[228:231], v248 offset:46080
    s_waitcnt vmcnt(2)
    s_waitcnt lgkmcnt(6)
    v_mfma_f32_32x32x16_bf16 v[8:23], v[236:239], v[172:175], v[8:23]
    v_add_u32 v248, 0xc000, v248
    ds_read_b128 v[232:235], v248 offset:1024
    s_waitcnt vmcnt(1)
    s_waitcnt lgkmcnt(6)
    v_mfma_f32_32x32x16_bf16 v[8:23], v[240:243], v[176:179], v[8:23]
    ds_read_b128 v[236:239], v248 offset:5120
    s_waitcnt vmcnt(0)
    s_waitcnt lgkmcnt(6)
    v_mfma_f32_32x32x16_bf16 v[8:23], v[244:247], v[180:183], v[8:23]
    ds_read_b128 v[240:243], v248 offset:9216
    s_waitcnt lgkmcnt(6)
    v_mfma_f32_32x32x16_bf16 v[24:39], v[216:219], v[152:155], v[24:39]
    ds_read_b128 v[244:247], v248 offset:13312
    s_waitcnt lgkmcnt(6)
    v_mfma_f32_32x32x16_bf16 v[24:39], v[220:223], v[156:159], v[24:39]
    v_add_u32 v248, 0xffff4000, v248
    ds_read_b128 v[216:219], v248 offset:34816
    s_nop 3
    v_cvt_pk_bf16_f32 v12, v12, v13
    v_cvt_pk_bf16_f32 v13, v14, v15
    v_cvt_pk_bf16_f32 v16, v16, v17
    s_waitcnt lgkmcnt(6)
    v_mfma_f32_32x32x16_bf16 v[24:39], v[224:227], v[160:163], v[24:39]
    ds_read_b128 v[220:223], v248 offset:38912
    v_cvt_pk_bf16_f32 v17, v18, v19
    v_cvt_pk_bf16_f32 v20, v20, v21
    v_cvt_pk_bf16_f32 v21, v22, v23
    s_waitcnt lgkmcnt(6)
    v_mfma_f32_32x32x16_bf16 v[24:39], v[228:231], v[164:167], v[24:39]
    ds_read_b128 v[224:227], v248 offset:43008
    s_waitcnt lgkmcnt(6)
    v_mfma_f32_32x32x16_bf16 v[24:39], v[232:235], v[168:171], v[24:39]
    ds_read_b128 v[228:231], v248 offset:47104
    s_waitcnt lgkmcnt(6)
    v_mfma_f32_32x32x16_bf16 v[24:39], v[236:239], v[172:175], v[24:39]
    v_add_u32 v248, 0xc000, v248
    ds_read_b128 v[232:235], v248 offset:2048
    s_waitcnt lgkmcnt(6)
    v_mfma_f32_32x32x16_bf16 v[24:39], v[240:243], v[176:179], v[24:39]
    ds_read_b128 v[236:239], v248 offset:6144
    s_waitcnt lgkmcnt(6)
    v_mfma_f32_32x32x16_bf16 v[24:39], v[244:247], v[180:183], v[24:39]
    ds_read_b128 v[240:243], v248 offset:10240
    s_waitcnt lgkmcnt(6)
    v_mfma_f32_32x32x16_bf16 v[40:55], v[216:219], v[152:155], v[40:55]
    ds_read_b128 v[244:247], v248 offset:14336
    s_waitcnt lgkmcnt(6)
    v_mfma_f32_32x32x16_bf16 v[40:55], v[220:223], v[156:159], v[40:55]
    v_add_u32 v248, 0xffff4000, v248
    ds_read_b128 v[216:219], v248 offset:35840
    s_nop 3
    v_cvt_pk_bf16_f32 v14, v28, v29
    v_cvt_pk_bf16_f32 v15, v30, v31
    buffer_store_dwordx4 v[12:15], v5, s[16:19], s60 offen offset:0 sc1
    s_waitcnt lgkmcnt(6)
    v_mfma_f32_32x32x16_bf16 v[40:55], v[224:227], v[160:163], v[40:55]
    ds_read_b128 v[220:223], v248 offset:39936
    v_cvt_pk_bf16_f32 v18, v32, v33
    v_cvt_pk_bf16_f32 v19, v34, v35
    buffer_store_dwordx4 v[16:19], v5, s[16:19], s61 offen offset:0 sc1
    s_waitcnt lgkmcnt(6)
    v_mfma_f32_32x32x16_bf16 v[40:55], v[228:231], v[164:167], v[40:55]
    ds_read_b128 v[224:227], v248 offset:44032
    v_cvt_pk_bf16_f32 v22, v36, v37
    v_cvt_pk_bf16_f32 v23, v38, v39
    buffer_store_dwordx4 v[20:23], v5, s[16:19], s62 offen offset:0 sc1
    s_waitcnt lgkmcnt(6)
    v_mfma_f32_32x32x16_bf16 v[40:55], v[232:235], v[168:171], v[40:55]
    ds_read_b128 v[228:231], v248 offset:48128
    s_waitcnt lgkmcnt(6)
    v_mfma_f32_32x32x16_bf16 v[40:55], v[236:239], v[172:175], v[40:55]
    v_add_u32 v248, 0xc000, v248
    ds_read_b128 v[232:235], v248 offset:3072
    s_waitcnt lgkmcnt(6)
    v_mfma_f32_32x32x16_bf16 v[40:55], v[240:243], v[176:179], v[40:55]
    ds_read_b128 v[236:239], v248 offset:7168
    s_waitcnt lgkmcnt(6)
    v_mfma_f32_32x32x16_bf16 v[40:55], v[244:247], v[180:183], v[40:55]
    ds_read_b128 v[240:243], v248 offset:11264
    s_waitcnt lgkmcnt(6)
    v_mfma_f32_32x32x16_bf16 v[56:71], v[216:219], v[152:155], v[56:71]
    ds_read_b128 v[244:247], v248 offset:15360
    s_waitcnt lgkmcnt(6)
    v_mfma_f32_32x32x16_bf16 v[56:71], v[220:223], v[156:159], v[56:71]
    s_nop 5
    v_cvt_pk_bf16_f32 v44, v44, v45
    v_cvt_pk_bf16_f32 v45, v46, v47
    v_cvt_pk_bf16_f32 v48, v48, v49
    s_waitcnt lgkmcnt(5)
    v_mfma_f32_32x32x16_bf16 v[56:71], v[224:227], v[160:163], v[56:71]
    v_cvt_pk_bf16_f32 v49, v50, v51
    v_cvt_pk_bf16_f32 v52, v52, v53
    v_cvt_pk_bf16_f32 v53, v54, v55
    s_waitcnt lgkmcnt(4)
    v_mfma_f32_32x32x16_bf16 v[56:71], v[228:231], v[164:167], v[56:71]
    s_waitcnt lgkmcnt(3)
    v_mfma_f32_32x32x16_bf16 v[56:71], v[232:235], v[168:171], v[56:71]
    s_waitcnt lgkmcnt(2)
    v_mfma_f32_32x32x16_bf16 v[56:71], v[236:239], v[172:175], v[56:71]
    s_waitcnt lgkmcnt(1)
    v_mfma_f32_32x32x16_bf16 v[56:71], v[240:243], v[176:179], v[56:71]
    s_waitcnt lgkmcnt(0)
    v_mfma_f32_32x32x16_bf16 v[56:71], v[244:247], v[180:183], v[56:71]
    s_nop 11
    v_cvt_pk_bf16_f32 v46, v60, v61
    v_cvt_pk_bf16_f32 v47, v62, v63
    buffer_store_dwordx4 v[44:47], v5, s[16:19], s60 offen offset:1024 sc1
    v_cvt_pk_bf16_f32 v50, v64, v65
    v_cvt_pk_bf16_f32 v51, v66, v67
    buffer_store_dwordx4 v[48:51], v5, s[16:19], s61 offen offset:1024 sc1
    v_cvt_pk_bf16_f32 v54, v68, v69
    v_cvt_pk_bf16_f32 v55, v70, v71
    buffer_store_dwordx4 v[52:55], v5, s[16:19], s62 offen offset:1024 sc1
    s_lshl_b32 s33, s25, 11
    buffer_load_dwordx4 v[120:123], v6, s[52:55], s33 offen offset:0
    buffer_load_dwordx4 v[124:127], v6, s[52:55], s33 offen offset:16
    buffer_load_dwordx4 v[128:131], v6, s[52:55], s33 offen offset:32
    s_mov_b32 s63, 0
K6_POLL4:
    buffer_load_dwordx4 v[88:91], v5, s[16:19], s56 offen offset:0 sc1
    buffer_load_dwordx4 v[92:95], v5, s[16:19], s56 offen offset:1024 sc1
    buffer_load_dwordx4 v[98:101], v5, s[16:19], s57 offen offset:0 sc1
    buffer_load_dwordx4 v[102:105], v5, s[16:19], s57 offen offset:1024 sc1
    buffer_load_dwordx4 v[108:111], v5, s[16:19], s58 offen offset:0 sc1
    buffer_load_dwordx4 v[112:115], v5, s[16:19], s58 offen offset:1024 sc1
    s_waitcnt vmcnt(0)
    v_max_u32 v250, v88, v89
    v_max3_u32 v250, v250, v90, v91
    v_max3_u32 v250, v250, v92, v93
    v_max3_u32 v250, v250, v94, v95
    v_max3_u32 v250, v250, v98, v99
    v_max3_u32 v250, v250, v100, v101
    v_max3_u32 v250, v250, v102, v103
    v_max3_u32 v250, v250, v104, v105
    v_max3_u32 v250, v250, v108, v109
    v_max3_u32 v250, v250, v110, v111
    v_max3_u32 v250, v250, v112, v113
    v_max3_u32 v250, v250, v114, v115
    v_cmp_eq_u32 vcc, -1, v250
    s_cbranch_vccz K6_GO4
    s_sleep 2
    s_add_u32 s63, s63, 1
    s_cmp_lt_u32 s63, 0x8000
    s_cbranch_scc1 K6_POLL4
K6_GO4:
    v_add_f32 v144, v120, v122
    v_add_f32 v144, v144, v124
    v_add_f32 v144, v144, v126
    v_add_f32 v144, v144, v128
    v_add_f32 v144, v144, v130
    v_mul_f32 v144, 0xbe2aaaab, v144
    v_add_f32 v145, v121, v123
    v_add_f32 v145, v145, v125
    v_add_f32 v145, v145, v127
    v_add_f32 v145, v145, v129
    v_add_f32 v145, v145, v131
    v_mov_b32 v146, 0
    v_add_f32 v120, v120, v144
    v_fmac_f32 v146, v120, v120
    v_add_f32 v122, v122, v144
    v_fmac_f32 v146, v122, v122
    v_add_f32 v124, v124, v144
    v_fmac_f32 v146, v124, v124
    v_add_f32 v126, v126, v144
    v_fmac_f32 v146, v126, v126
    v_add_f32 v128, v128, v144
    v_fmac_f32 v146, v128, v128
    v_add_f32 v130, v130, v144
    v_fmac_f32 v146, v130, v130
    v_fmac_f32 v145, 0x42c00000, v146
    v_mul_f32 v145, 0x3ae38e39, v145
    v_cvt_pk_bf16_f32 v145, v145, v145
    v_lshlrev_b32 v145, 16, v145
    v_add_f32 v145, 0x3727c5ac, v145
    v_cvt_pk_bf16_f32 v145, v145, v145
    v_lshlrev_b32 v145, 16, v145
    v_sqrt_f32 v145, v145
    s_nop 0
    v_cvt_pk_bf16_f32 v145, v145, v145
    v_lshlrev_b32 v145, 16, v145
    v_rcp_f32 v146, v145
    v_cvt_pk_bf16_f32 v144, v144, v144
    v_lshlrev_b32 v144, 16, v144
    v_mul_f32 v146, v146, v146
    v_lshlrev_b32 v12, 16, v88
    v_and_b32 v13, s30, v88
    v_pk_add_f32 v[8:9], v[8:9], v[12:13]
    v_lshlrev_b32 v12, 16, v98
    v_and_b32 v13, s30, v98
    v_pk_add_f32 v[8:9], v[8:9], v[12:13]
    v_lshlrev_b32 v12, 16, v108
    v_and_b32 v13, s30, v108
    v_pk_add_f32 v[8:9], v[8:9], v[12:13]
    v_pk_mul_f32 v[8:9], v[8:9], v[146:147] op_sel_hi:[1,0]
    v_lshlrev_b32 v12, 16, v184
    v_and_b32 v13, s30, v184
    v_pk_fma_f32 v[12:13], v[8:9], v[196:197], v[12:13]
    v_cvt_pk_bf16_f32 v184, v12, v13
    v_lshlrev_b32 v12, 16, v89
    v_and_b32 v13, s30, v89
    v_pk_add_f32 v[10:11], v[10:11], v[12:13]
    v_lshlrev_b32 v12, 16, v99
    v_and_b32 v13, s30, v99
    v_pk_add_f32 v[10:11], v[10:11], v[12:13]
    v_lshlrev_b32 v12, 16, v109
    v_and_b32 v13, s30, v109
    v_pk_add_f32 v[10:11], v[10:11], v[12:13]
    v_pk_mul_f32 v[10:11], v[10:11], v[146:147] op_sel_hi:[1,0]
    v_lshlrev_b32 v12, 16, v185
    v_and_b32 v13, s30, v185
    v_pk_fma_f32 v[12:13], v[10:11], v[198:199], v[12:13]
    v_cvt_pk_bf16_f32 v185, v12, v13
    buffer_store_dwordx2 v[184:185], v3, s[40:43], s36 offen offset:0
    v_lshlrev_b32 v28, 16, v90
    v_and_b32 v29, s30, v90
    v_pk_add_f32 v[24:25], v[24:25], v[28:29]
    v_lshlrev_b32 v28, 16, v100
    v_and_b32 v29, s30, v100
    v_pk_add_f32 v[24:25], v[24:25], v[28:29]
    v_lshlrev_b32 v28, 16, v110
    v_and_b32 v29, s30, v110
    v_pk_add_f32 v[24:25], v[24:25], v[28:29]
    v_pk_mul_f32 v[24:25], v[24:25], v[146:147] op_sel_hi:[1,0]
    v_lshlrev_b32 v28, 16, v186
    v_and_b32 v29, s30, v186
    v_pk_fma_f32 v[28:29], v[24:25], v[200:201], v[28:29]
    v_cvt_pk_bf16_f32 v186, v28, v29
    v_lshlrev_b32 v28, 16, v91
    v_and_b32 v29, s30, v91
    v_pk_add_f32 v[26:27], v[26:27], v[28:29]
    v_lshlrev_b32 v28, 16, v101
    v_and_b32 v29, s30, v101
    v_pk_add_f32 v[26:27], v[26:27], v[28:29]
    v_lshlrev_b32 v28, 16, v111
    v_and_b32 v29, s30, v111
    v_pk_add_f32 v[26:27], v[26:27], v[28:29]
    v_pk_mul_f32 v[26:27], v[26:27], v[146:147] op_sel_hi:[1,0]
    v_lshlrev_b32 v28, 16, v187
    v_and_b32 v29, s30, v187
    v_pk_fma_f32 v[28:29], v[26:27], v[202:203], v[28:29]
    v_cvt_pk_bf16_f32 v187, v28, v29
    buffer_store_dwordx2 v[186:187], v3, s[40:43], s36 offen offset:64
    v_lshlrev_b32 v44, 16, v92
    v_and_b32 v45, s30, v92
    v_pk_add_f32 v[40:41], v[40:41], v[44:45]
    v_lshlrev_b32 v44, 16, v102
    v_and_b32 v45, s30, v102
    v_pk_add_f32 v[40:41], v[40:41], v[44:45]
    v_lshlrev_b32 v44, 16, v112
    v_and_b32 v45, s30, v112
    v_pk_add_f32 v[40:41], v[40:41], v[44:45]
    v_pk_mul_f32 v[40:41], v[40:41], v[146:147] op_sel_hi:[1,0]
    v_lshlrev_b32 v44, 16, v188
    v_and_b32 v45, s30, v188
    v_pk_fma_f32 v[44:45], v[40:41], v[204:205], v[44:45]
    v_cvt_pk_bf16_f32 v188, v44, v45
    v_lshlrev_b32 v44, 16, v93
    v_and_b32 v45, s30, v93
    v_pk_add_f32 v[42:43], v[42:43], v[44:45]
    v_lshlrev_b32 v44, 16, v103
    v_and_b32 v45, s30, v103
    v_pk_add_f32 v[42:43], v[42:43], v[44:45]
    v_lshlrev_b32 v44, 16, v113
    v_and_b32 v45, s30, v113
    v_pk_add_f32 v[42:43], v[42:43], v[44:45]
    v_pk_mul_f32 v[42:43], v[42:43], v[146:147] op_sel_hi:[1,0]
    v_lshlrev_b32 v44, 16, v189
    v_and_b32 v45, s30, v189
    v_pk_fma_f32 v[44:45], v[42:43], v[206:207], v[44:45]
    v_cvt_pk_bf16_f32 v189, v44, v45
    buffer_store_dwordx2 v[188:189], v3, s[40:43], s36 offen offset:128
    v_lshlrev_b32 v60, 16, v94
    v_and_b32 v61, s30, v94
    v_pk_add_f32 v[56:57], v[56:57], v[60:61]
    v_lshlrev_b32 v60, 16, v104
    v_and_b32 v61, s30, v104
    v_pk_add_f32 v[56:57], v[56:57], v[60:61]
    v_lshlrev_b32 v60, 16, v114
    v_and_b32 v61, s30, v114
    v_pk_add_f32 v[56:57], v[56:57], v[60:61]
    v_pk_mul_f32 v[56:57], v[56:57], v[146:147] op_sel_hi:[1,0]
    v_lshlrev_b32 v60, 16, v190
    v_and_b32 v61, s30, v190
    v_pk_fma_f32 v[60:61], v[56:57], v[208:209], v[60:61]
    v_cvt_pk_bf16_f32 v190, v60, v61
    v_lshlrev_b32 v60, 16, v95
    v_and_b32 v61, s30, v95
    v_pk_add_f32 v[58:59], v[58:59], v[60:61]
    v_lshlrev_b32 v60, 16, v105
    v_and_b32 v61, s30, v105
    v_pk_add_f32 v[58:59], v[58:59], v[60:61]
    v_lshlrev_b32 v60, 16, v115
    v_and_b32 v61, s30, v115
    v_pk_add_f32 v[58:59], v[58:59], v[60:61]
    v_pk_mul_f32 v[58:59], v[58:59], v[146:147] op_sel_hi:[1,0]
    v_lshlrev_b32 v60, 16, v191
    v_and_b32 v61, s30, v191
    v_pk_fma_f32 v[60:61], v[58:59], v[210:211], v[60:61]
    v_cvt_pk_bf16_f32 v191, v60, v61
    buffer_store_dwordx2 v[190:191], v3, s[40:43], s36 offen offset:192
    s_endpgm
K6_END:
    s_endpgm
CODE_END:
    s_endpgm
.section .rodata,"a"
.p2align 6
.amdhsa_kernel k1_kernel
  .amdhsa_next_free_vgpr 80
  .amdhsa_next_free_sgpr 48
  .amdhsa_accum_offset 80
  .amdhsa_group_segment_fixed_size 0
  .amdhsa_kernarg_size 112
  .amdhsa_user_sgpr_count 2
  .amdhsa_user_sgpr_kernarg_segment_ptr 1
  .amdhsa_system_sgpr_workgroup_id_x 1
.end_amdhsa_kernel
.p2align 6
.amdhsa_kernel k2_kernel
  .amdhsa_next_free_vgpr 200
  .amdhsa_next_free_sgpr 64
  .amdhsa_accum_offset 200
  .amdhsa_group_segment_fixed_size 0
  .amdhsa_kernarg_size 112
  .amdhsa_user_sgpr_count 2
  .amdhsa_user_sgpr_kernarg_segment_ptr 1
  .amdhsa_system_sgpr_workgroup_id_x 1
.end_amdhsa_kernel
.p2align 6
.amdhsa_kernel k3_kernel
  .amdhsa_next_free_vgpr 152
  .amdhsa_next_free_sgpr 72
  .amdhsa_accum_offset 152
  .amdhsa_group_segment_fixed_size 0
  .amdhsa_kernarg_size 112
  .amdhsa_user_sgpr_count 2
  .amdhsa_user_sgpr_kernarg_segment_ptr 1
  .amdhsa_system_sgpr_workgroup_id_x 1
.end_amdhsa_kernel
.p2align 6
.amdhsa_kernel k4_kernel
  .amdhsa_next_free_vgpr 224
  .amdhsa_next_free_sgpr 56
  .amdhsa_accum_offset 224
  .amdhsa_group_segment_fixed_size 0
  .amdhsa_kernarg_size 112
  .amdhsa_user_sgpr_count 2
  .amdhsa_user_sgpr_kernarg_segment_ptr 1
  .amdhsa_system_sgpr_workgroup_id_x 1
.end_amdhsa_kernel
.p2align 6
.amdhsa_kernel k5_kernel
  .amdhsa_next_free_vgpr 512
  .amdhsa_next_free_sgpr 64
  .amdhsa_accum_offset 256
  .amdhsa_group_segment_fixed_size 0
  .amdhsa_kernarg_size 112
  .amdhsa_user_sgpr_count 2
  .amdhsa_user_sgpr_kernarg_segment_ptr 1
  .amdhsa_system_sgpr_workgroup_id_x 1
.end_amdhsa_kernel
.p2align 6
.amdhsa_kernel k6_kernel
  .amdhsa_next_free_vgpr 256
  .amdhsa_next_free_sgpr 64
  .amdhsa_accum_offset 256
  .amdhsa_group_segment_fixed_size 0
  .amdhsa_kernarg_size 112
  .amdhsa_user_sgpr_count 2
  .amdhsa_user_sgpr_kernarg_segment_ptr 1
  .amdhsa_system_sgpr_workgroup_id_x 1
.end_amdhsa_kernel
```
